```python
import torch

def _softmax(x, axis=-1):
    return torch.softmax(x, dim=axis)
def _gelu(x):
    return torch.nn.functional.gelu(x, approximate="tanh")
def _silu(x):
    return torch.nn.functional.silu(x)
def _sigmoid(x):
    return torch.sigmoid(x)
def _layernorm(x, axis=-1, eps=1e-5):
    m = x.mean(dim=axis, keepdim=True)
    v = x.var(dim=axis, keepdim=True, unbiased=False)
    return (x - m) / torch.sqrt(v + eps)
def _scatter_add(tgt, idx, src, axis=0):
    return tgt.clone().index_add_(axis, idx, src)
def _segment_sum(src, seg, n):
    out = torch.zeros((n,) + src.shape[1:], dtype=src.dtype)
    return out.index_add_(0, seg, src)
def _pad(x, pw):
    flat = tuple(v for pair in reversed(pw) for v in pair)
    return torch.nn.functional.pad(x, flat)

kernel_name = 'concat_heads__mha_block_cached__gqa_block_cached__near_ridge'

def setup_inputs():

    _w = (lambda a: (lambda t: t.to(torch.bfloat16) if t.is_floating_point() else t)(torch.as_tensor(a)))
    def _A_setup():
        B, Sq, D = 8, 224, 640
        H, Sk, Dh = 32, 512, 128
        return {
            "x": _w((lambda *s: torch.randn(*s, dtype=torch.bfloat16) * 0.8)(B, Sq, D)),
            "k_cache": _w((lambda *s: torch.randn(*s, dtype=torch.bfloat16) * 0.8)(B, H, Sk, Dh)),
            "v_cache": _w((lambda *s: torch.randn(*s, dtype=torch.bfloat16) * 0.05)(B, H, Sk, Dh)),
            "wq": _w((lambda *s: torch.randn(*s, dtype=torch.bfloat16) * 0.8)(D, H * Dh) * (D ** -0.5)),
            "wo": _w((lambda *s: torch.randn(*s, dtype=torch.bfloat16) * 0.05)(H * Dh, D) * ((H * Dh) ** -0.5)),
        }
    _A_in = _A_setup()

    def _B_setup():
        B, Sq, D = 8, 224, 640
        Hq, Hkv, Sk, Dh = 32, 32, 512, 128
        assert Hq % Hkv == 0, (Hq, Hkv)
        return {
            "x": _w((lambda *s: torch.randn(*s, dtype=torch.bfloat16) * 0.8)(B, Sq, D)),
            "k_cache": _w((lambda *s: torch.randn(*s, dtype=torch.bfloat16) * 0.8)(B, Hkv, Sk, Dh)),
            "v_cache": _w((lambda *s: torch.randn(*s, dtype=torch.bfloat16) * 0.05)(B, Hkv, Sk, Dh)),
            "wq": _w((lambda *s: torch.randn(*s, dtype=torch.bfloat16) * 0.8)(D, Hq * Dh) * (D ** -0.5)),
            "wo": _w((lambda *s: torch.randn(*s, dtype=torch.bfloat16) * 0.05)(Hq * Dh, D) * ((Hq * Dh) ** -0.5)),
        }
    _B_in = _B_setup()

    return {
        "A_x": _A_in["x"],
        "A_k_cache": _A_in["k_cache"],
        "A_v_cache": _A_in["v_cache"],
        "A_wq": _A_in["wq"],
        "A_wo": _A_in["wo"],
        "B_x": _B_in["x"],
        "B_k_cache": _B_in["k_cache"],
        "B_v_cache": _B_in["v_cache"],
        "B_wq": _B_in["wq"],
        "B_wo": _B_in["wo"],
    }

def reference(A_x, A_k_cache, A_v_cache, A_wq, A_wo, B_x, B_k_cache, B_v_cache, B_wq, B_wo):
    def _A_ref(x, k_cache, v_cache, wq, wo):
        B, Sq, D = x.shape
        H, Dh = 32, 128
        q = (lambda x, *d: x.permute(*d))((x @ wq).reshape(B, Sq, H, Dh), 0, 2, 1, 3)
        scores = torch.einsum("bhqd,bhkd->bhqk", q, k_cache) * (Dh ** -0.5)
        p = _softmax(scores, axis=-1)
        o = torch.einsum("bhqk,bhkd->bhqd", p, v_cache)
        return (lambda x, *d: x.permute(*d))(o, 0, 2, 1, 3).reshape(B, Sq, H * Dh) @ wo

    def _B_ref(x, k_cache, v_cache, wq, wo):
        B, Sq, D = x.shape
        Hq, Dh = 32, 128
        Hkv = k_cache.shape[1]
        rep = Hq // Hkv
        q = (lambda x, *d: x.permute(*d))((x @ wq).reshape(B, Sq, Hq, Dh), 0, 2, 1, 3)
        k = (lambda x, n, axis: torch.repeat_interleave(x, n, dim=axis))(k_cache, rep, axis=1)
        v = (lambda x, n, axis: torch.repeat_interleave(x, n, dim=axis))(v_cache, rep, axis=1)
        scores = torch.einsum("bhqd,bhkd->bhqk", q, k) * (Dh ** -0.5)
        p = _softmax(scores, axis=-1)
        o = torch.einsum("bhqk,bhkd->bhqd", p, v)
        return (lambda x, *d: x.permute(*d))(o, 0, 2, 1, 3).reshape(B, Sq, Hq * Dh) @ wo

    a = _A_ref(A_x, A_k_cache, A_v_cache, A_wq, A_wo)
    b = _B_ref(B_x, B_k_cache, B_v_cache, B_wq, B_wo)
    return torch.concatenate([a, b], axis=-1)
```

```asm
; @launch grid=(256,1,1) block=(256,1,1) lds=163840
.amdgcn_target "amdgcn-amd-amdhsa--gfx950"
.text
.globl concat_heads__mha_block_cached__gqa_block_cached__near_ridge_kernel
.p2align 8
.type concat_heads__mha_block_cached__gqa_block_cached__near_ridge_kernel,@function
concat_heads__mha_block_cached__gqa_block_cached__near_ridge_kernel:
    s_cmp_ge_u32 s2, 256
    s_cbranch_scc1 Lk1_end
    s_and_b32 s50, s2, 7
    s_lshr_b32 s49, s50, 2
    s_mul_i32 s45, s49, 40
    s_add_u32 s56, s0, s45
    s_addc_u32 s57, s1, 0
    s_load_dwordx4 s[4:7], s[56:57], 0
    s_load_dwordx4 s[8:11], s[56:57], 16
    s_load_dwordx2 s[24:25], s[56:57], 32
    s_load_dwordx2 s[20:21], s[0:1], 96
    s_load_dwordx4 s[52:55], s[0:1], 80
    s_getpc_b64 s[96:97]
Lk1_pc:
    s_mov_b32 s98, Lcode_end-Lk1_pc-4
    s_bfe_u32 s92, s2, 0x40003
    s_lshl_b32 s92, s92, 13
    v_lshrrev_b32 v8, 2, v0
    v_and_b32 v8, 0x30, v8
    v_and_b32 v9, 15, v0
    v_or_b32 v8, v8, v9
    v_lshlrev_b32 v8, 7, v8
    v_add_u32 v8, s92, v8
    v_min_u32 v8, s98, v8
    global_load_dword v255, v8, s[96:97]
    s_lshr_b32 s51, s2, 3
    s_lshr_b32 s93, s51, 2
    s_and_b32 s94, s50, 3
    s_lshl_b32 s94, s94, 2
    s_and_b32 s95, s51, 3
    s_add_u32 s94, s94, s95
    v_lshrrev_b32 v1, 6, v0
    v_and_b32 v247, 63, v0
    v_readfirstlane_b32 s28, v1
    v_and_b32 v2, 15, v247
    v_lshrrev_b32 v3, 4, v247
    v_bfe_u32 v4, v247, 2, 2
    v_and_b32 v5, 3, v247
    s_lshr_b32 s64, s28, 1
    s_and_b32 s65, s28, 1
    s_lshl_b32 s45, s65, 2
    v_add_u32 v6, s45, v3
    v_and_b32 v7, 7, v247
    v_xor_b32 v6, v6, v7
    v_lshrrev_b32 v7, 3, v247
    v_mul_u32_u24 v7, 0x500, v7
    v_lshl_add_u32 v243, v6, 4, v7
    v_lshlrev_b32 v6, 2, v3
    v_xor_b32 v6, v2, v6
    v_lshlrev_b32 v6, 4, v6
    v_lshl_add_u32 v244, v3, 13, v6
    s_mul_i32 s46, s64, 40960
    s_lshl_b32 s45, s65, 12
    s_add_u32 s29, s46, s45
    s_lshl_b32 s45, s65, 10
    s_add_u32 s30, s46, s45
    s_mul_i32 s31, s64, 143360
    s_mul_i32 s45, s65, 10240
    s_add_u32 s31, s31, s45
    s_lshl_b32 s32, s65, 17
    s_lshl_b32 s45, s64, 8
    s_add_u32 s32, s32, s45
    v_lshlrev_b32 v248, 4, v247
    v_lshlrev_b32 v6, 1, v3
    v_xor_b32 v6, v2, v6
    v_lshlrev_b32 v6, 4, v6
    v_lshl_add_u32 v249, v3, 8, v6
    v_xor_b32 v250, 0x80, v249
    v_mov_b32 v251, v249
    v_mov_b32 v252, v250
    s_mul_i32 s45, s65, 40960
    s_mul_i32 s46, s64, 40960
    s_add_u32 s47, s46, 81920
    v_lshrrev_b32 v6, 1, v2
    v_xor_b32 v6, v3, v6
    v_lshlrev_b32 v6, 4, v6
    v_lshl_add_u32 v6, v2, 7, v6
    v_add_u32 v238, s45, v6
    v_xor_b32 v245, 64, v238
    v_lshl_add_u32 v6, v3, 3, v4
    v_lshl_add_u32 v7, v4, 2, v5
    v_lshlrev_b32 v7, 4, v7
    v_lshl_add_u32 v6, v6, 8, v7
    v_add_u32 v239, s47, v6
    v_xor_b32 v240, 64, v239
    v_xor_b32 v241, 128, v239
    v_xor_b32 v242, 192, v239
    s_lshl_b32 s45, s93, 5
    s_lshl_b32 s46, s94, 1
    s_add_u32 s45, s45, s46
    s_lshl_b32 s45, s45, 17
    s_lshl_b32 s46, s94, 9
    s_mul_i32 s47, s93, 286720
    s_waitcnt lgkmcnt(0)
    s_add_u32 s12, s6, s45
    s_addc_u32 s13, s7, 0
    s_add_u32 s16, s8, s45
    s_addc_u32 s17, s9, 0
    s_add_u32 s8, s10, s46
    s_addc_u32 s9, s11, 0
    s_sub_u32 s10, 0x500000, s46
    s_mov_b32 s11, 0x20000
    s_add_u32 s4, s4, s47
    s_addc_u32 s5, s5, 0
    s_mov_b32 s6, 286720
    s_mov_b32 s7, 0x20000
    s_add_u32 s40, s32, 0
    s_add_u32 m0, s29, 81920
    s_nop 0
    buffer_load_dwordx4 v244, s[8:11], s40 offen nt lds
    s_add_u32 s40, s32, 32768
    s_add_u32 m0, s29, 82944
    s_nop 0
    buffer_load_dwordx4 v244, s[8:11], s40 offen nt lds
    s_add_u32 s40, s32, 65536
    s_add_u32 m0, s29, 83968
    s_nop 0
    buffer_load_dwordx4 v244, s[8:11], s40 offen nt lds
    s_add_u32 s40, s32, 98304
    s_add_u32 m0, s29, 84992
    s_nop 0
    buffer_load_dwordx4 v244, s[8:11], s40 offen nt lds
    s_add_u32 s40, s31, 0
    s_add_u32 m0, s30, 0
    s_nop 0
    buffer_load_dwordx4 v243, s[4:7], s40 offen  lds
    s_add_u32 s40, s31, 20480
    s_add_u32 m0, s30, 2048
    s_nop 0
    buffer_load_dwordx4 v243, s[4:7], s40 offen  lds
    s_add_u32 s40, s31, 40960
    s_add_u32 m0, s30, 4096
    s_nop 0
    buffer_load_dwordx4 v243, s[4:7], s40 offen  lds
    s_add_u32 s40, s31, 61440
    s_add_u32 m0, s30, 6144
    s_nop 0
    buffer_load_dwordx4 v243, s[4:7], s40 offen  lds
    s_add_u32 s40, s31, 81920
    s_add_u32 m0, s30, 8192
    s_nop 0
    buffer_load_dwordx4 v243, s[4:7], s40 offen  lds
    s_add_u32 s40, s31, 102400
    s_add_u32 m0, s30, 10240
    s_nop 0
    buffer_load_dwordx4 v243, s[4:7], s40 offen  lds
    s_add_u32 s40, s31, 122880
    s_add_u32 m0, s30, 12288
    s_nop 0
    buffer_load_dwordx4 v243, s[4:7], s40 offen  lds
    s_add_u32 s40, s32, 262144
    s_add_u32 m0, s29, 90112
    s_nop 0
    buffer_load_dwordx4 v244, s[8:11], s40 offen nt lds
    s_add_u32 s40, s32, 294912
    s_add_u32 m0, s29, 91136
    s_nop 0
    buffer_load_dwordx4 v244, s[8:11], s40 offen nt lds
    s_add_u32 s40, s32, 327680
    s_add_u32 m0, s29, 92160
    s_nop 0
    buffer_load_dwordx4 v244, s[8:11], s40 offen nt lds
    s_add_u32 s40, s32, 360448
    s_add_u32 m0, s29, 93184
    s_nop 0
    buffer_load_dwordx4 v244, s[8:11], s40 offen nt lds
    s_mov_b32 s14, 0x40000
    s_mov_b32 s15, 0x20000
    s_mov_b32 s18, 0x40000
    s_mov_b32 s19, 0x20000
    s_mov_b32 s22, 0x10000000
    s_mov_b32 s23, 0x20000
    s_lshl_b32 s43, s64, 17
    s_lshl_b32 s45, s65, 12
    s_add_u32 s43, s43, s45
    s_mul_i32 s46, s64, 40960
    s_add_u32 s47, s46, 81920
    v_and_b32 v6, 7, v2
    v_lshlrev_b32 v6, 1, v6
    v_xor_b32 v6, v3, v6
    v_lshlrev_b32 v6, 4, v6
    v_lshl_add_u32 v6, v2, 8, v6
    v_add_u32 v224, s46, v6
    v_xor_b32 v225, 64, v224
    v_xor_b32 v226, 128, v224
    v_xor_b32 v227, 192, v224
    v_lshl_add_u32 v6, v3, 2, v4
    v_and_b32 v7, 7, v6
    v_lshlrev_b32 v7, 1, v7
    v_lshrrev_b32 v8, 1, v5
    v_xor_b32 v7, v7, v8
    v_lshlrev_b32 v7, 4, v7
    v_and_b32 v8, 1, v5
    v_lshl_add_u32 v7, v8, 3, v7
    v_lshl_add_u32 v6, v6, 8, v7
    v_add_u32 v228, s47, v6
    v_xor_b32 v229, 32, v228
    v_xor_b32 v230, 64, v228
    v_xor_b32 v231, 96, v228
    v_xor_b32 v232, 128, v228
    v_xor_b32 v233, 160, v228
    v_xor_b32 v234, 192, v228
    v_xor_b32 v235, 224, v228
    v_min_u32 v246, 9, v247
    v_lshlrev_b32 v246, 7, v246
    s_sub_u32 s45, 0, s96
    s_and_b32 s45, s45, 0xfff
    s_min_u32 s47, s28, 1
    s_lshl_b32 s47, s47, 28
    s_or_b32 s45, s45, s47
    v_lshlrev_b32 v6, 12, v4
    v_lshl_add_u32 v6, v5, 7, v6
    v_add_u32 v253, s45, v6
    s_mov_b32 s56, s54
    s_mov_b32 s57, s55
    s_mov_b32 s58, 256
    s_mov_b32 s59, 0x20000
    s_mov_b32 s88, s24
    s_mov_b32 s89, s25
    s_mov_b32 s90, 0x500000
    s_mov_b32 s91, 0x20000
    s_mov_b32 s54, 0
    s_mov_b32 s55, 0x20000
    s_mov_b32 s26, 0
    s_mov_b32 s27, 0x20000
    s_add_u32 s37, s29, 81920
    v_add_u32 v236, s29, v248
    v_add_u32 v237, s37, v248
    s_mov_b64 exec, 0
    s_cmp_eq_u32 s28, 0
    s_cbranch_scc1 Lpg2
    s_cmp_eq_u32 s28, 1
    s_cbranch_scc1 Lpg5
    s_cmp_eq_u32 s28, 2
    s_cbranch_scc1 Lpg8
    s_branch Lpg11
.p2align 12
Ltch0:
    s_mov_b64 exec, -1
    s_add_u32 s40, s31, 128
    s_add_u32 m0, s30, 14336
    s_nop 0
    buffer_load_dwordx4 v243, s[4:7], s40 offen  lds
    s_add_u32 s40, s31, 20608
    s_add_u32 m0, s30, 16384
    s_nop 0
    buffer_load_dwordx4 v243, s[4:7], s40 offen  lds
    s_add_u32 s40, s31, 41088
    s_add_u32 m0, s30, 18432
    s_nop 0
    buffer_load_dwordx4 v243, s[4:7], s40 offen  lds
    s_add_u32 s40, s31, 61568
    s_add_u32 m0, s30, 20480
    s_nop 0
    buffer_load_dwordx4 v243, s[4:7], s40 offen  lds
    s_add_u32 s40, s31, 82048
    s_add_u32 m0, s30, 22528
    s_nop 0
    buffer_load_dwordx4 v243, s[4:7], s40 offen  lds
    s_add_u32 s40, s31, 102528
    s_add_u32 m0, s30, 24576
    s_nop 0
    buffer_load_dwordx4 v243, s[4:7], s40 offen  lds
    s_add_u32 s40, s31, 123008
    s_add_u32 m0, s30, 26624
    s_nop 0
    buffer_load_dwordx4 v243, s[4:7], s40 offen  lds
    s_add_u32 s40, s32, 524288
    s_add_u32 m0, s29, 98304
    s_nop 0
    buffer_load_dwordx4 v244, s[8:11], s40 offen nt lds
    s_add_u32 s40, s32, 557056
    s_add_u32 m0, s29, 99328
    s_nop 0
    buffer_load_dwordx4 v244, s[8:11], s40 offen nt lds
    s_add_u32 s40, s32, 589824
    s_add_u32 m0, s29, 100352
    s_nop 0
    buffer_load_dwordx4 v244, s[8:11], s40 offen nt lds
    s_add_u32 s40, s32, 622592
    s_add_u32 m0, s29, 101376
    s_nop 0
    buffer_load_dwordx4 v244, s[8:11], s40 offen nt lds
    s_waitcnt vmcnt(15)
    s_barrier
    ds_read_b64_tr_b16 a[224:225], v239 offset:0
    ds_read_b64_tr_b16 a[226:227], v239 offset:1024
    ds_read_b64_tr_b16 a[228:229], v239 offset:8
    ds_read_b64_tr_b16 a[230:231], v239 offset:1032
    ds_read_b64_tr_b16 a[232:233], v240 offset:0
    ds_read_b64_tr_b16 a[234:235], v240 offset:1024
    ds_read_b64_tr_b16 a[236:237], v240 offset:8
    ds_read_b64_tr_b16 a[238:239], v240 offset:1032
    ds_read_b64_tr_b16 a[240:241], v241 offset:0
    ds_read_b64_tr_b16 a[242:243], v241 offset:1024
    ds_read_b64_tr_b16 a[244:245], v241 offset:8
    ds_read_b64_tr_b16 a[246:247], v241 offset:1032
    ds_read_b128 a[196:199], v238 offset:0
    ds_read_b128 a[200:203], v238 offset:2048
    ds_read_b128 a[204:207], v238 offset:4096
    ds_read_b128 a[208:211], v238 offset:6144
    ds_read_b128 a[212:215], v238 offset:8192
    ds_read_b128 a[216:219], v238 offset:10240
    ds_read_b128 a[220:223], v238 offset:12288
    s_waitcnt lgkmcnt(6)
    v_mfma_f32_16x16x32_bf16 v[0:3], a[224:227], a[196:199], 0
    ds_read_b64_tr_b16 a[248:249], v242 offset:0
    ds_read_b64_tr_b16 a[250:251], v242 offset:1024
    v_mfma_f32_16x16x32_bf16 v[4:7], a[228:231], a[196:199], 0
    ds_read_b64_tr_b16 a[252:253], v242 offset:8
    ds_read_b64_tr_b16 a[254:255], v242 offset:1032
    s_waitcnt lgkmcnt(9)
    v_mfma_f32_16x16x32_bf16 v[8:11], a[224:227], a[200:203], 0
    s_add_u32 s40, s32, 786432
    s_add_u32 m0, s29, 106496
    v_mfma_f32_16x16x32_bf16 v[12:15], a[228:231], a[200:203], 0
    buffer_load_dwordx4 v244, s[8:11], s40 offen nt lds
    s_waitcnt lgkmcnt(8)
    v_mfma_f32_16x16x32_bf16 v[16:19], a[224:227], a[204:207], 0
    s_and_b32 s45, s50, 3
    s_lshl_b32 s45, s45, 5
    v_mfma_f32_16x16x32_bf16 v[20:23], a[228:231], a[204:207], 0
    s_waitcnt lgkmcnt(7)
    v_mfma_f32_16x16x32_bf16 v[24:27], a[224:227], a[208:211], 0
    s_add_u32 s40, s32, 819200
    s_add_u32 m0, s29, 107520
    v_mfma_f32_16x16x32_bf16 v[28:31], a[228:231], a[208:211], 0
    buffer_load_dwordx4 v244, s[8:11], s40 offen nt lds
    s_waitcnt lgkmcnt(6)
    v_mfma_f32_16x16x32_bf16 v[32:35], a[224:227], a[212:215], 0
    s_add_u32 s45, s45, s51
    s_lshl_b32 s45, s45, 2
    v_mfma_f32_16x16x32_bf16 v[36:39], a[228:231], a[212:215], 0
    s_waitcnt lgkmcnt(5)
    v_mfma_f32_16x16x32_bf16 v[40:43], a[224:227], a[216:219], 0
    s_add_u32 s40, s32, 851968
    s_add_u32 m0, s29, 108544
    v_mfma_f32_16x16x32_bf16 v[44:47], a[228:231], a[216:219], 0
    buffer_load_dwordx4 v244, s[8:11], s40 offen nt lds
    s_waitcnt lgkmcnt(4)
    v_mfma_f32_16x16x32_bf16 v[48:51], a[224:227], a[220:223], 0
    s_waitcnt vmcnt(14) lgkmcnt(0)
    s_barrier
    v_mfma_f32_16x16x32_bf16 v[52:55], a[228:231], a[220:223], 0
    ds_read_b64_tr_b16 a[224:225], v239 offset:8192
    ds_read_b64_tr_b16 a[226:227], v239 offset:9216
    v_mfma_f32_16x16x32_bf16 v[56:59], a[232:235], a[196:199], 0
    ds_read_b64_tr_b16 a[228:229], v239 offset:8200
    ds_read_b64_tr_b16 a[230:231], v239 offset:9224
    v_mfma_f32_16x16x32_bf16 v[64:67], a[232:235], a[200:203], 0
    s_add_u32 s40, s32, 884736
    s_add_u32 m0, s29, 109568
    v_mfma_f32_16x16x32_bf16 v[72:75], a[232:235], a[204:207], 0
    buffer_load_dwordx4 v244, s[8:11], s40 offen nt lds
    v_mfma_f32_16x16x32_bf16 v[80:83], a[232:235], a[208:211], 0
    s_add_u32 s45, s45, s28
    s_lshr_b32 s47, s45, 4
    v_mfma_f32_16x16x32_bf16 v[88:91], a[232:235], a[212:215], 0
    s_mul_i32 s47, s47, 163840
    s_and_b32 s33, s45, 15
    v_mfma_f32_16x16x32_bf16 v[96:99], a[232:235], a[216:219], 0
    s_add_u32 s40, s32, 1048576
    s_add_u32 m0, s29, 81920
    v_mfma_f32_16x16x32_bf16 v[104:107], a[232:235], a[220:223], 0
    buffer_load_dwordx4 v244, s[8:11], s40 offen nt lds
    v_mfma_f32_16x16x32_bf16 v[60:63], a[236:239], a[196:199], 0
    ds_read_b64_tr_b16 a[232:233], v240 offset:8192
    ds_read_b64_tr_b16 a[234:235], v240 offset:9216
    v_mfma_f32_16x16x32_bf16 v[68:71], a[236:239], a[200:203], 0
    s_mul_i32 s33, s33, 5120
    s_add_u32 s33, s33, s47
    v_mfma_f32_16x16x32_bf16 v[76:79], a[236:239], a[204:207], 0
    s_add_u32 s40, s32, 1081344
    s_add_u32 m0, s29, 82944
    v_mfma_f32_16x16x32_bf16 v[84:87], a[236:239], a[208:211], 0
    buffer_load_dwordx4 v244, s[8:11], s40 offen nt lds
    v_mfma_f32_16x16x32_bf16 v[92:95], a[236:239], a[212:215], 0
    s_lshl_b32 s45, s49, 3
    s_add_u32 s45, s45, s93
    v_mfma_f32_16x16x32_bf16 v[100:103], a[236:239], a[216:219], 0
    s_lshl_b32 s45, s45, 5
    s_lshl_b32 s46, s94, 1
    v_mfma_f32_16x16x32_bf16 v[108:111], a[236:239], a[220:223], 0
    s_add_u32 s45, s45, s46
    s_add_u32 s45, s45, s64
    v_mfma_f32_16x16x32_bf16 v[112:115], a[240:243], a[196:199], 0
    ds_read_b64_tr_b16 a[236:237], v240 offset:8200
    ds_read_b64_tr_b16 a[238:239], v240 offset:9224
    v_mfma_f32_16x16x32_bf16 v[120:123], a[240:243], a[200:203], 0
    s_add_u32 s40, s32, 1114112
    s_add_u32 m0, s29, 83968
    v_mfma_f32_16x16x32_bf16 v[128:131], a[240:243], a[204:207], 0
    buffer_load_dwordx4 v244, s[8:11], s40 offen nt lds
    v_mfma_f32_16x16x32_bf16 v[136:139], a[240:243], a[208:211], 0
    s_lshl_b32 s45, s45, 3
    s_add_u32 s45, s45, s65
    v_mfma_f32_16x16x32_bf16 v[144:147], a[240:243], a[212:215], 0
    s_add_u32 s40, s32, 1146880
    s_add_u32 m0, s29, 84992
    v_mfma_f32_16x16x32_bf16 v[152:155], a[240:243], a[216:219], 0
    buffer_load_dwordx4 v244, s[8:11], s40 offen nt lds
    v_mfma_f32_16x16x32_bf16 v[160:163], a[240:243], a[220:223], 0
    s_mul_i32 s48, s45, 7168
    s_and_b32 s39, s51, 15
    v_mfma_f32_16x16x32_bf16 v[116:119], a[244:247], a[196:199], 0
    ds_read_b64_tr_b16 a[240:241], v241 offset:8192
    ds_read_b64_tr_b16 a[242:243], v241 offset:9216
    v_mfma_f32_16x16x32_bf16 v[124:127], a[244:247], a[200:203], 0
    s_add_u32 s40, s31, 256
    s_add_u32 m0, s30, 28672
    v_mfma_f32_16x16x32_bf16 v[132:135], a[244:247], a[204:207], 0
    buffer_load_dwordx4 v243, s[4:7], s40 offen  lds
    v_mfma_f32_16x16x32_bf16 v[140:143], a[244:247], a[208:211], 0
    s_mul_i32 s42, s39, 52
    s_lshr_b32 s42, s42, 8
    v_mfma_f32_16x16x32_bf16 v[148:151], a[244:247], a[212:215], 0
    s_add_u32 s40, s31, 20736
    s_add_u32 m0, s30, 30720
    v_mfma_f32_16x16x32_bf16 v[156:159], a[244:247], a[216:219], 0
    buffer_load_dwordx4 v243, s[4:7], s40 offen  lds
    v_mfma_f32_16x16x32_bf16 v[164:167], a[244:247], a[220:223], 0
    s_add_u32 s40, s31, 41216
    s_add_u32 m0, s30, 32768
    v_mfma_f32_16x16x32_bf16 v[168:171], a[248:251], a[196:199], 0
    ds_read_b64_tr_b16 a[244:245], v241 offset:8200
    ds_read_b64_tr_b16 a[246:247], v241 offset:9224
    v_mfma_f32_16x16x32_bf16 v[172:175], a[252:255], a[196:199], 0
    ds_read_b128 a[196:199], v245 offset:0
    v_mfma_f32_16x16x32_bf16 v[176:179], a[248:251], a[200:203], 0
    buffer_load_dwordx4 v243, s[4:7], s40 offen  lds
    v_mfma_f32_16x16x32_bf16 v[180:183], a[252:255], a[200:203], 0
    ds_read_b128 a[200:203], v245 offset:2048
    v_mfma_f32_16x16x32_bf16 v[184:187], a[248:251], a[204:207], 0
    s_add_u32 s40, s31, 61696
    s_add_u32 m0, s30, 34816
    v_mfma_f32_16x16x32_bf16 v[188:191], a[252:255], a[204:207], 0
    ds_read_b128 a[204:207], v245 offset:4096
    v_mfma_f32_16x16x32_bf16 v[192:195], a[248:251], a[208:211], 0
    buffer_load_dwordx4 v243, s[4:7], s40 offen  lds
    v_mfma_f32_16x16x32_bf16 v[196:199], a[252:255], a[208:211], 0
    ds_read_b128 a[208:211], v245 offset:6144
    v_mfma_f32_16x16x32_bf16 v[200:203], a[248:251], a[212:215], 0
    s_mul_i32 s45, s42, 5
    s_sub_u32 s44, s39, s45
    v_mfma_f32_16x16x32_bf16 v[204:207], a[252:255], a[212:215], 0
    ds_read_b128 a[212:215], v245 offset:8192
    v_mfma_f32_16x16x32_bf16 v[208:211], a[248:251], a[216:219], 0
    s_cmp_eq_u32 s39, 15
    s_cselect_b32 s34, 1, 0
    v_mfma_f32_16x16x32_bf16 v[212:215], a[252:255], a[216:219], 0
    ds_read_b128 a[216:219], v245 offset:10240
    v_mfma_f32_16x16x32_bf16 v[216:219], a[248:251], a[220:223], 0
    s_and_b32 s45, s42, 1
    s_mul_i32 s95, s65, 5
    v_mfma_f32_16x16x32_bf16 v[220:223], a[252:255], a[220:223], 0
    ds_read_b128 a[220:223], v245 offset:12288
    s_waitcnt lgkmcnt(6)
    v_mfma_f32_16x16x32_bf16 v[0:3], a[224:227], a[196:199], v[0:3]
    ds_read_b64_tr_b16 a[248:249], v242 offset:8192
    ds_read_b64_tr_b16 a[250:251], v242 offset:9216
    v_mfma_f32_16x16x32_bf16 v[4:7], a[228:231], a[196:199], v[4:7]
    ds_read_b64_tr_b16 a[252:253], v242 offset:8200
    ds_read_b64_tr_b16 a[254:255], v242 offset:9224
    s_waitcnt lgkmcnt(9)
    v_mfma_f32_16x16x32_bf16 v[8:11], a[224:227], a[200:203], v[8:11]
    s_cmp_eq_u32 s42, 2
    s_cselect_b32 s45, s65, s45
    s_cselect_b32 s95, 10, s95
    v_mfma_f32_16x16x32_bf16 v[12:15], a[228:231], a[200:203], v[12:15]
    s_waitcnt lgkmcnt(8)
    v_mfma_f32_16x16x32_bf16 v[16:19], a[224:227], a[204:207], v[16:19]
    s_and_b32 s38, s50, 3
    s_lshl_b32 s38, s38, 1
    v_mfma_f32_16x16x32_bf16 v[20:23], a[228:231], a[204:207], v[20:23]
    s_waitcnt lgkmcnt(7)
    v_mfma_f32_16x16x32_bf16 v[24:27], a[224:227], a[208:211], v[24:27]
    s_add_u32 s38, s38, s45
    s_lshr_b32 s47, s51, 4
    v_mfma_f32_16x16x32_bf16 v[28:31], a[228:231], a[208:211], v[28:31]
    s_waitcnt lgkmcnt(6)
    v_mfma_f32_16x16x32_bf16 v[32:35], a[224:227], a[212:215], v[32:35]
    s_lshl_b32 s47, s47, 1
    s_add_u32 s47, s47, s64
    v_mfma_f32_16x16x32_bf16 v[36:39], a[228:231], a[212:215], v[36:39]
    s_waitcnt lgkmcnt(5)
    v_mfma_f32_16x16x32_bf16 v[40:43], a[224:227], a[216:219], v[40:43]
    s_mul_i32 s35, s64, 81920
    s_lshl_b32 s45, s65, 12
    v_mfma_f32_16x16x32_bf16 v[44:47], a[228:231], a[216:219], v[44:47]
    s_waitcnt lgkmcnt(4)
    v_mfma_f32_16x16x32_bf16 v[48:51], a[224:227], a[220:223], v[48:51]
    s_waitcnt vmcnt(12) lgkmcnt(0)
    s_barrier
    v_mfma_f32_16x16x32_bf16 v[52:55], a[228:231], a[220:223], v[52:55]
    ds_read_b64_tr_b16 a[224:225], v239 offset:16384
    ds_read_b64_tr_b16 a[226:227], v239 offset:17408
    v_mfma_f32_16x16x32_bf16 v[56:59], a[232:235], a[196:199], v[56:59]
    ds_read_b64_tr_b16 a[228:229], v239 offset:16392
    ds_read_b64_tr_b16 a[230:231], v239 offset:17416
    v_mfma_f32_16x16x32_bf16 v[64:67], a[232:235], a[200:203], v[64:67]
    s_add_u32 s40, s32, 1310720
    s_add_u32 m0, s29, 90112
    v_mfma_f32_16x16x32_bf16 v[72:75], a[232:235], a[204:207], v[72:75]
    buffer_load_dwordx4 v244, s[8:11], s40 offen nt lds
    v_mfma_f32_16x16x32_bf16 v[80:83], a[232:235], a[208:211], v[80:83]
    s_add_u32 s35, s35, s45
    s_mul_i32 s60, s47, 1310720
    v_mfma_f32_16x16x32_bf16 v[88:91], a[232:235], a[212:215], v[88:91]
    s_mul_i32 s45, s65, 20480
    s_add_u32 s60, s60, s45
    v_mfma_f32_16x16x32_bf16 v[96:99], a[232:235], a[216:219], v[96:99]
    s_add_u32 s40, s32, 1343488
    s_add_u32 m0, s29, 91136
    v_mfma_f32_16x16x32_bf16 v[104:107], a[232:235], a[220:223], v[104:107]
    buffer_load_dwordx4 v244, s[8:11], s40 offen nt lds
    v_mfma_f32_16x16x32_bf16 v[60:63], a[236:239], a[196:199], v[60:63]
    ds_read_b64_tr_b16 a[232:233], v240 offset:16384
    ds_read_b64_tr_b16 a[234:235], v240 offset:17408
    v_mfma_f32_16x16x32_bf16 v[68:71], a[236:239], a[200:203], v[68:71]
    s_lshl_b32 s45, s49, 3
    s_add_u32 s46, s45, s93
    v_mfma_f32_16x16x32_bf16 v[76:79], a[236:239], a[204:207], v[76:79]
    s_add_u32 s40, s32, 1376256
    s_add_u32 m0, s29, 92160
    v_mfma_f32_16x16x32_bf16 v[84:87], a[236:239], a[208:211], v[84:87]
    buffer_load_dwordx4 v244, s[8:11], s40 offen nt lds
    v_mfma_f32_16x16x32_bf16 v[92:95], a[236:239], a[212:215], v[92:95]
    s_lshl_b32 s62, s46, 4
    s_add_u32 s45, s45, s38
    v_mfma_f32_16x16x32_bf16 v[100:103], a[236:239], a[216:219], v[100:103]
    s_lshl_b32 s63, s45, 4
    s_lshl_b32 s45, s45, 2
    v_mfma_f32_16x16x32_bf16 v[108:111], a[236:239], a[220:223], v[108:111]
    s_add_u32 s45, s45, s47
    s_mul_i32 s45, s45, 458752
    v_mfma_f32_16x16x32_bf16 v[112:115], a[240:243], a[196:199], v[112:115]
    ds_read_b64_tr_b16 a[236:237], v240 offset:16392
    ds_read_b64_tr_b16 a[238:239], v240 offset:17416
    v_mfma_f32_16x16x32_bf16 v[120:123], a[240:243], a[200:203], v[120:123]
    s_add_u32 s40, s32, 1409024
    s_add_u32 m0, s29, 93184
    v_mfma_f32_16x16x32_bf16 v[128:131], a[240:243], a[204:207], v[128:131]
    buffer_load_dwordx4 v244, s[8:11], s40 offen nt lds
    v_mfma_f32_16x16x32_bf16 v[136:139], a[240:243], a[208:211], v[136:139]
    s_lshl_b32 s46, s95, 10
    s_add_u32 s61, s45, s46
    v_mfma_f32_16x16x32_bf16 v[144:147], a[240:243], a[212:215], v[144:147]
    s_add_u32 s40, s31, 82176
    s_add_u32 m0, s30, 0
    v_mfma_f32_16x16x32_bf16 v[152:155], a[240:243], a[216:219], v[152:155]
    buffer_load_dwordx4 v243, s[4:7], s40 offen  lds
    v_mfma_f32_16x16x32_bf16 v[160:163], a[240:243], a[220:223], v[160:163]
    s_lshl_b32 s92, s47, 2
    s_mul_i32 s45, s38, 224
    v_mfma_f32_16x16x32_bf16 v[116:119], a[244:247], a[196:199], v[116:119]
    ds_read_b64_tr_b16 a[240:241], v241 offset:16384
    ds_read_b64_tr_b16 a[242:243], v241 offset:17408
    v_mfma_f32_16x16x32_bf16 v[124:127], a[244:247], a[200:203], v[124:127]
    s_add_u32 s40, s31, 102656
    s_add_u32 m0, s30, 2048
    v_mfma_f32_16x16x32_bf16 v[132:135], a[244:247], a[204:207], v[132:135]
    buffer_load_dwordx4 v243, s[4:7], s40 offen  lds
    v_mfma_f32_16x16x32_bf16 v[140:143], a[244:247], a[208:211], v[140:143]
    s_lshl_b32 s46, s95, 4
    s_add_u32 s45, s45, s46
    v_mfma_f32_16x16x32_bf16 v[148:151], a[244:247], a[212:215], v[148:151]
    s_add_u32 s40, s31, 123136
    s_add_u32 m0, s30, 4096
    v_mfma_f32_16x16x32_bf16 v[156:159], a[244:247], a[216:219], v[156:159]
    buffer_load_dwordx4 v243, s[4:7], s40 offen  lds
    v_mfma_f32_16x16x32_bf16 v[164:167], a[244:247], a[220:223], v[164:167]
    s_add_u32 s41, s43, 0
    s_add_u32 m0, s29, 114688
    v_mfma_f32_16x16x32_bf16 v[168:171], a[248:251], a[196:199], v[168:171]
    ds_read_b64_tr_b16 a[244:245], v241 offset:16392
    ds_read_b64_tr_b16 a[246:247], v241 offset:17416
    v_mfma_f32_16x16x32_bf16 v[172:175], a[252:255], a[196:199], v[172:175]
    ds_read_b128 a[196:199], v238 offset:14336
    v_mfma_f32_16x16x32_bf16 v[176:179], a[248:251], a[200:203], v[176:179]
    buffer_load_dwordx4 v249, s[16:19], s41 offen offset:0 nt lds
    v_mfma_f32_16x16x32_bf16 v[180:183], a[252:255], a[200:203], v[180:183]
    ds_read_b128 a[200:203], v238 offset:16384
    v_mfma_f32_16x16x32_bf16 v[184:187], a[248:251], a[204:207], v[184:187]
    s_mul_i32 s45, s45, 2560
    s_mul_i32 s46, s49, 1280
    v_mfma_f32_16x16x32_bf16 v[188:191], a[252:255], a[204:207], v[188:191]
    ds_read_b128 a[204:207], v238 offset:18432
    v_mfma_f32_16x16x32_bf16 v[192:195], a[248:251], a[208:211], v[192:195]
    s_add_u32 s45, s45, s46
    s_lshl_b32 s46, s44, 8
    v_mfma_f32_16x16x32_bf16 v[196:199], a[252:255], a[208:211], v[196:199]
    ds_read_b128 a[208:211], v238 offset:20480
    v_mfma_f32_16x16x32_bf16 v[200:203], a[248:251], a[212:215], v[200:203]
    s_waitcnt vmcnt(24)
    s_barrier
    v_mfma_f32_16x16x32_bf16 v[204:207], a[252:255], a[212:215], v[204:207]
    ds_read_b128 a[212:215], v238 offset:22528
    v_mfma_f32_16x16x32_bf16 v[208:211], a[248:251], a[216:219], v[208:211]
    s_add_u32 s45, s45, s46
    v_mfma_f32_16x16x32_bf16 v[212:215], a[252:255], a[216:219], v[212:215]
    ds_read_b128 a[216:219], v238 offset:24576
    v_mfma_f32_16x16x32_bf16 v[216:219], a[248:251], a[220:223], v[216:219]
    s_add_u32 s52, s52, s45
    s_addc_u32 s53, s53, 0
    v_mfma_f32_16x16x32_bf16 v[220:223], a[252:255], a[220:223], v[220:223]
    ds_read_b128 a[220:223], v238 offset:26624
    s_waitcnt lgkmcnt(6)
    v_mfma_f32_16x16x32_bf16 v[0:3], a[224:227], a[196:199], v[0:3]
    ds_read_b64_tr_b16 a[248:249], v242 offset:16384
    ds_read_b64_tr_b16 a[250:251], v242 offset:17408
    v_mfma_f32_16x16x32_bf16 v[4:7], a[228:231], a[196:199], v[4:7]
    ds_read_b64_tr_b16 a[252:253], v242 offset:16392
    ds_read_b64_tr_b16 a[254:255], v242 offset:17416
    s_waitcnt lgkmcnt(9)
    v_mfma_f32_16x16x32_bf16 v[8:11], a[224:227], a[200:203], v[8:11]
    s_cmp_eq_u32 s42, 2
    s_mov_b32 s54, 202496
    s_cselect_b32 s54, 161536, s54
    v_mfma_f32_16x16x32_bf16 v[12:15], a[228:231], a[200:203], v[12:15]
    s_waitcnt lgkmcnt(8)
    v_mfma_f32_16x16x32_bf16 v[16:19], a[224:227], a[204:207], v[16:19]
    s_add_u32 s24, s24, s46
    s_addc_u32 s25, s25, 0
    v_mfma_f32_16x16x32_bf16 v[20:23], a[228:231], a[204:207], v[20:23]
    s_waitcnt lgkmcnt(7)
    v_mfma_f32_16x16x32_bf16 v[24:27], a[224:227], a[208:211], v[24:27]
    s_sub_u32 s26, 0x500000, s46
    s_mul_i32 s45, s62, 336
    v_mfma_f32_16x16x32_bf16 v[28:31], a[228:231], a[208:211], v[28:31]
    s_waitcnt lgkmcnt(6)
    v_mfma_f32_16x16x32_bf16 v[32:35], a[224:227], a[212:215], v[32:35]
    s_lshl_b32 s46, s94, 2
    s_add_u32 s45, s45, s46
    v_mfma_f32_16x16x32_bf16 v[36:39], a[228:231], a[212:215], v[36:39]
    s_waitcnt lgkmcnt(5)
    v_mfma_f32_16x16x32_bf16 v[40:43], a[224:227], a[216:219], v[40:43]
    s_add_u32 s36, s45, 0x2000000
    s_mul_i32 s45, s63, 336
    v_mfma_f32_16x16x32_bf16 v[44:47], a[228:231], a[216:219], v[44:47]
    s_waitcnt lgkmcnt(4)
    v_mfma_f32_16x16x32_bf16 v[48:51], a[224:227], a[220:223], v[48:51]
    s_waitcnt vmcnt(16) lgkmcnt(0)
    s_barrier
    v_mfma_f32_16x16x32_bf16 v[52:55], a[228:231], a[220:223], v[52:55]
    ds_read_b64_tr_b16 a[224:225], v239 offset:24576
    ds_read_b64_tr_b16 a[226:227], v239 offset:25600
    v_mfma_f32_16x16x32_bf16 v[56:59], a[232:235], a[196:199], v[56:59]
    ds_read_b64_tr_b16 a[228:229], v239 offset:24584
    ds_read_b64_tr_b16 a[230:231], v239 offset:25608
    v_mfma_f32_16x16x32_bf16 v[64:67], a[232:235], a[200:203], v[64:67]
    s_add_u32 s40, s32, 1572864
    s_add_u32 m0, s29, 98304
    v_mfma_f32_16x16x32_bf16 v[72:75], a[232:235], a[204:207], v[72:75]
    buffer_load_dwordx4 v244, s[8:11], s40 offen nt lds
    v_mfma_f32_16x16x32_bf16 v[80:83], a[232:235], a[208:211], v[80:83]
    s_add_u32 s38, s45, 0x2000000
    s_mov_b32 s44, s92
    v_mfma_f32_16x16x32_bf16 v[88:91], a[232:235], a[212:215], v[88:91]
    s_lshl_b32 s45, s92, 2
    s_add_u32 s38, s38, s45
    v_mfma_f32_16x16x32_bf16 v[96:99], a[232:235], a[216:219], v[96:99]
    s_add_u32 s40, s32, 1605632
    s_add_u32 m0, s29, 99328
    v_mfma_f32_16x16x32_bf16 v[104:107], a[232:235], a[220:223], v[104:107]
    buffer_load_dwordx4 v244, s[8:11], s40 offen nt lds
    v_mfma_f32_16x16x32_bf16 v[60:63], a[236:239], a[196:199], v[60:63]
    ds_read_b64_tr_b16 a[232:233], v240 offset:24576
    ds_read_b64_tr_b16 a[234:235], v240 offset:25600
    v_mfma_f32_16x16x32_bf16 v[68:71], a[236:239], a[200:203], v[68:71]
    s_lshl_b32 s63, s49, 7
    s_lshl_b32 s45, s2, 2
    v_mfma_f32_16x16x32_bf16 v[76:79], a[236:239], a[204:207], v[76:79]
    s_add_u32 s40, s32, 1638400
    s_add_u32 m0, s29, 100352
    v_mfma_f32_16x16x32_bf16 v[84:87], a[236:239], a[208:211], v[84:87]
    buffer_load_dwordx4 v244, s[8:11], s40 offen nt lds
    v_mfma_f32_16x16x32_bf16 v[92:95], a[236:239], a[212:215], v[92:95]
    s_add_u32 s45, s45, s28
    s_xor_b32 s46, s45, 512
    v_mfma_f32_16x16x32_bf16 v[100:103], a[236:239], a[216:219], v[100:103]
    s_mul_i32 s49, s45, 10240
    s_mul_i32 s50, s46, 10240
    v_mfma_f32_16x16x32_bf16 v[108:111], a[236:239], a[220:223], v[108:111]
    s_add_u32 s49, s49, 0x4000000
    s_add_u32 s50, s50, 0x4000000
    v_mfma_f32_16x16x32_bf16 v[112:115], a[240:243], a[196:199], v[112:115]
    ds_read_b64_tr_b16 a[236:237], v240 offset:24584
    ds_read_b64_tr_b16 a[238:239], v240 offset:25608
    v_mfma_f32_16x16x32_bf16 v[120:123], a[240:243], a[200:203], v[120:123]
    s_add_u32 s40, s32, 1671168
    s_add_u32 m0, s29, 101376
    v_mfma_f32_16x16x32_bf16 v[128:131], a[240:243], a[204:207], v[128:131]
    buffer_load_dwordx4 v244, s[8:11], s40 offen nt lds
    v_mfma_f32_16x16x32_bf16 v[136:139], a[240:243], a[208:211], v[136:139]
    s_lshl_b32 s45, s2, 8
    s_lshl_b32 s46, s28, 2
    v_mfma_f32_16x16x32_bf16 v[144:147], a[240:243], a[212:215], v[144:147]
    s_add_u32 s40, s31, 384
    s_add_u32 m0, s30, 6144
    v_mfma_f32_16x16x32_bf16 v[152:155], a[240:243], a[216:219], v[152:155]
    buffer_load_dwordx4 v243, s[4:7], s40 offen  lds
    v_mfma_f32_16x16x32_bf16 v[160:163], a[240:243], a[220:223], v[160:163]
    s_add_u32 s45, s45, s46
    s_add_u32 s51, s45, 0x2080000
    v_mfma_f32_16x16x32_bf16 v[116:119], a[244:247], a[196:199], v[116:119]
    ds_read_b64_tr_b16 a[240:241], v241 offset:24576
    ds_read_b64_tr_b16 a[242:243], v241 offset:25600
    v_mfma_f32_16x16x32_bf16 v[124:127], a[244:247], a[200:203], v[124:127]
    s_add_u32 s40, s31, 20864
    s_add_u32 m0, s30, 8192
    v_mfma_f32_16x16x32_bf16 v[132:135], a[244:247], a[204:207], v[132:135]
    buffer_load_dwordx4 v243, s[4:7], s40 offen  lds
    v_mfma_f32_16x16x32_bf16 v[140:143], a[244:247], a[208:211], v[140:143]
    s_xor_b32 s93, s51, 0x8000
    v_mfma_f32_16x16x32_bf16 v[148:151], a[244:247], a[212:215], v[148:151]
    s_add_u32 s40, s31, 41344
    s_add_u32 m0, s30, 10240
    v_mfma_f32_16x16x32_bf16 v[156:159], a[244:247], a[216:219], v[156:159]
    buffer_load_dwordx4 v243, s[4:7], s40 offen  lds
    v_mfma_f32_16x16x32_bf16 v[164:167], a[244:247], a[220:223], v[164:167]
    s_add_u32 s40, s31, 61824
    s_add_u32 m0, s30, 12288
    v_mfma_f32_16x16x32_bf16 v[168:171], a[248:251], a[196:199], v[168:171]
    ds_read_b64_tr_b16 a[244:245], v241 offset:24584
    ds_read_b64_tr_b16 a[246:247], v241 offset:25608
    v_mfma_f32_16x16x32_bf16 v[172:175], a[252:255], a[196:199], v[172:175]
    ds_read_b128 a[196:199], v245 offset:14336
    v_mfma_f32_16x16x32_bf16 v[176:179], a[248:251], a[200:203], v[176:179]
    buffer_load_dwordx4 v243, s[4:7], s40 offen  lds
    v_mfma_f32_16x16x32_bf16 v[180:183], a[252:255], a[200:203], v[180:183]
    ds_read_b128 a[200:203], v245 offset:16384
    v_mfma_f32_16x16x32_bf16 v[184:187], a[248:251], a[204:207], v[184:187]
    s_add_u32 s41, s43, 24576
    v_mfma_f32_16x16x32_bf16 v[188:191], a[252:255], a[204:207], v[188:191]
    ds_read_b128 a[204:207], v245 offset:18432
    v_mfma_f32_16x16x32_bf16 v[192:195], a[248:251], a[208:211], v[192:195]
    buffer_load_dwordx4 a[0:3], v249, s[12:15], s41 offen offset:0 nt
    v_mfma_f32_16x16x32_bf16 v[196:199], a[252:255], a[208:211], v[196:199]
    ds_read_b128 a[208:211], v245 offset:20480
    v_mfma_f32_16x16x32_bf16 v[200:203], a[248:251], a[212:215], v[200:203]
    v_mfma_f32_16x16x32_bf16 v[204:207], a[252:255], a[212:215], v[204:207]
    ds_read_b128 a[212:215], v245 offset:22528
    v_mfma_f32_16x16x32_bf16 v[208:211], a[248:251], a[216:219], v[208:211]
    v_mfma_f32_16x16x32_bf16 v[212:215], a[252:255], a[216:219], v[212:215]
    ds_read_b128 a[216:219], v245 offset:24576
    v_mfma_f32_16x16x32_bf16 v[216:219], a[248:251], a[220:223], v[216:219]
    v_mfma_f32_16x16x32_bf16 v[220:223], a[252:255], a[220:223], v[220:223]
    ds_read_b128 a[220:223], v245 offset:26624
    s_waitcnt lgkmcnt(6)
    v_mfma_f32_16x16x32_bf16 v[0:3], a[224:227], a[196:199], v[0:3]
    ds_read_b64_tr_b16 a[248:249], v242 offset:24576
    ds_read_b64_tr_b16 a[250:251], v242 offset:25600
    v_mfma_f32_16x16x32_bf16 v[4:7], a[228:231], a[196:199], v[4:7]
    ds_read_b64_tr_b16 a[252:253], v242 offset:24584
    ds_read_b64_tr_b16 a[254:255], v242 offset:25608
    s_waitcnt lgkmcnt(9)
    v_mfma_f32_16x16x32_bf16 v[8:11], a[224:227], a[200:203], v[8:11]
    v_mfma_f32_16x16x32_bf16 v[12:15], a[228:231], a[200:203], v[12:15]
    s_waitcnt lgkmcnt(8)
    v_mfma_f32_16x16x32_bf16 v[16:19], a[224:227], a[204:207], v[16:19]
    v_mfma_f32_16x16x32_bf16 v[20:23], a[228:231], a[204:207], v[20:23]
    s_waitcnt lgkmcnt(7)
    v_mfma_f32_16x16x32_bf16 v[24:27], a[224:227], a[208:211], v[24:27]
    v_mfma_f32_16x16x32_bf16 v[28:31], a[228:231], a[208:211], v[28:31]
    s_waitcnt lgkmcnt(6)
    v_mfma_f32_16x16x32_bf16 v[32:35], a[224:227], a[212:215], v[32:35]
    v_mfma_f32_16x16x32_bf16 v[36:39], a[228:231], a[212:215], v[36:39]
    s_waitcnt lgkmcnt(5)
    v_mfma_f32_16x16x32_bf16 v[40:43], a[224:227], a[216:219], v[40:43]
    v_mfma_f32_16x16x32_bf16 v[44:47], a[228:231], a[216:219], v[44:47]
    s_waitcnt lgkmcnt(4)
    v_mfma_f32_16x16x32_bf16 v[48:51], a[224:227], a[220:223], v[48:51]
    s_waitcnt vmcnt(17) lgkmcnt(0)
    s_barrier
    v_mfma_f32_16x16x32_bf16 v[52:55], a[228:231], a[220:223], v[52:55]
    ds_read_b64_tr_b16 a[224:225], v239 offset:0
    ds_read_b64_tr_b16 a[226:227], v239 offset:1024
    v_mfma_f32_16x16x32_bf16 v[56:59], a[232:235], a[196:199], v[56:59]
    ds_read_b64_tr_b16 a[228:229], v239 offset:8
    ds_read_b64_tr_b16 a[230:231], v239 offset:1032
    v_mfma_f32_16x16x32_bf16 v[64:67], a[232:235], a[200:203], v[64:67]
    s_add_u32 s40, s32, 1835008
    s_add_u32 m0, s29, 106496
    v_mfma_f32_16x16x32_bf16 v[72:75], a[232:235], a[204:207], v[72:75]
    buffer_load_dwordx4 v244, s[8:11], s40 offen nt lds
    v_mfma_f32_16x16x32_bf16 v[80:83], a[232:235], a[208:211], v[80:83]
    v_mfma_f32_16x16x32_bf16 v[88:91], a[232:235], a[212:215], v[88:91]
    v_mfma_f32_16x16x32_bf16 v[96:99], a[232:235], a[216:219], v[96:99]
    s_add_u32 s40, s32, 1867776
    s_add_u32 m0, s29, 107520
    v_mfma_f32_16x16x32_bf16 v[104:107], a[232:235], a[220:223], v[104:107]
    buffer_load_dwordx4 v244, s[8:11], s40 offen nt lds
    v_mfma_f32_16x16x32_bf16 v[60:63], a[236:239], a[196:199], v[60:63]
    ds_read_b64_tr_b16 a[232:233], v240 offset:0
    ds_read_b64_tr_b16 a[234:235], v240 offset:1024
    v_mfma_f32_16x16x32_bf16 v[68:71], a[236:239], a[200:203], v[68:71]
    v_mfma_f32_16x16x32_bf16 v[76:79], a[236:239], a[204:207], v[76:79]
    s_add_u32 s40, s32, 1900544
    s_add_u32 m0, s29, 108544
    v_mfma_f32_16x16x32_bf16 v[84:87], a[236:239], a[208:211], v[84:87]
    buffer_load_dwordx4 v244, s[8:11], s40 offen nt lds
    v_mfma_f32_16x16x32_bf16 v[92:95], a[236:239], a[212:215], v[92:95]
    v_mfma_f32_16x16x32_bf16 v[100:103], a[236:239], a[216:219], v[100:103]
    v_mfma_f32_16x16x32_bf16 v[108:111], a[236:239], a[220:223], v[108:111]
    v_mfma_f32_16x16x32_bf16 v[112:115], a[240:243], a[196:199], v[112:115]
    ds_read_b64_tr_b16 a[236:237], v240 offset:8
    ds_read_b64_tr_b16 a[238:239], v240 offset:1032
    v_mfma_f32_16x16x32_bf16 v[120:123], a[240:243], a[200:203], v[120:123]
    s_add_u32 s40, s32, 1933312
    s_add_u32 m0, s29, 109568
    v_mfma_f32_16x16x32_bf16 v[128:131], a[240:243], a[204:207], v[128:131]
    buffer_load_dwordx4 v244, s[8:11], s40 offen nt lds
    v_mfma_f32_16x16x32_bf16 v[136:139], a[240:243], a[208:211], v[136:139]
    v_mfma_f32_16x16x32_bf16 v[144:147], a[240:243], a[212:215], v[144:147]
    s_add_u32 s40, s31, 82304
    s_add_u32 m0, s30, 14336
    v_mfma_f32_16x16x32_bf16 v[152:155], a[240:243], a[216:219], v[152:155]
    buffer_load_dwordx4 v243, s[4:7], s40 offen  lds
    v_mfma_f32_16x16x32_bf16 v[160:163], a[240:243], a[220:223], v[160:163]
    v_mfma_f32_16x16x32_bf16 v[116:119], a[244:247], a[196:199], v[116:119]
    ds_read_b64_tr_b16 a[240:241], v241 offset:0
    ds_read_b64_tr_b16 a[242:243], v241 offset:1024
    v_mfma_f32_16x16x32_bf16 v[124:127], a[244:247], a[200:203], v[124:127]
    s_add_u32 s40, s31, 102784
    s_add_u32 m0, s30, 16384
    v_mfma_f32_16x16x32_bf16 v[132:135], a[244:247], a[204:207], v[132:135]
    buffer_load_dwordx4 v243, s[4:7], s40 offen  lds
    v_mfma_f32_16x16x32_bf16 v[140:143], a[244:247], a[208:211], v[140:143]
    v_mfma_f32_16x16x32_bf16 v[148:151], a[244:247], a[212:215], v[148:151]
    s_add_u32 s40, s31, 123264
    s_add_u32 m0, s30, 18432
    v_mfma_f32_16x16x32_bf16 v[156:159], a[244:247], a[216:219], v[156:159]
    buffer_load_dwordx4 v243, s[4:7], s40 offen  lds
    v_mfma_f32_16x16x32_bf16 v[164:167], a[244:247], a[220:223], v[164:167]
    s_nop 0
    v_mfma_f32_16x16x32_bf16 v[168:171], a[248:251], a[196:199], v[168:171]
    ds_read_b64_tr_b16 a[244:245], v241 offset:8
    ds_read_b64_tr_b16 a[246:247], v241 offset:1032
    v_mfma_f32_16x16x32_bf16 v[172:175], a[252:255], a[196:199], v[172:175]
    ds_read_b128 a[196:199], v238 offset:28672
    v_mfma_f32_16x16x32_bf16 v[176:179], a[248:251], a[200:203], v[176:179]
    buffer_load_dword a195, v246, s[88:91], s33 offen offset:0
    v_mfma_f32_16x16x32_bf16 v[180:183], a[252:255], a[200:203], v[180:183]
    ds_read_b128 a[200:203], v238 offset:30720
    v_mfma_f32_16x16x32_bf16 v[184:187], a[248:251], a[204:207], v[184:187]
    s_add_u32 s41, s43, 24576
    v_mfma_f32_16x16x32_bf16 v[188:191], a[252:255], a[204:207], v[188:191]
    ds_read_b128 a[204:207], v238 offset:32768
    v_mfma_f32_16x16x32_bf16 v[192:195], a[248:251], a[208:211], v[192:195]
    buffer_load_dwordx4 a[4:7], v250, s[12:15], s41 offen offset:1024 nt
    v_mfma_f32_16x16x32_bf16 v[196:199], a[252:255], a[208:211], v[196:199]
    ds_read_b128 a[208:211], v238 offset:34816
    v_mfma_f32_16x16x32_bf16 v[200:203], a[248:251], a[212:215], v[200:203]
    s_waitcnt vmcnt(19)
    s_barrier
    v_mfma_f32_16x16x32_bf16 v[204:207], a[252:255], a[212:215], v[204:207]
    ds_read_b128 a[212:215], v238 offset:0
    v_mfma_f32_16x16x32_bf16 v[208:211], a[248:251], a[216:219], v[208:211]
    v_mfma_f32_16x16x32_bf16 v[212:215], a[252:255], a[216:219], v[212:215]
    ds_read_b128 a[216:219], v238 offset:2048
    v_mfma_f32_16x16x32_bf16 v[216:219], a[248:251], a[220:223], v[216:219]
    v_mfma_f32_16x16x32_bf16 v[220:223], a[252:255], a[220:223], v[220:223]
    ds_read_b128 a[220:223], v238 offset:4096
    s_waitcnt lgkmcnt(6)
    v_mfma_f32_16x16x32_bf16 v[0:3], a[224:227], a[196:199], v[0:3]
    ds_read_b64_tr_b16 a[248:249], v242 offset:0
    ds_read_b64_tr_b16 a[250:251], v242 offset:1024
    v_mfma_f32_16x16x32_bf16 v[4:7], a[228:231], a[196:199], v[4:7]
    ds_read_b64_tr_b16 a[252:253], v242 offset:8
    ds_read_b64_tr_b16 a[254:255], v242 offset:1032
    s_waitcnt lgkmcnt(9)
    v_mfma_f32_16x16x32_bf16 v[8:11], a[224:227], a[200:203], v[8:11]
    v_mfma_f32_16x16x32_bf16 v[12:15], a[228:231], a[200:203], v[12:15]
    s_waitcnt lgkmcnt(8)
    v_mfma_f32_16x16x32_bf16 v[16:19], a[224:227], a[204:207], v[16:19]
    v_mfma_f32_16x16x32_bf16 v[20:23], a[228:231], a[204:207], v[20:23]
    s_waitcnt lgkmcnt(7)
    v_mfma_f32_16x16x32_bf16 v[24:27], a[224:227], a[208:211], v[24:27]
    v_mfma_f32_16x16x32_bf16 v[28:31], a[228:231], a[208:211], v[28:31]
    s_waitcnt lgkmcnt(6)
    v_mfma_f32_16x16x32_bf16 v[32:35], a[224:227], a[212:215], v[32:35]
    v_mfma_f32_16x16x32_bf16 v[36:39], a[228:231], a[212:215], v[36:39]
    s_waitcnt lgkmcnt(5)
    v_mfma_f32_16x16x32_bf16 v[40:43], a[224:227], a[216:219], v[40:43]
    v_mfma_f32_16x16x32_bf16 v[44:47], a[228:231], a[216:219], v[44:47]
    s_waitcnt lgkmcnt(4)
    v_mfma_f32_16x16x32_bf16 v[48:51], a[224:227], a[220:223], v[48:51]
    s_waitcnt vmcnt(22) lgkmcnt(0)
    s_barrier
    v_mfma_f32_16x16x32_bf16 v[52:55], a[228:231], a[220:223], v[52:55]
    ds_read_b64_tr_b16 a[224:225], v239 offset:8192
    ds_read_b64_tr_b16 a[226:227], v239 offset:9216
    v_mfma_f32_16x16x32_bf16 v[56:59], a[232:235], a[196:199], v[56:59]
    ds_read_b64_tr_b16 a[228:229], v239 offset:8200
    ds_read_b64_tr_b16 a[230:231], v239 offset:9224
    v_mfma_f32_16x16x32_bf16 v[64:67], a[232:235], a[200:203], v[64:67]
    s_add_u32 s40, s32, 2097152
    s_add_u32 m0, s29, 81920
    v_mfma_f32_16x16x32_bf16 v[72:75], a[232:235], a[204:207], v[72:75]
    buffer_load_dwordx4 v244, s[8:11], s40 offen nt lds
    v_mfma_f32_16x16x32_bf16 v[80:83], a[232:235], a[208:211], v[80:83]
    v_mfma_f32_16x16x32_bf16 v[88:91], a[232:235], a[212:215], v[88:91]
    v_mfma_f32_16x16x32_bf16 v[96:99], a[232:235], a[216:219], v[96:99]
    s_add_u32 s40, s32, 2129920
    s_add_u32 m0, s29, 82944
    v_mfma_f32_16x16x32_bf16 v[104:107], a[232:235], a[220:223], v[104:107]
    buffer_load_dwordx4 v244, s[8:11], s40 offen nt lds
    v_mfma_f32_16x16x32_bf16 v[60:63], a[236:239], a[196:199], v[60:63]
    ds_read_b64_tr_b16 a[232:233], v240 offset:8192
    ds_read_b64_tr_b16 a[234:235], v240 offset:9216
    v_mfma_f32_16x16x32_bf16 v[68:71], a[236:239], a[200:203], v[68:71]
    v_mfma_f32_16x16x32_bf16 v[76:79], a[236:239], a[204:207], v[76:79]
    s_add_u32 s40, s32, 2162688
    s_add_u32 m0, s29, 83968
    v_mfma_f32_16x16x32_bf16 v[84:87], a[236:239], a[208:211], v[84:87]
    buffer_load_dwordx4 v244, s[8:11], s40 offen nt lds
    v_mfma_f32_16x16x32_bf16 v[92:95], a[236:239], a[212:215], v[92:95]
    v_mfma_f32_16x16x32_bf16 v[100:103], a[236:239], a[216:219], v[100:103]
    v_mfma_f32_16x16x32_bf16 v[108:111], a[236:239], a[220:223], v[108:111]
    v_mfma_f32_16x16x32_bf16 v[112:115], a[240:243], a[196:199], v[112:115]
    ds_read_b64_tr_b16 a[236:237], v240 offset:8200
    ds_read_b64_tr_b16 a[238:239], v240 offset:9224
    v_mfma_f32_16x16x32_bf16 v[120:123], a[240:243], a[200:203], v[120:123]
    s_add_u32 s40, s32, 2195456
    s_add_u32 m0, s29, 84992
    v_mfma_f32_16x16x32_bf16 v[128:131], a[240:243], a[204:207], v[128:131]
    buffer_load_dwordx4 v244, s[8:11], s40 offen nt lds
    v_mfma_f32_16x16x32_bf16 v[136:139], a[240:243], a[208:211], v[136:139]
    v_mfma_f32_16x16x32_bf16 v[144:147], a[240:243], a[212:215], v[144:147]
    s_add_u32 s40, s31, 512
    s_add_u32 m0, s30, 20480
    v_mfma_f32_16x16x32_bf16 v[152:155], a[240:243], a[216:219], v[152:155]
    buffer_load_dwordx4 v243, s[4:7], s40 offen  lds
    v_mfma_f32_16x16x32_bf16 v[160:163], a[240:243], a[220:223], v[160:163]
    v_mfma_f32_16x16x32_bf16 v[116:119], a[244:247], a[196:199], v[116:119]
    ds_read_b64_tr_b16 a[240:241], v241 offset:8192
    ds_read_b64_tr_b16 a[242:243], v241 offset:9216
    v_mfma_f32_16x16x32_bf16 v[124:127], a[244:247], a[200:203], v[124:127]
    s_add_u32 s40, s31, 20992
    s_add_u32 m0, s30, 22528
    v_mfma_f32_16x16x32_bf16 v[132:135], a[244:247], a[204:207], v[132:135]
    buffer_load_dwordx4 v243, s[4:7], s40 offen  lds
    v_mfma_f32_16x16x32_bf16 v[140:143], a[244:247], a[208:211], v[140:143]
    v_mfma_f32_16x16x32_bf16 v[148:151], a[244:247], a[212:215], v[148:151]
    s_add_u32 s40, s31, 41472
    s_add_u32 m0, s30, 24576
    v_mfma_f32_16x16x32_bf16 v[156:159], a[244:247], a[216:219], v[156:159]
    buffer_load_dwordx4 v243, s[4:7], s40 offen  lds
    v_mfma_f32_16x16x32_bf16 v[164:167], a[244:247], a[220:223], v[164:167]
    s_add_u32 s40, s31, 61952
    s_add_u32 m0, s30, 26624
    v_mfma_f32_16x16x32_bf16 v[168:171], a[248:251], a[196:199], v[168:171]
    ds_read_b64_tr_b16 a[244:245], v241 offset:8200
    ds_read_b64_tr_b16 a[246:247], v241 offset:9224
    v_mfma_f32_16x16x32_bf16 v[172:175], a[252:255], a[196:199], v[172:175]
    ds_read_b128 a[196:199], v245 offset:28672
    v_mfma_f32_16x16x32_bf16 v[176:179], a[248:251], a[200:203], v[176:179]
    buffer_load_dwordx4 v243, s[4:7], s40 offen  lds
    v_mfma_f32_16x16x32_bf16 v[180:183], a[252:255], a[200:203], v[180:183]
    ds_read_b128 a[200:203], v245 offset:30720
    v_mfma_f32_16x16x32_bf16 v[184:187], a[248:251], a[204:207], v[184:187]
    s_add_u32 s41, s43, 0
    s_add_u32 m0, s29, 114688
    v_mfma_f32_16x16x32_bf16 v[188:191], a[252:255], a[204:207], v[188:191]
    ds_read_b128 a[204:207], v245 offset:32768
    v_mfma_f32_16x16x32_bf16 v[192:195], a[248:251], a[208:211], v[192:195]
    buffer_load_dwordx4 v250, s[16:19], s41 offen offset:1024 nt lds
    v_mfma_f32_16x16x32_bf16 v[196:199], a[252:255], a[208:211], v[196:199]
    ds_read_b128 a[208:211], v245 offset:34816
    v_mfma_f32_16x16x32_bf16 v[200:203], a[248:251], a[212:215], v[200:203]
    s_add_u32 s41, s43, 24576
    v_mfma_f32_16x16x32_bf16 v[204:207], a[252:255], a[212:215], v[204:207]
    ds_read_b128 a[212:215], v245 offset:0
    v_mfma_f32_16x16x32_bf16 v[208:211], a[248:251], a[216:219], v[208:211]
    buffer_load_dwordx4 a[8:11], v251, s[12:15], s41 offen offset:2048 nt
    v_mfma_f32_16x16x32_bf16 v[212:215], a[252:255], a[216:219], v[212:215]
    ds_read_b128 a[216:219], v245 offset:2048
    v_mfma_f32_16x16x32_bf16 v[216:219], a[248:251], a[220:223], v[216:219]
    v_mfma_f32_16x16x32_bf16 v[220:223], a[252:255], a[220:223], v[220:223]
    ds_read_b128 a[220:223], v245 offset:4096
    s_waitcnt lgkmcnt(6)
    v_mfma_f32_16x16x32_bf16 v[0:3], a[224:227], a[196:199], v[0:3]
    ds_read_b64_tr_b16 a[248:249], v242 offset:8192
    ds_read_b64_tr_b16 a[250:251], v242 offset:9216
    v_mfma_f32_16x16x32_bf16 v[4:7], a[228:231], a[196:199], v[4:7]
    ds_read_b64_tr_b16 a[252:253], v242 offset:8200
    ds_read_b64_tr_b16 a[254:255], v242 offset:9224
    s_waitcnt lgkmcnt(9)
    v_mfma_f32_16x16x32_bf16 v[8:11], a[224:227], a[200:203], v[8:11]
    v_mfma_f32_16x16x32_bf16 v[12:15], a[228:231], a[200:203], v[12:15]
    s_waitcnt lgkmcnt(8)
    v_mfma_f32_16x16x32_bf16 v[16:19], a[224:227], a[204:207], v[16:19]
    v_mfma_f32_16x16x32_bf16 v[20:23], a[228:231], a[204:207], v[20:23]
    s_waitcnt lgkmcnt(7)
    v_mfma_f32_16x16x32_bf16 v[24:27], a[224:227], a[208:211], v[24:27]
    v_mfma_f32_16x16x32_bf16 v[28:31], a[228:231], a[208:211], v[28:31]
    s_waitcnt lgkmcnt(6)
    v_mfma_f32_16x16x32_bf16 v[32:35], a[224:227], a[212:215], v[32:35]
    v_mfma_f32_16x16x32_bf16 v[36:39], a[228:231], a[212:215], v[36:39]
    s_waitcnt lgkmcnt(5)
    v_mfma_f32_16x16x32_bf16 v[40:43], a[224:227], a[216:219], v[40:43]
    v_mfma_f32_16x16x32_bf16 v[44:47], a[228:231], a[216:219], v[44:47]
    s_waitcnt lgkmcnt(4)
    v_mfma_f32_16x16x32_bf16 v[48:51], a[224:227], a[220:223], v[48:51]
    s_waitcnt vmcnt(20) lgkmcnt(0)
    s_barrier
    v_mfma_f32_16x16x32_bf16 v[52:55], a[228:231], a[220:223], v[52:55]
    ds_read_b64_tr_b16 a[224:225], v239 offset:16384
    ds_read_b64_tr_b16 a[226:227], v239 offset:17408
    v_mfma_f32_16x16x32_bf16 v[56:59], a[232:235], a[196:199], v[56:59]
    ds_read_b64_tr_b16 a[228:229], v239 offset:16392
    ds_read_b64_tr_b16 a[230:231], v239 offset:17416
    v_mfma_f32_16x16x32_bf16 v[64:67], a[232:235], a[200:203], v[64:67]
    s_add_u32 s40, s32, 2359296
    s_add_u32 m0, s29, 90112
    v_mfma_f32_16x16x32_bf16 v[72:75], a[232:235], a[204:207], v[72:75]
    buffer_load_dwordx4 v244, s[8:11], s40 offen nt lds
    v_mfma_f32_16x16x32_bf16 v[80:83], a[232:235], a[208:211], v[80:83]
    v_mfma_f32_16x16x32_bf16 v[88:91], a[232:235], a[212:215], v[88:91]
    v_mfma_f32_16x16x32_bf16 v[96:99], a[232:235], a[216:219], v[96:99]
    s_add_u32 s40, s32, 2392064
    s_add_u32 m0, s29, 91136
    v_mfma_f32_16x16x32_bf16 v[104:107], a[232:235], a[220:223], v[104:107]
    buffer_load_dwordx4 v244, s[8:11], s40 offen nt lds
    v_mfma_f32_16x16x32_bf16 v[60:63], a[236:239], a[196:199], v[60:63]
    ds_read_b64_tr_b16 a[232:233], v240 offset:16384
    ds_read_b64_tr_b16 a[234:235], v240 offset:17408
    v_mfma_f32_16x16x32_bf16 v[68:71], a[236:239], a[200:203], v[68:71]
    v_mfma_f32_16x16x32_bf16 v[76:79], a[236:239], a[204:207], v[76:79]
    s_add_u32 s40, s32, 2424832
    s_add_u32 m0, s29, 92160
    v_mfma_f32_16x16x32_bf16 v[84:87], a[236:239], a[208:211], v[84:87]
    buffer_load_dwordx4 v244, s[8:11], s40 offen nt lds
    v_mfma_f32_16x16x32_bf16 v[92:95], a[236:239], a[212:215], v[92:95]
    v_mfma_f32_16x16x32_bf16 v[100:103], a[236:239], a[216:219], v[100:103]
    v_mfma_f32_16x16x32_bf16 v[108:111], a[236:239], a[220:223], v[108:111]
    v_mfma_f32_16x16x32_bf16 v[112:115], a[240:243], a[196:199], v[112:115]
    ds_read_b64_tr_b16 a[236:237], v240 offset:16392
    ds_read_b64_tr_b16 a[238:239], v240 offset:17416
    v_mfma_f32_16x16x32_bf16 v[120:123], a[240:243], a[200:203], v[120:123]
    s_add_u32 s40, s32, 2457600
    s_add_u32 m0, s29, 93184
    v_mfma_f32_16x16x32_bf16 v[128:131], a[240:243], a[204:207], v[128:131]
    buffer_load_dwordx4 v244, s[8:11], s40 offen nt lds
    v_mfma_f32_16x16x32_bf16 v[136:139], a[240:243], a[208:211], v[136:139]
    v_mfma_f32_16x16x32_bf16 v[144:147], a[240:243], a[212:215], v[144:147]
    s_add_u32 s40, s31, 82432
    s_add_u32 m0, s30, 28672
    v_mfma_f32_16x16x32_bf16 v[152:155], a[240:243], a[216:219], v[152:155]
    buffer_load_dwordx4 v243, s[4:7], s40 offen  lds
    v_mfma_f32_16x16x32_bf16 v[160:163], a[240:243], a[220:223], v[160:163]
    v_mfma_f32_16x16x32_bf16 v[116:119], a[244:247], a[196:199], v[116:119]
    ds_read_b64_tr_b16 a[240:241], v241 offset:16384
    ds_read_b64_tr_b16 a[242:243], v241 offset:17408
    v_mfma_f32_16x16x32_bf16 v[124:127], a[244:247], a[200:203], v[124:127]
    s_add_u32 s40, s31, 102912
    s_add_u32 m0, s30, 30720
    v_mfma_f32_16x16x32_bf16 v[132:135], a[244:247], a[204:207], v[132:135]
    buffer_load_dwordx4 v243, s[4:7], s40 offen  lds
    v_mfma_f32_16x16x32_bf16 v[140:143], a[244:247], a[208:211], v[140:143]
    v_mfma_f32_16x16x32_bf16 v[148:151], a[244:247], a[212:215], v[148:151]
    s_add_u32 s40, s31, 123392
    s_add_u32 m0, s30, 32768
    v_mfma_f32_16x16x32_bf16 v[156:159], a[244:247], a[216:219], v[156:159]
    buffer_load_dwordx4 v243, s[4:7], s40 offen  lds
    v_mfma_f32_16x16x32_bf16 v[164:167], a[244:247], a[220:223], v[164:167]
    s_add_u32 s41, s43, 24576
    v_mfma_f32_16x16x32_bf16 v[168:171], a[248:251], a[196:199], v[168:171]
    ds_read_b64_tr_b16 a[244:245], v241 offset:16392
    ds_read_b64_tr_b16 a[246:247], v241 offset:17416
    v_mfma_f32_16x16x32_bf16 v[172:175], a[252:255], a[196:199], v[172:175]
    ds_read_b128 a[196:199], v238 offset:6144
    v_mfma_f32_16x16x32_bf16 v[176:179], a[248:251], a[200:203], v[176:179]
    buffer_load_dwordx4 a[12:15], v252, s[12:15], s41 offen offset:3072 nt
    v_mfma_f32_16x16x32_bf16 v[180:183], a[252:255], a[200:203], v[180:183]
    ds_read_b128 a[200:203], v238 offset:8192
    v_mfma_f32_16x16x32_bf16 v[184:187], a[248:251], a[204:207], v[184:187]
    v_mfma_f32_16x16x32_bf16 v[188:191], a[252:255], a[204:207], v[188:191]
    ds_read_b128 a[204:207], v238 offset:10240
    v_mfma_f32_16x16x32_bf16 v[192:195], a[248:251], a[208:211], v[192:195]
    v_mfma_f32_16x16x32_bf16 v[196:199], a[252:255], a[208:211], v[196:199]
    ds_read_b128 a[208:211], v238 offset:12288
    v_mfma_f32_16x16x32_bf16 v[200:203], a[248:251], a[212:215], v[200:203]
    s_waitcnt vmcnt(20)
    s_barrier
    v_mfma_f32_16x16x32_bf16 v[204:207], a[252:255], a[212:215], v[204:207]
    ds_read_b128 a[212:215], v238 offset:14336
    v_mfma_f32_16x16x32_bf16 v[208:211], a[248:251], a[216:219], v[208:211]
    v_mfma_f32_16x16x32_bf16 v[212:215], a[252:255], a[216:219], v[212:215]
    ds_read_b128 a[216:219], v238 offset:16384
    v_mfma_f32_16x16x32_bf16 v[216:219], a[248:251], a[220:223], v[216:219]
    v_mfma_f32_16x16x32_bf16 v[220:223], a[252:255], a[220:223], v[220:223]
    ds_read_b128 a[220:223], v238 offset:18432
    s_waitcnt lgkmcnt(6)
    v_mfma_f32_16x16x32_bf16 v[0:3], a[224:227], a[196:199], v[0:3]
    ds_read_b64_tr_b16 a[248:249], v242 offset:16384
    ds_read_b64_tr_b16 a[250:251], v242 offset:17408
    v_mfma_f32_16x16x32_bf16 v[4:7], a[228:231], a[196:199], v[4:7]
    ds_read_b64_tr_b16 a[252:253], v242 offset:16392
    ds_read_b64_tr_b16 a[254:255], v242 offset:17416
    s_waitcnt lgkmcnt(9)
    v_mfma_f32_16x16x32_bf16 v[8:11], a[224:227], a[200:203], v[8:11]
    v_mfma_f32_16x16x32_bf16 v[12:15], a[228:231], a[200:203], v[12:15]
    s_waitcnt lgkmcnt(8)
    v_mfma_f32_16x16x32_bf16 v[16:19], a[224:227], a[204:207], v[16:19]
    v_mfma_f32_16x16x32_bf16 v[20:23], a[228:231], a[204:207], v[20:23]
    s_waitcnt lgkmcnt(7)
    v_mfma_f32_16x16x32_bf16 v[24:27], a[224:227], a[208:211], v[24:27]
    v_mfma_f32_16x16x32_bf16 v[28:31], a[228:231], a[208:211], v[28:31]
    s_waitcnt lgkmcnt(6)
    v_mfma_f32_16x16x32_bf16 v[32:35], a[224:227], a[212:215], v[32:35]
    v_mfma_f32_16x16x32_bf16 v[36:39], a[228:231], a[212:215], v[36:39]
    s_waitcnt lgkmcnt(5)
    v_mfma_f32_16x16x32_bf16 v[40:43], a[224:227], a[216:219], v[40:43]
    v_mfma_f32_16x16x32_bf16 v[44:47], a[228:231], a[216:219], v[44:47]
    s_waitcnt lgkmcnt(4)
    v_mfma_f32_16x16x32_bf16 v[48:51], a[224:227], a[220:223], v[48:51]
    s_waitcnt vmcnt(23) lgkmcnt(0)
    s_barrier
    v_mfma_f32_16x16x32_bf16 v[52:55], a[228:231], a[220:223], v[52:55]
    ds_read_b64_tr_b16 a[224:225], v239 offset:24576
    ds_read_b64_tr_b16 a[226:227], v239 offset:25600
    v_mfma_f32_16x16x32_bf16 v[56:59], a[232:235], a[196:199], v[56:59]
    ds_read_b64_tr_b16 a[228:229], v239 offset:24584
    ds_read_b64_tr_b16 a[230:231], v239 offset:25608
    v_mfma_f32_16x16x32_bf16 v[64:67], a[232:235], a[200:203], v[64:67]
    s_add_u32 s40, s32, 2621440
    s_add_u32 m0, s29, 98304
    v_mfma_f32_16x16x32_bf16 v[72:75], a[232:235], a[204:207], v[72:75]
    buffer_load_dwordx4 v244, s[8:11], s40 offen nt lds
    v_mfma_f32_16x16x32_bf16 v[80:83], a[232:235], a[208:211], v[80:83]
    v_mfma_f32_16x16x32_bf16 v[88:91], a[232:235], a[212:215], v[88:91]
    v_mfma_f32_16x16x32_bf16 v[96:99], a[232:235], a[216:219], v[96:99]
    s_add_u32 s40, s32, 2654208
    s_add_u32 m0, s29, 99328
    v_mfma_f32_16x16x32_bf16 v[104:107], a[232:235], a[220:223], v[104:107]
    buffer_load_dwordx4 v244, s[8:11], s40 offen nt lds
    v_mfma_f32_16x16x32_bf16 v[60:63], a[236:239], a[196:199], v[60:63]
    ds_read_b64_tr_b16 a[232:233], v240 offset:24576
    ds_read_b64_tr_b16 a[234:235], v240 offset:25600
    v_mfma_f32_16x16x32_bf16 v[68:71], a[236:239], a[200:203], v[68:71]
    v_mfma_f32_16x16x32_bf16 v[76:79], a[236:239], a[204:207], v[76:79]
    s_add_u32 s40, s32, 2686976
    s_add_u32 m0, s29, 100352
    v_mfma_f32_16x16x32_bf16 v[84:87], a[236:239], a[208:211], v[84:87]
    buffer_load_dwordx4 v244, s[8:11], s40 offen nt lds
    v_mfma_f32_16x16x32_bf16 v[92:95], a[236:239], a[212:215], v[92:95]
    v_mfma_f32_16x16x32_bf16 v[100:103], a[236:239], a[216:219], v[100:103]
    v_mfma_f32_16x16x32_bf16 v[108:111], a[236:239], a[220:223], v[108:111]
    v_mfma_f32_16x16x32_bf16 v[112:115], a[240:243], a[196:199], v[112:115]
    ds_read_b64_tr_b16 a[236:237], v240 offset:24584
    ds_read_b64_tr_b16 a[238:239], v240 offset:25608
    v_mfma_f32_16x16x32_bf16 v[120:123], a[240:243], a[200:203], v[120:123]
    s_add_u32 s40, s32, 2719744
    s_add_u32 m0, s29, 101376
    v_mfma_f32_16x16x32_bf16 v[128:131], a[240:243], a[204:207], v[128:131]
    buffer_load_dwordx4 v244, s[8:11], s40 offen nt lds
    v_mfma_f32_16x16x32_bf16 v[136:139], a[240:243], a[208:211], v[136:139]
    v_mfma_f32_16x16x32_bf16 v[144:147], a[240:243], a[212:215], v[144:147]
    s_add_u32 s40, s31, 640
    s_add_u32 m0, s30, 34816
    v_mfma_f32_16x16x32_bf16 v[152:155], a[240:243], a[216:219], v[152:155]
    buffer_load_dwordx4 v243, s[4:7], s40 offen  lds
    v_mfma_f32_16x16x32_bf16 v[160:163], a[240:243], a[220:223], v[160:163]
    v_mfma_f32_16x16x32_bf16 v[116:119], a[244:247], a[196:199], v[116:119]
    ds_read_b64_tr_b16 a[240:241], v241 offset:24576
    ds_read_b64_tr_b16 a[242:243], v241 offset:25600
    v_mfma_f32_16x16x32_bf16 v[124:127], a[244:247], a[200:203], v[124:127]
    s_add_u32 s40, s31, 21120
    s_add_u32 m0, s30, 0
    v_mfma_f32_16x16x32_bf16 v[132:135], a[244:247], a[204:207], v[132:135]
    buffer_load_dwordx4 v243, s[4:7], s40 offen  lds
    v_mfma_f32_16x16x32_bf16 v[140:143], a[244:247], a[208:211], v[140:143]
    v_mfma_f32_16x16x32_bf16 v[148:151], a[244:247], a[212:215], v[148:151]
    s_add_u32 s40, s31, 41600
    s_add_u32 m0, s30, 2048
    v_mfma_f32_16x16x32_bf16 v[156:159], a[244:247], a[216:219], v[156:159]
    buffer_load_dwordx4 v243, s[4:7], s40 offen  lds
    v_mfma_f32_16x16x32_bf16 v[164:167], a[244:247], a[220:223], v[164:167]
    s_add_u32 s40, s31, 62080
    s_add_u32 m0, s30, 4096
    v_mfma_f32_16x16x32_bf16 v[168:171], a[248:251], a[196:199], v[168:171]
    ds_read_b64_tr_b16 a[244:245], v241 offset:24584
    ds_read_b64_tr_b16 a[246:247], v241 offset:25608
    v_mfma_f32_16x16x32_bf16 v[172:175], a[252:255], a[196:199], v[172:175]
    ds_read_b128 a[196:199], v245 offset:6144
    v_mfma_f32_16x16x32_bf16 v[176:179], a[248:251], a[200:203], v[176:179]
    buffer_load_dwordx4 v243, s[4:7], s40 offen  lds
    v_mfma_f32_16x16x32_bf16 v[180:183], a[252:255], a[200:203], v[180:183]
    ds_read_b128 a[200:203], v245 offset:8192
    v_mfma_f32_16x16x32_bf16 v[184:187], a[248:251], a[204:207], v[184:187]
    s_nop 0
    v_mfma_f32_16x16x32_bf16 v[188:191], a[252:255], a[204:207], v[188:191]
    ds_read_b128 a[204:207], v245 offset:10240
    v_mfma_f32_16x16x32_bf16 v[192:195], a[248:251], a[208:211], v[192:195]
    buffer_load_dword a195, v246, s[88:91], s33 offen offset:1280
    v_mfma_f32_16x16x32_bf16 v[196:199], a[252:255], a[208:211], v[196:199]
    ds_read_b128 a[208:211], v245 offset:12288
    v_mfma_f32_16x16x32_bf16 v[200:203], a[248:251], a[212:215], v[200:203]
    s_add_u32 s41, s43, 32768
    v_mfma_f32_16x16x32_bf16 v[204:207], a[252:255], a[212:215], v[204:207]
    ds_read_b128 a[212:215], v245 offset:14336
    v_mfma_f32_16x16x32_bf16 v[208:211], a[248:251], a[216:219], v[208:211]
    buffer_load_dwordx4 a[16:19], v249, s[12:15], s41 offen offset:0 nt
    v_mfma_f32_16x16x32_bf16 v[212:215], a[252:255], a[216:219], v[212:215]
    ds_read_b128 a[216:219], v245 offset:16384
    v_mfma_f32_16x16x32_bf16 v[216:219], a[248:251], a[220:223], v[216:219]
    v_mfma_f32_16x16x32_bf16 v[220:223], a[252:255], a[220:223], v[220:223]
    ds_read_b128 a[220:223], v245 offset:18432
    s_waitcnt lgkmcnt(6)
    v_mfma_f32_16x16x32_bf16 v[0:3], a[224:227], a[196:199], v[0:3]
    ds_read_b64_tr_b16 a[248:249], v242 offset:24576
    ds_read_b64_tr_b16 a[250:251], v242 offset:25600
    v_mfma_f32_16x16x32_bf16 v[4:7], a[228:231], a[196:199], v[4:7]
    ds_read_b64_tr_b16 a[252:253], v242 offset:24584
    ds_read_b64_tr_b16 a[254:255], v242 offset:25608
    s_waitcnt lgkmcnt(9)
    v_mfma_f32_16x16x32_bf16 v[8:11], a[224:227], a[200:203], v[8:11]
    v_mfma_f32_16x16x32_bf16 v[12:15], a[228:231], a[200:203], v[12:15]
    s_waitcnt lgkmcnt(8)
    v_mfma_f32_16x16x32_bf16 v[16:19], a[224:227], a[204:207], v[16:19]
    v_mfma_f32_16x16x32_bf16 v[20:23], a[228:231], a[204:207], v[20:23]
    s_waitcnt lgkmcnt(7)
    v_mfma_f32_16x16x32_bf16 v[24:27], a[224:227], a[208:211], v[24:27]
    v_mfma_f32_16x16x32_bf16 v[28:31], a[228:231], a[208:211], v[28:31]
    s_waitcnt lgkmcnt(6)
    v_mfma_f32_16x16x32_bf16 v[32:35], a[224:227], a[212:215], v[32:35]
    v_mfma_f32_16x16x32_bf16 v[36:39], a[228:231], a[212:215], v[36:39]
    s_waitcnt lgkmcnt(5)
    v_mfma_f32_16x16x32_bf16 v[40:43], a[224:227], a[216:219], v[40:43]
    v_mfma_f32_16x16x32_bf16 v[44:47], a[228:231], a[216:219], v[44:47]
    s_waitcnt lgkmcnt(4)
    v_mfma_f32_16x16x32_bf16 v[48:51], a[224:227], a[220:223], v[48:51]
    s_waitcnt vmcnt(20) lgkmcnt(0)
    s_barrier
    v_mfma_f32_16x16x32_bf16 v[52:55], a[228:231], a[220:223], v[52:55]
    ds_read_b64_tr_b16 a[224:225], v239 offset:0
    ds_read_b64_tr_b16 a[226:227], v239 offset:1024
    v_mfma_f32_16x16x32_bf16 v[56:59], a[232:235], a[196:199], v[56:59]
    ds_read_b64_tr_b16 a[228:229], v239 offset:8
    ds_read_b64_tr_b16 a[230:231], v239 offset:1032
    v_mfma_f32_16x16x32_bf16 v[64:67], a[232:235], a[200:203], v[64:67]
    s_add_u32 s40, s32, 2883584
    s_add_u32 m0, s29, 106496
    v_mfma_f32_16x16x32_bf16 v[72:75], a[232:235], a[204:207], v[72:75]
    buffer_load_dwordx4 v244, s[8:11], s40 offen nt lds
    v_mfma_f32_16x16x32_bf16 v[80:83], a[232:235], a[208:211], v[80:83]
    v_mfma_f32_16x16x32_bf16 v[88:91], a[232:235], a[212:215], v[88:91]
    v_mfma_f32_16x16x32_bf16 v[96:99], a[232:235], a[216:219], v[96:99]
    s_add_u32 s40, s32, 2916352
    s_add_u32 m0, s29, 107520
    v_mfma_f32_16x16x32_bf16 v[104:107], a[232:235], a[220:223], v[104:107]
    buffer_load_dwordx4 v244, s[8:11], s40 offen nt lds
    v_mfma_f32_16x16x32_bf16 v[60:63], a[236:239], a[196:199], v[60:63]
    ds_read_b64_tr_b16 a[232:233], v240 offset:0
    ds_read_b64_tr_b16 a[234:235], v240 offset:1024
    v_mfma_f32_16x16x32_bf16 v[68:71], a[236:239], a[200:203], v[68:71]
    v_mfma_f32_16x16x32_bf16 v[76:79], a[236:239], a[204:207], v[76:79]
    s_add_u32 s40, s32, 2949120
    s_add_u32 m0, s29, 108544
    v_mfma_f32_16x16x32_bf16 v[84:87], a[236:239], a[208:211], v[84:87]
    buffer_load_dwordx4 v244, s[8:11], s40 offen nt lds
    v_mfma_f32_16x16x32_bf16 v[92:95], a[236:239], a[212:215], v[92:95]
    v_mfma_f32_16x16x32_bf16 v[100:103], a[236:239], a[216:219], v[100:103]
    v_mfma_f32_16x16x32_bf16 v[108:111], a[236:239], a[220:223], v[108:111]
    v_mfma_f32_16x16x32_bf16 v[112:115], a[240:243], a[196:199], v[112:115]
    ds_read_b64_tr_b16 a[236:237], v240 offset:8
    ds_read_b64_tr_b16 a[238:239], v240 offset:1032
    v_mfma_f32_16x16x32_bf16 v[120:123], a[240:243], a[200:203], v[120:123]
    s_add_u32 s40, s32, 2981888
    s_add_u32 m0, s29, 109568
    v_mfma_f32_16x16x32_bf16 v[128:131], a[240:243], a[204:207], v[128:131]
    buffer_load_dwordx4 v244, s[8:11], s40 offen nt lds
    v_mfma_f32_16x16x32_bf16 v[136:139], a[240:243], a[208:211], v[136:139]
    v_mfma_f32_16x16x32_bf16 v[144:147], a[240:243], a[212:215], v[144:147]
    s_add_u32 s40, s31, 82560
    s_add_u32 m0, s30, 6144
    v_mfma_f32_16x16x32_bf16 v[152:155], a[240:243], a[216:219], v[152:155]
    buffer_load_dwordx4 v243, s[4:7], s40 offen  lds
    v_mfma_f32_16x16x32_bf16 v[160:163], a[240:243], a[220:223], v[160:163]
    v_mfma_f32_16x16x32_bf16 v[116:119], a[244:247], a[196:199], v[116:119]
    ds_read_b64_tr_b16 a[240:241], v241 offset:0
    ds_read_b64_tr_b16 a[242:243], v241 offset:1024
    v_mfma_f32_16x16x32_bf16 v[124:127], a[244:247], a[200:203], v[124:127]
    s_add_u32 s40, s31, 103040
    s_add_u32 m0, s30, 8192
    v_mfma_f32_16x16x32_bf16 v[132:135], a[244:247], a[204:207], v[132:135]
    buffer_load_dwordx4 v243, s[4:7], s40 offen  lds
    v_mfma_f32_16x16x32_bf16 v[140:143], a[244:247], a[208:211], v[140:143]
    v_mfma_f32_16x16x32_bf16 v[148:151], a[244:247], a[212:215], v[148:151]
    s_add_u32 s40, s31, 123520
    s_add_u32 m0, s30, 10240
    v_mfma_f32_16x16x32_bf16 v[156:159], a[244:247], a[216:219], v[156:159]
    buffer_load_dwordx4 v243, s[4:7], s40 offen  lds
    v_mfma_f32_16x16x32_bf16 v[164:167], a[244:247], a[220:223], v[164:167]
    s_add_u32 s41, s43, 0
    s_add_u32 m0, s29, 114688
    v_mfma_f32_16x16x32_bf16 v[168:171], a[248:251], a[196:199], v[168:171]
    ds_read_b64_tr_b16 a[244:245], v241 offset:8
    ds_read_b64_tr_b16 a[246:247], v241 offset:1032
    v_mfma_f32_16x16x32_bf16 v[172:175], a[252:255], a[196:199], v[172:175]
    ds_read_b128 a[196:199], v238 offset:20480
    v_mfma_f32_16x16x32_bf16 v[176:179], a[248:251], a[200:203], v[176:179]
    buffer_load_dwordx4 v251, s[16:19], s41 offen offset:2048 nt lds
    v_mfma_f32_16x16x32_bf16 v[180:183], a[252:255], a[200:203], v[180:183]
    ds_read_b128 a[200:203], v238 offset:22528
    v_mfma_f32_16x16x32_bf16 v[184:187], a[248:251], a[204:207], v[184:187]
    s_add_u32 s41, s43, 32768
    v_mfma_f32_16x16x32_bf16 v[188:191], a[252:255], a[204:207], v[188:191]
    ds_read_b128 a[204:207], v238 offset:24576
    v_mfma_f32_16x16x32_bf16 v[192:195], a[248:251], a[208:211], v[192:195]
    buffer_load_dwordx4 a[20:23], v250, s[12:15], s41 offen offset:1024 nt
    v_mfma_f32_16x16x32_bf16 v[196:199], a[252:255], a[208:211], v[196:199]
    ds_read_b128 a[208:211], v238 offset:26624
    v_mfma_f32_16x16x32_bf16 v[200:203], a[248:251], a[212:215], v[200:203]
    s_waitcnt vmcnt(20)
    s_barrier
    v_mfma_f32_16x16x32_bf16 v[204:207], a[252:255], a[212:215], v[204:207]
    ds_read_b128 a[212:215], v238 offset:28672
    v_mfma_f32_16x16x32_bf16 v[208:211], a[248:251], a[216:219], v[208:211]
    v_mfma_f32_16x16x32_bf16 v[212:215], a[252:255], a[216:219], v[212:215]
    ds_read_b128 a[216:219], v238 offset:30720
    v_mfma_f32_16x16x32_bf16 v[216:219], a[248:251], a[220:223], v[216:219]
    v_mfma_f32_16x16x32_bf16 v[220:223], a[252:255], a[220:223], v[220:223]
    ds_read_b128 a[220:223], v238 offset:32768
    s_waitcnt lgkmcnt(6)
    v_mfma_f32_16x16x32_bf16 v[0:3], a[224:227], a[196:199], v[0:3]
    ds_read_b64_tr_b16 a[248:249], v242 offset:0
    ds_read_b64_tr_b16 a[250:251], v242 offset:1024
    v_mfma_f32_16x16x32_bf16 v[4:7], a[228:231], a[196:199], v[4:7]
    ds_read_b64_tr_b16 a[252:253], v242 offset:8
    ds_read_b64_tr_b16 a[254:255], v242 offset:1032
    s_waitcnt lgkmcnt(9)
    v_mfma_f32_16x16x32_bf16 v[8:11], a[224:227], a[200:203], v[8:11]
    v_mfma_f32_16x16x32_bf16 v[12:15], a[228:231], a[200:203], v[12:15]
    s_waitcnt lgkmcnt(8)
    v_mfma_f32_16x16x32_bf16 v[16:19], a[224:227], a[204:207], v[16:19]
    v_mfma_f32_16x16x32_bf16 v[20:23], a[228:231], a[204:207], v[20:23]
    s_waitcnt lgkmcnt(7)
    v_mfma_f32_16x16x32_bf16 v[24:27], a[224:227], a[208:211], v[24:27]
    v_mfma_f32_16x16x32_bf16 v[28:31], a[228:231], a[208:211], v[28:31]
    s_waitcnt lgkmcnt(6)
    v_mfma_f32_16x16x32_bf16 v[32:35], a[224:227], a[212:215], v[32:35]
    v_mfma_f32_16x16x32_bf16 v[36:39], a[228:231], a[212:215], v[36:39]
    s_waitcnt lgkmcnt(5)
    v_mfma_f32_16x16x32_bf16 v[40:43], a[224:227], a[216:219], v[40:43]
    v_mfma_f32_16x16x32_bf16 v[44:47], a[228:231], a[216:219], v[44:47]
    s_waitcnt lgkmcnt(4)
    v_mfma_f32_16x16x32_bf16 v[48:51], a[224:227], a[220:223], v[48:51]
    s_waitcnt vmcnt(23) lgkmcnt(0)
    s_barrier
Lpg2:
    s_cbranch_execz Lpg3
    v_mfma_f32_16x16x32_bf16 v[52:55], a[228:231], a[220:223], v[52:55]
    ds_read_b64_tr_b16 a[224:225], v239 offset:8192
    ds_read_b64_tr_b16 a[226:227], v239 offset:9216
    v_mfma_f32_16x16x32_bf16 v[56:59], a[232:235], a[196:199], v[56:59]
    ds_read_b64_tr_b16 a[228:229], v239 offset:8200
    ds_read_b64_tr_b16 a[230:231], v239 offset:9224
    v_mfma_f32_16x16x32_bf16 v[64:67], a[232:235], a[200:203], v[64:67]
    s_add_u32 s40, s32, 3145728
    s_add_u32 m0, s29, 81920
    v_mfma_f32_16x16x32_bf16 v[72:75], a[232:235], a[204:207], v[72:75]
    buffer_load_dwordx4 v244, s[8:11], s40 offen nt lds
    v_mfma_f32_16x16x32_bf16 v[80:83], a[232:235], a[208:211], v[80:83]
    v_mfma_f32_16x16x32_bf16 v[88:91], a[232:235], a[212:215], v[88:91]
    v_mfma_f32_16x16x32_bf16 v[96:99], a[232:235], a[216:219], v[96:99]
    s_add_u32 s40, s32, 3178496
    s_add_u32 m0, s29, 82944
    v_mfma_f32_16x16x32_bf16 v[104:107], a[232:235], a[220:223], v[104:107]
    buffer_load_dwordx4 v244, s[8:11], s40 offen nt lds
    v_mfma_f32_16x16x32_bf16 v[60:63], a[236:239], a[196:199], v[60:63]
    ds_read_b64_tr_b16 a[232:233], v240 offset:8192
    ds_read_b64_tr_b16 a[234:235], v240 offset:9216
    v_mfma_f32_16x16x32_bf16 v[68:71], a[236:239], a[200:203], v[68:71]
    v_mfma_f32_16x16x32_bf16 v[76:79], a[236:239], a[204:207], v[76:79]
    s_add_u32 s40, s32, 3211264
    s_add_u32 m0, s29, 83968
    v_mfma_f32_16x16x32_bf16 v[84:87], a[236:239], a[208:211], v[84:87]
    buffer_load_dwordx4 v244, s[8:11], s40 offen nt lds
    v_mfma_f32_16x16x32_bf16 v[92:95], a[236:239], a[212:215], v[92:95]
    v_mfma_f32_16x16x32_bf16 v[100:103], a[236:239], a[216:219], v[100:103]
    v_mfma_f32_16x16x32_bf16 v[108:111], a[236:239], a[220:223], v[108:111]
    v_mfma_f32_16x16x32_bf16 v[112:115], a[240:243], a[196:199], v[112:115]
    ds_read_b64_tr_b16 a[236:237], v240 offset:8200
    ds_read_b64_tr_b16 a[238:239], v240 offset:9224
    v_mfma_f32_16x16x32_bf16 v[120:123], a[240:243], a[200:203], v[120:123]
    s_add_u32 s40, s32, 3244032
    s_add_u32 m0, s29, 84992
    v_mfma_f32_16x16x32_bf16 v[128:131], a[240:243], a[204:207], v[128:131]
    buffer_load_dwordx4 v244, s[8:11], s40 offen nt lds
    v_mfma_f32_16x16x32_bf16 v[136:139], a[240:243], a[208:211], v[136:139]
    v_mfma_f32_16x16x32_bf16 v[144:147], a[240:243], a[212:215], v[144:147]
    s_add_u32 s40, s31, 768
    s_add_u32 m0, s30, 12288
    v_mfma_f32_16x16x32_bf16 v[152:155], a[240:243], a[216:219], v[152:155]
    buffer_load_dwordx4 v243, s[4:7], s40 offen  lds
    v_mfma_f32_16x16x32_bf16 v[160:163], a[240:243], a[220:223], v[160:163]
    v_mfma_f32_16x16x32_bf16 v[116:119], a[244:247], a[196:199], v[116:119]
    ds_read_b64_tr_b16 a[240:241], v241 offset:8192
    ds_read_b64_tr_b16 a[242:243], v241 offset:9216
    v_mfma_f32_16x16x32_bf16 v[124:127], a[244:247], a[200:203], v[124:127]
    s_add_u32 s40, s31, 21248
    s_add_u32 m0, s30, 14336
    v_mfma_f32_16x16x32_bf16 v[132:135], a[244:247], a[204:207], v[132:135]
    buffer_load_dwordx4 v243, s[4:7], s40 offen  lds
    v_mfma_f32_16x16x32_bf16 v[140:143], a[244:247], a[208:211], v[140:143]
    v_mfma_f32_16x16x32_bf16 v[148:151], a[244:247], a[212:215], v[148:151]
    s_add_u32 s40, s31, 41728
    s_add_u32 m0, s30, 16384
    v_mfma_f32_16x16x32_bf16 v[156:159], a[244:247], a[216:219], v[156:159]
    buffer_load_dwordx4 v243, s[4:7], s40 offen  lds
    v_mfma_f32_16x16x32_bf16 v[164:167], a[244:247], a[220:223], v[164:167]
    s_add_u32 s40, s31, 62208
    s_add_u32 m0, s30, 18432
    v_mfma_f32_16x16x32_bf16 v[168:171], a[248:251], a[196:199], v[168:171]
    ds_read_b64_tr_b16 a[244:245], v241 offset:8200
    ds_read_b64_tr_b16 a[246:247], v241 offset:9224
    v_mfma_f32_16x16x32_bf16 v[172:175], a[252:255], a[196:199], v[172:175]
    ds_read_b128 a[196:199], v245 offset:20480
    v_mfma_f32_16x16x32_bf16 v[176:179], a[248:251], a[200:203], v[176:179]
    buffer_load_dwordx4 v243, s[4:7], s40 offen  lds
    v_mfma_f32_16x16x32_bf16 v[180:183], a[252:255], a[200:203], v[180:183]
    ds_read_b128 a[200:203], v245 offset:22528
    v_mfma_f32_16x16x32_bf16 v[184:187], a[248:251], a[204:207], v[184:187]
    v_mfma_f32_16x16x32_bf16 v[188:191], a[252:255], a[204:207], v[188:191]
    ds_read_b128 a[204:207], v245 offset:24576
    v_mfma_f32_16x16x32_bf16 v[192:195], a[248:251], a[208:211], v[192:195]
    v_mfma_f32_16x16x32_bf16 v[196:199], a[252:255], a[208:211], v[196:199]
    ds_read_b128 a[208:211], v245 offset:26624
    v_mfma_f32_16x16x32_bf16 v[200:203], a[248:251], a[212:215], v[200:203]
    v_mfma_f32_16x16x32_bf16 v[204:207], a[252:255], a[212:215], v[204:207]
    ds_read_b128 a[212:215], v245 offset:28672
    v_mfma_f32_16x16x32_bf16 v[208:211], a[248:251], a[216:219], v[208:211]
    v_mfma_f32_16x16x32_bf16 v[212:215], a[252:255], a[216:219], v[212:215]
    ds_read_b128 a[216:219], v245 offset:30720
    v_mfma_f32_16x16x32_bf16 v[216:219], a[248:251], a[220:223], v[216:219]
    v_mfma_f32_16x16x32_bf16 v[220:223], a[252:255], a[220:223], v[220:223]
    ds_read_b128 a[220:223], v245 offset:32768
    s_waitcnt lgkmcnt(6)
    v_mfma_f32_16x16x32_bf16 v[0:3], a[224:227], a[196:199], v[0:3]
    ds_read_b64_tr_b16 a[248:249], v242 offset:8192
    ds_read_b64_tr_b16 a[250:251], v242 offset:9216
    v_mfma_f32_16x16x32_bf16 v[4:7], a[228:231], a[196:199], v[4:7]
    ds_read_b64_tr_b16 a[252:253], v242 offset:8200
    ds_read_b64_tr_b16 a[254:255], v242 offset:9224
    s_waitcnt lgkmcnt(9)
    v_mfma_f32_16x16x32_bf16 v[8:11], a[224:227], a[200:203], v[8:11]
    v_mfma_f32_16x16x32_bf16 v[12:15], a[228:231], a[200:203], v[12:15]
    s_waitcnt lgkmcnt(8)
    v_mfma_f32_16x16x32_bf16 v[16:19], a[224:227], a[204:207], v[16:19]
    v_mfma_f32_16x16x32_bf16 v[20:23], a[228:231], a[204:207], v[20:23]
    s_waitcnt lgkmcnt(7)
    v_mfma_f32_16x16x32_bf16 v[24:27], a[224:227], a[208:211], v[24:27]
    v_mfma_f32_16x16x32_bf16 v[28:31], a[228:231], a[208:211], v[28:31]
    s_waitcnt lgkmcnt(6)
    v_mfma_f32_16x16x32_bf16 v[32:35], a[224:227], a[212:215], v[32:35]
    v_mfma_f32_16x16x32_bf16 v[36:39], a[228:231], a[212:215], v[36:39]
    s_waitcnt lgkmcnt(5)
    v_mfma_f32_16x16x32_bf16 v[40:43], a[224:227], a[216:219], v[40:43]
    v_mfma_f32_16x16x32_bf16 v[44:47], a[228:231], a[216:219], v[44:47]
    s_waitcnt lgkmcnt(4)
    v_mfma_f32_16x16x32_bf16 v[48:51], a[224:227], a[220:223], v[48:51]
    s_waitcnt vmcnt(19) lgkmcnt(0)
    s_barrier
    v_mfma_f32_16x16x32_bf16 v[52:55], a[228:231], a[220:223], v[52:55]
    ds_read_b64_tr_b16 a[224:225], v239 offset:16384
    ds_read_b64_tr_b16 a[226:227], v239 offset:17408
    v_mfma_f32_16x16x32_bf16 v[56:59], a[232:235], a[196:199], v[56:59]
    ds_read_b64_tr_b16 a[228:229], v239 offset:16392
    ds_read_b64_tr_b16 a[230:231], v239 offset:17416
    v_mfma_f32_16x16x32_bf16 v[64:67], a[232:235], a[200:203], v[64:67]
    s_add_u32 s40, s32, 3407872
    s_add_u32 m0, s29, 90112
    v_mfma_f32_16x16x32_bf16 v[72:75], a[232:235], a[204:207], v[72:75]
    buffer_load_dwordx4 v244, s[8:11], s40 offen nt lds
    v_mfma_f32_16x16x32_bf16 v[80:83], a[232:235], a[208:211], v[80:83]
    v_mfma_f32_16x16x32_bf16 v[88:91], a[232:235], a[212:215], v[88:91]
    v_mfma_f32_16x16x32_bf16 v[96:99], a[232:235], a[216:219], v[96:99]
    s_add_u32 s40, s32, 3440640
    s_add_u32 m0, s29, 91136
    v_mfma_f32_16x16x32_bf16 v[104:107], a[232:235], a[220:223], v[104:107]
    buffer_load_dwordx4 v244, s[8:11], s40 offen nt lds
    v_mfma_f32_16x16x32_bf16 v[60:63], a[236:239], a[196:199], v[60:63]
    ds_read_b64_tr_b16 a[232:233], v240 offset:16384
    ds_read_b64_tr_b16 a[234:235], v240 offset:17408
    v_mfma_f32_16x16x32_bf16 v[68:71], a[236:239], a[200:203], v[68:71]
    v_mfma_f32_16x16x32_bf16 v[76:79], a[236:239], a[204:207], v[76:79]
    s_add_u32 s40, s32, 3473408
    s_add_u32 m0, s29, 92160
    v_mfma_f32_16x16x32_bf16 v[84:87], a[236:239], a[208:211], v[84:87]
    buffer_load_dwordx4 v244, s[8:11], s40 offen nt lds
    v_mfma_f32_16x16x32_bf16 v[92:95], a[236:239], a[212:215], v[92:95]
    v_mfma_f32_16x16x32_bf16 v[100:103], a[236:239], a[216:219], v[100:103]
    v_mfma_f32_16x16x32_bf16 v[108:111], a[236:239], a[220:223], v[108:111]
    v_mfma_f32_16x16x32_bf16 v[112:115], a[240:243], a[196:199], v[112:115]
    ds_read_b64_tr_b16 a[236:237], v240 offset:16392
    ds_read_b64_tr_b16 a[238:239], v240 offset:17416
    v_mfma_f32_16x16x32_bf16 v[120:123], a[240:243], a[200:203], v[120:123]
    s_add_u32 s40, s32, 3506176
    s_add_u32 m0, s29, 93184
    v_mfma_f32_16x16x32_bf16 v[128:131], a[240:243], a[204:207], v[128:131]
    buffer_load_dwordx4 v244, s[8:11], s40 offen nt lds
    v_mfma_f32_16x16x32_bf16 v[136:139], a[240:243], a[208:211], v[136:139]
    v_mfma_f32_16x16x32_bf16 v[144:147], a[240:243], a[212:215], v[144:147]
    s_add_u32 s40, s31, 82688
    s_add_u32 m0, s30, 20480
    v_mfma_f32_16x16x32_bf16 v[152:155], a[240:243], a[216:219], v[152:155]
    buffer_load_dwordx4 v243, s[4:7], s40 offen  lds
    v_mfma_f32_16x16x32_bf16 v[160:163], a[240:243], a[220:223], v[160:163]
    v_mfma_f32_16x16x32_bf16 v[116:119], a[244:247], a[196:199], v[116:119]
    ds_read_b64_tr_b16 a[240:241], v241 offset:16384
    ds_read_b64_tr_b16 a[242:243], v241 offset:17408
    v_mfma_f32_16x16x32_bf16 v[124:127], a[244:247], a[200:203], v[124:127]
    s_add_u32 s40, s31, 103168
    s_add_u32 m0, s30, 22528
    v_mfma_f32_16x16x32_bf16 v[132:135], a[244:247], a[204:207], v[132:135]
    buffer_load_dwordx4 v243, s[4:7], s40 offen  lds
    v_mfma_f32_16x16x32_bf16 v[140:143], a[244:247], a[208:211], v[140:143]
    v_mfma_f32_16x16x32_bf16 v[148:151], a[244:247], a[212:215], v[148:151]
    s_add_u32 s40, s31, 123648
    s_add_u32 m0, s30, 24576
    v_mfma_f32_16x16x32_bf16 v[156:159], a[244:247], a[216:219], v[156:159]
    buffer_load_dwordx4 v243, s[4:7], s40 offen  lds
    v_mfma_f32_16x16x32_bf16 v[164:167], a[244:247], a[220:223], v[164:167]
    s_nop 0
    v_mfma_f32_16x16x32_bf16 v[168:171], a[248:251], a[196:199], v[168:171]
    ds_read_b64_tr_b16 a[244:245], v241 offset:16392
    ds_read_b64_tr_b16 a[246:247], v241 offset:17416
    v_mfma_f32_16x16x32_bf16 v[172:175], a[252:255], a[196:199], v[172:175]
    ds_read_b128 a[196:199], v238 offset:34816
    v_mfma_f32_16x16x32_bf16 v[176:179], a[248:251], a[200:203], v[176:179]
    buffer_load_dword a195, v246, s[88:91], s33 offen offset:2560
    v_mfma_f32_16x16x32_bf16 v[180:183], a[252:255], a[200:203], v[180:183]
    ds_read_b128 a[200:203], v238 offset:0
    v_mfma_f32_16x16x32_bf16 v[184:187], a[248:251], a[204:207], v[184:187]
    s_add_u32 s41, s43, 32768
    v_mfma_f32_16x16x32_bf16 v[188:191], a[252:255], a[204:207], v[188:191]
    ds_read_b128 a[204:207], v238 offset:2048
    v_mfma_f32_16x16x32_bf16 v[192:195], a[248:251], a[208:211], v[192:195]
    buffer_load_dwordx4 a[24:27], v251, s[12:15], s41 offen offset:2048 nt
    v_mfma_f32_16x16x32_bf16 v[196:199], a[252:255], a[208:211], v[196:199]
    ds_read_b128 a[208:211], v238 offset:4096
    v_mfma_f32_16x16x32_bf16 v[200:203], a[248:251], a[212:215], v[200:203]
    s_waitcnt vmcnt(19)
    s_barrier
    v_mfma_f32_16x16x32_bf16 v[204:207], a[252:255], a[212:215], v[204:207]
    ds_read_b128 a[212:215], v238 offset:6144
    v_mfma_f32_16x16x32_bf16 v[208:211], a[248:251], a[216:219], v[208:211]
    v_mfma_f32_16x16x32_bf16 v[212:215], a[252:255], a[216:219], v[212:215]
    ds_read_b128 a[216:219], v238 offset:8192
    v_mfma_f32_16x16x32_bf16 v[216:219], a[248:251], a[220:223], v[216:219]
    v_mfma_f32_16x16x32_bf16 v[220:223], a[252:255], a[220:223], v[220:223]
    ds_read_b128 a[220:223], v238 offset:10240
    s_waitcnt lgkmcnt(6)
    v_mfma_f32_16x16x32_bf16 v[0:3], a[224:227], a[196:199], v[0:3]
    ds_read_b64_tr_b16 a[248:249], v242 offset:16384
    ds_read_b64_tr_b16 a[250:251], v242 offset:17408
    v_mfma_f32_16x16x32_bf16 v[4:7], a[228:231], a[196:199], v[4:7]
    ds_read_b64_tr_b16 a[252:253], v242 offset:16392
    ds_read_b64_tr_b16 a[254:255], v242 offset:17416
    s_waitcnt lgkmcnt(9)
    v_mfma_f32_16x16x32_bf16 v[8:11], a[224:227], a[200:203], v[8:11]
    v_mfma_f32_16x16x32_bf16 v[12:15], a[228:231], a[200:203], v[12:15]
    s_waitcnt lgkmcnt(8)
    v_mfma_f32_16x16x32_bf16 v[16:19], a[224:227], a[204:207], v[16:19]
    v_mfma_f32_16x16x32_bf16 v[20:23], a[228:231], a[204:207], v[20:23]
    s_waitcnt lgkmcnt(7)
    v_mfma_f32_16x16x32_bf16 v[24:27], a[224:227], a[208:211], v[24:27]
    v_mfma_f32_16x16x32_bf16 v[28:31], a[228:231], a[208:211], v[28:31]
    s_waitcnt lgkmcnt(6)
    v_mfma_f32_16x16x32_bf16 v[32:35], a[224:227], a[212:215], v[32:35]
    v_mfma_f32_16x16x32_bf16 v[36:39], a[228:231], a[212:215], v[36:39]
    s_waitcnt lgkmcnt(5)
    v_mfma_f32_16x16x32_bf16 v[40:43], a[224:227], a[216:219], v[40:43]
    v_mfma_f32_16x16x32_bf16 v[44:47], a[228:231], a[216:219], v[44:47]
    s_waitcnt lgkmcnt(4)
    v_mfma_f32_16x16x32_bf16 v[48:51], a[224:227], a[220:223], v[48:51]
    s_waitcnt vmcnt(22) lgkmcnt(0)
    s_barrier
    v_mfma_f32_16x16x32_bf16 v[52:55], a[228:231], a[220:223], v[52:55]
    ds_read_b64_tr_b16 a[224:225], v239 offset:24576
    ds_read_b64_tr_b16 a[226:227], v239 offset:25600
    v_mfma_f32_16x16x32_bf16 v[56:59], a[232:235], a[196:199], v[56:59]
    ds_read_b64_tr_b16 a[228:229], v239 offset:24584
    ds_read_b64_tr_b16 a[230:231], v239 offset:25608
    v_mfma_f32_16x16x32_bf16 v[64:67], a[232:235], a[200:203], v[64:67]
    s_add_u32 s40, s32, 3670016
    s_add_u32 m0, s29, 98304
    v_mfma_f32_16x16x32_bf16 v[72:75], a[232:235], a[204:207], v[72:75]
    buffer_load_dwordx4 v244, s[8:11], s40 offen nt lds
    v_mfma_f32_16x16x32_bf16 v[80:83], a[232:235], a[208:211], v[80:83]
    v_mfma_f32_16x16x32_bf16 v[88:91], a[232:235], a[212:215], v[88:91]
    v_mfma_f32_16x16x32_bf16 v[96:99], a[232:235], a[216:219], v[96:99]
    s_add_u32 s40, s32, 3702784
    s_add_u32 m0, s29, 99328
    v_mfma_f32_16x16x32_bf16 v[104:107], a[232:235], a[220:223], v[104:107]
    buffer_load_dwordx4 v244, s[8:11], s40 offen nt lds
    v_mfma_f32_16x16x32_bf16 v[60:63], a[236:239], a[196:199], v[60:63]
    ds_read_b64_tr_b16 a[232:233], v240 offset:24576
    ds_read_b64_tr_b16 a[234:235], v240 offset:25600
    v_mfma_f32_16x16x32_bf16 v[68:71], a[236:239], a[200:203], v[68:71]
    v_mfma_f32_16x16x32_bf16 v[76:79], a[236:239], a[204:207], v[76:79]
    s_add_u32 s40, s32, 3735552
    s_add_u32 m0, s29, 100352
    v_mfma_f32_16x16x32_bf16 v[84:87], a[236:239], a[208:211], v[84:87]
    buffer_load_dwordx4 v244, s[8:11], s40 offen nt lds
    v_mfma_f32_16x16x32_bf16 v[92:95], a[236:239], a[212:215], v[92:95]
    v_mfma_f32_16x16x32_bf16 v[100:103], a[236:239], a[216:219], v[100:103]
    v_mfma_f32_16x16x32_bf16 v[108:111], a[236:239], a[220:223], v[108:111]
    v_mfma_f32_16x16x32_bf16 v[112:115], a[240:243], a[196:199], v[112:115]
    ds_read_b64_tr_b16 a[236:237], v240 offset:24584
    ds_read_b64_tr_b16 a[238:239], v240 offset:25608
    v_mfma_f32_16x16x32_bf16 v[120:123], a[240:243], a[200:203], v[120:123]
    s_add_u32 s40, s32, 3768320
    s_add_u32 m0, s29, 101376
    v_mfma_f32_16x16x32_bf16 v[128:131], a[240:243], a[204:207], v[128:131]
    buffer_load_dwordx4 v244, s[8:11], s40 offen nt lds
    v_mfma_f32_16x16x32_bf16 v[136:139], a[240:243], a[208:211], v[136:139]
    v_mfma_f32_16x16x32_bf16 v[144:147], a[240:243], a[212:215], v[144:147]
    s_add_u32 s40, s31, 896
    s_add_u32 m0, s30, 26624
    v_mfma_f32_16x16x32_bf16 v[152:155], a[240:243], a[216:219], v[152:155]
    buffer_load_dwordx4 v243, s[4:7], s40 offen  lds
    v_mfma_f32_16x16x32_bf16 v[160:163], a[240:243], a[220:223], v[160:163]
    v_mfma_f32_16x16x32_bf16 v[116:119], a[244:247], a[196:199], v[116:119]
    ds_read_b64_tr_b16 a[240:241], v241 offset:24576
    ds_read_b64_tr_b16 a[242:243], v241 offset:25600
    v_mfma_f32_16x16x32_bf16 v[124:127], a[244:247], a[200:203], v[124:127]
    s_add_u32 s40, s31, 21376
    s_add_u32 m0, s30, 28672
    v_mfma_f32_16x16x32_bf16 v[132:135], a[244:247], a[204:207], v[132:135]
    buffer_load_dwordx4 v243, s[4:7], s40 offen  lds
    v_mfma_f32_16x16x32_bf16 v[140:143], a[244:247], a[208:211], v[140:143]
    v_mfma_f32_16x16x32_bf16 v[148:151], a[244:247], a[212:215], v[148:151]
    s_add_u32 s40, s31, 41856
    s_add_u32 m0, s30, 30720
    v_mfma_f32_16x16x32_bf16 v[156:159], a[244:247], a[216:219], v[156:159]
    buffer_load_dwordx4 v243, s[4:7], s40 offen  lds
    v_mfma_f32_16x16x32_bf16 v[164:167], a[244:247], a[220:223], v[164:167]
    s_add_u32 s40, s31, 62336
    s_add_u32 m0, s30, 32768
    v_mfma_f32_16x16x32_bf16 v[168:171], a[248:251], a[196:199], v[168:171]
    ds_read_b64_tr_b16 a[244:245], v241 offset:24584
    ds_read_b64_tr_b16 a[246:247], v241 offset:25608
    v_mfma_f32_16x16x32_bf16 v[172:175], a[252:255], a[196:199], v[172:175]
    ds_read_b128 a[196:199], v245 offset:34816
    v_mfma_f32_16x16x32_bf16 v[176:179], a[248:251], a[200:203], v[176:179]
    buffer_load_dwordx4 v243, s[4:7], s40 offen  lds
    v_mfma_f32_16x16x32_bf16 v[180:183], a[252:255], a[200:203], v[180:183]
    ds_read_b128 a[200:203], v245 offset:0
    v_mfma_f32_16x16x32_bf16 v[184:187], a[248:251], a[204:207], v[184:187]
    s_add_u32 s41, s43, 0
    s_add_u32 m0, s29, 114688
    v_mfma_f32_16x16x32_bf16 v[188:191], a[252:255], a[204:207], v[188:191]
    ds_read_b128 a[204:207], v245 offset:2048
    v_mfma_f32_16x16x32_bf16 v[192:195], a[248:251], a[208:211], v[192:195]
    buffer_load_dwordx4 v252, s[16:19], s41 offen offset:3072 nt lds
    v_mfma_f32_16x16x32_bf16 v[196:199], a[252:255], a[208:211], v[196:199]
    ds_read_b128 a[208:211], v245 offset:4096
    v_mfma_f32_16x16x32_bf16 v[200:203], a[248:251], a[212:215], v[200:203]
    s_add_u32 s41, s43, 32768
    v_mfma_f32_16x16x32_bf16 v[204:207], a[252:255], a[212:215], v[204:207]
    ds_read_b128 a[212:215], v245 offset:6144
    v_mfma_f32_16x16x32_bf16 v[208:211], a[248:251], a[216:219], v[208:211]
    buffer_load_dwordx4 a[28:31], v252, s[12:15], s41 offen offset:3072 nt
    v_mfma_f32_16x16x32_bf16 v[212:215], a[252:255], a[216:219], v[212:215]
    ds_read_b128 a[216:219], v245 offset:8192
    v_mfma_f32_16x16x32_bf16 v[216:219], a[248:251], a[220:223], v[216:219]
    v_mfma_f32_16x16x32_bf16 v[220:223], a[252:255], a[220:223], v[220:223]
    ds_read_b128 a[220:223], v245 offset:10240
    s_waitcnt lgkmcnt(6)
    v_mfma_f32_16x16x32_bf16 v[0:3], a[224:227], a[196:199], v[0:3]
    ds_read_b64_tr_b16 a[248:249], v242 offset:24576
    ds_read_b64_tr_b16 a[250:251], v242 offset:25600
    v_mfma_f32_16x16x32_bf16 v[4:7], a[228:231], a[196:199], v[4:7]
    ds_read_b64_tr_b16 a[252:253], v242 offset:24584
    ds_read_b64_tr_b16 a[254:255], v242 offset:25608
    s_waitcnt lgkmcnt(9)
    v_mfma_f32_16x16x32_bf16 v[8:11], a[224:227], a[200:203], v[8:11]
    v_mfma_f32_16x16x32_bf16 v[12:15], a[228:231], a[200:203], v[12:15]
    s_waitcnt lgkmcnt(8)
    v_mfma_f32_16x16x32_bf16 v[16:19], a[224:227], a[204:207], v[16:19]
    v_mfma_f32_16x16x32_bf16 v[20:23], a[228:231], a[204:207], v[20:23]
    s_waitcnt lgkmcnt(7)
    v_mfma_f32_16x16x32_bf16 v[24:27], a[224:227], a[208:211], v[24:27]
    v_mfma_f32_16x16x32_bf16 v[28:31], a[228:231], a[208:211], v[28:31]
    s_waitcnt lgkmcnt(6)
    v_mfma_f32_16x16x32_bf16 v[32:35], a[224:227], a[212:215], v[32:35]
    v_mfma_f32_16x16x32_bf16 v[36:39], a[228:231], a[212:215], v[36:39]
    s_waitcnt lgkmcnt(5)
    v_mfma_f32_16x16x32_bf16 v[40:43], a[224:227], a[216:219], v[40:43]
    v_mfma_f32_16x16x32_bf16 v[44:47], a[228:231], a[216:219], v[44:47]
    s_waitcnt lgkmcnt(4)
    v_mfma_f32_16x16x32_bf16 v[48:51], a[224:227], a[220:223], v[48:51]
    s_waitcnt vmcnt(19) lgkmcnt(0)
    s_barrier
    v_mfma_f32_16x16x32_bf16 v[52:55], a[228:231], a[220:223], v[52:55]
    ds_read_b64_tr_b16 a[224:225], v239 offset:0
    ds_read_b64_tr_b16 a[226:227], v239 offset:1024
    v_mfma_f32_16x16x32_bf16 v[56:59], a[232:235], a[196:199], v[56:59]
    ds_read_b64_tr_b16 a[228:229], v239 offset:8
    ds_read_b64_tr_b16 a[230:231], v239 offset:1032
    v_mfma_f32_16x16x32_bf16 v[64:67], a[232:235], a[200:203], v[64:67]
    s_add_u32 s40, s32, 3932160
    s_add_u32 m0, s29, 106496
    v_mfma_f32_16x16x32_bf16 v[72:75], a[232:235], a[204:207], v[72:75]
    buffer_load_dwordx4 v244, s[8:11], s40 offen nt lds
    v_mfma_f32_16x16x32_bf16 v[80:83], a[232:235], a[208:211], v[80:83]
    v_mfma_f32_16x16x32_bf16 v[88:91], a[232:235], a[212:215], v[88:91]
    v_mfma_f32_16x16x32_bf16 v[96:99], a[232:235], a[216:219], v[96:99]
    s_add_u32 s40, s32, 3964928
    s_add_u32 m0, s29, 107520
    v_mfma_f32_16x16x32_bf16 v[104:107], a[232:235], a[220:223], v[104:107]
    buffer_load_dwordx4 v244, s[8:11], s40 offen nt lds
    v_mfma_f32_16x16x32_bf16 v[60:63], a[236:239], a[196:199], v[60:63]
    ds_read_b64_tr_b16 a[232:233], v240 offset:0
    ds_read_b64_tr_b16 a[234:235], v240 offset:1024
    v_mfma_f32_16x16x32_bf16 v[68:71], a[236:239], a[200:203], v[68:71]
    v_mfma_f32_16x16x32_bf16 v[76:79], a[236:239], a[204:207], v[76:79]
    s_add_u32 s40, s32, 3997696
    s_add_u32 m0, s29, 108544
    v_mfma_f32_16x16x32_bf16 v[84:87], a[236:239], a[208:211], v[84:87]
    buffer_load_dwordx4 v244, s[8:11], s40 offen nt lds
    v_mfma_f32_16x16x32_bf16 v[92:95], a[236:239], a[212:215], v[92:95]
    v_mfma_f32_16x16x32_bf16 v[100:103], a[236:239], a[216:219], v[100:103]
    v_mfma_f32_16x16x32_bf16 v[108:111], a[236:239], a[220:223], v[108:111]
    v_mfma_f32_16x16x32_bf16 v[112:115], a[240:243], a[196:199], v[112:115]
    ds_read_b64_tr_b16 a[236:237], v240 offset:8
    ds_read_b64_tr_b16 a[238:239], v240 offset:1032
    v_mfma_f32_16x16x32_bf16 v[120:123], a[240:243], a[200:203], v[120:123]
    s_add_u32 s40, s32, 4030464
    s_add_u32 m0, s29, 109568
    v_mfma_f32_16x16x32_bf16 v[128:131], a[240:243], a[204:207], v[128:131]
    buffer_load_dwordx4 v244, s[8:11], s40 offen nt lds
    v_mfma_f32_16x16x32_bf16 v[136:139], a[240:243], a[208:211], v[136:139]
    v_mfma_f32_16x16x32_bf16 v[144:147], a[240:243], a[212:215], v[144:147]
    s_add_u32 s40, s31, 82816
    s_add_u32 m0, s30, 34816
    v_mfma_f32_16x16x32_bf16 v[152:155], a[240:243], a[216:219], v[152:155]
    buffer_load_dwordx4 v243, s[4:7], s40 offen  lds
    v_mfma_f32_16x16x32_bf16 v[160:163], a[240:243], a[220:223], v[160:163]
    v_mfma_f32_16x16x32_bf16 v[116:119], a[244:247], a[196:199], v[116:119]
    ds_read_b64_tr_b16 a[240:241], v241 offset:0
    ds_read_b64_tr_b16 a[242:243], v241 offset:1024
    v_mfma_f32_16x16x32_bf16 v[124:127], a[244:247], a[200:203], v[124:127]
    s_add_u32 s40, s31, 103296
    s_add_u32 m0, s30, 0
    v_mfma_f32_16x16x32_bf16 v[132:135], a[244:247], a[204:207], v[132:135]
    buffer_load_dwordx4 v243, s[4:7], s40 offen  lds
    v_mfma_f32_16x16x32_bf16 v[140:143], a[244:247], a[208:211], v[140:143]
    v_mfma_f32_16x16x32_bf16 v[148:151], a[244:247], a[212:215], v[148:151]
    s_add_u32 s40, s31, 123776
    s_add_u32 m0, s30, 2048
    v_mfma_f32_16x16x32_bf16 v[156:159], a[244:247], a[216:219], v[156:159]
    buffer_load_dwordx4 v243, s[4:7], s40 offen  lds
    v_mfma_f32_16x16x32_bf16 v[164:167], a[244:247], a[220:223], v[164:167]
    s_add_u32 s41, s43, 32768
    v_mfma_f32_16x16x32_bf16 v[168:171], a[248:251], a[196:199], v[168:171]
    ds_read_b64_tr_b16 a[244:245], v241 offset:8
    ds_read_b64_tr_b16 a[246:247], v241 offset:1032
    v_mfma_f32_16x16x32_bf16 v[172:175], a[252:255], a[196:199], v[172:175]
    ds_read_b128 a[196:199], v238 offset:12288
    v_mfma_f32_16x16x32_bf16 v[176:179], a[248:251], a[200:203], v[176:179]
    buffer_load_dwordx4 a[32:35], v249, s[16:19], s41 offen offset:0 nt
    v_mfma_f32_16x16x32_bf16 v[180:183], a[252:255], a[200:203], v[180:183]
    ds_read_b128 a[200:203], v238 offset:14336
    v_mfma_f32_16x16x32_bf16 v[184:187], a[248:251], a[204:207], v[184:187]
    v_mfma_f32_16x16x32_bf16 v[188:191], a[252:255], a[204:207], v[188:191]
    ds_read_b128 a[204:207], v238 offset:16384
    v_mfma_f32_16x16x32_bf16 v[192:195], a[248:251], a[208:211], v[192:195]
    v_mfma_f32_16x16x32_bf16 v[196:199], a[252:255], a[208:211], v[196:199]
    ds_read_b128 a[208:211], v238 offset:18432
    v_mfma_f32_16x16x32_bf16 v[200:203], a[248:251], a[212:215], v[200:203]
    s_waitcnt vmcnt(20)
    s_barrier
    v_mfma_f32_16x16x32_bf16 v[204:207], a[252:255], a[212:215], v[204:207]
    ds_read_b128 a[212:215], v238 offset:20480
    v_mfma_f32_16x16x32_bf16 v[208:211], a[248:251], a[216:219], v[208:211]
    v_mfma_f32_16x16x32_bf16 v[212:215], a[252:255], a[216:219], v[212:215]
    ds_read_b128 a[216:219], v238 offset:22528
    v_mfma_f32_16x16x32_bf16 v[216:219], a[248:251], a[220:223], v[216:219]
    v_mfma_f32_16x16x32_bf16 v[220:223], a[252:255], a[220:223], v[220:223]
    ds_read_b128 a[220:223], v238 offset:24576
    s_waitcnt lgkmcnt(6)
    v_mfma_f32_16x16x32_bf16 v[0:3], a[224:227], a[196:199], v[0:3]
    ds_read_b64_tr_b16 a[248:249], v242 offset:0
    ds_read_b64_tr_b16 a[250:251], v242 offset:1024
    v_mfma_f32_16x16x32_bf16 v[4:7], a[228:231], a[196:199], v[4:7]
    ds_read_b64_tr_b16 a[252:253], v242 offset:8
    ds_read_b64_tr_b16 a[254:255], v242 offset:1032
    s_waitcnt lgkmcnt(9)
    v_mfma_f32_16x16x32_bf16 v[8:11], a[224:227], a[200:203], v[8:11]
    v_mfma_f32_16x16x32_bf16 v[12:15], a[228:231], a[200:203], v[12:15]
    s_waitcnt lgkmcnt(8)
    v_mfma_f32_16x16x32_bf16 v[16:19], a[224:227], a[204:207], v[16:19]
    v_mfma_f32_16x16x32_bf16 v[20:23], a[228:231], a[204:207], v[20:23]
    s_waitcnt lgkmcnt(7)
    v_mfma_f32_16x16x32_bf16 v[24:27], a[224:227], a[208:211], v[24:27]
    v_mfma_f32_16x16x32_bf16 v[28:31], a[228:231], a[208:211], v[28:31]
    s_waitcnt lgkmcnt(6)
    v_mfma_f32_16x16x32_bf16 v[32:35], a[224:227], a[212:215], v[32:35]
    v_mfma_f32_16x16x32_bf16 v[36:39], a[228:231], a[212:215], v[36:39]
    s_waitcnt lgkmcnt(5)
    v_mfma_f32_16x16x32_bf16 v[40:43], a[224:227], a[216:219], v[40:43]
    v_mfma_f32_16x16x32_bf16 v[44:47], a[228:231], a[216:219], v[44:47]
    s_waitcnt lgkmcnt(4)
    v_mfma_f32_16x16x32_bf16 v[48:51], a[224:227], a[220:223], v[48:51]
    s_waitcnt vmcnt(23) lgkmcnt(0)
    s_barrier
    v_mfma_f32_16x16x32_bf16 v[52:55], a[228:231], a[220:223], v[52:55]
    ds_read_b64_tr_b16 a[224:225], v239 offset:8192
    ds_read_b64_tr_b16 a[226:227], v239 offset:9216
    v_mfma_f32_16x16x32_bf16 v[56:59], a[232:235], a[196:199], v[56:59]
    ds_read_b64_tr_b16 a[228:229], v239 offset:8200
    ds_read_b64_tr_b16 a[230:231], v239 offset:9224
    v_mfma_f32_16x16x32_bf16 v[64:67], a[232:235], a[200:203], v[64:67]
    s_add_u32 s40, s32, 4194304
    s_add_u32 m0, s29, 81920
    v_mfma_f32_16x16x32_bf16 v[72:75], a[232:235], a[204:207], v[72:75]
    buffer_load_dwordx4 v244, s[8:11], s40 offen nt lds
    v_mfma_f32_16x16x32_bf16 v[80:83], a[232:235], a[208:211], v[80:83]
    v_mfma_f32_16x16x32_bf16 v[88:91], a[232:235], a[212:215], v[88:91]
    v_mfma_f32_16x16x32_bf16 v[96:99], a[232:235], a[216:219], v[96:99]
    s_add_u32 s40, s32, 4227072
    s_add_u32 m0, s29, 82944
    v_mfma_f32_16x16x32_bf16 v[104:107], a[232:235], a[220:223], v[104:107]
    buffer_load_dwordx4 v244, s[8:11], s40 offen nt lds
    v_mfma_f32_16x16x32_bf16 v[60:63], a[236:239], a[196:199], v[60:63]
    ds_read_b64_tr_b16 a[232:233], v240 offset:8192
    ds_read_b64_tr_b16 a[234:235], v240 offset:9216
    v_mfma_f32_16x16x32_bf16 v[68:71], a[236:239], a[200:203], v[68:71]
    v_mfma_f32_16x16x32_bf16 v[76:79], a[236:239], a[204:207], v[76:79]
    s_add_u32 s40, s32, 4259840
    s_add_u32 m0, s29, 83968
    v_mfma_f32_16x16x32_bf16 v[84:87], a[236:239], a[208:211], v[84:87]
    buffer_load_dwordx4 v244, s[8:11], s40 offen nt lds
    v_mfma_f32_16x16x32_bf16 v[92:95], a[236:239], a[212:215], v[92:95]
    v_mfma_f32_16x16x32_bf16 v[100:103], a[236:239], a[216:219], v[100:103]
    v_mfma_f32_16x16x32_bf16 v[108:111], a[236:239], a[220:223], v[108:111]
    v_mfma_f32_16x16x32_bf16 v[112:115], a[240:243], a[196:199], v[112:115]
    ds_read_b64_tr_b16 a[236:237], v240 offset:8200
    ds_read_b64_tr_b16 a[238:239], v240 offset:9224
    v_mfma_f32_16x16x32_bf16 v[120:123], a[240:243], a[200:203], v[120:123]
    s_add_u32 s40, s32, 4292608
    s_add_u32 m0, s29, 84992
    v_mfma_f32_16x16x32_bf16 v[128:131], a[240:243], a[204:207], v[128:131]
    buffer_load_dwordx4 v244, s[8:11], s40 offen nt lds
    v_mfma_f32_16x16x32_bf16 v[136:139], a[240:243], a[208:211], v[136:139]
    v_mfma_f32_16x16x32_bf16 v[144:147], a[240:243], a[212:215], v[144:147]
    s_add_u32 s40, s31, 1024
    s_add_u32 m0, s30, 4096
    v_mfma_f32_16x16x32_bf16 v[152:155], a[240:243], a[216:219], v[152:155]
    buffer_load_dwordx4 v243, s[4:7], s40 offen  lds
    v_mfma_f32_16x16x32_bf16 v[160:163], a[240:243], a[220:223], v[160:163]
    v_mfma_f32_16x16x32_bf16 v[116:119], a[244:247], a[196:199], v[116:119]
    ds_read_b64_tr_b16 a[240:241], v241 offset:8192
    ds_read_b64_tr_b16 a[242:243], v241 offset:9216
    v_mfma_f32_16x16x32_bf16 v[124:127], a[244:247], a[200:203], v[124:127]
    s_add_u32 s40, s31, 21504
    s_add_u32 m0, s30, 6144
    v_mfma_f32_16x16x32_bf16 v[132:135], a[244:247], a[204:207], v[132:135]
    buffer_load_dwordx4 v243, s[4:7], s40 offen  lds
    v_mfma_f32_16x16x32_bf16 v[140:143], a[244:247], a[208:211], v[140:143]
    v_mfma_f32_16x16x32_bf16 v[148:151], a[244:247], a[212:215], v[148:151]
    s_add_u32 s40, s31, 41984
    s_add_u32 m0, s30, 8192
    v_mfma_f32_16x16x32_bf16 v[156:159], a[244:247], a[216:219], v[156:159]
    buffer_load_dwordx4 v243, s[4:7], s40 offen  lds
    v_mfma_f32_16x16x32_bf16 v[164:167], a[244:247], a[220:223], v[164:167]
    s_add_u32 s40, s31, 62464
    s_add_u32 m0, s30, 10240
    v_mfma_f32_16x16x32_bf16 v[168:171], a[248:251], a[196:199], v[168:171]
    ds_read_b64_tr_b16 a[244:245], v241 offset:8200
    ds_read_b64_tr_b16 a[246:247], v241 offset:9224
    v_mfma_f32_16x16x32_bf16 v[172:175], a[252:255], a[196:199], v[172:175]
    ds_read_b128 a[196:199], v245 offset:12288
    v_mfma_f32_16x16x32_bf16 v[176:179], a[248:251], a[200:203], v[176:179]
    buffer_load_dwordx4 v243, s[4:7], s40 offen  lds
    v_mfma_f32_16x16x32_bf16 v[180:183], a[252:255], a[200:203], v[180:183]
    ds_read_b128 a[200:203], v245 offset:14336
    v_mfma_f32_16x16x32_bf16 v[184:187], a[248:251], a[204:207], v[184:187]
    s_nop 0
    v_mfma_f32_16x16x32_bf16 v[188:191], a[252:255], a[204:207], v[188:191]
    ds_read_b128 a[204:207], v245 offset:16384
    v_mfma_f32_16x16x32_bf16 v[192:195], a[248:251], a[208:211], v[192:195]
    buffer_load_dword a195, v246, s[88:91], s33 offen offset:3840
Lpg3:
    s_cbranch_execz Lpg4
    v_mfma_f32_16x16x32_bf16 v[196:199], a[252:255], a[208:211], v[196:199]
    ds_read_b128 a[208:211], v245 offset:18432
    v_mfma_f32_16x16x32_bf16 v[200:203], a[248:251], a[212:215], v[200:203]
    s_add_u32 s41, s43, 32768
    v_mfma_f32_16x16x32_bf16 v[204:207], a[252:255], a[212:215], v[204:207]
    ds_read_b128 a[212:215], v245 offset:20480
    v_mfma_f32_16x16x32_bf16 v[208:211], a[248:251], a[216:219], v[208:211]
    buffer_load_dwordx4 a[36:39], v250, s[16:19], s41 offen offset:1024 nt
    v_mfma_f32_16x16x32_bf16 v[212:215], a[252:255], a[216:219], v[212:215]
    ds_read_b128 a[216:219], v245 offset:22528
    v_mfma_f32_16x16x32_bf16 v[216:219], a[248:251], a[220:223], v[216:219]
    v_mfma_f32_16x16x32_bf16 v[220:223], a[252:255], a[220:223], v[220:223]
    ds_read_b128 a[220:223], v245 offset:24576
    s_waitcnt lgkmcnt(6)
    v_mfma_f32_16x16x32_bf16 v[0:3], a[224:227], a[196:199], v[0:3]
    ds_read_b64_tr_b16 a[248:249], v242 offset:8192
    ds_read_b64_tr_b16 a[250:251], v242 offset:9216
    v_mfma_f32_16x16x32_bf16 v[4:7], a[228:231], a[196:199], v[4:7]
    ds_read_b64_tr_b16 a[252:253], v242 offset:8200
    ds_read_b64_tr_b16 a[254:255], v242 offset:9224
    s_waitcnt lgkmcnt(9)
    v_mfma_f32_16x16x32_bf16 v[8:11], a[224:227], a[200:203], v[8:11]
    v_mfma_f32_16x16x32_bf16 v[12:15], a[228:231], a[200:203], v[12:15]
    s_waitcnt lgkmcnt(8)
    v_mfma_f32_16x16x32_bf16 v[16:19], a[224:227], a[204:207], v[16:19]
    v_mfma_f32_16x16x32_bf16 v[20:23], a[228:231], a[204:207], v[20:23]
    s_waitcnt lgkmcnt(7)
    v_mfma_f32_16x16x32_bf16 v[24:27], a[224:227], a[208:211], v[24:27]
    v_mfma_f32_16x16x32_bf16 v[28:31], a[228:231], a[208:211], v[28:31]
    s_waitcnt lgkmcnt(6)
    v_mfma_f32_16x16x32_bf16 v[32:35], a[224:227], a[212:215], v[32:35]
    v_mfma_f32_16x16x32_bf16 v[36:39], a[228:231], a[212:215], v[36:39]
    s_waitcnt lgkmcnt(5)
    v_mfma_f32_16x16x32_bf16 v[40:43], a[224:227], a[216:219], v[40:43]
    v_mfma_f32_16x16x32_bf16 v[44:47], a[228:231], a[216:219], v[44:47]
    s_waitcnt lgkmcnt(4)
    v_mfma_f32_16x16x32_bf16 v[48:51], a[224:227], a[220:223], v[48:51]
    s_waitcnt vmcnt(20) lgkmcnt(0)
    s_barrier
    v_mfma_f32_16x16x32_bf16 v[52:55], a[228:231], a[220:223], v[52:55]
    ds_read_b64_tr_b16 a[224:225], v239 offset:16384
    ds_read_b64_tr_b16 a[226:227], v239 offset:17408
    v_mfma_f32_16x16x32_bf16 v[56:59], a[232:235], a[196:199], v[56:59]
    ds_read_b64_tr_b16 a[228:229], v239 offset:16392
    ds_read_b64_tr_b16 a[230:231], v239 offset:17416
    v_mfma_f32_16x16x32_bf16 v[64:67], a[232:235], a[200:203], v[64:67]
    s_add_u32 s40, s32, 4456448
    s_add_u32 m0, s29, 90112
    v_mfma_f32_16x16x32_bf16 v[72:75], a[232:235], a[204:207], v[72:75]
    buffer_load_dwordx4 v244, s[8:11], s40 offen nt lds
    v_mfma_f32_16x16x32_bf16 v[80:83], a[232:235], a[208:211], v[80:83]
    v_mfma_f32_16x16x32_bf16 v[88:91], a[232:235], a[212:215], v[88:91]
    v_mfma_f32_16x16x32_bf16 v[96:99], a[232:235], a[216:219], v[96:99]
    s_add_u32 s40, s32, 4489216
    s_add_u32 m0, s29, 91136
    v_mfma_f32_16x16x32_bf16 v[104:107], a[232:235], a[220:223], v[104:107]
    buffer_load_dwordx4 v244, s[8:11], s40 offen nt lds
    v_mfma_f32_16x16x32_bf16 v[60:63], a[236:239], a[196:199], v[60:63]
    ds_read_b64_tr_b16 a[232:233], v240 offset:16384
    ds_read_b64_tr_b16 a[234:235], v240 offset:17408
    v_mfma_f32_16x16x32_bf16 v[68:71], a[236:239], a[200:203], v[68:71]
    v_mfma_f32_16x16x32_bf16 v[76:79], a[236:239], a[204:207], v[76:79]
    s_add_u32 s40, s32, 4521984
    s_add_u32 m0, s29, 92160
    v_mfma_f32_16x16x32_bf16 v[84:87], a[236:239], a[208:211], v[84:87]
    buffer_load_dwordx4 v244, s[8:11], s40 offen nt lds
    v_mfma_f32_16x16x32_bf16 v[92:95], a[236:239], a[212:215], v[92:95]
    v_mfma_f32_16x16x32_bf16 v[100:103], a[236:239], a[216:219], v[100:103]
    v_mfma_f32_16x16x32_bf16 v[108:111], a[236:239], a[220:223], v[108:111]
    v_mfma_f32_16x16x32_bf16 v[112:115], a[240:243], a[196:199], v[112:115]
    ds_read_b64_tr_b16 a[236:237], v240 offset:16392
    ds_read_b64_tr_b16 a[238:239], v240 offset:17416
    v_mfma_f32_16x16x32_bf16 v[120:123], a[240:243], a[200:203], v[120:123]
    s_add_u32 s40, s32, 4554752
    s_add_u32 m0, s29, 93184
    v_mfma_f32_16x16x32_bf16 v[128:131], a[240:243], a[204:207], v[128:131]
    buffer_load_dwordx4 v244, s[8:11], s40 offen nt lds
    v_mfma_f32_16x16x32_bf16 v[136:139], a[240:243], a[208:211], v[136:139]
    v_mfma_f32_16x16x32_bf16 v[144:147], a[240:243], a[212:215], v[144:147]
    s_add_u32 s40, s31, 82944
    s_add_u32 m0, s30, 12288
    v_mfma_f32_16x16x32_bf16 v[152:155], a[240:243], a[216:219], v[152:155]
    buffer_load_dwordx4 v243, s[4:7], s40 offen  lds
    v_mfma_f32_16x16x32_bf16 v[160:163], a[240:243], a[220:223], v[160:163]
    v_mfma_f32_16x16x32_bf16 v[116:119], a[244:247], a[196:199], v[116:119]
    ds_read_b64_tr_b16 a[240:241], v241 offset:16384
    ds_read_b64_tr_b16 a[242:243], v241 offset:17408
    v_mfma_f32_16x16x32_bf16 v[124:127], a[244:247], a[200:203], v[124:127]
    s_add_u32 s40, s31, 103424
    s_add_u32 m0, s30, 14336
    v_mfma_f32_16x16x32_bf16 v[132:135], a[244:247], a[204:207], v[132:135]
    buffer_load_dwordx4 v243, s[4:7], s40 offen  lds
    v_mfma_f32_16x16x32_bf16 v[140:143], a[244:247], a[208:211], v[140:143]
    v_mfma_f32_16x16x32_bf16 v[148:151], a[244:247], a[212:215], v[148:151]
    s_add_u32 s40, s31, 123904
    s_add_u32 m0, s30, 16384
    v_mfma_f32_16x16x32_bf16 v[156:159], a[244:247], a[216:219], v[156:159]
    buffer_load_dwordx4 v243, s[4:7], s40 offen  lds
    v_mfma_f32_16x16x32_bf16 v[164:167], a[244:247], a[220:223], v[164:167]
    s_add_u32 s41, s43, 32768
    v_mfma_f32_16x16x32_bf16 v[168:171], a[248:251], a[196:199], v[168:171]
    ds_read_b64_tr_b16 a[244:245], v241 offset:16392
    ds_read_b64_tr_b16 a[246:247], v241 offset:17416
    v_mfma_f32_16x16x32_bf16 v[172:175], a[252:255], a[196:199], v[172:175]
    ds_read_b128 a[196:199], v238 offset:26624
    v_mfma_f32_16x16x32_bf16 v[176:179], a[248:251], a[200:203], v[176:179]
    buffer_load_dwordx4 a[40:43], v251, s[16:19], s41 offen offset:2048 nt
    v_mfma_f32_16x16x32_bf16 v[180:183], a[252:255], a[200:203], v[180:183]
    ds_read_b128 a[200:203], v238 offset:28672
    v_mfma_f32_16x16x32_bf16 v[184:187], a[248:251], a[204:207], v[184:187]
    v_mfma_f32_16x16x32_bf16 v[188:191], a[252:255], a[204:207], v[188:191]
    ds_read_b128 a[204:207], v238 offset:30720
    v_mfma_f32_16x16x32_bf16 v[192:195], a[248:251], a[208:211], v[192:195]
    v_mfma_f32_16x16x32_bf16 v[196:199], a[252:255], a[208:211], v[196:199]
    ds_read_b128 a[208:211], v238 offset:32768
    v_mfma_f32_16x16x32_bf16 v[200:203], a[248:251], a[212:215], v[200:203]
    s_waitcnt vmcnt(19)
    s_barrier
    v_mfma_f32_16x16x32_bf16 v[204:207], a[252:255], a[212:215], v[204:207]
    ds_read_b128 a[212:215], v238 offset:34816
    v_mfma_f32_16x16x32_bf16 v[208:211], a[248:251], a[216:219], v[208:211]
    v_mfma_f32_16x16x32_bf16 v[212:215], a[252:255], a[216:219], v[212:215]
    ds_read_b128 a[216:219], v238 offset:0
    v_mfma_f32_16x16x32_bf16 v[216:219], a[248:251], a[220:223], v[216:219]
    v_mfma_f32_16x16x32_bf16 v[220:223], a[252:255], a[220:223], v[220:223]
    ds_read_b128 a[220:223], v238 offset:2048
    s_waitcnt lgkmcnt(6)
    v_mfma_f32_16x16x32_bf16 v[0:3], a[224:227], a[196:199], v[0:3]
    ds_read_b64_tr_b16 a[248:249], v242 offset:16384
    ds_read_b64_tr_b16 a[250:251], v242 offset:17408
    v_mfma_f32_16x16x32_bf16 v[4:7], a[228:231], a[196:199], v[4:7]
    ds_read_b64_tr_b16 a[252:253], v242 offset:16392
    ds_read_b64_tr_b16 a[254:255], v242 offset:17416
    s_waitcnt lgkmcnt(9)
    v_mfma_f32_16x16x32_bf16 v[8:11], a[224:227], a[200:203], v[8:11]
    v_mfma_f32_16x16x32_bf16 v[12:15], a[228:231], a[200:203], v[12:15]
    s_waitcnt lgkmcnt(8)
    v_mfma_f32_16x16x32_bf16 v[16:19], a[224:227], a[204:207], v[16:19]
    v_mfma_f32_16x16x32_bf16 v[20:23], a[228:231], a[204:207], v[20:23]
    s_waitcnt lgkmcnt(7)
    v_mfma_f32_16x16x32_bf16 v[24:27], a[224:227], a[208:211], v[24:27]
    v_mfma_f32_16x16x32_bf16 v[28:31], a[228:231], a[208:211], v[28:31]
    s_waitcnt lgkmcnt(6)
    v_mfma_f32_16x16x32_bf16 v[32:35], a[224:227], a[212:215], v[32:35]
    v_mfma_f32_16x16x32_bf16 v[36:39], a[228:231], a[212:215], v[36:39]
    s_waitcnt lgkmcnt(5)
    v_mfma_f32_16x16x32_bf16 v[40:43], a[224:227], a[216:219], v[40:43]
    v_mfma_f32_16x16x32_bf16 v[44:47], a[228:231], a[216:219], v[44:47]
    s_waitcnt lgkmcnt(4)
    v_mfma_f32_16x16x32_bf16 v[48:51], a[224:227], a[220:223], v[48:51]
    s_waitcnt vmcnt(22) lgkmcnt(0)
    s_barrier
    v_mfma_f32_16x16x32_bf16 v[52:55], a[228:231], a[220:223], v[52:55]
    ds_read_b64_tr_b16 a[224:225], v239 offset:24576
    ds_read_b64_tr_b16 a[226:227], v239 offset:25600
    v_mfma_f32_16x16x32_bf16 v[56:59], a[232:235], a[196:199], v[56:59]
    ds_read_b64_tr_b16 a[228:229], v239 offset:24584
    ds_read_b64_tr_b16 a[230:231], v239 offset:25608
    v_mfma_f32_16x16x32_bf16 v[64:67], a[232:235], a[200:203], v[64:67]
    s_add_u32 s40, s32, 4718592
    s_add_u32 m0, s29, 98304
    v_mfma_f32_16x16x32_bf16 v[72:75], a[232:235], a[204:207], v[72:75]
    buffer_load_dwordx4 v244, s[8:11], s40 offen nt lds
    v_mfma_f32_16x16x32_bf16 v[80:83], a[232:235], a[208:211], v[80:83]
    v_mfma_f32_16x16x32_bf16 v[88:91], a[232:235], a[212:215], v[88:91]
    v_mfma_f32_16x16x32_bf16 v[96:99], a[232:235], a[216:219], v[96:99]
    s_add_u32 s40, s32, 4751360
    s_add_u32 m0, s29, 99328
    v_mfma_f32_16x16x32_bf16 v[104:107], a[232:235], a[220:223], v[104:107]
    buffer_load_dwordx4 v244, s[8:11], s40 offen nt lds
    v_mfma_f32_16x16x32_bf16 v[60:63], a[236:239], a[196:199], v[60:63]
    ds_read_b64_tr_b16 a[232:233], v240 offset:24576
    ds_read_b64_tr_b16 a[234:235], v240 offset:25600
    v_mfma_f32_16x16x32_bf16 v[68:71], a[236:239], a[200:203], v[68:71]
    v_mfma_f32_16x16x32_bf16 v[76:79], a[236:239], a[204:207], v[76:79]
    s_add_u32 s40, s32, 4784128
    s_add_u32 m0, s29, 100352
    v_mfma_f32_16x16x32_bf16 v[84:87], a[236:239], a[208:211], v[84:87]
    buffer_load_dwordx4 v244, s[8:11], s40 offen nt lds
    v_mfma_f32_16x16x32_bf16 v[92:95], a[236:239], a[212:215], v[92:95]
    v_mfma_f32_16x16x32_bf16 v[100:103], a[236:239], a[216:219], v[100:103]
    v_mfma_f32_16x16x32_bf16 v[108:111], a[236:239], a[220:223], v[108:111]
    v_mfma_f32_16x16x32_bf16 v[112:115], a[240:243], a[196:199], v[112:115]
    ds_read_b64_tr_b16 a[236:237], v240 offset:24584
    ds_read_b64_tr_b16 a[238:239], v240 offset:25608
    v_mfma_f32_16x16x32_bf16 v[120:123], a[240:243], a[200:203], v[120:123]
    s_add_u32 s40, s32, 4816896
    s_add_u32 m0, s29, 101376
    v_mfma_f32_16x16x32_bf16 v[128:131], a[240:243], a[204:207], v[128:131]
    buffer_load_dwordx4 v244, s[8:11], s40 offen nt lds
    v_mfma_f32_16x16x32_bf16 v[136:139], a[240:243], a[208:211], v[136:139]
    v_mfma_f32_16x16x32_bf16 v[144:147], a[240:243], a[212:215], v[144:147]
    s_add_u32 s40, s31, 1152
    s_add_u32 m0, s30, 18432
    v_mfma_f32_16x16x32_bf16 v[152:155], a[240:243], a[216:219], v[152:155]
    buffer_load_dwordx4 v243, s[4:7], s40 offen  lds
    v_mfma_f32_16x16x32_bf16 v[160:163], a[240:243], a[220:223], v[160:163]
    v_mfma_f32_16x16x32_bf16 v[116:119], a[244:247], a[196:199], v[116:119]
    ds_read_b64_tr_b16 a[240:241], v241 offset:24576
    ds_read_b64_tr_b16 a[242:243], v241 offset:25600
    v_mfma_f32_16x16x32_bf16 v[124:127], a[244:247], a[200:203], v[124:127]
    s_add_u32 s40, s31, 21632
    s_add_u32 m0, s30, 20480
    v_mfma_f32_16x16x32_bf16 v[132:135], a[244:247], a[204:207], v[132:135]
    buffer_load_dwordx4 v243, s[4:7], s40 offen  lds
    v_mfma_f32_16x16x32_bf16 v[140:143], a[244:247], a[208:211], v[140:143]
    v_mfma_f32_16x16x32_bf16 v[148:151], a[244:247], a[212:215], v[148:151]
    s_add_u32 s40, s31, 42112
    s_add_u32 m0, s30, 22528
    v_mfma_f32_16x16x32_bf16 v[156:159], a[244:247], a[216:219], v[156:159]
    buffer_load_dwordx4 v243, s[4:7], s40 offen  lds
    v_mfma_f32_16x16x32_bf16 v[164:167], a[244:247], a[220:223], v[164:167]
    s_add_u32 s40, s31, 62592
    s_add_u32 m0, s30, 24576
    v_mfma_f32_16x16x32_bf16 v[168:171], a[248:251], a[196:199], v[168:171]
    ds_read_b64_tr_b16 a[244:245], v241 offset:24584
    ds_read_b64_tr_b16 a[246:247], v241 offset:25608
    v_mfma_f32_16x16x32_bf16 v[172:175], a[252:255], a[196:199], v[172:175]
    ds_read_b128 a[196:199], v245 offset:26624
    v_mfma_f32_16x16x32_bf16 v[176:179], a[248:251], a[200:203], v[176:179]
    buffer_load_dwordx4 v243, s[4:7], s40 offen  lds
    v_mfma_f32_16x16x32_bf16 v[180:183], a[252:255], a[200:203], v[180:183]
    ds_read_b128 a[200:203], v245 offset:28672
    v_mfma_f32_16x16x32_bf16 v[184:187], a[248:251], a[204:207], v[184:187]
    s_add_u32 s41, s43, 32768
    v_mfma_f32_16x16x32_bf16 v[188:191], a[252:255], a[204:207], v[188:191]
    ds_read_b128 a[204:207], v245 offset:30720
    v_mfma_f32_16x16x32_bf16 v[192:195], a[248:251], a[208:211], v[192:195]
    buffer_load_dwordx4 a[44:47], v252, s[16:19], s41 offen offset:3072 nt
    v_mfma_f32_16x16x32_bf16 v[196:199], a[252:255], a[208:211], v[196:199]
    ds_read_b128 a[208:211], v245 offset:32768
    v_mfma_f32_16x16x32_bf16 v[200:203], a[248:251], a[212:215], v[200:203]
    v_mfma_f32_16x16x32_bf16 v[204:207], a[252:255], a[212:215], v[204:207]
    ds_read_b128 a[212:215], v245 offset:34816
    v_mfma_f32_16x16x32_bf16 v[208:211], a[248:251], a[216:219], v[208:211]
    v_mfma_f32_16x16x32_bf16 v[212:215], a[252:255], a[216:219], v[212:215]
    ds_read_b128 a[216:219], v245 offset:0
    v_mfma_f32_16x16x32_bf16 v[216:219], a[248:251], a[220:223], v[216:219]
    v_mfma_f32_16x16x32_bf16 v[220:223], a[252:255], a[220:223], v[220:223]
    ds_read_b128 a[220:223], v245 offset:2048
    s_waitcnt lgkmcnt(6)
    v_mfma_f32_16x16x32_bf16 v[0:3], a[224:227], a[196:199], v[0:3]
    ds_read_b64_tr_b16 a[248:249], v242 offset:24576
    ds_read_b64_tr_b16 a[250:251], v242 offset:25600
    v_mfma_f32_16x16x32_bf16 v[4:7], a[228:231], a[196:199], v[4:7]
    ds_read_b64_tr_b16 a[252:253], v242 offset:24584
    ds_read_b64_tr_b16 a[254:255], v242 offset:25608
    s_waitcnt lgkmcnt(9)
    v_mfma_f32_16x16x32_bf16 v[8:11], a[224:227], a[200:203], v[8:11]
    v_mfma_f32_16x16x32_bf16 v[12:15], a[228:231], a[200:203], v[12:15]
    s_waitcnt lgkmcnt(8)
    v_mfma_f32_16x16x32_bf16 v[16:19], a[224:227], a[204:207], v[16:19]
    v_mfma_f32_16x16x32_bf16 v[20:23], a[228:231], a[204:207], v[20:23]
    s_waitcnt lgkmcnt(7)
    v_mfma_f32_16x16x32_bf16 v[24:27], a[224:227], a[208:211], v[24:27]
    v_mfma_f32_16x16x32_bf16 v[28:31], a[228:231], a[208:211], v[28:31]
    s_waitcnt lgkmcnt(6)
    v_mfma_f32_16x16x32_bf16 v[32:35], a[224:227], a[212:215], v[32:35]
    v_mfma_f32_16x16x32_bf16 v[36:39], a[228:231], a[212:215], v[36:39]
    s_waitcnt lgkmcnt(5)
    v_mfma_f32_16x16x32_bf16 v[40:43], a[224:227], a[216:219], v[40:43]
    v_mfma_f32_16x16x32_bf16 v[44:47], a[228:231], a[216:219], v[44:47]
    s_waitcnt lgkmcnt(4)
    v_mfma_f32_16x16x32_bf16 v[48:51], a[224:227], a[220:223], v[48:51]
    s_waitcnt vmcnt(19) lgkmcnt(0)
    s_barrier
    v_mfma_f32_16x16x32_bf16 v[52:55], a[228:231], a[220:223], v[52:55]
    ds_read_b64_tr_b16 a[224:225], v239 offset:0
    ds_read_b64_tr_b16 a[226:227], v239 offset:1024
    v_mfma_f32_16x16x32_bf16 v[56:59], a[232:235], a[196:199], v[56:59]
    ds_read_b64_tr_b16 a[228:229], v239 offset:8
    ds_read_b64_tr_b16 a[230:231], v239 offset:1032
    v_mfma_f32_16x16x32_bf16 v[64:67], a[232:235], a[200:203], v[64:67]
    s_add_u32 s40, s32, 4980736
    s_add_u32 m0, s29, 106496
    v_mfma_f32_16x16x32_bf16 v[72:75], a[232:235], a[204:207], v[72:75]
    buffer_load_dwordx4 v244, s[8:11], s40 offen nt lds
    v_mfma_f32_16x16x32_bf16 v[80:83], a[232:235], a[208:211], v[80:83]
    v_mfma_f32_16x16x32_bf16 v[88:91], a[232:235], a[212:215], v[88:91]
    v_mfma_f32_16x16x32_bf16 v[96:99], a[232:235], a[216:219], v[96:99]
    s_add_u32 s40, s32, 5013504
    s_add_u32 m0, s29, 107520
    v_mfma_f32_16x16x32_bf16 v[104:107], a[232:235], a[220:223], v[104:107]
    buffer_load_dwordx4 v244, s[8:11], s40 offen nt lds
    v_mfma_f32_16x16x32_bf16 v[60:63], a[236:239], a[196:199], v[60:63]
    ds_read_b64_tr_b16 a[232:233], v240 offset:0
    ds_read_b64_tr_b16 a[234:235], v240 offset:1024
    v_mfma_f32_16x16x32_bf16 v[68:71], a[236:239], a[200:203], v[68:71]
    v_mfma_f32_16x16x32_bf16 v[76:79], a[236:239], a[204:207], v[76:79]
    s_add_u32 s40, s32, 5046272
    s_add_u32 m0, s29, 108544
    v_mfma_f32_16x16x32_bf16 v[84:87], a[236:239], a[208:211], v[84:87]
    buffer_load_dwordx4 v244, s[8:11], s40 offen nt lds
    v_mfma_f32_16x16x32_bf16 v[92:95], a[236:239], a[212:215], v[92:95]
    v_mfma_f32_16x16x32_bf16 v[100:103], a[236:239], a[216:219], v[100:103]
    v_mfma_f32_16x16x32_bf16 v[108:111], a[236:239], a[220:223], v[108:111]
    v_mfma_f32_16x16x32_bf16 v[112:115], a[240:243], a[196:199], v[112:115]
    ds_read_b64_tr_b16 a[236:237], v240 offset:8
    ds_read_b64_tr_b16 a[238:239], v240 offset:1032
    v_mfma_f32_16x16x32_bf16 v[120:123], a[240:243], a[200:203], v[120:123]
    s_add_u32 s40, s32, 5079040
    s_add_u32 m0, s29, 109568
    v_mfma_f32_16x16x32_bf16 v[128:131], a[240:243], a[204:207], v[128:131]
    buffer_load_dwordx4 v244, s[8:11], s40 offen nt lds
    v_mfma_f32_16x16x32_bf16 v[136:139], a[240:243], a[208:211], v[136:139]
    v_mfma_f32_16x16x32_bf16 v[144:147], a[240:243], a[212:215], v[144:147]
    s_add_u32 s40, s31, 83072
    s_add_u32 m0, s30, 26624
    v_mfma_f32_16x16x32_bf16 v[152:155], a[240:243], a[216:219], v[152:155]
    buffer_load_dwordx4 v243, s[4:7], s40 offen  lds
    v_mfma_f32_16x16x32_bf16 v[160:163], a[240:243], a[220:223], v[160:163]
    v_mfma_f32_16x16x32_bf16 v[116:119], a[244:247], a[196:199], v[116:119]
    ds_read_b64_tr_b16 a[240:241], v241 offset:0
    ds_read_b64_tr_b16 a[242:243], v241 offset:1024
    v_mfma_f32_16x16x32_bf16 v[124:127], a[244:247], a[200:203], v[124:127]
    s_add_u32 s40, s31, 103552
    s_add_u32 m0, s30, 28672
    v_mfma_f32_16x16x32_bf16 v[132:135], a[244:247], a[204:207], v[132:135]
    buffer_load_dwordx4 v243, s[4:7], s40 offen  lds
    v_mfma_f32_16x16x32_bf16 v[140:143], a[244:247], a[208:211], v[140:143]
    v_mfma_f32_16x16x32_bf16 v[148:151], a[244:247], a[212:215], v[148:151]
    s_add_u32 s40, s31, 124032
    s_add_u32 m0, s30, 30720
    v_mfma_f32_16x16x32_bf16 v[156:159], a[244:247], a[216:219], v[156:159]
    buffer_load_dwordx4 v243, s[4:7], s40 offen  lds
    v_mfma_f32_16x16x32_bf16 v[164:167], a[244:247], a[220:223], v[164:167]
    s_add_u32 s41, s43, 0
    s_add_u32 m0, s29, 32768
    v_mfma_f32_16x16x32_bf16 v[168:171], a[248:251], a[196:199], v[168:171]
    ds_read_b64_tr_b16 a[244:245], v241 offset:8
    ds_read_b64_tr_b16 a[246:247], v241 offset:1032
    v_mfma_f32_16x16x32_bf16 v[172:175], a[252:255], a[196:199], v[172:175]
    ds_read_b128 a[196:199], v238 offset:4096
    v_mfma_f32_16x16x32_bf16 v[176:179], a[248:251], a[200:203], v[176:179]
    buffer_load_dwordx4 v249, s[12:15], s41 offen offset:0 nt lds
    v_mfma_f32_16x16x32_bf16 v[180:183], a[252:255], a[200:203], v[180:183]
    ds_read_b128 a[200:203], v238 offset:6144
    v_mfma_f32_16x16x32_bf16 v[184:187], a[248:251], a[204:207], v[184:187]
    s_add_u32 s41, s43, 0
    s_add_u32 m0, s29, 32768
    v_mfma_f32_16x16x32_bf16 v[188:191], a[252:255], a[204:207], v[188:191]
    ds_read_b128 a[204:207], v238 offset:8192
    v_mfma_f32_16x16x32_bf16 v[192:195], a[248:251], a[208:211], v[192:195]
    buffer_load_dwordx4 v250, s[12:15], s41 offen offset:1024 nt lds
    v_mfma_f32_16x16x32_bf16 v[196:199], a[252:255], a[208:211], v[196:199]
    ds_read_b128 a[208:211], v238 offset:10240
    v_mfma_f32_16x16x32_bf16 v[200:203], a[248:251], a[212:215], v[200:203]
    s_add_u32 s41, s43, 0
    s_add_u32 m0, s29, 32768
    s_waitcnt vmcnt(19)
    s_barrier
    v_mfma_f32_16x16x32_bf16 v[204:207], a[252:255], a[212:215], v[204:207]
    ds_read_b128 a[212:215], v238 offset:12288
    v_mfma_f32_16x16x32_bf16 v[208:211], a[248:251], a[216:219], v[208:211]
    buffer_load_dwordx4 v251, s[12:15], s41 offen offset:2048 nt lds
    v_mfma_f32_16x16x32_bf16 v[212:215], a[252:255], a[216:219], v[212:215]
    ds_read_b128 a[216:219], v238 offset:14336
    s_add_u32 s41, s43, 0
    s_add_u32 m0, s29, 32768
    v_mfma_f32_16x16x32_bf16 v[216:219], a[248:251], a[220:223], v[216:219]
    buffer_load_dwordx4 v252, s[12:15], s41 offen offset:3072 nt lds
    v_mfma_f32_16x16x32_bf16 v[220:223], a[252:255], a[220:223], v[220:223]
    ds_read_b128 a[220:223], v238 offset:16384
    s_waitcnt lgkmcnt(6)
    v_mfma_f32_16x16x32_bf16 v[0:3], a[224:227], a[196:199], v[0:3]
    ds_read_b64_tr_b16 a[248:249], v242 offset:0
    ds_read_b64_tr_b16 a[250:251], v242 offset:1024
    v_mfma_f32_16x16x32_bf16 v[4:7], a[228:231], a[196:199], v[4:7]
    ds_read_b64_tr_b16 a[252:253], v242 offset:8
    ds_read_b64_tr_b16 a[254:255], v242 offset:1032
    s_waitcnt lgkmcnt(9)
    v_mfma_f32_16x16x32_bf16 v[8:11], a[224:227], a[200:203], v[8:11]
    v_mfma_f32_16x16x32_bf16 v[12:15], a[228:231], a[200:203], v[12:15]
    s_waitcnt lgkmcnt(8)
    v_mfma_f32_16x16x32_bf16 v[16:19], a[224:227], a[204:207], v[16:19]
    v_mfma_f32_16x16x32_bf16 v[20:23], a[228:231], a[204:207], v[20:23]
    s_waitcnt lgkmcnt(7)
    v_mfma_f32_16x16x32_bf16 v[24:27], a[224:227], a[208:211], v[24:27]
    v_mfma_f32_16x16x32_bf16 v[28:31], a[228:231], a[208:211], v[28:31]
    s_waitcnt lgkmcnt(6)
    v_mfma_f32_16x16x32_bf16 v[32:35], a[224:227], a[212:215], v[32:35]
    v_mfma_f32_16x16x32_bf16 v[36:39], a[228:231], a[212:215], v[36:39]
    s_waitcnt lgkmcnt(5)
    v_mfma_f32_16x16x32_bf16 v[40:43], a[224:227], a[216:219], v[40:43]
    v_mfma_f32_16x16x32_bf16 v[44:47], a[228:231], a[216:219], v[44:47]
    s_waitcnt lgkmcnt(4)
    v_mfma_f32_16x16x32_bf16 v[48:51], a[224:227], a[220:223], v[48:51]
    s_waitcnt vmcnt(24) lgkmcnt(0)
    s_barrier
    v_mfma_f32_16x16x32_bf16 v[52:55], a[228:231], a[220:223], v[52:55]
    ds_read_b64_tr_b16 a[224:225], v239 offset:8192
    ds_read_b64_tr_b16 a[226:227], v239 offset:9216
    v_mfma_f32_16x16x32_bf16 v[56:59], a[232:235], a[196:199], v[56:59]
    ds_read_b64_tr_b16 a[228:229], v239 offset:8200
    ds_read_b64_tr_b16 a[230:231], v239 offset:9224
    v_mfma_f32_16x16x32_bf16 v[64:67], a[232:235], a[200:203], v[64:67]
    s_add_u32 s41, s43, 8192
    s_add_u32 m0, s29, 81920
    v_mfma_f32_16x16x32_bf16 v[72:75], a[232:235], a[204:207], v[72:75]
    buffer_load_dwordx4 v249, s[16:19], s41 offen offset:0 nt lds
    v_mfma_f32_16x16x32_bf16 v[80:83], a[232:235], a[208:211], v[80:83]
    v_mfma_f32_16x16x32_bf16 v[88:91], a[232:235], a[212:215], v[88:91]
    v_mfma_f32_16x16x32_bf16 v[96:99], a[232:235], a[216:219], v[96:99]
    s_add_u32 s41, s43, 8192
    s_add_u32 m0, s29, 81920
    v_mfma_f32_16x16x32_bf16 v[104:107], a[232:235], a[220:223], v[104:107]
    buffer_load_dwordx4 v250, s[16:19], s41 offen offset:1024 nt lds
    v_mfma_f32_16x16x32_bf16 v[60:63], a[236:239], a[196:199], v[60:63]
    ds_read_b64_tr_b16 a[232:233], v240 offset:8192
    ds_read_b64_tr_b16 a[234:235], v240 offset:9216
    v_mfma_f32_16x16x32_bf16 v[68:71], a[236:239], a[200:203], v[68:71]
    v_mfma_f32_16x16x32_bf16 v[76:79], a[236:239], a[204:207], v[76:79]
    s_add_u32 s41, s43, 8192
    s_add_u32 m0, s29, 81920
    v_mfma_f32_16x16x32_bf16 v[84:87], a[236:239], a[208:211], v[84:87]
    buffer_load_dwordx4 v251, s[16:19], s41 offen offset:2048 nt lds
    v_mfma_f32_16x16x32_bf16 v[92:95], a[236:239], a[212:215], v[92:95]
    v_mfma_f32_16x16x32_bf16 v[100:103], a[236:239], a[216:219], v[100:103]
    v_mfma_f32_16x16x32_bf16 v[108:111], a[236:239], a[220:223], v[108:111]
    v_mfma_f32_16x16x32_bf16 v[112:115], a[240:243], a[196:199], v[112:115]
    ds_read_b64_tr_b16 a[236:237], v240 offset:8200
    ds_read_b64_tr_b16 a[238:239], v240 offset:9224
    v_mfma_f32_16x16x32_bf16 v[120:123], a[240:243], a[200:203], v[120:123]
    s_add_u32 s41, s43, 8192
    s_add_u32 m0, s29, 81920
    v_mfma_f32_16x16x32_bf16 v[128:131], a[240:243], a[204:207], v[128:131]
    buffer_load_dwordx4 v252, s[16:19], s41 offen offset:3072 nt lds
    v_mfma_f32_16x16x32_bf16 v[136:139], a[240:243], a[208:211], v[136:139]
    v_mfma_f32_16x16x32_bf16 v[144:147], a[240:243], a[212:215], v[144:147]
    v_mfma_f32_16x16x32_bf16 v[152:155], a[240:243], a[216:219], v[152:155]
    v_mfma_f32_16x16x32_bf16 v[160:163], a[240:243], a[220:223], v[160:163]
    v_mfma_f32_16x16x32_bf16 v[116:119], a[244:247], a[196:199], v[116:119]
    ds_read_b64_tr_b16 a[240:241], v241 offset:8192
    ds_read_b64_tr_b16 a[242:243], v241 offset:9216
    v_mfma_f32_16x16x32_bf16 v[124:127], a[244:247], a[200:203], v[124:127]
    v_mfma_f32_16x16x32_bf16 v[132:135], a[244:247], a[204:207], v[132:135]
    v_mfma_f32_16x16x32_bf16 v[140:143], a[244:247], a[208:211], v[140:143]
    v_mfma_f32_16x16x32_bf16 v[148:151], a[244:247], a[212:215], v[148:151]
    v_mfma_f32_16x16x32_bf16 v[156:159], a[244:247], a[216:219], v[156:159]
    v_mfma_f32_16x16x32_bf16 v[164:167], a[244:247], a[220:223], v[164:167]
    v_mfma_f32_16x16x32_bf16 v[168:171], a[248:251], a[196:199], v[168:171]
    ds_read_b64_tr_b16 a[244:245], v241 offset:8200
    ds_read_b64_tr_b16 a[246:247], v241 offset:9224
    v_mfma_f32_16x16x32_bf16 v[172:175], a[252:255], a[196:199], v[172:175]
    ds_read_b128 a[196:199], v245 offset:4096
    v_mfma_f32_16x16x32_bf16 v[176:179], a[248:251], a[200:203], v[176:179]
    v_mfma_f32_16x16x32_bf16 v[180:183], a[252:255], a[200:203], v[180:183]
    ds_read_b128 a[200:203], v245 offset:6144
    v_mfma_f32_16x16x32_bf16 v[184:187], a[248:251], a[204:207], v[184:187]
    v_mfma_f32_16x16x32_bf16 v[188:191], a[252:255], a[204:207], v[188:191]
    ds_read_b128 a[204:207], v245 offset:8192
    v_mfma_f32_16x16x32_bf16 v[192:195], a[248:251], a[208:211], v[192:195]
    v_mfma_f32_16x16x32_bf16 v[196:199], a[252:255], a[208:211], v[196:199]
    ds_read_b128 a[208:211], v245 offset:10240
    v_mfma_f32_16x16x32_bf16 v[200:203], a[248:251], a[212:215], v[200:203]
    v_mfma_f32_16x16x32_bf16 v[204:207], a[252:255], a[212:215], v[204:207]
    ds_read_b128 a[212:215], v245 offset:12288
    v_mfma_f32_16x16x32_bf16 v[208:211], a[248:251], a[216:219], v[208:211]
    v_mfma_f32_16x16x32_bf16 v[212:215], a[252:255], a[216:219], v[212:215]
    ds_read_b128 a[216:219], v245 offset:14336
    v_mfma_f32_16x16x32_bf16 v[216:219], a[248:251], a[220:223], v[216:219]
    v_mfma_f32_16x16x32_bf16 v[220:223], a[252:255], a[220:223], v[220:223]
    ds_read_b128 a[220:223], v245 offset:16384
    s_waitcnt lgkmcnt(6)
    v_mfma_f32_16x16x32_bf16 v[0:3], a[224:227], a[196:199], v[0:3]
    ds_read_b64_tr_b16 a[248:249], v242 offset:8192
    ds_read_b64_tr_b16 a[250:251], v242 offset:9216
    v_mfma_f32_16x16x32_bf16 v[4:7], a[228:231], a[196:199], v[4:7]
    ds_read_b64_tr_b16 a[252:253], v242 offset:8200
    ds_read_b64_tr_b16 a[254:255], v242 offset:9224
    s_waitcnt lgkmcnt(9)
    v_mfma_f32_16x16x32_bf16 v[8:11], a[224:227], a[200:203], v[8:11]
    v_mfma_f32_16x16x32_bf16 v[12:15], a[228:231], a[200:203], v[12:15]
    s_waitcnt lgkmcnt(8)
    v_mfma_f32_16x16x32_bf16 v[16:19], a[224:227], a[204:207], v[16:19]
    v_mfma_f32_16x16x32_bf16 v[20:23], a[228:231], a[204:207], v[20:23]
    s_waitcnt lgkmcnt(7)
    v_mfma_f32_16x16x32_bf16 v[24:27], a[224:227], a[208:211], v[24:27]
    v_mfma_f32_16x16x32_bf16 v[28:31], a[228:231], a[208:211], v[28:31]
    s_waitcnt lgkmcnt(6)
    v_mfma_f32_16x16x32_bf16 v[32:35], a[224:227], a[212:215], v[32:35]
    v_mfma_f32_16x16x32_bf16 v[36:39], a[228:231], a[212:215], v[36:39]
    s_waitcnt lgkmcnt(5)
    v_mfma_f32_16x16x32_bf16 v[40:43], a[224:227], a[216:219], v[40:43]
    v_mfma_f32_16x16x32_bf16 v[44:47], a[228:231], a[216:219], v[44:47]
    s_waitcnt lgkmcnt(4)
    v_mfma_f32_16x16x32_bf16 v[48:51], a[224:227], a[220:223], v[48:51]
    s_waitcnt vmcnt(16) lgkmcnt(0)
    s_barrier
    v_mfma_f32_16x16x32_bf16 v[52:55], a[228:231], a[220:223], v[52:55]
    ds_read_b64_tr_b16 a[224:225], v239 offset:16384
    ds_read_b64_tr_b16 a[226:227], v239 offset:17408
    v_mfma_f32_16x16x32_bf16 v[56:59], a[232:235], a[196:199], v[56:59]
    ds_read_b64_tr_b16 a[228:229], v239 offset:16392
    ds_read_b64_tr_b16 a[230:231], v239 offset:17416
    v_mfma_f32_16x16x32_bf16 v[64:67], a[232:235], a[200:203], v[64:67]
    s_add_u32 s41, s43, 8192
    s_add_u32 m0, s29, 0
    v_mfma_f32_16x16x32_bf16 v[72:75], a[232:235], a[204:207], v[72:75]
    buffer_load_dwordx4 v249, s[12:15], s41 offen offset:0 nt lds
    v_mfma_f32_16x16x32_bf16 v[80:83], a[232:235], a[208:211], v[80:83]
    v_mfma_f32_16x16x32_bf16 v[88:91], a[232:235], a[212:215], v[88:91]
    v_mfma_f32_16x16x32_bf16 v[96:99], a[232:235], a[216:219], v[96:99]
    s_add_u32 s41, s43, 8192
    s_add_u32 m0, s29, 0
    v_mfma_f32_16x16x32_bf16 v[104:107], a[232:235], a[220:223], v[104:107]
    buffer_load_dwordx4 v250, s[12:15], s41 offen offset:1024 nt lds
    v_mfma_f32_16x16x32_bf16 v[60:63], a[236:239], a[196:199], v[60:63]
    ds_read_b64_tr_b16 a[232:233], v240 offset:16384
    ds_read_b64_tr_b16 a[234:235], v240 offset:17408
    v_mfma_f32_16x16x32_bf16 v[68:71], a[236:239], a[200:203], v[68:71]
    v_mfma_f32_16x16x32_bf16 v[76:79], a[236:239], a[204:207], v[76:79]
    s_add_u32 s41, s43, 8192
    s_add_u32 m0, s29, 0
    v_mfma_f32_16x16x32_bf16 v[84:87], a[236:239], a[208:211], v[84:87]
    buffer_load_dwordx4 v251, s[12:15], s41 offen offset:2048 nt lds
    v_mfma_f32_16x16x32_bf16 v[92:95], a[236:239], a[212:215], v[92:95]
    v_mfma_f32_16x16x32_bf16 v[100:103], a[236:239], a[216:219], v[100:103]
    v_mfma_f32_16x16x32_bf16 v[108:111], a[236:239], a[220:223], v[108:111]
    v_mfma_f32_16x16x32_bf16 v[112:115], a[240:243], a[196:199], v[112:115]
    ds_read_b64_tr_b16 a[236:237], v240 offset:16392
    ds_read_b64_tr_b16 a[238:239], v240 offset:17416
    v_mfma_f32_16x16x32_bf16 v[120:123], a[240:243], a[200:203], v[120:123]
    s_add_u32 s41, s43, 8192
    s_add_u32 m0, s29, 0
    v_mfma_f32_16x16x32_bf16 v[128:131], a[240:243], a[204:207], v[128:131]
    buffer_load_dwordx4 v252, s[12:15], s41 offen offset:3072 nt lds
    v_mfma_f32_16x16x32_bf16 v[136:139], a[240:243], a[208:211], v[136:139]
    v_mfma_f32_16x16x32_bf16 v[144:147], a[240:243], a[212:215], v[144:147]
    v_mfma_f32_16x16x32_bf16 v[152:155], a[240:243], a[216:219], v[152:155]
    v_mfma_f32_16x16x32_bf16 v[160:163], a[240:243], a[220:223], v[160:163]
    v_mfma_f32_16x16x32_bf16 v[116:119], a[244:247], a[196:199], v[116:119]
    ds_read_b64_tr_b16 a[240:241], v241 offset:16384
    ds_read_b64_tr_b16 a[242:243], v241 offset:17408
    v_mfma_f32_16x16x32_bf16 v[124:127], a[244:247], a[200:203], v[124:127]
    v_mfma_f32_16x16x32_bf16 v[132:135], a[244:247], a[204:207], v[132:135]
    v_mfma_f32_16x16x32_bf16 v[140:143], a[244:247], a[208:211], v[140:143]
    v_mfma_f32_16x16x32_bf16 v[148:151], a[244:247], a[212:215], v[148:151]
    v_mfma_f32_16x16x32_bf16 v[156:159], a[244:247], a[216:219], v[156:159]
    v_mfma_f32_16x16x32_bf16 v[164:167], a[244:247], a[220:223], v[164:167]
Lpg4:
    s_cbranch_execz Lt15
    v_mfma_f32_16x16x32_bf16 v[168:171], a[248:251], a[196:199], v[168:171]
    ds_read_b64_tr_b16 a[244:245], v241 offset:16392
    ds_read_b64_tr_b16 a[246:247], v241 offset:17416
    v_mfma_f32_16x16x32_bf16 v[172:175], a[252:255], a[196:199], v[172:175]
    ds_read_b128 a[196:199], v238 offset:18432
    v_mfma_f32_16x16x32_bf16 v[176:179], a[248:251], a[200:203], v[176:179]
    v_mfma_f32_16x16x32_bf16 v[180:183], a[252:255], a[200:203], v[180:183]
    ds_read_b128 a[200:203], v238 offset:20480
    v_mfma_f32_16x16x32_bf16 v[184:187], a[248:251], a[204:207], v[184:187]
    v_mfma_f32_16x16x32_bf16 v[188:191], a[252:255], a[204:207], v[188:191]
    ds_read_b128 a[204:207], v238 offset:22528
    v_mfma_f32_16x16x32_bf16 v[192:195], a[248:251], a[208:211], v[192:195]
    v_mfma_f32_16x16x32_bf16 v[196:199], a[252:255], a[208:211], v[196:199]
    ds_read_b128 a[208:211], v238 offset:24576
    v_mfma_f32_16x16x32_bf16 v[200:203], a[248:251], a[212:215], v[200:203]
    s_waitcnt vmcnt(12)
    s_barrier
    v_mfma_f32_16x16x32_bf16 v[204:207], a[252:255], a[212:215], v[204:207]
    ds_read_b128 a[212:215], v238 offset:26624
    v_mfma_f32_16x16x32_bf16 v[208:211], a[248:251], a[216:219], v[208:211]
    v_mfma_f32_16x16x32_bf16 v[212:215], a[252:255], a[216:219], v[212:215]
    ds_read_b128 a[216:219], v238 offset:28672
    v_mfma_f32_16x16x32_bf16 v[216:219], a[248:251], a[220:223], v[216:219]
    v_mfma_f32_16x16x32_bf16 v[220:223], a[252:255], a[220:223], v[220:223]
    ds_read_b128 a[220:223], v238 offset:30720
    s_waitcnt lgkmcnt(6)
    v_mfma_f32_16x16x32_bf16 v[0:3], a[224:227], a[196:199], v[0:3]
    ds_read_b64_tr_b16 a[248:249], v242 offset:16384
    ds_read_b64_tr_b16 a[250:251], v242 offset:17408
    v_mfma_f32_16x16x32_bf16 v[4:7], a[228:231], a[196:199], v[4:7]
    ds_read_b64_tr_b16 a[252:253], v242 offset:16392
    ds_read_b64_tr_b16 a[254:255], v242 offset:17416
    s_waitcnt lgkmcnt(9)
    v_mfma_f32_16x16x32_bf16 v[8:11], a[224:227], a[200:203], v[8:11]
    v_mfma_f32_16x16x32_bf16 v[12:15], a[228:231], a[200:203], v[12:15]
    s_waitcnt lgkmcnt(8)
    v_mfma_f32_16x16x32_bf16 v[16:19], a[224:227], a[204:207], v[16:19]
    v_mfma_f32_16x16x32_bf16 v[20:23], a[228:231], a[204:207], v[20:23]
    s_waitcnt lgkmcnt(7)
    v_mfma_f32_16x16x32_bf16 v[24:27], a[224:227], a[208:211], v[24:27]
    v_mfma_f32_16x16x32_bf16 v[28:31], a[228:231], a[208:211], v[28:31]
    s_waitcnt lgkmcnt(6)
    v_mfma_f32_16x16x32_bf16 v[32:35], a[224:227], a[212:215], v[32:35]
    v_mfma_f32_16x16x32_bf16 v[36:39], a[228:231], a[212:215], v[36:39]
    s_waitcnt lgkmcnt(5)
    v_mfma_f32_16x16x32_bf16 v[40:43], a[224:227], a[216:219], v[40:43]
    v_mfma_f32_16x16x32_bf16 v[44:47], a[228:231], a[216:219], v[44:47]
    s_waitcnt lgkmcnt(4)
    v_mfma_f32_16x16x32_bf16 v[48:51], a[224:227], a[220:223], v[48:51]
    s_waitcnt vmcnt(15) lgkmcnt(0)
    s_barrier
    v_mfma_f32_16x16x32_bf16 v[52:55], a[228:231], a[220:223], v[52:55]
    ds_read_b64_tr_b16 a[224:225], v239 offset:24576
    ds_read_b64_tr_b16 a[226:227], v239 offset:25600
    v_mfma_f32_16x16x32_bf16 v[56:59], a[232:235], a[196:199], v[56:59]
    ds_read_b64_tr_b16 a[228:229], v239 offset:24584
    ds_read_b64_tr_b16 a[230:231], v239 offset:25608
    v_mfma_f32_16x16x32_bf16 v[64:67], a[232:235], a[200:203], v[64:67]
    s_add_u32 s41, s43, 16384
    s_add_u32 m0, s29, 90112
    v_mfma_f32_16x16x32_bf16 v[72:75], a[232:235], a[204:207], v[72:75]
    buffer_load_dwordx4 v249, s[16:19], s41 offen offset:0 nt lds
    v_mfma_f32_16x16x32_bf16 v[80:83], a[232:235], a[208:211], v[80:83]
    v_mfma_f32_16x16x32_bf16 v[88:91], a[232:235], a[212:215], v[88:91]
    v_mfma_f32_16x16x32_bf16 v[96:99], a[232:235], a[216:219], v[96:99]
    s_add_u32 s41, s43, 16384
    s_add_u32 m0, s29, 90112
    v_mfma_f32_16x16x32_bf16 v[104:107], a[232:235], a[220:223], v[104:107]
    buffer_load_dwordx4 v250, s[16:19], s41 offen offset:1024 nt lds
    v_mfma_f32_16x16x32_bf16 v[60:63], a[236:239], a[196:199], v[60:63]
    ds_read_b64_tr_b16 a[232:233], v240 offset:24576
    ds_read_b64_tr_b16 a[234:235], v240 offset:25600
    v_mfma_f32_16x16x32_bf16 v[68:71], a[236:239], a[200:203], v[68:71]
    v_mfma_f32_16x16x32_bf16 v[76:79], a[236:239], a[204:207], v[76:79]
    s_add_u32 s41, s43, 16384
    s_add_u32 m0, s29, 90112
    v_mfma_f32_16x16x32_bf16 v[84:87], a[236:239], a[208:211], v[84:87]
    buffer_load_dwordx4 v251, s[16:19], s41 offen offset:2048 nt lds
    v_mfma_f32_16x16x32_bf16 v[92:95], a[236:239], a[212:215], v[92:95]
    v_mfma_f32_16x16x32_bf16 v[100:103], a[236:239], a[216:219], v[100:103]
    v_mfma_f32_16x16x32_bf16 v[108:111], a[236:239], a[220:223], v[108:111]
    v_mfma_f32_16x16x32_bf16 v[112:115], a[240:243], a[196:199], v[112:115]
    ds_read_b64_tr_b16 a[236:237], v240 offset:24584
    ds_read_b64_tr_b16 a[238:239], v240 offset:25608
    v_mfma_f32_16x16x32_bf16 v[120:123], a[240:243], a[200:203], v[120:123]
    s_add_u32 s41, s43, 16384
    s_add_u32 m0, s29, 90112
    v_mfma_f32_16x16x32_bf16 v[128:131], a[240:243], a[204:207], v[128:131]
    buffer_load_dwordx4 v252, s[16:19], s41 offen offset:3072 nt lds
    v_mfma_f32_16x16x32_bf16 v[136:139], a[240:243], a[208:211], v[136:139]
    v_mfma_f32_16x16x32_bf16 v[144:147], a[240:243], a[212:215], v[144:147]
    v_mfma_f32_16x16x32_bf16 v[152:155], a[240:243], a[216:219], v[152:155]
    v_mfma_f32_16x16x32_bf16 v[160:163], a[240:243], a[220:223], v[160:163]
    v_mfma_f32_16x16x32_bf16 v[116:119], a[244:247], a[196:199], v[116:119]
    ds_read_b64_tr_b16 a[240:241], v241 offset:24576
    ds_read_b64_tr_b16 a[242:243], v241 offset:25600
    v_mfma_f32_16x16x32_bf16 v[124:127], a[244:247], a[200:203], v[124:127]
    v_mfma_f32_16x16x32_bf16 v[132:135], a[244:247], a[204:207], v[132:135]
    v_mfma_f32_16x16x32_bf16 v[140:143], a[244:247], a[208:211], v[140:143]
    v_mfma_f32_16x16x32_bf16 v[148:151], a[244:247], a[212:215], v[148:151]
    v_mfma_f32_16x16x32_bf16 v[156:159], a[244:247], a[216:219], v[156:159]
    v_mfma_f32_16x16x32_bf16 v[164:167], a[244:247], a[220:223], v[164:167]
    v_mfma_f32_16x16x32_bf16 v[168:171], a[248:251], a[196:199], v[168:171]
    ds_read_b64_tr_b16 a[244:245], v241 offset:24584
    ds_read_b64_tr_b16 a[246:247], v241 offset:25608
    v_mfma_f32_16x16x32_bf16 v[172:175], a[252:255], a[196:199], v[172:175]
    ds_read_b128 a[196:199], v245 offset:18432
    v_mfma_f32_16x16x32_bf16 v[176:179], a[248:251], a[200:203], v[176:179]
    v_mfma_f32_16x16x32_bf16 v[180:183], a[252:255], a[200:203], v[180:183]
    ds_read_b128 a[200:203], v245 offset:20480
    v_mfma_f32_16x16x32_bf16 v[184:187], a[248:251], a[204:207], v[184:187]
    v_mfma_f32_16x16x32_bf16 v[188:191], a[252:255], a[204:207], v[188:191]
    ds_read_b128 a[204:207], v245 offset:22528
    v_mfma_f32_16x16x32_bf16 v[192:195], a[248:251], a[208:211], v[192:195]
    v_mfma_f32_16x16x32_bf16 v[196:199], a[252:255], a[208:211], v[196:199]
    ds_read_b128 a[208:211], v245 offset:24576
    v_mfma_f32_16x16x32_bf16 v[200:203], a[248:251], a[212:215], v[200:203]
    v_mfma_f32_16x16x32_bf16 v[204:207], a[252:255], a[212:215], v[204:207]
    ds_read_b128 a[212:215], v245 offset:26624
    v_mfma_f32_16x16x32_bf16 v[208:211], a[248:251], a[216:219], v[208:211]
    v_mfma_f32_16x16x32_bf16 v[212:215], a[252:255], a[216:219], v[212:215]
    ds_read_b128 a[216:219], v245 offset:28672
    v_mfma_f32_16x16x32_bf16 v[216:219], a[248:251], a[220:223], v[216:219]
    v_mfma_f32_16x16x32_bf16 v[220:223], a[252:255], a[220:223], v[220:223]
    ds_read_b128 a[220:223], v245 offset:30720
    s_waitcnt lgkmcnt(6)
    v_mfma_f32_16x16x32_bf16 v[0:3], a[224:227], a[196:199], v[0:3]
    ds_read_b64_tr_b16 a[248:249], v242 offset:24576
    ds_read_b64_tr_b16 a[250:251], v242 offset:25600
    v_mfma_f32_16x16x32_bf16 v[4:7], a[228:231], a[196:199], v[4:7]
    ds_read_b64_tr_b16 a[252:253], v242 offset:24584
    ds_read_b64_tr_b16 a[254:255], v242 offset:25608
    s_waitcnt lgkmcnt(9)
    v_mfma_f32_16x16x32_bf16 v[8:11], a[224:227], a[200:203], v[8:11]
    v_mfma_f32_16x16x32_bf16 v[12:15], a[228:231], a[200:203], v[12:15]
    s_waitcnt lgkmcnt(8)
    v_mfma_f32_16x16x32_bf16 v[16:19], a[224:227], a[204:207], v[16:19]
    v_mfma_f32_16x16x32_bf16 v[20:23], a[228:231], a[204:207], v[20:23]
    s_waitcnt lgkmcnt(7)
    v_mfma_f32_16x16x32_bf16 v[24:27], a[224:227], a[208:211], v[24:27]
    v_mfma_f32_16x16x32_bf16 v[28:31], a[228:231], a[208:211], v[28:31]
    s_waitcnt lgkmcnt(6)
    v_mfma_f32_16x16x32_bf16 v[32:35], a[224:227], a[212:215], v[32:35]
    v_mfma_f32_16x16x32_bf16 v[36:39], a[228:231], a[212:215], v[36:39]
    s_waitcnt lgkmcnt(5)
    v_mfma_f32_16x16x32_bf16 v[40:43], a[224:227], a[216:219], v[40:43]
    v_mfma_f32_16x16x32_bf16 v[44:47], a[228:231], a[216:219], v[44:47]
    s_waitcnt lgkmcnt(4)
    v_mfma_f32_16x16x32_bf16 v[48:51], a[224:227], a[220:223], v[48:51]
    s_waitcnt vmcnt(12) lgkmcnt(0)
    s_barrier
    v_mfma_f32_16x16x32_bf16 v[52:55], a[228:231], a[220:223], v[52:55]
    v_mfma_f32_16x16x32_bf16 v[56:59], a[232:235], a[196:199], v[56:59]
    s_waitcnt vmcnt(23)
    v_mfma_f32_16x16x32_bf16 v[64:67], a[232:235], a[200:203], v[64:67]
    ds_write_b128 v236, a[0:3] offset:16384
    s_add_u32 s41, s43, 16384
    s_add_u32 m0, s29, 8192
    v_mfma_f32_16x16x32_bf16 v[72:75], a[232:235], a[204:207], v[72:75]
    buffer_load_dwordx4 v249, s[12:15], s41 offen offset:0 nt lds
    v_mfma_f32_16x16x32_bf16 v[80:83], a[232:235], a[208:211], v[80:83]
    ds_write_b128 v236, a[4:7] offset:17408
    v_mfma_f32_16x16x32_bf16 v[88:91], a[232:235], a[212:215], v[88:91]
    v_mfma_f32_16x16x32_bf16 v[96:99], a[232:235], a[216:219], v[96:99]
    ds_write_b128 v236, a[8:11] offset:18432
    s_add_u32 s41, s43, 16384
    s_add_u32 m0, s29, 8192
    v_mfma_f32_16x16x32_bf16 v[104:107], a[232:235], a[220:223], v[104:107]
    buffer_load_dwordx4 v250, s[12:15], s41 offen offset:1024 nt lds
    v_mfma_f32_16x16x32_bf16 v[60:63], a[236:239], a[196:199], v[60:63]
    v_mfma_f32_16x16x32_bf16 v[68:71], a[236:239], a[200:203], v[68:71]
    v_mfma_f32_16x16x32_bf16 v[76:79], a[236:239], a[204:207], v[76:79]
    ds_write_b128 v236, a[12:15] offset:19456
    s_add_u32 s41, s43, 16384
    s_add_u32 m0, s29, 8192
    v_mfma_f32_16x16x32_bf16 v[84:87], a[236:239], a[208:211], v[84:87]
    buffer_load_dwordx4 v251, s[12:15], s41 offen offset:2048 nt lds
    v_mfma_f32_16x16x32_bf16 v[92:95], a[236:239], a[212:215], v[92:95]
    ds_write_b128 v236, a[16:19] offset:24576
    v_mfma_f32_16x16x32_bf16 v[100:103], a[236:239], a[216:219], v[100:103]
    v_mfma_f32_16x16x32_bf16 v[108:111], a[236:239], a[220:223], v[108:111]
    ds_write_b128 v236, a[20:23] offset:25600
    v_mfma_f32_16x16x32_bf16 v[112:115], a[240:243], a[196:199], v[112:115]
    v_mfma_f32_16x16x32_bf16 v[120:123], a[240:243], a[200:203], v[120:123]
    s_add_u32 s41, s43, 16384
    s_add_u32 m0, s29, 8192
    v_mfma_f32_16x16x32_bf16 v[128:131], a[240:243], a[204:207], v[128:131]
    ds_write_b128 v236, a[24:27] offset:26624
    buffer_load_dwordx4 v252, s[12:15], s41 offen offset:3072 nt lds
    v_mfma_f32_16x16x32_bf16 v[136:139], a[240:243], a[208:211], v[136:139]
    v_mfma_f32_16x16x32_bf16 v[144:147], a[240:243], a[212:215], v[144:147]
    ds_write_b128 v236, a[28:31] offset:27648
    v_mfma_f32_16x16x32_bf16 v[152:155], a[240:243], a[216:219], v[152:155]
    v_mfma_f32_16x16x32_bf16 v[160:163], a[240:243], a[220:223], v[160:163]
    ds_write_b128 v237, a[32:35] offset:24576
    v_mfma_f32_16x16x32_bf16 v[116:119], a[244:247], a[196:199], v[116:119]
    v_mfma_f32_16x16x32_bf16 v[124:127], a[244:247], a[200:203], v[124:127]
    v_mfma_f32_16x16x32_bf16 v[132:135], a[244:247], a[204:207], v[132:135]
    ds_write_b128 v237, a[36:39] offset:25600
    v_mfma_f32_16x16x32_bf16 v[140:143], a[244:247], a[208:211], v[140:143]
    v_mfma_f32_16x16x32_bf16 v[148:151], a[244:247], a[212:215], v[148:151]
    ds_write_b128 v237, a[40:43] offset:26624
    v_mfma_f32_16x16x32_bf16 v[156:159], a[244:247], a[216:219], v[156:159]
    v_mfma_f32_16x16x32_bf16 v[164:167], a[244:247], a[220:223], v[164:167]
    ds_write_b128 v237, a[44:47] offset:27648
    v_mfma_f32_16x16x32_bf16 v[168:171], a[248:251], a[196:199], v[168:171]
    v_mfma_f32_16x16x32_bf16 v[172:175], a[252:255], a[196:199], v[172:175]
    v_mfma_f32_16x16x32_bf16 v[176:179], a[248:251], a[200:203], v[176:179]
    v_mfma_f32_16x16x32_bf16 v[180:183], a[252:255], a[200:203], v[180:183]
    v_mfma_f32_16x16x32_bf16 v[184:187], a[248:251], a[204:207], v[184:187]
    v_mfma_f32_16x16x32_bf16 v[188:191], a[252:255], a[204:207], v[188:191]
    v_mfma_f32_16x16x32_bf16 v[192:195], a[248:251], a[208:211], v[192:195]
    v_mfma_f32_16x16x32_bf16 v[196:199], a[252:255], a[208:211], v[196:199]
    v_mfma_f32_16x16x32_bf16 v[200:203], a[248:251], a[212:215], v[200:203]
    v_mfma_f32_16x16x32_bf16 v[204:207], a[252:255], a[212:215], v[204:207]
    v_mfma_f32_16x16x32_bf16 v[208:211], a[248:251], a[216:219], v[208:211]
    v_mfma_f32_16x16x32_bf16 v[212:215], a[252:255], a[216:219], v[212:215]
    v_mfma_f32_16x16x32_bf16 v[216:219], a[248:251], a[220:223], v[216:219]
    v_mfma_f32_16x16x32_bf16 v[220:223], a[252:255], a[220:223], v[220:223]
    s_mov_b32 s46, 0x3e0293ee
    s_mov_b32 s47, 0x3e0293ee
    s_nop 5
    ds_read_b128 a[224:227], v224 offset:32768
    ds_read_b128 a[228:231], v225 offset:32768
    ds_read_b128 a[232:235], v226 offset:32768
    ds_read_b128 a[236:239], v227 offset:32768
    ds_read_b128 a[240:243], v224 offset:36864
    ds_read_b128 a[244:247], v225 offset:36864
    ds_read_b128 a[248:251], v226 offset:36864
    ds_read_b128 a[252:255], v227 offset:36864
    s_add_u32 s41, s43, 24576
    s_add_u32 m0, s29, 98304
    s_nop 0
    buffer_load_dwordx4 v249, s[16:19], s41 offen offset:0 nt lds
    v_pk_mul_f32 v[0:1], v[0:1], s[46:47]
    v_pk_mul_f32 v[2:3], v[2:3], s[46:47]
    v_pk_mul_f32 v[4:5], v[4:5], s[46:47]
    v_pk_mul_f32 v[6:7], v[6:7], s[46:47]
    v_cvt_pk_bf16_f32 v0, v0, v1
    v_cvt_pk_bf16_f32 v1, v2, v3
    v_cvt_pk_bf16_f32 v2, v4, v5
    v_cvt_pk_bf16_f32 v3, v6, v7
    v_pk_mul_f32 v[8:9], v[8:9], s[46:47]
    v_pk_mul_f32 v[10:11], v[10:11], s[46:47]
    v_pk_mul_f32 v[12:13], v[12:13], s[46:47]
    v_pk_mul_f32 v[14:15], v[14:15], s[46:47]
    v_cvt_pk_bf16_f32 v4, v8, v9
    v_cvt_pk_bf16_f32 v5, v10, v11
    v_cvt_pk_bf16_f32 v6, v12, v13
    v_cvt_pk_bf16_f32 v7, v14, v15
    v_pk_mul_f32 v[16:17], v[16:17], s[46:47]
    v_pk_mul_f32 v[18:19], v[18:19], s[46:47]
    v_pk_mul_f32 v[20:21], v[20:21], s[46:47]
    v_pk_mul_f32 v[22:23], v[22:23], s[46:47]
    v_cvt_pk_bf16_f32 v8, v16, v17
    v_cvt_pk_bf16_f32 v9, v18, v19
    v_cvt_pk_bf16_f32 v10, v20, v21
    v_cvt_pk_bf16_f32 v11, v22, v23
    v_pk_mul_f32 v[24:25], v[24:25], s[46:47]
    v_pk_mul_f32 v[26:27], v[26:27], s[46:47]
    v_pk_mul_f32 v[28:29], v[28:29], s[46:47]
    v_pk_mul_f32 v[30:31], v[30:31], s[46:47]
    v_cvt_pk_bf16_f32 v12, v24, v25
    v_cvt_pk_bf16_f32 v13, v26, v27
    v_cvt_pk_bf16_f32 v14, v28, v29
    v_cvt_pk_bf16_f32 v15, v30, v31
    v_pk_mul_f32 v[32:33], v[32:33], s[46:47]
    v_pk_mul_f32 v[34:35], v[34:35], s[46:47]
    v_pk_mul_f32 v[36:37], v[36:37], s[46:47]
    v_pk_mul_f32 v[38:39], v[38:39], s[46:47]
    v_cvt_pk_bf16_f32 v16, v32, v33
    v_cvt_pk_bf16_f32 v17, v34, v35
    v_cvt_pk_bf16_f32 v18, v36, v37
    v_cvt_pk_bf16_f32 v19, v38, v39
    v_pk_mul_f32 v[40:41], v[40:41], s[46:47]
    v_pk_mul_f32 v[42:43], v[42:43], s[46:47]
    v_pk_mul_f32 v[44:45], v[44:45], s[46:47]
    v_pk_mul_f32 v[46:47], v[46:47], s[46:47]
    v_cvt_pk_bf16_f32 v20, v40, v41
    v_cvt_pk_bf16_f32 v21, v42, v43
    v_cvt_pk_bf16_f32 v22, v44, v45
    v_cvt_pk_bf16_f32 v23, v46, v47
    v_pk_mul_f32 v[48:49], v[48:49], s[46:47]
    v_pk_mul_f32 v[50:51], v[50:51], s[46:47]
    v_pk_mul_f32 v[52:53], v[52:53], s[46:47]
    v_pk_mul_f32 v[54:55], v[54:55], s[46:47]
    v_cvt_pk_bf16_f32 v24, v48, v49
    v_cvt_pk_bf16_f32 v25, v50, v51
    v_cvt_pk_bf16_f32 v26, v52, v53
    v_cvt_pk_bf16_f32 v27, v54, v55
    s_add_u32 s41, s43, 24576
    s_add_u32 m0, s29, 98304
    s_nop 0
    buffer_load_dwordx4 v250, s[16:19], s41 offen offset:1024 nt lds
    v_pk_mul_f32 v[56:57], v[56:57], s[46:47]
    v_pk_mul_f32 v[58:59], v[58:59], s[46:47]
    v_pk_mul_f32 v[60:61], v[60:61], s[46:47]
    v_pk_mul_f32 v[62:63], v[62:63], s[46:47]
    v_cvt_pk_bf16_f32 v28, v56, v57
    v_cvt_pk_bf16_f32 v29, v58, v59
    v_cvt_pk_bf16_f32 v30, v60, v61
    v_cvt_pk_bf16_f32 v31, v62, v63
    v_pk_mul_f32 v[64:65], v[64:65], s[46:47]
    v_pk_mul_f32 v[66:67], v[66:67], s[46:47]
    v_pk_mul_f32 v[68:69], v[68:69], s[46:47]
    v_pk_mul_f32 v[70:71], v[70:71], s[46:47]
    v_cvt_pk_bf16_f32 v32, v64, v65
    v_cvt_pk_bf16_f32 v33, v66, v67
    v_cvt_pk_bf16_f32 v34, v68, v69
    v_cvt_pk_bf16_f32 v35, v70, v71
    v_pk_mul_f32 v[72:73], v[72:73], s[46:47]
    v_pk_mul_f32 v[74:75], v[74:75], s[46:47]
    v_pk_mul_f32 v[76:77], v[76:77], s[46:47]
    v_pk_mul_f32 v[78:79], v[78:79], s[46:47]
    v_cvt_pk_bf16_f32 v36, v72, v73
    v_cvt_pk_bf16_f32 v37, v74, v75
    v_cvt_pk_bf16_f32 v38, v76, v77
    v_cvt_pk_bf16_f32 v39, v78, v79
    v_pk_mul_f32 v[80:81], v[80:81], s[46:47]
    v_pk_mul_f32 v[82:83], v[82:83], s[46:47]
    v_pk_mul_f32 v[84:85], v[84:85], s[46:47]
    v_pk_mul_f32 v[86:87], v[86:87], s[46:47]
    v_cvt_pk_bf16_f32 v40, v80, v81
    v_cvt_pk_bf16_f32 v41, v82, v83
    v_cvt_pk_bf16_f32 v42, v84, v85
    v_cvt_pk_bf16_f32 v43, v86, v87
    v_pk_mul_f32 v[88:89], v[88:89], s[46:47]
    v_pk_mul_f32 v[90:91], v[90:91], s[46:47]
    v_pk_mul_f32 v[92:93], v[92:93], s[46:47]
    v_pk_mul_f32 v[94:95], v[94:95], s[46:47]
    v_cvt_pk_bf16_f32 v44, v88, v89
    v_cvt_pk_bf16_f32 v45, v90, v91
    v_cvt_pk_bf16_f32 v46, v92, v93
    v_cvt_pk_bf16_f32 v47, v94, v95
    v_pk_mul_f32 v[96:97], v[96:97], s[46:47]
    v_pk_mul_f32 v[98:99], v[98:99], s[46:47]
    v_pk_mul_f32 v[100:101], v[100:101], s[46:47]
    v_pk_mul_f32 v[102:103], v[102:103], s[46:47]
    v_cvt_pk_bf16_f32 v48, v96, v97
    v_cvt_pk_bf16_f32 v49, v98, v99
    v_cvt_pk_bf16_f32 v50, v100, v101
    v_cvt_pk_bf16_f32 v51, v102, v103
    v_pk_mul_f32 v[104:105], v[104:105], s[46:47]
    v_pk_mul_f32 v[106:107], v[106:107], s[46:47]
    v_pk_mul_f32 v[108:109], v[108:109], s[46:47]
    v_pk_mul_f32 v[110:111], v[110:111], s[46:47]
    v_cvt_pk_bf16_f32 v52, v104, v105
    v_cvt_pk_bf16_f32 v53, v106, v107
    v_cvt_pk_bf16_f32 v54, v108, v109
    v_cvt_pk_bf16_f32 v55, v110, v111
    s_add_u32 s41, s43, 24576
    s_add_u32 m0, s29, 98304
    s_nop 0
    buffer_load_dwordx4 v251, s[16:19], s41 offen offset:2048 nt lds
    v_pk_mul_f32 v[112:113], v[112:113], s[46:47]
    v_pk_mul_f32 v[114:115], v[114:115], s[46:47]
    v_pk_mul_f32 v[116:117], v[116:117], s[46:47]
    v_pk_mul_f32 v[118:119], v[118:119], s[46:47]
    v_cvt_pk_bf16_f32 v56, v112, v113
    v_cvt_pk_bf16_f32 v57, v114, v115
    v_cvt_pk_bf16_f32 v58, v116, v117
    v_cvt_pk_bf16_f32 v59, v118, v119
    v_pk_mul_f32 v[120:121], v[120:121], s[46:47]
    v_pk_mul_f32 v[122:123], v[122:123], s[46:47]
    v_pk_mul_f32 v[124:125], v[124:125], s[46:47]
    v_pk_mul_f32 v[126:127], v[126:127], s[46:47]
    v_cvt_pk_bf16_f32 v60, v120, v121
    v_cvt_pk_bf16_f32 v61, v122, v123
    v_cvt_pk_bf16_f32 v62, v124, v125
    v_cvt_pk_bf16_f32 v63, v126, v127
    v_pk_mul_f32 v[128:129], v[128:129], s[46:47]
    v_pk_mul_f32 v[130:131], v[130:131], s[46:47]
    v_pk_mul_f32 v[132:133], v[132:133], s[46:47]
    v_pk_mul_f32 v[134:135], v[134:135], s[46:47]
    v_cvt_pk_bf16_f32 v64, v128, v129
    v_cvt_pk_bf16_f32 v65, v130, v131
    v_cvt_pk_bf16_f32 v66, v132, v133
    v_cvt_pk_bf16_f32 v67, v134, v135
    v_pk_mul_f32 v[136:137], v[136:137], s[46:47]
    v_pk_mul_f32 v[138:139], v[138:139], s[46:47]
    v_pk_mul_f32 v[140:141], v[140:141], s[46:47]
    v_pk_mul_f32 v[142:143], v[142:143], s[46:47]
    v_cvt_pk_bf16_f32 v68, v136, v137
    v_cvt_pk_bf16_f32 v69, v138, v139
    v_cvt_pk_bf16_f32 v70, v140, v141
    v_cvt_pk_bf16_f32 v71, v142, v143
    v_pk_mul_f32 v[144:145], v[144:145], s[46:47]
    v_pk_mul_f32 v[146:147], v[146:147], s[46:47]
    v_pk_mul_f32 v[148:149], v[148:149], s[46:47]
    v_pk_mul_f32 v[150:151], v[150:151], s[46:47]
    v_cvt_pk_bf16_f32 v72, v144, v145
    v_cvt_pk_bf16_f32 v73, v146, v147
    v_cvt_pk_bf16_f32 v74, v148, v149
    v_cvt_pk_bf16_f32 v75, v150, v151
    v_pk_mul_f32 v[152:153], v[152:153], s[46:47]
    v_pk_mul_f32 v[154:155], v[154:155], s[46:47]
    v_pk_mul_f32 v[156:157], v[156:157], s[46:47]
    v_pk_mul_f32 v[158:159], v[158:159], s[46:47]
    v_cvt_pk_bf16_f32 v76, v152, v153
    v_cvt_pk_bf16_f32 v77, v154, v155
    v_cvt_pk_bf16_f32 v78, v156, v157
    v_cvt_pk_bf16_f32 v79, v158, v159
    v_pk_mul_f32 v[160:161], v[160:161], s[46:47]
    v_pk_mul_f32 v[162:163], v[162:163], s[46:47]
    v_pk_mul_f32 v[164:165], v[164:165], s[46:47]
    v_pk_mul_f32 v[166:167], v[166:167], s[46:47]
    v_cvt_pk_bf16_f32 v80, v160, v161
    v_cvt_pk_bf16_f32 v81, v162, v163
    v_cvt_pk_bf16_f32 v82, v164, v165
    v_cvt_pk_bf16_f32 v83, v166, v167
    s_add_u32 s41, s43, 24576
    s_add_u32 m0, s29, 98304
    s_nop 0
    buffer_load_dwordx4 v252, s[16:19], s41 offen offset:3072 nt lds
    v_pk_mul_f32 v[168:169], v[168:169], s[46:47]
    v_pk_mul_f32 v[170:171], v[170:171], s[46:47]
    v_pk_mul_f32 v[172:173], v[172:173], s[46:47]
    v_pk_mul_f32 v[174:175], v[174:175], s[46:47]
    v_cvt_pk_bf16_f32 v84, v168, v169
    v_cvt_pk_bf16_f32 v85, v170, v171
    v_cvt_pk_bf16_f32 v86, v172, v173
    v_cvt_pk_bf16_f32 v87, v174, v175
    v_pk_mul_f32 v[176:177], v[176:177], s[46:47]
    v_pk_mul_f32 v[178:179], v[178:179], s[46:47]
    v_pk_mul_f32 v[180:181], v[180:181], s[46:47]
    v_pk_mul_f32 v[182:183], v[182:183], s[46:47]
    v_cvt_pk_bf16_f32 v88, v176, v177
    v_cvt_pk_bf16_f32 v89, v178, v179
    v_cvt_pk_bf16_f32 v90, v180, v181
    v_cvt_pk_bf16_f32 v91, v182, v183
    v_pk_mul_f32 v[184:185], v[184:185], s[46:47]
    v_pk_mul_f32 v[186:187], v[186:187], s[46:47]
    v_pk_mul_f32 v[188:189], v[188:189], s[46:47]
    v_pk_mul_f32 v[190:191], v[190:191], s[46:47]
    v_cvt_pk_bf16_f32 v92, v184, v185
    v_cvt_pk_bf16_f32 v93, v186, v187
    v_cvt_pk_bf16_f32 v94, v188, v189
    v_cvt_pk_bf16_f32 v95, v190, v191
    v_pk_mul_f32 v[192:193], v[192:193], s[46:47]
    v_pk_mul_f32 v[194:195], v[194:195], s[46:47]
    v_pk_mul_f32 v[196:197], v[196:197], s[46:47]
    v_pk_mul_f32 v[198:199], v[198:199], s[46:47]
    v_cvt_pk_bf16_f32 v96, v192, v193
    v_cvt_pk_bf16_f32 v97, v194, v195
    v_cvt_pk_bf16_f32 v98, v196, v197
    v_cvt_pk_bf16_f32 v99, v198, v199
    v_pk_mul_f32 v[200:201], v[200:201], s[46:47]
    v_pk_mul_f32 v[202:203], v[202:203], s[46:47]
    v_pk_mul_f32 v[204:205], v[204:205], s[46:47]
    v_pk_mul_f32 v[206:207], v[206:207], s[46:47]
    v_cvt_pk_bf16_f32 v100, v200, v201
    v_cvt_pk_bf16_f32 v101, v202, v203
    v_cvt_pk_bf16_f32 v102, v204, v205
    v_cvt_pk_bf16_f32 v103, v206, v207
    v_pk_mul_f32 v[208:209], v[208:209], s[46:47]
    v_pk_mul_f32 v[210:211], v[210:211], s[46:47]
    v_pk_mul_f32 v[212:213], v[212:213], s[46:47]
    v_pk_mul_f32 v[214:215], v[214:215], s[46:47]
    v_cvt_pk_bf16_f32 v104, v208, v209
    v_cvt_pk_bf16_f32 v105, v210, v211
    v_cvt_pk_bf16_f32 v106, v212, v213
    v_cvt_pk_bf16_f32 v107, v214, v215
    v_pk_mul_f32 v[216:217], v[216:217], s[46:47]
    v_pk_mul_f32 v[218:219], v[218:219], s[46:47]
    v_pk_mul_f32 v[220:221], v[220:221], s[46:47]
    v_pk_mul_f32 v[222:223], v[222:223], s[46:47]
    v_cvt_pk_bf16_f32 v108, v216, v217
    v_cvt_pk_bf16_f32 v109, v218, v219
    v_cvt_pk_bf16_f32 v110, v220, v221
    v_cvt_pk_bf16_f32 v111, v222, v223
    v_mov_b32 v200, 0
    v_mov_b32 v201, 0
    v_mov_b32 v202, 0
    v_mov_b32 v203, 0
    v_mov_b32 v204, 0
    v_mov_b32 v205, 0
    v_mov_b32 v206, 0
    s_cmp_eq_u32 s34, 1
    s_cselect_b32 s26, 0, s26
    s_waitcnt lgkmcnt(0)
    v_mfma_f32_16x16x32_bf16 v[112:115], a[224:227], v[0:3], 0
    ds_read_b64_tr_b16 v[168:169], v228 offset:32768
    ds_read_b64_tr_b16 v[170:171], v228 offset:36864
    v_lshrrev_b32 v207, 4, v247
    v_lshlrev_b32 v207, 10, v207
    v_mfma_f32_16x16x32_bf16 v[112:115], a[228:231], v[28:31], v[112:115]
    ds_read_b64_tr_b16 v[172:173], v229 offset:32768
    ds_read_b64_tr_b16 v[174:175], v229 offset:36864
    v_add_u32 v208, v249, v207
    v_add_u32 v207, 4096, v207
    v_mfma_f32_16x16x32_bf16 v[112:115], a[232:235], v[56:59], v[112:115]
    ds_read_b64_tr_b16 v[176:177], v230 offset:32768
    ds_read_b64_tr_b16 v[178:179], v230 offset:36864
    v_add_u32 v209, v250, v207
    v_add_u32 v207, 4096, v207
    v_mfma_f32_16x16x32_bf16 v[112:115], a[236:239], v[84:87], v[112:115]
    ds_read_b64_tr_b16 v[180:181], v231 offset:32768
    ds_read_b64_tr_b16 v[182:183], v231 offset:36864
    v_add_u32 v210, v249, v207
    v_add_u32 v207, 4096, v207
    v_mfma_f32_16x16x32_bf16 v[116:119], a[240:243], v[0:3], 0
    ds_read_b64_tr_b16 v[184:185], v232 offset:32768
    ds_read_b64_tr_b16 v[186:187], v232 offset:36864
    v_add_u32 v211, v250, v207
    v_mfma_f32_16x16x32_bf16 v[116:119], a[244:247], v[28:31], v[116:119]
    ds_read_b64_tr_b16 v[188:189], v233 offset:32768
    ds_read_b64_tr_b16 v[190:191], v233 offset:36864
    v_lshl_add_u32 v207, s28, 6, v247
    v_min_u32 v207, 1, v207
    v_mfma_f32_16x16x32_bf16 v[116:119], a[248:251], v[56:59], v[116:119]
    ds_read_b64_tr_b16 v[192:193], v234 offset:32768
    ds_read_b64_tr_b16 v[194:195], v234 offset:36864
    v_min_u32 v245, 39, v247
    v_lshlrev_b32 v245, 7, v245
    v_mfma_f32_16x16x32_bf16 v[116:119], a[252:255], v[84:87], v[116:119]
    ds_read_b64_tr_b16 v[196:197], v235 offset:32768
    ds_read_b64_tr_b16 v[198:199], v235 offset:36864
    v_lshlrev_b32 v207, 28, v207
    v_or_b32 v219, s36, v207
    v_or_b32 v217, s62, v207
    v_mov_b32 v216, 0
    v_mov_b32 v218, 1
    v_and_b32 v214, 7, v247
    v_lshl_add_u32 v214, v214, 4, s63
    v_min_u32 v213, 1, v247
    v_lshlrev_b32 v213, 28, v213
    v_or_b32 v213, s51, v213
    v_mfma_f32_16x16x32_bf16 v[120:123], a[224:227], v[4:7], 0
    v_exp_f32 v112, v112
    v_mfma_f32_16x16x32_bf16 v[120:123], a[228:231], v[32:35], v[120:123]
    v_exp_f32 v113, v113
    v_add_f32 v200, v200, v112
    v_mfma_f32_16x16x32_bf16 v[120:123], a[232:235], v[60:63], v[120:123]
    v_exp_f32 v114, v114
    v_mfma_f32_16x16x32_bf16 v[120:123], a[236:239], v[88:91], v[120:123]
    v_exp_f32 v115, v115
    v_mfma_f32_16x16x32_bf16 v[124:127], a[240:243], v[4:7], 0
    v_exp_f32 v116, v116
    v_mfma_f32_16x16x32_bf16 v[124:127], a[244:247], v[32:35], v[124:127]
    v_exp_f32 v117, v117
    v_mfma_f32_16x16x32_bf16 v[124:127], a[248:251], v[60:63], v[124:127]
    v_exp_f32 v118, v118
Lpg5:
    s_cbranch_execz Lpg6
    v_mfma_f32_16x16x32_bf16 v[124:127], a[252:255], v[88:91], v[124:127]
    v_exp_f32 v119, v119
    v_mfma_f32_16x16x32_bf16 v[128:131], a[224:227], v[8:11], 0
    v_exp_f32 v120, v120
    v_add_f32 v200, v200, v113
    v_mfma_f32_16x16x32_bf16 v[128:131], a[228:231], v[36:39], v[128:131]
    v_cvt_pk_bf16_f32 v112, v112, v113
    v_add_f32 v200, v200, v114
    v_add_f32 v200, v200, v115
    v_mfma_f32_16x16x32_bf16 v[128:131], a[232:235], v[64:67], v[128:131]
    v_cvt_pk_bf16_f32 v113, v114, v115
    v_add_f32 v200, v200, v116
    v_mfma_f32_16x16x32_bf16 v[128:131], a[236:239], v[92:95], v[128:131]
    v_add_f32 v200, v200, v117
    v_cvt_pk_bf16_f32 v114, v116, v117
    v_mfma_f32_16x16x32_bf16 v[132:135], a[240:243], v[8:11], 0
    v_add_f32 v200, v200, v118
    v_add_f32 v200, v200, v119
    v_mfma_f32_16x16x32_bf16 v[132:135], a[244:247], v[36:39], v[132:135]
    v_cvt_pk_bf16_f32 v115, v118, v119
    v_add_f32 v201, v201, v120
    v_mfma_f32_16x16x32_bf16 v[132:135], a[248:251], v[64:67], v[132:135]
    v_exp_f32 v121, v121
    v_mfma_f32_16x16x32_bf16 v[132:135], a[252:255], v[92:95], v[132:135]
    s_waitcnt lgkmcnt(0)
    v_exp_f32 v122, v122
    v_mfma_f32_16x16x32_bf16 a[0:3], v[168:171], v[112:115], 0
    v_exp_f32 v123, v123
    v_mfma_f32_16x16x32_bf16 a[4:7], v[172:175], v[112:115], 0
    v_exp_f32 v124, v124
    v_mfma_f32_16x16x32_bf16 a[8:11], v[176:179], v[112:115], 0
    v_exp_f32 v125, v125
    v_mfma_f32_16x16x32_bf16 a[12:15], v[180:183], v[112:115], 0
    v_exp_f32 v126, v126
    v_mfma_f32_16x16x32_bf16 a[16:19], v[184:187], v[112:115], 0
    v_exp_f32 v127, v127
    v_mfma_f32_16x16x32_bf16 a[20:23], v[188:191], v[112:115], 0
    v_exp_f32 v128, v128
    v_mfma_f32_16x16x32_bf16 a[24:27], v[192:195], v[112:115], 0
    s_waitcnt vmcnt(12)
    v_exp_f32 v129, v129
    v_mfma_f32_16x16x32_bf16 a[28:31], v[196:199], v[112:115], 0
    s_barrier
    v_exp_f32 v130, v130
    v_add_f32 v201, v201, v121
    v_mfma_f32_16x16x32_bf16 v[136:139], a[224:227], v[12:15], 0
    s_add_u32 s41, s43, 40960
    v_exp_f32 v131, v131
    v_cvt_pk_bf16_f32 v120, v120, v121
    v_mfma_f32_16x16x32_bf16 v[136:139], a[228:231], v[40:43], v[136:139]
    s_add_u32 m0, s29, 32768
    v_add_f32 v201, v201, v122
    v_add_f32 v201, v201, v123
    v_cvt_pk_bf16_f32 v121, v122, v123
    v_mfma_f32_16x16x32_bf16 v[136:139], a[232:235], v[68:71], v[136:139]
    s_waitcnt vmcnt(4)
    buffer_load_dwordx4 v249, s[12:15], s41 offen offset:0 nt lds
    v_add_f32 v201, v201, v124
    v_mfma_f32_16x16x32_bf16 v[136:139], a[236:239], v[96:99], v[136:139]
    v_add_f32 v201, v201, v125
    v_cvt_pk_bf16_f32 v122, v124, v125
    v_mfma_f32_16x16x32_bf16 v[140:143], a[240:243], v[12:15], 0
    v_add_f32 v201, v201, v126
    v_add_f32 v201, v201, v127
    v_mfma_f32_16x16x32_bf16 v[140:143], a[244:247], v[40:43], v[140:143]
    v_cvt_pk_bf16_f32 v123, v126, v127
    v_add_f32 v202, v202, v128
    v_mfma_f32_16x16x32_bf16 v[140:143], a[248:251], v[68:71], v[140:143]
    v_exp_f32 v132, v132
    v_mfma_f32_16x16x32_bf16 v[140:143], a[252:255], v[96:99], v[140:143]
    v_exp_f32 v133, v133
    v_mfma_f32_16x16x32_bf16 a[32:35], v[168:171], v[120:123], 0
    v_exp_f32 v134, v134
    v_mfma_f32_16x16x32_bf16 a[36:39], v[172:175], v[120:123], 0
    v_exp_f32 v135, v135
    v_mfma_f32_16x16x32_bf16 a[40:43], v[176:179], v[120:123], 0
    v_exp_f32 v136, v136
    v_mfma_f32_16x16x32_bf16 a[44:47], v[180:183], v[120:123], 0
    v_exp_f32 v137, v137
    v_mfma_f32_16x16x32_bf16 a[48:51], v[184:187], v[120:123], 0
    v_exp_f32 v138, v138
    v_mfma_f32_16x16x32_bf16 a[52:55], v[188:191], v[120:123], 0
    v_exp_f32 v139, v139
    v_mfma_f32_16x16x32_bf16 a[56:59], v[192:195], v[120:123], 0
    v_exp_f32 v140, v140
    v_mfma_f32_16x16x32_bf16 a[60:63], v[196:199], v[120:123], 0
    v_exp_f32 v141, v141
    v_mfma_f32_16x16x32_bf16 v[144:147], a[224:227], v[16:19], 0
    v_exp_f32 v142, v142
    v_add_f32 v202, v202, v129
    v_mfma_f32_16x16x32_bf16 v[144:147], a[228:231], v[44:47], v[144:147]
    v_cvt_pk_bf16_f32 v128, v128, v129
    v_add_f32 v202, v202, v130
    v_add_f32 v202, v202, v131
    v_mfma_f32_16x16x32_bf16 v[144:147], a[232:235], v[72:75], v[144:147]
    v_cvt_pk_bf16_f32 v129, v130, v131
    v_add_f32 v202, v202, v132
    v_mfma_f32_16x16x32_bf16 v[144:147], a[236:239], v[100:103], v[144:147]
    v_add_f32 v202, v202, v133
    v_cvt_pk_bf16_f32 v130, v132, v133
    v_mfma_f32_16x16x32_bf16 v[148:151], a[240:243], v[16:19], 0
    v_add_f32 v202, v202, v134
    v_add_f32 v202, v202, v135
    v_mfma_f32_16x16x32_bf16 v[148:151], a[244:247], v[44:47], v[148:151]
    v_cvt_pk_bf16_f32 v131, v134, v135
    v_add_f32 v203, v203, v136
    v_mfma_f32_16x16x32_bf16 v[148:151], a[248:251], v[72:75], v[148:151]
    v_exp_f32 v143, v143
    v_mfma_f32_16x16x32_bf16 v[148:151], a[252:255], v[100:103], v[148:151]
    v_exp_f32 v144, v144
    v_mfma_f32_16x16x32_bf16 a[64:67], v[168:171], v[128:131], 0
    v_exp_f32 v145, v145
    v_mfma_f32_16x16x32_bf16 a[68:71], v[172:175], v[128:131], 0
    v_exp_f32 v146, v146
    v_mfma_f32_16x16x32_bf16 a[72:75], v[176:179], v[128:131], 0
    v_exp_f32 v147, v147
    v_mfma_f32_16x16x32_bf16 a[76:79], v[180:183], v[128:131], 0
    s_waitcnt vmcnt(4)
    buffer_load_dwordx4 v250, s[12:15], s41 offen offset:1024 nt lds
    v_mfma_f32_16x16x32_bf16 a[80:83], v[184:187], v[128:131], 0
    v_exp_f32 v148, v148
    v_mfma_f32_16x16x32_bf16 a[84:87], v[188:191], v[128:131], 0
    v_exp_f32 v149, v149
    v_mfma_f32_16x16x32_bf16 a[88:91], v[192:195], v[128:131], 0
    v_exp_f32 v150, v150
    v_mfma_f32_16x16x32_bf16 a[92:95], v[196:199], v[128:131], 0
    v_exp_f32 v151, v151
    v_mfma_f32_16x16x32_bf16 v[152:155], a[224:227], v[20:23], 0
    v_add_f32 v203, v203, v137
    v_cvt_pk_bf16_f32 v136, v136, v137
    v_mfma_f32_16x16x32_bf16 v[152:155], a[228:231], v[48:51], v[152:155]
    v_add_f32 v203, v203, v138
    v_add_f32 v203, v203, v139
    v_mfma_f32_16x16x32_bf16 v[152:155], a[232:235], v[76:79], v[152:155]
    v_cvt_pk_bf16_f32 v137, v138, v139
    v_add_f32 v203, v203, v140
    v_mfma_f32_16x16x32_bf16 v[152:155], a[236:239], v[104:107], v[152:155]
    v_add_f32 v203, v203, v141
    v_cvt_pk_bf16_f32 v138, v140, v141
    v_mfma_f32_16x16x32_bf16 v[156:159], a[240:243], v[20:23], 0
    v_add_f32 v203, v203, v142
    v_add_f32 v203, v203, v143
    v_mfma_f32_16x16x32_bf16 v[156:159], a[244:247], v[48:51], v[156:159]
    v_cvt_pk_bf16_f32 v139, v142, v143
    v_add_f32 v204, v204, v144
    v_mfma_f32_16x16x32_bf16 v[156:159], a[248:251], v[76:79], v[156:159]
    v_add_f32 v204, v204, v145
    v_cvt_pk_bf16_f32 v144, v144, v145
    v_mfma_f32_16x16x32_bf16 v[156:159], a[252:255], v[104:107], v[156:159]
    v_exp_f32 v152, v152
    v_mfma_f32_16x16x32_bf16 a[96:99], v[168:171], v[136:139], 0
    v_exp_f32 v153, v153
    v_mfma_f32_16x16x32_bf16 a[100:103], v[172:175], v[136:139], 0
    v_exp_f32 v154, v154
    v_mfma_f32_16x16x32_bf16 a[104:107], v[176:179], v[136:139], 0
    v_exp_f32 v155, v155
    v_mfma_f32_16x16x32_bf16 a[108:111], v[180:183], v[136:139], 0
    v_exp_f32 v156, v156
    v_mfma_f32_16x16x32_bf16 a[112:115], v[184:187], v[136:139], 0
    v_exp_f32 v157, v157
    v_mfma_f32_16x16x32_bf16 a[116:119], v[188:191], v[136:139], 0
    v_exp_f32 v158, v158
    v_mfma_f32_16x16x32_bf16 a[120:123], v[192:195], v[136:139], 0
    v_exp_f32 v159, v159
    v_add_f32 v204, v204, v146
    v_mfma_f32_16x16x32_bf16 a[124:127], v[196:199], v[136:139], 0
    v_add_f32 v204, v204, v147
    v_cvt_pk_bf16_f32 v145, v146, v147
    v_add_f32 v204, v204, v148
    v_mfma_f32_16x16x32_bf16 v[160:163], a[224:227], v[24:27], 0
    v_add_f32 v204, v204, v149
    v_cvt_pk_bf16_f32 v146, v148, v149
    v_mfma_f32_16x16x32_bf16 v[160:163], a[228:231], v[52:55], v[160:163]
    ds_read_b128 a[224:227], v224 offset:0
    v_add_f32 v204, v204, v150
    v_mfma_f32_16x16x32_bf16 v[160:163], a[232:235], v[80:83], v[160:163]
    ds_read_b128 a[228:231], v225 offset:0
    v_add_f32 v204, v204, v151
    v_mfma_f32_16x16x32_bf16 v[160:163], a[236:239], v[108:111], v[160:163]
    ds_read_b128 a[232:235], v226 offset:0
    v_cvt_pk_bf16_f32 v147, v150, v151
    v_mfma_f32_16x16x32_bf16 v[164:167], a[240:243], v[24:27], 0
    ds_read_b128 a[236:239], v227 offset:0
    v_add_f32 v205, v205, v152
    v_mfma_f32_16x16x32_bf16 v[164:167], a[244:247], v[52:55], v[164:167]
    ds_read_b128 a[240:243], v224 offset:4096
    v_add_f32 v205, v205, v153
    v_mfma_f32_16x16x32_bf16 v[164:167], a[248:251], v[80:83], v[164:167]
    ds_read_b128 a[244:247], v225 offset:4096
    v_cvt_pk_bf16_f32 v152, v152, v153
    v_mfma_f32_16x16x32_bf16 v[164:167], a[252:255], v[108:111], v[164:167]
    ds_read_b128 a[248:251], v226 offset:4096
    v_add_f32 v205, v205, v154
    v_mfma_f32_16x16x32_bf16 a[128:131], v[168:171], v[144:147], 0
    ds_read_b128 a[252:255], v227 offset:4096
    v_add_f32 v205, v205, v155
    v_mfma_f32_16x16x32_bf16 a[132:135], v[172:175], v[144:147], 0
    v_exp_f32 v160, v160
    v_mfma_f32_16x16x32_bf16 a[136:139], v[176:179], v[144:147], 0
    v_exp_f32 v161, v161
    v_mfma_f32_16x16x32_bf16 a[140:143], v[180:183], v[144:147], 0
    s_waitcnt vmcnt(4)
    buffer_load_dwordx4 v251, s[12:15], s41 offen offset:2048 nt lds
    v_mfma_f32_16x16x32_bf16 a[144:147], v[184:187], v[144:147], 0
    v_exp_f32 v162, v162
    v_mfma_f32_16x16x32_bf16 a[148:151], v[188:191], v[144:147], 0
    v_exp_f32 v163, v163
    v_mfma_f32_16x16x32_bf16 a[152:155], v[192:195], v[144:147], 0
    s_waitcnt lgkmcnt(4)
    v_exp_f32 v164, v164
    v_mfma_f32_16x16x32_bf16 a[156:159], v[196:199], v[144:147], 0
    v_exp_f32 v165, v165
    v_mfma_f32_16x16x32_bf16 v[112:115], a[224:227], v[0:3], 0
    v_exp_f32 v166, v166
    v_mfma_f32_16x16x32_bf16 v[112:115], a[228:231], v[28:31], v[112:115]
    v_cvt_pk_bf16_f32 v153, v154, v155
    v_add_f32 v205, v205, v156
    v_mfma_f32_16x16x32_bf16 v[112:115], a[232:235], v[56:59], v[112:115]
    s_waitcnt lgkmcnt(0)
    v_add_f32 v205, v205, v157
    v_cvt_pk_bf16_f32 v154, v156, v157
    v_mfma_f32_16x16x32_bf16 v[112:115], a[236:239], v[84:87], v[112:115]
    v_add_f32 v205, v205, v158
    v_add_f32 v205, v205, v159
    v_mfma_f32_16x16x32_bf16 v[116:119], a[240:243], v[0:3], 0
    v_cvt_pk_bf16_f32 v155, v158, v159
    v_add_f32 v206, v206, v160
    v_mfma_f32_16x16x32_bf16 v[116:119], a[244:247], v[28:31], v[116:119]
    v_exp_f32 v167, v167
    v_mfma_f32_16x16x32_bf16 v[116:119], a[248:251], v[56:59], v[116:119]
    v_add_f32 v206, v206, v161
    v_cvt_pk_bf16_f32 v160, v160, v161
    v_mfma_f32_16x16x32_bf16 v[116:119], a[252:255], v[84:87], v[116:119]
    v_exp_f32 v112, v112
    v_mfma_f32_16x16x32_bf16 a[160:163], v[168:171], v[152:155], 0
    s_waitcnt vmcnt(4)
    buffer_load_dwordx4 v252, s[12:15], s41 offen offset:3072 nt lds
    v_mfma_f32_16x16x32_bf16 a[164:167], v[172:175], v[152:155], 0
    v_exp_f32 v113, v113
    v_mfma_f32_16x16x32_bf16 a[168:171], v[176:179], v[152:155], 0
    v_exp_f32 v114, v114
    v_mfma_f32_16x16x32_bf16 a[172:175], v[180:183], v[152:155], 0
    v_exp_f32 v115, v115
    v_mfma_f32_16x16x32_bf16 a[176:179], v[184:187], v[152:155], 0
    buffer_store_dword v216, v219, s[20:23], 0 offen sc1
    v_mfma_f32_16x16x32_bf16 a[180:183], v[188:191], v[152:155], 0
    v_exp_f32 v116, v116
    v_mfma_f32_16x16x32_bf16 a[184:187], v[192:195], v[152:155], 0
    v_exp_f32 v117, v117
    v_mfma_f32_16x16x32_bf16 a[188:191], v[196:199], v[152:155], 0
    v_exp_f32 v118, v118
    v_add_f32 v206, v206, v162
    v_mfma_f32_16x16x32_bf16 v[120:123], a[224:227], v[4:7], 0
    buffer_store_dword v216, v219, s[20:23], 0 offen offset:1792 sc1
    v_add_f32 v206, v206, v163
    v_mfma_f32_16x16x32_bf16 v[120:123], a[228:231], v[32:35], v[120:123]
    v_cvt_pk_bf16_f32 v161, v162, v163
    v_add_f32 v206, v206, v164
    v_mfma_f32_16x16x32_bf16 v[120:123], a[232:235], v[60:63], v[120:123]
    v_add_f32 v206, v206, v165
    v_cvt_pk_bf16_f32 v162, v164, v165
    v_mfma_f32_16x16x32_bf16 v[120:123], a[236:239], v[88:91], v[120:123]
    v_add_f32 v206, v206, v166
    v_add_f32 v206, v206, v167
    v_mfma_f32_16x16x32_bf16 v[124:127], a[240:243], v[4:7], 0
    buffer_store_dword v216, v213, s[20:23], 0 offen sc1
    v_mfma_f32_16x16x32_bf16 v[124:127], a[244:247], v[32:35], v[124:127]
    v_cvt_pk_bf16_f32 v163, v166, v167
    v_add_f32 v200, v200, v112
    v_mfma_f32_16x16x32_bf16 v[124:127], a[248:251], v[60:63], v[124:127]
    v_exp_f32 v119, v119
    v_mfma_f32_16x16x32_bf16 v[124:127], a[252:255], v[88:91], v[124:127]
    v_exp_f32 v120, v120
    v_mfma_f32_16x16x32_bf16 a[192:195], v[168:171], v[160:163], 0
    ds_read_b64_tr_b16 v[168:169], v228 offset:0
    v_add_f32 v200, v200, v113
    v_mfma_f32_16x16x32_bf16 a[196:199], v[172:175], v[160:163], 0
    ds_read_b64_tr_b16 v[170:171], v228 offset:4096
    v_cvt_pk_bf16_f32 v112, v112, v113
    v_mfma_f32_16x16x32_bf16 a[200:203], v[176:179], v[160:163], 0
    ds_read_b64_tr_b16 v[172:173], v229 offset:0
    v_add_f32 v200, v200, v114
    v_mfma_f32_16x16x32_bf16 a[204:207], v[180:183], v[160:163], 0
    ds_read_b64_tr_b16 v[174:175], v229 offset:4096
    v_add_f32 v200, v200, v115
    v_mfma_f32_16x16x32_bf16 a[208:211], v[184:187], v[160:163], 0
    ds_read_b64_tr_b16 v[176:177], v230 offset:0
    v_cvt_pk_bf16_f32 v113, v114, v115
    v_mfma_f32_16x16x32_bf16 a[212:215], v[188:191], v[160:163], 0
    ds_read_b64_tr_b16 v[178:179], v230 offset:4096
    v_add_f32 v200, v200, v116
    v_mfma_f32_16x16x32_bf16 a[216:219], v[192:195], v[160:163], 0
    ds_read_b64_tr_b16 v[180:181], v231 offset:0
    v_add_f32 v200, v200, v117
    v_mfma_f32_16x16x32_bf16 a[220:223], v[196:199], v[160:163], 0
    ds_read_b64_tr_b16 v[182:183], v231 offset:4096
    v_cvt_pk_bf16_f32 v114, v116, v117
    v_mfma_f32_16x16x32_bf16 v[128:131], a[224:227], v[8:11], 0
    ds_read_b64_tr_b16 v[184:185], v232 offset:0
    v_add_f32 v200, v200, v118
    v_mfma_f32_16x16x32_bf16 v[128:131], a[228:231], v[36:39], v[128:131]
    ds_read_b64_tr_b16 v[186:187], v232 offset:4096
    v_add_f32 v200, v200, v119
    v_mfma_f32_16x16x32_bf16 v[128:131], a[232:235], v[64:67], v[128:131]
    ds_read_b64_tr_b16 v[188:189], v233 offset:0
    v_cvt_pk_bf16_f32 v115, v118, v119
    v_mfma_f32_16x16x32_bf16 v[128:131], a[236:239], v[92:95], v[128:131]
    ds_read_b64_tr_b16 v[190:191], v233 offset:4096
    v_add_f32 v201, v201, v120
    v_mfma_f32_16x16x32_bf16 v[132:135], a[240:243], v[8:11], 0
    ds_read_b64_tr_b16 v[192:193], v234 offset:0
    ds_read_b64_tr_b16 v[194:195], v234 offset:4096
    v_mfma_f32_16x16x32_bf16 v[132:135], a[244:247], v[36:39], v[132:135]
    ds_read_b64_tr_b16 v[196:197], v235 offset:0
    ds_read_b64_tr_b16 v[198:199], v235 offset:4096
    v_mfma_f32_16x16x32_bf16 v[132:135], a[248:251], v[64:67], v[132:135]
    v_exp_f32 v121, v121
    v_mfma_f32_16x16x32_bf16 v[132:135], a[252:255], v[92:95], v[132:135]
    s_waitcnt lgkmcnt(12)
    v_exp_f32 v122, v122
    v_mfma_f32_16x16x32_bf16 a[0:3], v[168:171], v[112:115], a[0:3]
    v_exp_f32 v123, v123
    v_mfma_f32_16x16x32_bf16 a[4:7], v[172:175], v[112:115], a[4:7]
    s_waitcnt lgkmcnt(8)
    v_exp_f32 v124, v124
    v_mfma_f32_16x16x32_bf16 a[8:11], v[176:179], v[112:115], a[8:11]
    v_exp_f32 v125, v125
    v_mfma_f32_16x16x32_bf16 a[12:15], v[180:183], v[112:115], a[12:15]
    s_waitcnt lgkmcnt(4)
    v_exp_f32 v126, v126
    v_mfma_f32_16x16x32_bf16 a[16:19], v[184:187], v[112:115], a[16:19]
    v_exp_f32 v127, v127
    v_mfma_f32_16x16x32_bf16 a[20:23], v[188:191], v[112:115], a[20:23]
    s_waitcnt lgkmcnt(0)
    v_exp_f32 v128, v128
    v_mfma_f32_16x16x32_bf16 a[24:27], v[192:195], v[112:115], a[24:27]
    s_waitcnt vmcnt(11)
    v_exp_f32 v129, v129
    v_add_f32 v201, v201, v121
    v_mfma_f32_16x16x32_bf16 a[28:31], v[196:199], v[112:115], a[28:31]
    s_barrier
    v_exp_f32 v130, v130
    v_cvt_pk_bf16_f32 v120, v120, v121
    v_mfma_f32_16x16x32_bf16 v[136:139], a[224:227], v[12:15], 0
    v_exp_f32 v131, v131
    v_add_f32 v201, v201, v122
    v_mfma_f32_16x16x32_bf16 v[136:139], a[228:231], v[40:43], v[136:139]
    s_add_u32 m0, s29, 114688
    v_add_f32 v201, v201, v123
    v_cvt_pk_bf16_f32 v121, v122, v123
    v_add_f32 v201, v201, v124
    v_mfma_f32_16x16x32_bf16 v[136:139], a[232:235], v[68:71], v[136:139]
    s_waitcnt vmcnt(7)
    buffer_load_dwordx4 v249, s[16:19], s41 offen offset:0 nt lds
    v_add_f32 v201, v201, v125
    v_mfma_f32_16x16x32_bf16 v[136:139], a[236:239], v[96:99], v[136:139]
    v_cvt_pk_bf16_f32 v122, v124, v125
    v_add_f32 v201, v201, v126
    v_add_f32 v201, v201, v127
    v_mfma_f32_16x16x32_bf16 v[140:143], a[240:243], v[12:15], 0
    v_cvt_pk_bf16_f32 v123, v126, v127
    v_add_f32 v202, v202, v128
    v_mfma_f32_16x16x32_bf16 v[140:143], a[244:247], v[40:43], v[140:143]
    v_exp_f32 v132, v132
    v_mfma_f32_16x16x32_bf16 v[140:143], a[248:251], v[68:71], v[140:143]
    s_waitcnt vmcnt(7)
    buffer_load_dwordx4 v250, s[16:19], s41 offen offset:1024 nt lds
    v_mfma_f32_16x16x32_bf16 v[140:143], a[252:255], v[96:99], v[140:143]
    v_exp_f32 v133, v133
    v_mfma_f32_16x16x32_bf16 a[32:35], v[168:171], v[120:123], a[32:35]
    v_exp_f32 v134, v134
    v_mfma_f32_16x16x32_bf16 a[36:39], v[172:175], v[120:123], a[36:39]
    v_exp_f32 v135, v135
    v_mfma_f32_16x16x32_bf16 a[40:43], v[176:179], v[120:123], a[40:43]
    buffer_store_dword v216, v219, s[20:23], 0 offen offset:3584 sc1
    v_mfma_f32_16x16x32_bf16 a[44:47], v[180:183], v[120:123], a[44:47]
    v_exp_f32 v136, v136
    v_mfma_f32_16x16x32_bf16 a[48:51], v[184:187], v[120:123], a[48:51]
    v_exp_f32 v137, v137
    v_mfma_f32_16x16x32_bf16 a[52:55], v[188:191], v[120:123], a[52:55]
    v_exp_f32 v138, v138
    v_mfma_f32_16x16x32_bf16 a[56:59], v[192:195], v[120:123], a[56:59]
    v_exp_f32 v139, v139
    v_mfma_f32_16x16x32_bf16 a[60:63], v[196:199], v[120:123], a[60:63]
    v_exp_f32 v140, v140
    v_mfma_f32_16x16x32_bf16 v[144:147], a[224:227], v[16:19], 0
    v_exp_f32 v141, v141
    v_add_f32 v202, v202, v129
    v_mfma_f32_16x16x32_bf16 v[144:147], a[228:231], v[44:47], v[144:147]
    v_cvt_pk_bf16_f32 v128, v128, v129
    v_add_f32 v202, v202, v130
    v_add_f32 v202, v202, v131
    v_mfma_f32_16x16x32_bf16 v[144:147], a[232:235], v[72:75], v[144:147]
    v_cvt_pk_bf16_f32 v129, v130, v131
    v_add_f32 v202, v202, v132
    v_mfma_f32_16x16x32_bf16 v[144:147], a[236:239], v[100:103], v[144:147]
    v_add_f32 v202, v202, v133
    v_cvt_pk_bf16_f32 v130, v132, v133
    v_mfma_f32_16x16x32_bf16 v[148:151], a[240:243], v[16:19], 0
    v_add_f32 v202, v202, v134
    v_add_f32 v202, v202, v135
    v_mfma_f32_16x16x32_bf16 v[148:151], a[244:247], v[44:47], v[148:151]
    v_cvt_pk_bf16_f32 v131, v134, v135
    v_add_f32 v203, v203, v136
    v_mfma_f32_16x16x32_bf16 v[148:151], a[248:251], v[72:75], v[148:151]
    v_exp_f32 v142, v142
    v_mfma_f32_16x16x32_bf16 v[148:151], a[252:255], v[100:103], v[148:151]
    s_waitcnt vmcnt(8)
    buffer_load_dwordx4 v251, s[16:19], s41 offen offset:2048 nt lds
    v_mfma_f32_16x16x32_bf16 a[64:67], v[168:171], v[128:131], a[64:67]
    v_exp_f32 v143, v143
    v_mfma_f32_16x16x32_bf16 a[68:71], v[172:175], v[128:131], a[68:71]
    v_exp_f32 v144, v144
    v_mfma_f32_16x16x32_bf16 a[72:75], v[176:179], v[128:131], a[72:75]
    v_exp_f32 v145, v145
    v_mfma_f32_16x16x32_bf16 a[76:79], v[180:183], v[128:131], a[76:79]
    v_exp_f32 v146, v146
    v_mfma_f32_16x16x32_bf16 a[80:83], v[184:187], v[128:131], a[80:83]
    v_exp_f32 v147, v147
    v_mfma_f32_16x16x32_bf16 a[84:87], v[188:191], v[128:131], a[84:87]
    v_exp_f32 v148, v148
    v_mfma_f32_16x16x32_bf16 a[88:91], v[192:195], v[128:131], a[88:91]
    v_exp_f32 v149, v149
    v_mfma_f32_16x16x32_bf16 a[92:95], v[196:199], v[128:131], a[92:95]
    v_exp_f32 v150, v150
    v_mfma_f32_16x16x32_bf16 v[152:155], a[224:227], v[20:23], 0
    v_exp_f32 v151, v151
    v_add_f32 v203, v203, v137
    v_mfma_f32_16x16x32_bf16 v[152:155], a[228:231], v[48:51], v[152:155]
    v_cvt_pk_bf16_f32 v136, v136, v137
    v_add_f32 v203, v203, v138
    v_add_f32 v203, v203, v139
    v_mfma_f32_16x16x32_bf16 v[152:155], a[232:235], v[76:79], v[152:155]
    v_cvt_pk_bf16_f32 v137, v138, v139
    v_add_f32 v203, v203, v140
    v_mfma_f32_16x16x32_bf16 v[152:155], a[236:239], v[104:107], v[152:155]
    v_add_f32 v203, v203, v141
    v_cvt_pk_bf16_f32 v138, v140, v141
    v_mfma_f32_16x16x32_bf16 v[156:159], a[240:243], v[20:23], 0
    v_add_f32 v203, v203, v142
    v_add_f32 v203, v203, v143
    v_mfma_f32_16x16x32_bf16 v[156:159], a[244:247], v[48:51], v[156:159]
    v_cvt_pk_bf16_f32 v139, v142, v143
    v_add_f32 v204, v204, v144
    v_mfma_f32_16x16x32_bf16 v[156:159], a[248:251], v[76:79], v[156:159]
    v_add_f32 v204, v204, v145
    v_cvt_pk_bf16_f32 v144, v144, v145
    v_mfma_f32_16x16x32_bf16 v[156:159], a[252:255], v[104:107], v[156:159]
    v_exp_f32 v152, v152
    v_mfma_f32_16x16x32_bf16 a[96:99], v[168:171], v[136:139], a[96:99]
    v_exp_f32 v153, v153
    v_mfma_f32_16x16x32_bf16 a[100:103], v[172:175], v[136:139], a[100:103]
    v_exp_f32 v154, v154
    v_mfma_f32_16x16x32_bf16 a[104:107], v[176:179], v[136:139], a[104:107]
    v_exp_f32 v155, v155
    v_mfma_f32_16x16x32_bf16 a[108:111], v[180:183], v[136:139], a[108:111]
    v_exp_f32 v156, v156
    v_mfma_f32_16x16x32_bf16 a[112:115], v[184:187], v[136:139], a[112:115]
    s_waitcnt vmcnt(8)
    buffer_load_dwordx4 v252, s[16:19], s41 offen offset:3072 nt lds
    v_mfma_f32_16x16x32_bf16 a[116:119], v[188:191], v[136:139], a[116:119]
    v_exp_f32 v157, v157
    v_mfma_f32_16x16x32_bf16 a[120:123], v[192:195], v[136:139], a[120:123]
    v_exp_f32 v158, v158
    v_add_f32 v204, v204, v146
    v_mfma_f32_16x16x32_bf16 a[124:127], v[196:199], v[136:139], a[124:127]
    v_exp_f32 v159, v159
    v_add_f32 v204, v204, v147
    v_mfma_f32_16x16x32_bf16 v[160:163], a[224:227], v[24:27], 0
    v_cvt_pk_bf16_f32 v145, v146, v147
    v_add_f32 v204, v204, v148
    v_add_f32 v204, v204, v149
    v_mfma_f32_16x16x32_bf16 v[160:163], a[228:231], v[52:55], v[160:163]
    ds_read_b128 a[224:227], v224 offset:8192
    v_cvt_pk_bf16_f32 v146, v148, v149
    v_add_f32 v204, v204, v150
    v_mfma_f32_16x16x32_bf16 v[160:163], a[232:235], v[80:83], v[160:163]
    ds_read_b128 a[228:231], v225 offset:8192
    v_add_f32 v204, v204, v151
    v_mfma_f32_16x16x32_bf16 v[160:163], a[236:239], v[108:111], v[160:163]
    ds_read_b128 a[232:235], v226 offset:8192
    v_cvt_pk_bf16_f32 v147, v150, v151
    v_mfma_f32_16x16x32_bf16 v[164:167], a[240:243], v[24:27], 0
    ds_read_b128 a[236:239], v227 offset:8192
    v_add_f32 v205, v205, v152
    v_mfma_f32_16x16x32_bf16 v[164:167], a[244:247], v[52:55], v[164:167]
    ds_read_b128 a[240:243], v224 offset:12288
    v_add_f32 v205, v205, v153
    v_mfma_f32_16x16x32_bf16 v[164:167], a[248:251], v[80:83], v[164:167]
    ds_read_b128 a[244:247], v225 offset:12288
    v_cvt_pk_bf16_f32 v152, v152, v153
    v_mfma_f32_16x16x32_bf16 v[164:167], a[252:255], v[108:111], v[164:167]
    ds_read_b128 a[248:251], v226 offset:12288
    v_add_f32 v205, v205, v154
    v_mfma_f32_16x16x32_bf16 a[128:131], v[168:171], v[144:147], a[128:131]
    ds_read_b128 a[252:255], v227 offset:12288
    v_add_f32 v205, v205, v155
    v_mfma_f32_16x16x32_bf16 a[132:135], v[172:175], v[144:147], a[132:135]
    v_exp_f32 v160, v160
    v_mfma_f32_16x16x32_bf16 a[136:139], v[176:179], v[144:147], a[136:139]
    v_exp_f32 v161, v161
    v_mfma_f32_16x16x32_bf16 a[140:143], v[180:183], v[144:147], a[140:143]
    v_exp_f32 v162, v162
    v_mfma_f32_16x16x32_bf16 a[144:147], v[184:187], v[144:147], a[144:147]
    v_exp_f32 v163, v163
    v_mfma_f32_16x16x32_bf16 a[148:151], v[188:191], v[144:147], a[148:151]
    v_exp_f32 v164, v164
    v_mfma_f32_16x16x32_bf16 a[152:155], v[192:195], v[144:147], a[152:155]
    s_waitcnt lgkmcnt(4)
    v_exp_f32 v165, v165
    v_mfma_f32_16x16x32_bf16 a[156:159], v[196:199], v[144:147], a[156:159]
    v_exp_f32 v166, v166
    v_mfma_f32_16x16x32_bf16 v[112:115], a[224:227], v[0:3], 0
    v_exp_f32 v167, v167
    v_mfma_f32_16x16x32_bf16 v[112:115], a[228:231], v[28:31], v[112:115]
    v_cvt_pk_bf16_f32 v153, v154, v155
    v_add_f32 v205, v205, v156
    v_mfma_f32_16x16x32_bf16 v[112:115], a[232:235], v[56:59], v[112:115]
    s_waitcnt lgkmcnt(0)
    v_add_f32 v205, v205, v157
    v_cvt_pk_bf16_f32 v154, v156, v157
    v_mfma_f32_16x16x32_bf16 v[112:115], a[236:239], v[84:87], v[112:115]
    s_add_u32 s41, s43, 49152
    v_add_f32 v205, v205, v158
    v_add_f32 v205, v205, v159
    v_mfma_f32_16x16x32_bf16 v[116:119], a[240:243], v[0:3], 0
    s_add_u32 m0, s29, 0
    v_cvt_pk_bf16_f32 v155, v158, v159
    v_add_f32 v206, v206, v160
    v_mfma_f32_16x16x32_bf16 v[116:119], a[244:247], v[28:31], v[116:119]
    s_waitcnt vmcnt(8)
    buffer_load_dwordx4 v249, s[12:15], s41 offen offset:0 nt lds
    v_mfma_f32_16x16x32_bf16 v[116:119], a[248:251], v[56:59], v[116:119]
    v_add_f32 v206, v206, v161
    v_cvt_pk_bf16_f32 v160, v160, v161
    v_mfma_f32_16x16x32_bf16 v[116:119], a[252:255], v[84:87], v[116:119]
    v_exp_f32 v112, v112
    v_mfma_f32_16x16x32_bf16 a[160:163], v[168:171], v[152:155], a[160:163]
    v_exp_f32 v113, v113
    v_mfma_f32_16x16x32_bf16 a[164:167], v[172:175], v[152:155], a[164:167]
    v_exp_f32 v114, v114
    v_mfma_f32_16x16x32_bf16 a[168:171], v[176:179], v[152:155], a[168:171]
    v_exp_f32 v115, v115
    v_mfma_f32_16x16x32_bf16 a[172:175], v[180:183], v[152:155], a[172:175]
    v_exp_f32 v116, v116
    v_mfma_f32_16x16x32_bf16 a[176:179], v[184:187], v[152:155], a[176:179]
    v_exp_f32 v117, v117
    v_mfma_f32_16x16x32_bf16 a[180:183], v[188:191], v[152:155], a[180:183]
    v_exp_f32 v118, v118
    v_mfma_f32_16x16x32_bf16 a[184:187], v[192:195], v[152:155], a[184:187]
    v_exp_f32 v119, v119
    v_mfma_f32_16x16x32_bf16 a[188:191], v[196:199], v[152:155], a[188:191]
    v_add_f32 v206, v206, v162
    v_add_f32 v206, v206, v163
    v_mfma_f32_16x16x32_bf16 v[120:123], a[224:227], v[4:7], 0
    v_cvt_pk_bf16_f32 v161, v162, v163
    v_add_f32 v206, v206, v164
    v_mfma_f32_16x16x32_bf16 v[120:123], a[228:231], v[32:35], v[120:123]
    v_add_f32 v206, v206, v165
    v_cvt_pk_bf16_f32 v162, v164, v165
    v_mfma_f32_16x16x32_bf16 v[120:123], a[232:235], v[60:63], v[120:123]
    v_add_f32 v206, v206, v166
    v_add_f32 v206, v206, v167
    v_mfma_f32_16x16x32_bf16 v[120:123], a[236:239], v[88:91], v[120:123]
    s_waitcnt vmcnt(5)
    buffer_load_dwordx4 v250, s[12:15], s41 offen offset:1024 nt lds
    v_mfma_f32_16x16x32_bf16 v[124:127], a[240:243], v[4:7], 0
    v_cvt_pk_bf16_f32 v163, v166, v167
    v_add_f32 v200, v200, v112
    v_mfma_f32_16x16x32_bf16 v[124:127], a[244:247], v[32:35], v[124:127]
    v_add_f32 v200, v200, v113
    v_cvt_pk_bf16_f32 v112, v112, v113
    v_mfma_f32_16x16x32_bf16 v[124:127], a[248:251], v[60:63], v[124:127]
    v_add_f32 v200, v200, v114
    v_add_f32 v200, v200, v115
    v_mfma_f32_16x16x32_bf16 v[124:127], a[252:255], v[88:91], v[124:127]
    v_exp_f32 v120, v120
    v_mfma_f32_16x16x32_bf16 a[192:195], v[168:171], v[160:163], a[192:195]
    ds_read_b64_tr_b16 v[168:169], v228 offset:8192
    v_cvt_pk_bf16_f32 v113, v114, v115
    v_mfma_f32_16x16x32_bf16 a[196:199], v[172:175], v[160:163], a[196:199]
    ds_read_b64_tr_b16 v[170:171], v228 offset:12288
    v_add_f32 v200, v200, v116
    v_mfma_f32_16x16x32_bf16 a[200:203], v[176:179], v[160:163], a[200:203]
    ds_read_b64_tr_b16 v[172:173], v229 offset:8192
    v_add_f32 v200, v200, v117
    v_mfma_f32_16x16x32_bf16 a[204:207], v[180:183], v[160:163], a[204:207]
    ds_read_b64_tr_b16 v[174:175], v229 offset:12288
    v_cvt_pk_bf16_f32 v114, v116, v117
    v_mfma_f32_16x16x32_bf16 a[208:211], v[184:187], v[160:163], a[208:211]
    ds_read_b64_tr_b16 v[176:177], v230 offset:8192
    v_add_f32 v200, v200, v118
    v_mfma_f32_16x16x32_bf16 a[212:215], v[188:191], v[160:163], a[212:215]
    ds_read_b64_tr_b16 v[178:179], v230 offset:12288
    v_add_f32 v200, v200, v119
    v_mfma_f32_16x16x32_bf16 a[216:219], v[192:195], v[160:163], a[216:219]
    ds_read_b64_tr_b16 v[180:181], v231 offset:8192
    v_cvt_pk_bf16_f32 v115, v118, v119
    v_mfma_f32_16x16x32_bf16 a[220:223], v[196:199], v[160:163], a[220:223]
    ds_read_b64_tr_b16 v[182:183], v231 offset:12288
    v_add_f32 v201, v201, v120
    v_mfma_f32_16x16x32_bf16 v[128:131], a[224:227], v[8:11], 0
    ds_read_b64_tr_b16 v[184:185], v232 offset:8192
    v_mfma_f32_16x16x32_bf16 v[128:131], a[228:231], v[36:39], v[128:131]
    ds_read_b64_tr_b16 v[186:187], v232 offset:12288
    v_mfma_f32_16x16x32_bf16 v[128:131], a[232:235], v[64:67], v[128:131]
    ds_read_b64_tr_b16 v[188:189], v233 offset:8192
    v_mfma_f32_16x16x32_bf16 v[128:131], a[236:239], v[92:95], v[128:131]
    ds_read_b64_tr_b16 v[190:191], v233 offset:12288
    v_mfma_f32_16x16x32_bf16 v[132:135], a[240:243], v[8:11], 0
    ds_read_b64_tr_b16 v[192:193], v234 offset:8192
    ds_read_b64_tr_b16 v[194:195], v234 offset:12288
    v_mfma_f32_16x16x32_bf16 v[132:135], a[244:247], v[36:39], v[132:135]
    ds_read_b64_tr_b16 v[196:197], v235 offset:8192
    ds_read_b64_tr_b16 v[198:199], v235 offset:12288
    v_mfma_f32_16x16x32_bf16 v[132:135], a[248:251], v[64:67], v[132:135]
    v_exp_f32 v121, v121
    v_mfma_f32_16x16x32_bf16 v[132:135], a[252:255], v[92:95], v[132:135]
    s_waitcnt lgkmcnt(12)
    v_exp_f32 v122, v122
    v_mfma_f32_16x16x32_bf16 a[0:3], v[168:171], v[112:115], a[0:3]
    v_exp_f32 v123, v123
    v_mfma_f32_16x16x32_bf16 a[4:7], v[172:175], v[112:115], a[4:7]
    s_waitcnt lgkmcnt(8)
    v_exp_f32 v124, v124
    v_mfma_f32_16x16x32_bf16 a[8:11], v[176:179], v[112:115], a[8:11]
    v_exp_f32 v125, v125
    v_mfma_f32_16x16x32_bf16 a[12:15], v[180:183], v[112:115], a[12:15]
    s_waitcnt lgkmcnt(4)
    v_exp_f32 v126, v126
    v_mfma_f32_16x16x32_bf16 a[16:19], v[184:187], v[112:115], a[16:19]
    v_exp_f32 v127, v127
    v_mfma_f32_16x16x32_bf16 a[20:23], v[188:191], v[112:115], a[20:23]
    s_waitcnt lgkmcnt(0)
    v_exp_f32 v128, v128
    v_mfma_f32_16x16x32_bf16 a[24:27], v[192:195], v[112:115], a[24:27]
    s_waitcnt vmcnt(14)
    v_exp_f32 v129, v129
    v_mfma_f32_16x16x32_bf16 a[28:31], v[196:199], v[112:115], a[28:31]
    s_barrier
    v_exp_f32 v130, v130
    v_add_f32 v201, v201, v121
    v_mfma_f32_16x16x32_bf16 v[136:139], a[224:227], v[12:15], 0
    v_exp_f32 v131, v131
    v_cvt_pk_bf16_f32 v120, v120, v121
    v_mfma_f32_16x16x32_bf16 v[136:139], a[228:231], v[40:43], v[136:139]
    v_add_f32 v201, v201, v122
    v_add_f32 v201, v201, v123
    v_cvt_pk_bf16_f32 v121, v122, v123
    v_mfma_f32_16x16x32_bf16 v[136:139], a[232:235], v[68:71], v[136:139]
    s_waitcnt vmcnt(5)
Lpg6:
    s_cbranch_execz Lpg7
    buffer_load_dwordx4 v251, s[12:15], s41 offen offset:2048 nt lds
    v_add_f32 v201, v201, v124
    v_mfma_f32_16x16x32_bf16 v[136:139], a[236:239], v[96:99], v[136:139]
    v_add_f32 v201, v201, v125
    v_cvt_pk_bf16_f32 v122, v124, v125
    v_mfma_f32_16x16x32_bf16 v[140:143], a[240:243], v[12:15], 0
    v_add_f32 v201, v201, v126
    v_add_f32 v201, v201, v127
    v_mfma_f32_16x16x32_bf16 v[140:143], a[244:247], v[40:43], v[140:143]
    v_cvt_pk_bf16_f32 v123, v126, v127
    v_add_f32 v202, v202, v128
    v_mfma_f32_16x16x32_bf16 v[140:143], a[248:251], v[68:71], v[140:143]
    v_exp_f32 v132, v132
    v_mfma_f32_16x16x32_bf16 v[140:143], a[252:255], v[96:99], v[140:143]
    v_exp_f32 v133, v133
    v_mfma_f32_16x16x32_bf16 a[32:35], v[168:171], v[120:123], a[32:35]
    v_exp_f32 v134, v134
    v_mfma_f32_16x16x32_bf16 a[36:39], v[172:175], v[120:123], a[36:39]
    v_exp_f32 v135, v135
    v_mfma_f32_16x16x32_bf16 a[40:43], v[176:179], v[120:123], a[40:43]
    s_waitcnt vmcnt(4)
    buffer_load_dwordx4 v252, s[12:15], s41 offen offset:3072 nt lds
    v_mfma_f32_16x16x32_bf16 a[44:47], v[180:183], v[120:123], a[44:47]
    v_exp_f32 v136, v136
    v_mfma_f32_16x16x32_bf16 a[48:51], v[184:187], v[120:123], a[48:51]
    v_exp_f32 v137, v137
    v_mfma_f32_16x16x32_bf16 a[52:55], v[188:191], v[120:123], a[52:55]
    v_exp_f32 v138, v138
    v_mfma_f32_16x16x32_bf16 a[56:59], v[192:195], v[120:123], a[56:59]
    v_exp_f32 v139, v139
    v_mfma_f32_16x16x32_bf16 a[60:63], v[196:199], v[120:123], a[60:63]
    v_exp_f32 v140, v140
    v_mfma_f32_16x16x32_bf16 v[144:147], a[224:227], v[16:19], 0
    v_exp_f32 v141, v141
    v_add_f32 v202, v202, v129
    v_mfma_f32_16x16x32_bf16 v[144:147], a[228:231], v[44:47], v[144:147]
    v_cvt_pk_bf16_f32 v128, v128, v129
    v_add_f32 v202, v202, v130
    v_add_f32 v202, v202, v131
    v_mfma_f32_16x16x32_bf16 v[144:147], a[232:235], v[72:75], v[144:147]
    v_cvt_pk_bf16_f32 v129, v130, v131
    v_add_f32 v202, v202, v132
    v_mfma_f32_16x16x32_bf16 v[144:147], a[236:239], v[100:103], v[144:147]
    v_add_f32 v202, v202, v133
    v_cvt_pk_bf16_f32 v130, v132, v133
    v_mfma_f32_16x16x32_bf16 v[148:151], a[240:243], v[16:19], 0
    v_add_f32 v202, v202, v134
    v_add_f32 v202, v202, v135
    v_mfma_f32_16x16x32_bf16 v[148:151], a[244:247], v[44:47], v[148:151]
    v_cvt_pk_bf16_f32 v131, v134, v135
    v_add_f32 v203, v203, v136
    v_mfma_f32_16x16x32_bf16 v[148:151], a[248:251], v[72:75], v[148:151]
    v_exp_f32 v142, v142
    v_mfma_f32_16x16x32_bf16 v[148:151], a[252:255], v[100:103], v[148:151]
    v_exp_f32 v143, v143
    v_mfma_f32_16x16x32_bf16 a[64:67], v[168:171], v[128:131], a[64:67]
    v_exp_f32 v144, v144
    v_mfma_f32_16x16x32_bf16 a[68:71], v[172:175], v[128:131], a[68:71]
    v_exp_f32 v145, v145
    v_mfma_f32_16x16x32_bf16 a[72:75], v[176:179], v[128:131], a[72:75]
    v_exp_f32 v146, v146
    v_mfma_f32_16x16x32_bf16 a[76:79], v[180:183], v[128:131], a[76:79]
    v_exp_f32 v147, v147
    v_mfma_f32_16x16x32_bf16 a[80:83], v[184:187], v[128:131], a[80:83]
    s_add_u32 m0, s29, 81920
    v_exp_f32 v148, v148
    v_mfma_f32_16x16x32_bf16 a[84:87], v[188:191], v[128:131], a[84:87]
    s_waitcnt vmcnt(4)
    buffer_load_dwordx4 v249, s[16:19], s41 offen offset:0 nt lds
    v_mfma_f32_16x16x32_bf16 a[88:91], v[192:195], v[128:131], a[88:91]
    v_exp_f32 v149, v149
    v_mfma_f32_16x16x32_bf16 a[92:95], v[196:199], v[128:131], a[92:95]
    v_exp_f32 v150, v150
    v_mfma_f32_16x16x32_bf16 v[152:155], a[224:227], v[20:23], 0
    v_exp_f32 v151, v151
    v_add_f32 v203, v203, v137
    v_mfma_f32_16x16x32_bf16 v[152:155], a[228:231], v[48:51], v[152:155]
    v_cvt_pk_bf16_f32 v136, v136, v137
    v_add_f32 v203, v203, v138
    v_add_f32 v203, v203, v139
    v_mfma_f32_16x16x32_bf16 v[152:155], a[232:235], v[76:79], v[152:155]
    v_cvt_pk_bf16_f32 v137, v138, v139
    v_add_f32 v203, v203, v140
    v_mfma_f32_16x16x32_bf16 v[152:155], a[236:239], v[104:107], v[152:155]
    v_add_f32 v203, v203, v141
    v_cvt_pk_bf16_f32 v138, v140, v141
    v_mfma_f32_16x16x32_bf16 v[156:159], a[240:243], v[20:23], 0
    v_add_f32 v203, v203, v142
    v_add_f32 v203, v203, v143
    v_mfma_f32_16x16x32_bf16 v[156:159], a[244:247], v[48:51], v[156:159]
    v_cvt_pk_bf16_f32 v139, v142, v143
    v_add_f32 v204, v204, v144
    v_mfma_f32_16x16x32_bf16 v[156:159], a[248:251], v[76:79], v[156:159]
    v_add_f32 v204, v204, v145
    v_cvt_pk_bf16_f32 v144, v144, v145
    v_mfma_f32_16x16x32_bf16 v[156:159], a[252:255], v[104:107], v[156:159]
    v_exp_f32 v152, v152
    v_mfma_f32_16x16x32_bf16 a[96:99], v[168:171], v[136:139], a[96:99]
    v_exp_f32 v153, v153
    v_mfma_f32_16x16x32_bf16 a[100:103], v[172:175], v[136:139], a[100:103]
    v_exp_f32 v154, v154
    v_mfma_f32_16x16x32_bf16 a[104:107], v[176:179], v[136:139], a[104:107]
    v_exp_f32 v155, v155
    v_mfma_f32_16x16x32_bf16 a[108:111], v[180:183], v[136:139], a[108:111]
    v_exp_f32 v156, v156
    v_mfma_f32_16x16x32_bf16 a[112:115], v[184:187], v[136:139], a[112:115]
    v_exp_f32 v157, v157
    v_mfma_f32_16x16x32_bf16 a[116:119], v[188:191], v[136:139], a[116:119]
    v_exp_f32 v158, v158
    v_add_f32 v204, v204, v146
    v_mfma_f32_16x16x32_bf16 a[120:123], v[192:195], v[136:139], a[120:123]
    v_exp_f32 v159, v159
    v_add_f32 v204, v204, v147
    v_mfma_f32_16x16x32_bf16 a[124:127], v[196:199], v[136:139], a[124:127]
    v_cvt_pk_bf16_f32 v145, v146, v147
    v_add_f32 v204, v204, v148
    v_add_f32 v204, v204, v149
    v_mfma_f32_16x16x32_bf16 v[160:163], a[224:227], v[24:27], 0
    s_waitcnt vmcnt(4)
    buffer_load_dwordx4 v250, s[16:19], s41 offen offset:1024 nt lds
    v_cvt_pk_bf16_f32 v146, v148, v149
    v_mfma_f32_16x16x32_bf16 v[160:163], a[228:231], v[52:55], v[160:163]
    ds_read_b128 a[224:227], v224 offset:16384
    v_add_f32 v204, v204, v150
    v_mfma_f32_16x16x32_bf16 v[160:163], a[232:235], v[80:83], v[160:163]
    ds_read_b128 a[228:231], v225 offset:16384
    v_add_f32 v204, v204, v151
    v_mfma_f32_16x16x32_bf16 v[160:163], a[236:239], v[108:111], v[160:163]
    ds_read_b128 a[232:235], v226 offset:16384
    v_cvt_pk_bf16_f32 v147, v150, v151
    v_mfma_f32_16x16x32_bf16 v[164:167], a[240:243], v[24:27], 0
    ds_read_b128 a[236:239], v227 offset:16384
    v_add_f32 v205, v205, v152
    v_mfma_f32_16x16x32_bf16 v[164:167], a[244:247], v[52:55], v[164:167]
    ds_read_b128 a[240:243], v224 offset:20480
    v_add_f32 v205, v205, v153
    v_mfma_f32_16x16x32_bf16 v[164:167], a[248:251], v[80:83], v[164:167]
    ds_read_b128 a[244:247], v225 offset:20480
    v_cvt_pk_bf16_f32 v152, v152, v153
    v_mfma_f32_16x16x32_bf16 v[164:167], a[252:255], v[108:111], v[164:167]
    ds_read_b128 a[248:251], v226 offset:20480
    v_add_f32 v205, v205, v154
    v_mfma_f32_16x16x32_bf16 a[128:131], v[168:171], v[144:147], a[128:131]
    ds_read_b128 a[252:255], v227 offset:20480
    v_add_f32 v205, v205, v155
    v_mfma_f32_16x16x32_bf16 a[132:135], v[172:175], v[144:147], a[132:135]
    v_exp_f32 v160, v160
    v_mfma_f32_16x16x32_bf16 a[136:139], v[176:179], v[144:147], a[136:139]
    v_exp_f32 v161, v161
    v_mfma_f32_16x16x32_bf16 a[140:143], v[180:183], v[144:147], a[140:143]
    v_exp_f32 v162, v162
    v_mfma_f32_16x16x32_bf16 a[144:147], v[184:187], v[144:147], a[144:147]
    v_exp_f32 v163, v163
    v_mfma_f32_16x16x32_bf16 a[148:151], v[188:191], v[144:147], a[148:151]
    v_exp_f32 v164, v164
    v_mfma_f32_16x16x32_bf16 a[152:155], v[192:195], v[144:147], a[152:155]
    s_waitcnt lgkmcnt(4)
    v_exp_f32 v165, v165
    v_mfma_f32_16x16x32_bf16 a[156:159], v[196:199], v[144:147], a[156:159]
    v_exp_f32 v166, v166
    v_mfma_f32_16x16x32_bf16 v[112:115], a[224:227], v[0:3], 0
    v_exp_f32 v167, v167
    v_mfma_f32_16x16x32_bf16 v[112:115], a[228:231], v[28:31], v[112:115]
    v_cvt_pk_bf16_f32 v153, v154, v155
    v_add_f32 v205, v205, v156
    v_mfma_f32_16x16x32_bf16 v[112:115], a[232:235], v[56:59], v[112:115]
    s_waitcnt lgkmcnt(0)
    v_add_f32 v205, v205, v157
    v_cvt_pk_bf16_f32 v154, v156, v157
    v_mfma_f32_16x16x32_bf16 v[112:115], a[236:239], v[84:87], v[112:115]
    v_add_f32 v205, v205, v158
    v_add_f32 v205, v205, v159
    v_mfma_f32_16x16x32_bf16 v[116:119], a[240:243], v[0:3], 0
    v_cvt_pk_bf16_f32 v155, v158, v159
    v_add_f32 v206, v206, v160
    v_mfma_f32_16x16x32_bf16 v[116:119], a[244:247], v[28:31], v[116:119]
    s_waitcnt vmcnt(4)
    buffer_load_dwordx4 v251, s[16:19], s41 offen offset:2048 nt lds
    v_mfma_f32_16x16x32_bf16 v[116:119], a[248:251], v[56:59], v[116:119]
    v_add_f32 v206, v206, v161
    v_cvt_pk_bf16_f32 v160, v160, v161
    v_mfma_f32_16x16x32_bf16 v[116:119], a[252:255], v[84:87], v[116:119]
    v_exp_f32 v112, v112
    v_mfma_f32_16x16x32_bf16 a[160:163], v[168:171], v[152:155], a[160:163]
    v_exp_f32 v113, v113
    v_mfma_f32_16x16x32_bf16 a[164:167], v[172:175], v[152:155], a[164:167]
    v_exp_f32 v114, v114
    v_mfma_f32_16x16x32_bf16 a[168:171], v[176:179], v[152:155], a[168:171]
    v_exp_f32 v115, v115
    v_mfma_f32_16x16x32_bf16 a[172:175], v[180:183], v[152:155], a[172:175]
    v_exp_f32 v116, v116
    v_mfma_f32_16x16x32_bf16 a[176:179], v[184:187], v[152:155], a[176:179]
    v_exp_f32 v117, v117
    v_mfma_f32_16x16x32_bf16 a[180:183], v[188:191], v[152:155], a[180:183]
    v_exp_f32 v118, v118
    v_mfma_f32_16x16x32_bf16 a[184:187], v[192:195], v[152:155], a[184:187]
    v_exp_f32 v119, v119
    v_mfma_f32_16x16x32_bf16 a[188:191], v[196:199], v[152:155], a[188:191]
    v_add_f32 v206, v206, v162
    v_add_f32 v206, v206, v163
    v_mfma_f32_16x16x32_bf16 v[120:123], a[224:227], v[4:7], 0
    v_cvt_pk_bf16_f32 v161, v162, v163
    v_add_f32 v206, v206, v164
    v_mfma_f32_16x16x32_bf16 v[120:123], a[228:231], v[32:35], v[120:123]
    v_add_f32 v206, v206, v165
    v_cvt_pk_bf16_f32 v162, v164, v165
    v_mfma_f32_16x16x32_bf16 v[120:123], a[232:235], v[60:63], v[120:123]
    v_add_f32 v206, v206, v166
    v_add_f32 v206, v206, v167
    v_mfma_f32_16x16x32_bf16 v[120:123], a[236:239], v[88:91], v[120:123]
    v_cvt_pk_bf16_f32 v163, v166, v167
    v_add_f32 v200, v200, v112
    v_mfma_f32_16x16x32_bf16 v[124:127], a[240:243], v[4:7], 0
    v_add_f32 v200, v200, v113
    v_cvt_pk_bf16_f32 v112, v112, v113
    v_mfma_f32_16x16x32_bf16 v[124:127], a[244:247], v[32:35], v[124:127]
    v_add_f32 v200, v200, v114
    v_add_f32 v200, v200, v115
    v_mfma_f32_16x16x32_bf16 v[124:127], a[248:251], v[60:63], v[124:127]
    s_waitcnt vmcnt(4)
    buffer_load_dwordx4 v252, s[16:19], s41 offen offset:3072 nt lds
    v_mfma_f32_16x16x32_bf16 v[124:127], a[252:255], v[88:91], v[124:127]
    v_exp_f32 v120, v120
    v_mfma_f32_16x16x32_bf16 a[192:195], v[168:171], v[160:163], a[192:195]
    ds_read_b64_tr_b16 v[168:169], v228 offset:16384
    v_cvt_pk_bf16_f32 v113, v114, v115
    v_mfma_f32_16x16x32_bf16 a[196:199], v[172:175], v[160:163], a[196:199]
    ds_read_b64_tr_b16 v[170:171], v228 offset:20480
    v_add_f32 v200, v200, v116
    v_mfma_f32_16x16x32_bf16 a[200:203], v[176:179], v[160:163], a[200:203]
    ds_read_b64_tr_b16 v[172:173], v229 offset:16384
    v_add_f32 v200, v200, v117
    v_mfma_f32_16x16x32_bf16 a[204:207], v[180:183], v[160:163], a[204:207]
    ds_read_b64_tr_b16 v[174:175], v229 offset:20480
    v_cvt_pk_bf16_f32 v114, v116, v117
    v_mfma_f32_16x16x32_bf16 a[208:211], v[184:187], v[160:163], a[208:211]
    ds_read_b64_tr_b16 v[176:177], v230 offset:16384
    v_add_f32 v200, v200, v118
    v_mfma_f32_16x16x32_bf16 a[212:215], v[188:191], v[160:163], a[212:215]
    ds_read_b64_tr_b16 v[178:179], v230 offset:20480
    v_add_f32 v200, v200, v119
    v_mfma_f32_16x16x32_bf16 a[216:219], v[192:195], v[160:163], a[216:219]
    ds_read_b64_tr_b16 v[180:181], v231 offset:16384
    v_cvt_pk_bf16_f32 v115, v118, v119
    v_mfma_f32_16x16x32_bf16 a[220:223], v[196:199], v[160:163], a[220:223]
    ds_read_b64_tr_b16 v[182:183], v231 offset:20480
    v_add_f32 v201, v201, v120
    v_mfma_f32_16x16x32_bf16 v[128:131], a[224:227], v[8:11], 0
    ds_read_b64_tr_b16 v[184:185], v232 offset:16384
    v_mfma_f32_16x16x32_bf16 v[128:131], a[228:231], v[36:39], v[128:131]
    ds_read_b64_tr_b16 v[186:187], v232 offset:20480
    v_mfma_f32_16x16x32_bf16 v[128:131], a[232:235], v[64:67], v[128:131]
    ds_read_b64_tr_b16 v[188:189], v233 offset:16384
    v_mfma_f32_16x16x32_bf16 v[128:131], a[236:239], v[92:95], v[128:131]
    ds_read_b64_tr_b16 v[190:191], v233 offset:20480
    v_mfma_f32_16x16x32_bf16 v[132:135], a[240:243], v[8:11], 0
    ds_read_b64_tr_b16 v[192:193], v234 offset:16384
    ds_read_b64_tr_b16 v[194:195], v234 offset:20480
    v_mfma_f32_16x16x32_bf16 v[132:135], a[244:247], v[36:39], v[132:135]
    ds_read_b64_tr_b16 v[196:197], v235 offset:16384
    ds_read_b64_tr_b16 v[198:199], v235 offset:20480
    v_mfma_f32_16x16x32_bf16 v[132:135], a[248:251], v[64:67], v[132:135]
    v_exp_f32 v121, v121
    v_mfma_f32_16x16x32_bf16 v[132:135], a[252:255], v[92:95], v[132:135]
    s_waitcnt lgkmcnt(12)
    v_exp_f32 v122, v122
    v_mfma_f32_16x16x32_bf16 a[0:3], v[168:171], v[112:115], a[0:3]
    v_exp_f32 v123, v123
    v_mfma_f32_16x16x32_bf16 a[4:7], v[172:175], v[112:115], a[4:7]
    s_waitcnt lgkmcnt(8)
    v_exp_f32 v124, v124
    v_mfma_f32_16x16x32_bf16 a[8:11], v[176:179], v[112:115], a[8:11]
    v_exp_f32 v125, v125
    v_mfma_f32_16x16x32_bf16 a[12:15], v[180:183], v[112:115], a[12:15]
    s_waitcnt lgkmcnt(4)
    v_exp_f32 v126, v126
    v_mfma_f32_16x16x32_bf16 a[16:19], v[184:187], v[112:115], a[16:19]
    v_exp_f32 v127, v127
    v_mfma_f32_16x16x32_bf16 a[20:23], v[188:191], v[112:115], a[20:23]
    s_waitcnt lgkmcnt(0)
    v_exp_f32 v128, v128
    v_mfma_f32_16x16x32_bf16 a[24:27], v[192:195], v[112:115], a[24:27]
    s_waitcnt vmcnt(63)
    v_exp_f32 v129, v129
    v_mfma_f32_16x16x32_bf16 a[28:31], v[196:199], v[112:115], a[28:31]
    s_barrier
    v_exp_f32 v130, v130
    v_add_f32 v201, v201, v121
    v_mfma_f32_16x16x32_bf16 v[136:139], a[224:227], v[12:15], 0
    s_add_u32 s41, s43, 57344
    v_exp_f32 v131, v131
    v_cvt_pk_bf16_f32 v120, v120, v121
    v_mfma_f32_16x16x32_bf16 v[136:139], a[228:231], v[40:43], v[136:139]
    s_add_u32 m0, s29, 8192
    v_add_f32 v201, v201, v122
    v_add_f32 v201, v201, v123
    v_cvt_pk_bf16_f32 v121, v122, v123
    v_mfma_f32_16x16x32_bf16 v[136:139], a[232:235], v[68:71], v[136:139]
    s_waitcnt vmcnt(4)
    buffer_load_dwordx4 v249, s[12:15], s41 offen offset:0 nt lds
    v_add_f32 v201, v201, v124
    v_mfma_f32_16x16x32_bf16 v[136:139], a[236:239], v[96:99], v[136:139]
    v_add_f32 v201, v201, v125
    v_cvt_pk_bf16_f32 v122, v124, v125
    v_mfma_f32_16x16x32_bf16 v[140:143], a[240:243], v[12:15], 0
    v_add_f32 v201, v201, v126
    v_add_f32 v201, v201, v127
    v_mfma_f32_16x16x32_bf16 v[140:143], a[244:247], v[40:43], v[140:143]
    v_cvt_pk_bf16_f32 v123, v126, v127
    v_add_f32 v202, v202, v128
    v_mfma_f32_16x16x32_bf16 v[140:143], a[248:251], v[68:71], v[140:143]
    v_exp_f32 v132, v132
    v_mfma_f32_16x16x32_bf16 v[140:143], a[252:255], v[96:99], v[140:143]
    v_exp_f32 v133, v133
    v_mfma_f32_16x16x32_bf16 a[32:35], v[168:171], v[120:123], a[32:35]
    v_exp_f32 v134, v134
    v_mfma_f32_16x16x32_bf16 a[36:39], v[172:175], v[120:123], a[36:39]
    v_exp_f32 v135, v135
    v_mfma_f32_16x16x32_bf16 a[40:43], v[176:179], v[120:123], a[40:43]
    v_exp_f32 v136, v136
    v_mfma_f32_16x16x32_bf16 a[44:47], v[180:183], v[120:123], a[44:47]
    s_waitcnt vmcnt(4)
    buffer_load_dwordx4 v250, s[12:15], s41 offen offset:1024 nt lds
    v_mfma_f32_16x16x32_bf16 a[48:51], v[184:187], v[120:123], a[48:51]
    v_exp_f32 v137, v137
    v_mfma_f32_16x16x32_bf16 a[52:55], v[188:191], v[120:123], a[52:55]
    v_exp_f32 v138, v138
    v_mfma_f32_16x16x32_bf16 a[56:59], v[192:195], v[120:123], a[56:59]
    v_exp_f32 v139, v139
    v_mfma_f32_16x16x32_bf16 a[60:63], v[196:199], v[120:123], a[60:63]
    v_exp_f32 v140, v140
    v_mfma_f32_16x16x32_bf16 v[144:147], a[224:227], v[16:19], 0
    v_exp_f32 v141, v141
    v_add_f32 v202, v202, v129
    v_mfma_f32_16x16x32_bf16 v[144:147], a[228:231], v[44:47], v[144:147]
    v_cvt_pk_bf16_f32 v128, v128, v129
    v_add_f32 v202, v202, v130
    v_add_f32 v202, v202, v131
    v_mfma_f32_16x16x32_bf16 v[144:147], a[232:235], v[72:75], v[144:147]
    v_cvt_pk_bf16_f32 v129, v130, v131
    v_add_f32 v202, v202, v132
    v_mfma_f32_16x16x32_bf16 v[144:147], a[236:239], v[100:103], v[144:147]
    v_add_f32 v202, v202, v133
    v_cvt_pk_bf16_f32 v130, v132, v133
    v_mfma_f32_16x16x32_bf16 v[148:151], a[240:243], v[16:19], 0
    v_add_f32 v202, v202, v134
    v_add_f32 v202, v202, v135
    v_mfma_f32_16x16x32_bf16 v[148:151], a[244:247], v[44:47], v[148:151]
    v_cvt_pk_bf16_f32 v131, v134, v135
    v_add_f32 v203, v203, v136
    v_mfma_f32_16x16x32_bf16 v[148:151], a[248:251], v[72:75], v[148:151]
    v_exp_f32 v142, v142
    v_mfma_f32_16x16x32_bf16 v[148:151], a[252:255], v[100:103], v[148:151]
    v_exp_f32 v143, v143
    v_mfma_f32_16x16x32_bf16 a[64:67], v[168:171], v[128:131], a[64:67]
    v_exp_f32 v144, v144
    v_mfma_f32_16x16x32_bf16 a[68:71], v[172:175], v[128:131], a[68:71]
    v_exp_f32 v145, v145
    v_mfma_f32_16x16x32_bf16 a[72:75], v[176:179], v[128:131], a[72:75]
    v_exp_f32 v146, v146
    v_mfma_f32_16x16x32_bf16 a[76:79], v[180:183], v[128:131], a[76:79]
    v_exp_f32 v147, v147
    v_mfma_f32_16x16x32_bf16 a[80:83], v[184:187], v[128:131], a[80:83]
    v_exp_f32 v148, v148
    v_mfma_f32_16x16x32_bf16 a[84:87], v[188:191], v[128:131], a[84:87]
    s_waitcnt vmcnt(4)
    buffer_load_dwordx4 v251, s[12:15], s41 offen offset:2048 nt lds
    v_mfma_f32_16x16x32_bf16 a[88:91], v[192:195], v[128:131], a[88:91]
    v_exp_f32 v149, v149
    v_mfma_f32_16x16x32_bf16 a[92:95], v[196:199], v[128:131], a[92:95]
    v_exp_f32 v150, v150
    v_mfma_f32_16x16x32_bf16 v[152:155], a[224:227], v[20:23], 0
    v_exp_f32 v151, v151
    v_add_f32 v203, v203, v137
    v_mfma_f32_16x16x32_bf16 v[152:155], a[228:231], v[48:51], v[152:155]
    v_cvt_pk_bf16_f32 v136, v136, v137
    v_add_f32 v203, v203, v138
    v_add_f32 v203, v203, v139
    v_mfma_f32_16x16x32_bf16 v[152:155], a[232:235], v[76:79], v[152:155]
    v_cvt_pk_bf16_f32 v137, v138, v139
    v_add_f32 v203, v203, v140
    v_mfma_f32_16x16x32_bf16 v[152:155], a[236:239], v[104:107], v[152:155]
    v_add_f32 v203, v203, v141
    v_cvt_pk_bf16_f32 v138, v140, v141
    v_mfma_f32_16x16x32_bf16 v[156:159], a[240:243], v[20:23], 0
    v_add_f32 v203, v203, v142
    v_add_f32 v203, v203, v143
    v_mfma_f32_16x16x32_bf16 v[156:159], a[244:247], v[48:51], v[156:159]
    v_cvt_pk_bf16_f32 v139, v142, v143
    v_add_f32 v204, v204, v144
    v_mfma_f32_16x16x32_bf16 v[156:159], a[248:251], v[76:79], v[156:159]
    v_add_f32 v204, v204, v145
    v_cvt_pk_bf16_f32 v144, v144, v145
    v_mfma_f32_16x16x32_bf16 v[156:159], a[252:255], v[104:107], v[156:159]
    v_exp_f32 v152, v152
    v_mfma_f32_16x16x32_bf16 a[96:99], v[168:171], v[136:139], a[96:99]
    v_exp_f32 v153, v153
    v_mfma_f32_16x16x32_bf16 a[100:103], v[172:175], v[136:139], a[100:103]
    v_exp_f32 v154, v154
    v_mfma_f32_16x16x32_bf16 a[104:107], v[176:179], v[136:139], a[104:107]
    v_exp_f32 v155, v155
    v_mfma_f32_16x16x32_bf16 a[108:111], v[180:183], v[136:139], a[108:111]
    v_exp_f32 v156, v156
    v_mfma_f32_16x16x32_bf16 a[112:115], v[184:187], v[136:139], a[112:115]
    v_exp_f32 v157, v157
    v_mfma_f32_16x16x32_bf16 a[116:119], v[188:191], v[136:139], a[116:119]
    v_exp_f32 v158, v158
    v_add_f32 v204, v204, v146
    v_mfma_f32_16x16x32_bf16 a[120:123], v[192:195], v[136:139], a[120:123]
    v_exp_f32 v159, v159
    v_add_f32 v204, v204, v147
    v_mfma_f32_16x16x32_bf16 a[124:127], v[196:199], v[136:139], a[124:127]
    s_waitcnt vmcnt(4)
    buffer_load_dwordx4 v252, s[12:15], s41 offen offset:3072 nt lds
    v_cvt_pk_bf16_f32 v145, v146, v147
    v_mfma_f32_16x16x32_bf16 v[160:163], a[224:227], v[24:27], 0
    v_add_f32 v204, v204, v148
    v_add_f32 v204, v204, v149
    v_cvt_pk_bf16_f32 v146, v148, v149
    v_mfma_f32_16x16x32_bf16 v[160:163], a[228:231], v[52:55], v[160:163]
    ds_read_b128 a[224:227], v224 offset:24576
    v_add_f32 v204, v204, v150
    v_mfma_f32_16x16x32_bf16 v[160:163], a[232:235], v[80:83], v[160:163]
    ds_read_b128 a[228:231], v225 offset:24576
    v_add_f32 v204, v204, v151
    v_mfma_f32_16x16x32_bf16 v[160:163], a[236:239], v[108:111], v[160:163]
    ds_read_b128 a[232:235], v226 offset:24576
    v_cvt_pk_bf16_f32 v147, v150, v151
    v_mfma_f32_16x16x32_bf16 v[164:167], a[240:243], v[24:27], 0
    ds_read_b128 a[236:239], v227 offset:24576
    v_add_f32 v205, v205, v152
    v_mfma_f32_16x16x32_bf16 v[164:167], a[244:247], v[52:55], v[164:167]
    ds_read_b128 a[240:243], v224 offset:28672
    v_add_f32 v205, v205, v153
    v_mfma_f32_16x16x32_bf16 v[164:167], a[248:251], v[80:83], v[164:167]
    ds_read_b128 a[244:247], v225 offset:28672
    v_cvt_pk_bf16_f32 v152, v152, v153
    v_mfma_f32_16x16x32_bf16 v[164:167], a[252:255], v[108:111], v[164:167]
    ds_read_b128 a[248:251], v226 offset:28672
    v_add_f32 v205, v205, v154
    v_mfma_f32_16x16x32_bf16 a[128:131], v[168:171], v[144:147], a[128:131]
    ds_read_b128 a[252:255], v227 offset:28672
    v_add_f32 v205, v205, v155
    v_mfma_f32_16x16x32_bf16 a[132:135], v[172:175], v[144:147], a[132:135]
    v_exp_f32 v160, v160
    v_mfma_f32_16x16x32_bf16 a[136:139], v[176:179], v[144:147], a[136:139]
    v_exp_f32 v161, v161
    v_mfma_f32_16x16x32_bf16 a[140:143], v[180:183], v[144:147], a[140:143]
    v_exp_f32 v162, v162
    v_mfma_f32_16x16x32_bf16 a[144:147], v[184:187], v[144:147], a[144:147]
    v_exp_f32 v163, v163
    v_mfma_f32_16x16x32_bf16 a[148:151], v[188:191], v[144:147], a[148:151]
    v_exp_f32 v164, v164
    v_mfma_f32_16x16x32_bf16 a[152:155], v[192:195], v[144:147], a[152:155]
    s_waitcnt lgkmcnt(4)
    v_exp_f32 v165, v165
    v_mfma_f32_16x16x32_bf16 a[156:159], v[196:199], v[144:147], a[156:159]
    v_exp_f32 v166, v166
    v_mfma_f32_16x16x32_bf16 v[112:115], a[224:227], v[0:3], 0
    v_exp_f32 v167, v167
    v_mfma_f32_16x16x32_bf16 v[112:115], a[228:231], v[28:31], v[112:115]
    v_cvt_pk_bf16_f32 v153, v154, v155
    v_add_f32 v205, v205, v156
    v_mfma_f32_16x16x32_bf16 v[112:115], a[232:235], v[56:59], v[112:115]
    s_waitcnt lgkmcnt(0)
    v_add_f32 v205, v205, v157
    v_cvt_pk_bf16_f32 v154, v156, v157
    v_mfma_f32_16x16x32_bf16 v[112:115], a[236:239], v[84:87], v[112:115]
    v_add_f32 v205, v205, v158
    v_add_f32 v205, v205, v159
    v_mfma_f32_16x16x32_bf16 v[116:119], a[240:243], v[0:3], 0
    s_add_u32 m0, s29, 90112
    v_cvt_pk_bf16_f32 v155, v158, v159
    v_add_f32 v206, v206, v160
    v_mfma_f32_16x16x32_bf16 v[116:119], a[244:247], v[28:31], v[116:119]
    s_waitcnt vmcnt(4)
    buffer_load_dwordx4 v249, s[16:19], s41 offen offset:0 nt lds
    v_mfma_f32_16x16x32_bf16 v[116:119], a[248:251], v[56:59], v[116:119]
    v_add_f32 v206, v206, v161
    v_cvt_pk_bf16_f32 v160, v160, v161
    v_mfma_f32_16x16x32_bf16 v[116:119], a[252:255], v[84:87], v[116:119]
    v_exp_f32 v112, v112
    v_mfma_f32_16x16x32_bf16 a[160:163], v[168:171], v[152:155], a[160:163]
    v_exp_f32 v113, v113
    v_mfma_f32_16x16x32_bf16 a[164:167], v[172:175], v[152:155], a[164:167]
    v_exp_f32 v114, v114
    v_mfma_f32_16x16x32_bf16 a[168:171], v[176:179], v[152:155], a[168:171]
    v_exp_f32 v115, v115
    v_mfma_f32_16x16x32_bf16 a[172:175], v[180:183], v[152:155], a[172:175]
    v_exp_f32 v116, v116
    v_mfma_f32_16x16x32_bf16 a[176:179], v[184:187], v[152:155], a[176:179]
    v_exp_f32 v117, v117
    v_mfma_f32_16x16x32_bf16 a[180:183], v[188:191], v[152:155], a[180:183]
    v_exp_f32 v118, v118
    v_mfma_f32_16x16x32_bf16 a[184:187], v[192:195], v[152:155], a[184:187]
    v_exp_f32 v119, v119
    v_mfma_f32_16x16x32_bf16 a[188:191], v[196:199], v[152:155], a[188:191]
    v_add_f32 v206, v206, v162
    v_add_f32 v206, v206, v163
    v_mfma_f32_16x16x32_bf16 v[120:123], a[224:227], v[4:7], 0
    v_cvt_pk_bf16_f32 v161, v162, v163
    v_add_f32 v206, v206, v164
    v_mfma_f32_16x16x32_bf16 v[120:123], a[228:231], v[32:35], v[120:123]
    v_add_f32 v206, v206, v165
    v_cvt_pk_bf16_f32 v162, v164, v165
    v_mfma_f32_16x16x32_bf16 v[120:123], a[232:235], v[60:63], v[120:123]
    v_add_f32 v206, v206, v166
    v_add_f32 v206, v206, v167
    v_mfma_f32_16x16x32_bf16 v[120:123], a[236:239], v[88:91], v[120:123]
    s_waitcnt vmcnt(4)
    buffer_load_dwordx4 v250, s[16:19], s41 offen offset:1024 nt lds
    v_mfma_f32_16x16x32_bf16 v[124:127], a[240:243], v[4:7], 0
    v_cvt_pk_bf16_f32 v163, v166, v167
    v_add_f32 v200, v200, v112
    v_mfma_f32_16x16x32_bf16 v[124:127], a[244:247], v[32:35], v[124:127]
    v_add_f32 v200, v200, v113
    v_cvt_pk_bf16_f32 v112, v112, v113
    v_mfma_f32_16x16x32_bf16 v[124:127], a[248:251], v[60:63], v[124:127]
    v_add_f32 v200, v200, v114
    v_add_f32 v200, v200, v115
    v_mfma_f32_16x16x32_bf16 v[124:127], a[252:255], v[88:91], v[124:127]
    v_exp_f32 v120, v120
    v_mfma_f32_16x16x32_bf16 a[192:195], v[168:171], v[160:163], a[192:195]
    ds_read_b64_tr_b16 v[168:169], v228 offset:24576
    v_cvt_pk_bf16_f32 v113, v114, v115
    v_mfma_f32_16x16x32_bf16 a[196:199], v[172:175], v[160:163], a[196:199]
    ds_read_b64_tr_b16 v[170:171], v228 offset:28672
    v_add_f32 v200, v200, v116
    v_mfma_f32_16x16x32_bf16 a[200:203], v[176:179], v[160:163], a[200:203]
    ds_read_b64_tr_b16 v[172:173], v229 offset:24576
    v_add_f32 v200, v200, v117
    v_mfma_f32_16x16x32_bf16 a[204:207], v[180:183], v[160:163], a[204:207]
    ds_read_b64_tr_b16 v[174:175], v229 offset:28672
    v_cvt_pk_bf16_f32 v114, v116, v117
    v_mfma_f32_16x16x32_bf16 a[208:211], v[184:187], v[160:163], a[208:211]
    ds_read_b64_tr_b16 v[176:177], v230 offset:24576
    v_add_f32 v200, v200, v118
    v_mfma_f32_16x16x32_bf16 a[212:215], v[188:191], v[160:163], a[212:215]
    ds_read_b64_tr_b16 v[178:179], v230 offset:28672
    v_add_f32 v200, v200, v119
    v_mfma_f32_16x16x32_bf16 a[216:219], v[192:195], v[160:163], a[216:219]
    ds_read_b64_tr_b16 v[180:181], v231 offset:24576
    v_cvt_pk_bf16_f32 v115, v118, v119
    v_mfma_f32_16x16x32_bf16 a[220:223], v[196:199], v[160:163], a[220:223]
    ds_read_b64_tr_b16 v[182:183], v231 offset:28672
    v_add_f32 v201, v201, v120
    v_mfma_f32_16x16x32_bf16 v[128:131], a[224:227], v[8:11], 0
    ds_read_b64_tr_b16 v[184:185], v232 offset:24576
    v_mfma_f32_16x16x32_bf16 v[128:131], a[228:231], v[36:39], v[128:131]
    ds_read_b64_tr_b16 v[186:187], v232 offset:28672
    v_mfma_f32_16x16x32_bf16 v[128:131], a[232:235], v[64:67], v[128:131]
    ds_read_b64_tr_b16 v[188:189], v233 offset:24576
    v_mfma_f32_16x16x32_bf16 v[128:131], a[236:239], v[92:95], v[128:131]
    ds_read_b64_tr_b16 v[190:191], v233 offset:28672
    v_mfma_f32_16x16x32_bf16 v[132:135], a[240:243], v[8:11], 0
    ds_read_b64_tr_b16 v[192:193], v234 offset:24576
    ds_read_b64_tr_b16 v[194:195], v234 offset:28672
    v_mfma_f32_16x16x32_bf16 v[132:135], a[244:247], v[36:39], v[132:135]
    ds_read_b64_tr_b16 v[196:197], v235 offset:24576
    ds_read_b64_tr_b16 v[198:199], v235 offset:28672
    v_mfma_f32_16x16x32_bf16 v[132:135], a[248:251], v[64:67], v[132:135]
    v_exp_f32 v121, v121
    v_mfma_f32_16x16x32_bf16 v[132:135], a[252:255], v[92:95], v[132:135]
    s_waitcnt lgkmcnt(12)
    v_exp_f32 v122, v122
    v_mfma_f32_16x16x32_bf16 a[0:3], v[168:171], v[112:115], a[0:3]
    v_exp_f32 v123, v123
    v_mfma_f32_16x16x32_bf16 a[4:7], v[172:175], v[112:115], a[4:7]
    s_waitcnt lgkmcnt(8)
    v_exp_f32 v124, v124
    v_mfma_f32_16x16x32_bf16 a[8:11], v[176:179], v[112:115], a[8:11]
    v_exp_f32 v125, v125
    v_mfma_f32_16x16x32_bf16 a[12:15], v[180:183], v[112:115], a[12:15]
    s_waitcnt lgkmcnt(4)
    v_exp_f32 v126, v126
    v_mfma_f32_16x16x32_bf16 a[16:19], v[184:187], v[112:115], a[16:19]
    v_exp_f32 v127, v127
    v_mfma_f32_16x16x32_bf16 a[20:23], v[188:191], v[112:115], a[20:23]
    s_waitcnt lgkmcnt(0)
    v_exp_f32 v128, v128
    v_mfma_f32_16x16x32_bf16 a[24:27], v[192:195], v[112:115], a[24:27]
    s_waitcnt vmcnt(14)
    v_exp_f32 v129, v129
    v_mfma_f32_16x16x32_bf16 a[28:31], v[196:199], v[112:115], a[28:31]
    s_barrier
    v_exp_f32 v130, v130
    v_add_f32 v201, v201, v121
    v_mfma_f32_16x16x32_bf16 v[136:139], a[224:227], v[12:15], 0
    v_exp_f32 v131, v131
    v_cvt_pk_bf16_f32 v120, v120, v121
    v_mfma_f32_16x16x32_bf16 v[136:139], a[228:231], v[40:43], v[136:139]
    v_add_f32 v201, v201, v122
    v_add_f32 v201, v201, v123
    v_cvt_pk_bf16_f32 v121, v122, v123
    v_mfma_f32_16x16x32_bf16 v[136:139], a[232:235], v[68:71], v[136:139]
    s_waitcnt vmcnt(4)
    buffer_load_dwordx4 v251, s[16:19], s41 offen offset:2048 nt lds
    v_add_f32 v201, v201, v124
    v_mfma_f32_16x16x32_bf16 v[136:139], a[236:239], v[96:99], v[136:139]
    v_add_f32 v201, v201, v125
    v_cvt_pk_bf16_f32 v122, v124, v125
    v_mfma_f32_16x16x32_bf16 v[140:143], a[240:243], v[12:15], 0
    v_add_f32 v201, v201, v126
    v_add_f32 v201, v201, v127
    v_mfma_f32_16x16x32_bf16 v[140:143], a[244:247], v[40:43], v[140:143]
    v_cvt_pk_bf16_f32 v123, v126, v127
    v_add_f32 v202, v202, v128
    v_mfma_f32_16x16x32_bf16 v[140:143], a[248:251], v[68:71], v[140:143]
    v_exp_f32 v132, v132
    v_mfma_f32_16x16x32_bf16 v[140:143], a[252:255], v[96:99], v[140:143]
    s_waitcnt vmcnt(4)
    buffer_load_dwordx4 v252, s[16:19], s41 offen offset:3072 nt lds
    v_mfma_f32_16x16x32_bf16 a[32:35], v[168:171], v[120:123], a[32:35]
    v_exp_f32 v133, v133
    v_mfma_f32_16x16x32_bf16 a[36:39], v[172:175], v[120:123], a[36:39]
    v_exp_f32 v134, v134
    v_mfma_f32_16x16x32_bf16 a[40:43], v[176:179], v[120:123], a[40:43]
    v_exp_f32 v135, v135
    v_mfma_f32_16x16x32_bf16 a[44:47], v[180:183], v[120:123], a[44:47]
    v_exp_f32 v136, v136
    v_mfma_f32_16x16x32_bf16 a[48:51], v[184:187], v[120:123], a[48:51]
    v_exp_f32 v137, v137
    v_mfma_f32_16x16x32_bf16 a[52:55], v[188:191], v[120:123], a[52:55]
    v_exp_f32 v138, v138
    v_mfma_f32_16x16x32_bf16 a[56:59], v[192:195], v[120:123], a[56:59]
    v_exp_f32 v139, v139
    v_mfma_f32_16x16x32_bf16 a[60:63], v[196:199], v[120:123], a[60:63]
    v_exp_f32 v140, v140
    v_mfma_f32_16x16x32_bf16 v[144:147], a[224:227], v[16:19], 0
    v_exp_f32 v141, v141
    v_add_f32 v202, v202, v129
    v_mfma_f32_16x16x32_bf16 v[144:147], a[228:231], v[44:47], v[144:147]
    v_cvt_pk_bf16_f32 v128, v128, v129
    v_add_f32 v202, v202, v130
    v_add_f32 v202, v202, v131
    v_mfma_f32_16x16x32_bf16 v[144:147], a[232:235], v[72:75], v[144:147]
    v_cvt_pk_bf16_f32 v129, v130, v131
    v_add_f32 v202, v202, v132
    v_mfma_f32_16x16x32_bf16 v[144:147], a[236:239], v[100:103], v[144:147]
    v_add_f32 v202, v202, v133
    v_cvt_pk_bf16_f32 v130, v132, v133
    v_mfma_f32_16x16x32_bf16 v[148:151], a[240:243], v[16:19], 0
    v_add_f32 v202, v202, v134
    v_add_f32 v202, v202, v135
    v_mfma_f32_16x16x32_bf16 v[148:151], a[244:247], v[44:47], v[148:151]
    v_cvt_pk_bf16_f32 v131, v134, v135
    v_add_f32 v203, v203, v136
    v_mfma_f32_16x16x32_bf16 v[148:151], a[248:251], v[72:75], v[148:151]
    v_exp_f32 v142, v142
    v_mfma_f32_16x16x32_bf16 v[148:151], a[252:255], v[100:103], v[148:151]
Lpg7:
    s_cbranch_execz Ltch0
    s_add_u32 s41, s43, 65536
    v_exp_f32 v143, v143
    v_mfma_f32_16x16x32_bf16 a[64:67], v[168:171], v[128:131], a[64:67]
    s_add_u32 m0, s29, 16384
    v_exp_f32 v144, v144
    v_mfma_f32_16x16x32_bf16 a[68:71], v[172:175], v[128:131], a[68:71]
    s_waitcnt vmcnt(4)
    buffer_load_dwordx4 v249, s[12:15], s41 offen offset:0 nt lds
    v_mfma_f32_16x16x32_bf16 a[72:75], v[176:179], v[128:131], a[72:75]
    v_exp_f32 v145, v145
    v_mfma_f32_16x16x32_bf16 a[76:79], v[180:183], v[128:131], a[76:79]
    v_exp_f32 v146, v146
    v_mfma_f32_16x16x32_bf16 a[80:83], v[184:187], v[128:131], a[80:83]
    v_exp_f32 v147, v147
    v_mfma_f32_16x16x32_bf16 a[84:87], v[188:191], v[128:131], a[84:87]
    v_exp_f32 v148, v148
    v_mfma_f32_16x16x32_bf16 a[88:91], v[192:195], v[128:131], a[88:91]
    v_exp_f32 v149, v149
    v_mfma_f32_16x16x32_bf16 a[92:95], v[196:199], v[128:131], a[92:95]
    v_exp_f32 v150, v150
    v_mfma_f32_16x16x32_bf16 v[152:155], a[224:227], v[20:23], 0
    v_exp_f32 v151, v151
    v_add_f32 v203, v203, v137
    v_mfma_f32_16x16x32_bf16 v[152:155], a[228:231], v[48:51], v[152:155]
    v_cvt_pk_bf16_f32 v136, v136, v137
    v_add_f32 v203, v203, v138
    v_add_f32 v203, v203, v139
    v_mfma_f32_16x16x32_bf16 v[152:155], a[232:235], v[76:79], v[152:155]
    v_cvt_pk_bf16_f32 v137, v138, v139
    v_add_f32 v203, v203, v140
    v_mfma_f32_16x16x32_bf16 v[152:155], a[236:239], v[104:107], v[152:155]
    v_add_f32 v203, v203, v141
    v_cvt_pk_bf16_f32 v138, v140, v141
    v_mfma_f32_16x16x32_bf16 v[156:159], a[240:243], v[20:23], 0
    v_add_f32 v203, v203, v142
    v_add_f32 v203, v203, v143
    v_mfma_f32_16x16x32_bf16 v[156:159], a[244:247], v[48:51], v[156:159]
    v_cvt_pk_bf16_f32 v139, v142, v143
    v_add_f32 v204, v204, v144
    v_mfma_f32_16x16x32_bf16 v[156:159], a[248:251], v[76:79], v[156:159]
    v_add_f32 v204, v204, v145
    v_cvt_pk_bf16_f32 v144, v144, v145
    v_mfma_f32_16x16x32_bf16 v[156:159], a[252:255], v[104:107], v[156:159]
    v_exp_f32 v152, v152
    v_mfma_f32_16x16x32_bf16 a[96:99], v[168:171], v[136:139], a[96:99]
    v_exp_f32 v153, v153
    v_mfma_f32_16x16x32_bf16 a[100:103], v[172:175], v[136:139], a[100:103]
    v_exp_f32 v154, v154
    v_mfma_f32_16x16x32_bf16 a[104:107], v[176:179], v[136:139], a[104:107]
    v_exp_f32 v155, v155
    v_mfma_f32_16x16x32_bf16 a[108:111], v[180:183], v[136:139], a[108:111]
    s_waitcnt vmcnt(4)
    buffer_load_dwordx4 v250, s[12:15], s41 offen offset:1024 nt lds
    v_mfma_f32_16x16x32_bf16 a[112:115], v[184:187], v[136:139], a[112:115]
    v_exp_f32 v156, v156
    v_mfma_f32_16x16x32_bf16 a[116:119], v[188:191], v[136:139], a[116:119]
    v_exp_f32 v157, v157
    v_mfma_f32_16x16x32_bf16 a[120:123], v[192:195], v[136:139], a[120:123]
    v_exp_f32 v158, v158
    v_add_f32 v204, v204, v146
    v_mfma_f32_16x16x32_bf16 a[124:127], v[196:199], v[136:139], a[124:127]
    v_exp_f32 v159, v159
    v_add_f32 v204, v204, v147
    v_mfma_f32_16x16x32_bf16 v[160:163], a[224:227], v[24:27], 0
    v_cvt_pk_bf16_f32 v145, v146, v147
    v_add_f32 v204, v204, v148
    v_add_f32 v204, v204, v149
    v_mfma_f32_16x16x32_bf16 v[160:163], a[228:231], v[52:55], v[160:163]
    ds_read_b128 a[224:227], v224 offset:32768
    v_cvt_pk_bf16_f32 v146, v148, v149
    v_add_f32 v204, v204, v150
    v_mfma_f32_16x16x32_bf16 v[160:163], a[232:235], v[80:83], v[160:163]
    ds_read_b128 a[228:231], v225 offset:32768
    v_add_f32 v204, v204, v151
    v_mfma_f32_16x16x32_bf16 v[160:163], a[236:239], v[108:111], v[160:163]
    ds_read_b128 a[232:235], v226 offset:32768
    v_cvt_pk_bf16_f32 v147, v150, v151
    v_mfma_f32_16x16x32_bf16 v[164:167], a[240:243], v[24:27], 0
    ds_read_b128 a[236:239], v227 offset:32768
    v_add_f32 v205, v205, v152
    v_mfma_f32_16x16x32_bf16 v[164:167], a[244:247], v[52:55], v[164:167]
    ds_read_b128 a[240:243], v224 offset:36864
    v_add_f32 v205, v205, v153
    v_mfma_f32_16x16x32_bf16 v[164:167], a[248:251], v[80:83], v[164:167]
    ds_read_b128 a[244:247], v225 offset:36864
    v_cvt_pk_bf16_f32 v152, v152, v153
    v_mfma_f32_16x16x32_bf16 v[164:167], a[252:255], v[108:111], v[164:167]
    ds_read_b128 a[248:251], v226 offset:36864
    v_add_f32 v205, v205, v154
    v_mfma_f32_16x16x32_bf16 a[128:131], v[168:171], v[144:147], a[128:131]
    ds_read_b128 a[252:255], v227 offset:36864
    v_add_f32 v205, v205, v155
    v_mfma_f32_16x16x32_bf16 a[132:135], v[172:175], v[144:147], a[132:135]
    v_exp_f32 v160, v160
    v_mfma_f32_16x16x32_bf16 a[136:139], v[176:179], v[144:147], a[136:139]
    v_exp_f32 v161, v161
    v_mfma_f32_16x16x32_bf16 a[140:143], v[180:183], v[144:147], a[140:143]
    v_exp_f32 v162, v162
    v_mfma_f32_16x16x32_bf16 a[144:147], v[184:187], v[144:147], a[144:147]
    s_waitcnt vmcnt(4)
    buffer_load_dwordx4 v251, s[12:15], s41 offen offset:2048 nt lds
    v_mfma_f32_16x16x32_bf16 a[148:151], v[188:191], v[144:147], a[148:151]
    v_exp_f32 v163, v163
    v_mfma_f32_16x16x32_bf16 a[152:155], v[192:195], v[144:147], a[152:155]
    s_waitcnt lgkmcnt(4)
    v_exp_f32 v164, v164
    v_mfma_f32_16x16x32_bf16 a[156:159], v[196:199], v[144:147], a[156:159]
    v_exp_f32 v165, v165
    v_mfma_f32_16x16x32_bf16 v[112:115], a[224:227], v[0:3], 0
    v_exp_f32 v166, v166
    v_mfma_f32_16x16x32_bf16 v[112:115], a[228:231], v[28:31], v[112:115]
    v_cvt_pk_bf16_f32 v153, v154, v155
    v_add_f32 v205, v205, v156
    v_mfma_f32_16x16x32_bf16 v[112:115], a[232:235], v[56:59], v[112:115]
    s_waitcnt lgkmcnt(0)
    v_add_f32 v205, v205, v157
    v_cvt_pk_bf16_f32 v154, v156, v157
    v_mfma_f32_16x16x32_bf16 v[112:115], a[236:239], v[84:87], v[112:115]
    v_add_f32 v205, v205, v158
    v_add_f32 v205, v205, v159
    v_mfma_f32_16x16x32_bf16 v[116:119], a[240:243], v[0:3], 0
    v_cvt_pk_bf16_f32 v155, v158, v159
    v_add_f32 v206, v206, v160
    v_mfma_f32_16x16x32_bf16 v[116:119], a[244:247], v[28:31], v[116:119]
    v_exp_f32 v167, v167
    v_mfma_f32_16x16x32_bf16 v[116:119], a[248:251], v[56:59], v[116:119]
    v_add_f32 v206, v206, v161
    v_cvt_pk_bf16_f32 v160, v160, v161
    v_mfma_f32_16x16x32_bf16 v[116:119], a[252:255], v[84:87], v[116:119]
    v_exp_f32 v112, v112
    v_mfma_f32_16x16x32_bf16 a[160:163], v[168:171], v[152:155], a[160:163]
    v_exp_f32 v113, v113
    v_mfma_f32_16x16x32_bf16 a[164:167], v[172:175], v[152:155], a[164:167]
    v_exp_f32 v114, v114
    v_mfma_f32_16x16x32_bf16 a[168:171], v[176:179], v[152:155], a[168:171]
    v_exp_f32 v115, v115
    v_mfma_f32_16x16x32_bf16 a[172:175], v[180:183], v[152:155], a[172:175]
    v_exp_f32 v116, v116
    v_mfma_f32_16x16x32_bf16 a[176:179], v[184:187], v[152:155], a[176:179]
    v_exp_f32 v117, v117
    v_mfma_f32_16x16x32_bf16 a[180:183], v[188:191], v[152:155], a[180:183]
    v_exp_f32 v118, v118
    v_mfma_f32_16x16x32_bf16 a[184:187], v[192:195], v[152:155], a[184:187]
    s_waitcnt vmcnt(4)
    buffer_load_dwordx4 v252, s[12:15], s41 offen offset:3072 nt lds
    v_mfma_f32_16x16x32_bf16 a[188:191], v[196:199], v[152:155], a[188:191]
    v_exp_f32 v119, v119
    v_mfma_f32_16x16x32_bf16 v[120:123], a[224:227], v[4:7], 0
    v_add_f32 v206, v206, v162
    v_add_f32 v206, v206, v163
    v_mfma_f32_16x16x32_bf16 v[120:123], a[228:231], v[32:35], v[120:123]
    v_cvt_pk_bf16_f32 v161, v162, v163
    v_add_f32 v206, v206, v164
    v_mfma_f32_16x16x32_bf16 v[120:123], a[232:235], v[60:63], v[120:123]
    v_add_f32 v206, v206, v165
    v_cvt_pk_bf16_f32 v162, v164, v165
    v_mfma_f32_16x16x32_bf16 v[120:123], a[236:239], v[88:91], v[120:123]
    v_add_f32 v206, v206, v166
    v_add_f32 v206, v206, v167
    v_mfma_f32_16x16x32_bf16 v[124:127], a[240:243], v[4:7], 0
    v_cvt_pk_bf16_f32 v163, v166, v167
    v_add_f32 v200, v200, v112
    v_mfma_f32_16x16x32_bf16 v[124:127], a[244:247], v[32:35], v[124:127]
    v_add_f32 v200, v200, v113
    v_cvt_pk_bf16_f32 v112, v112, v113
    v_mfma_f32_16x16x32_bf16 v[124:127], a[248:251], v[60:63], v[124:127]
    v_add_f32 v200, v200, v114
    v_add_f32 v200, v200, v115
    v_mfma_f32_16x16x32_bf16 v[124:127], a[252:255], v[88:91], v[124:127]
    v_exp_f32 v120, v120
    v_mfma_f32_16x16x32_bf16 a[192:195], v[168:171], v[160:163], a[192:195]
    ds_read_b64_tr_b16 v[168:169], v228 offset:32768
    v_cvt_pk_bf16_f32 v113, v114, v115
    v_mfma_f32_16x16x32_bf16 a[196:199], v[172:175], v[160:163], a[196:199]
    ds_read_b64_tr_b16 v[170:171], v228 offset:36864
    v_add_f32 v200, v200, v116
    v_mfma_f32_16x16x32_bf16 a[200:203], v[176:179], v[160:163], a[200:203]
    ds_read_b64_tr_b16 v[172:173], v229 offset:32768
    v_add_f32 v200, v200, v117
    v_mfma_f32_16x16x32_bf16 a[204:207], v[180:183], v[160:163], a[204:207]
    ds_read_b64_tr_b16 v[174:175], v229 offset:36864
    v_cvt_pk_bf16_f32 v114, v116, v117
    v_mfma_f32_16x16x32_bf16 a[208:211], v[184:187], v[160:163], a[208:211]
    ds_read_b64_tr_b16 v[176:177], v230 offset:32768
    v_add_f32 v200, v200, v118
    v_mfma_f32_16x16x32_bf16 a[212:215], v[188:191], v[160:163], a[212:215]
    ds_read_b64_tr_b16 v[178:179], v230 offset:36864
    v_add_f32 v200, v200, v119
    v_mfma_f32_16x16x32_bf16 a[216:219], v[192:195], v[160:163], a[216:219]
    ds_read_b64_tr_b16 v[180:181], v231 offset:32768
    v_cvt_pk_bf16_f32 v115, v118, v119
    v_mfma_f32_16x16x32_bf16 a[220:223], v[196:199], v[160:163], a[220:223]
    ds_read_b64_tr_b16 v[182:183], v231 offset:36864
    v_add_f32 v201, v201, v120
    v_mfma_f32_16x16x32_bf16 v[128:131], a[224:227], v[8:11], 0
    ds_read_b64_tr_b16 v[184:185], v232 offset:32768
    v_mfma_f32_16x16x32_bf16 v[128:131], a[228:231], v[36:39], v[128:131]
    ds_read_b64_tr_b16 v[186:187], v232 offset:36864
    v_mfma_f32_16x16x32_bf16 v[128:131], a[232:235], v[64:67], v[128:131]
    ds_read_b64_tr_b16 v[188:189], v233 offset:32768
    v_mfma_f32_16x16x32_bf16 v[128:131], a[236:239], v[92:95], v[128:131]
    ds_read_b64_tr_b16 v[190:191], v233 offset:36864
    v_mfma_f32_16x16x32_bf16 v[132:135], a[240:243], v[8:11], 0
    ds_read_b64_tr_b16 v[192:193], v234 offset:32768
    ds_read_b64_tr_b16 v[194:195], v234 offset:36864
    v_mfma_f32_16x16x32_bf16 v[132:135], a[244:247], v[36:39], v[132:135]
    ds_read_b64_tr_b16 v[196:197], v235 offset:32768
    ds_read_b64_tr_b16 v[198:199], v235 offset:36864
    v_mfma_f32_16x16x32_bf16 v[132:135], a[248:251], v[64:67], v[132:135]
    v_exp_f32 v121, v121
    v_mfma_f32_16x16x32_bf16 v[132:135], a[252:255], v[92:95], v[132:135]
    s_waitcnt lgkmcnt(12)
    v_exp_f32 v122, v122
    v_mfma_f32_16x16x32_bf16 a[0:3], v[168:171], v[112:115], a[0:3]
    v_exp_f32 v123, v123
    v_mfma_f32_16x16x32_bf16 a[4:7], v[172:175], v[112:115], a[4:7]
    s_waitcnt lgkmcnt(8)
    v_exp_f32 v124, v124
    v_mfma_f32_16x16x32_bf16 a[8:11], v[176:179], v[112:115], a[8:11]
    v_exp_f32 v125, v125
    v_mfma_f32_16x16x32_bf16 a[12:15], v[180:183], v[112:115], a[12:15]
    s_waitcnt lgkmcnt(4)
    v_exp_f32 v126, v126
    v_mfma_f32_16x16x32_bf16 a[16:19], v[184:187], v[112:115], a[16:19]
    v_exp_f32 v127, v127
    v_mfma_f32_16x16x32_bf16 a[20:23], v[188:191], v[112:115], a[20:23]
    s_waitcnt lgkmcnt(0)
    v_exp_f32 v128, v128
    v_mfma_f32_16x16x32_bf16 a[24:27], v[192:195], v[112:115], a[24:27]
    s_waitcnt vmcnt(12)
    v_exp_f32 v129, v129
    v_add_f32 v201, v201, v121
    v_mfma_f32_16x16x32_bf16 a[28:31], v[196:199], v[112:115], a[28:31]
    s_barrier
    v_exp_f32 v130, v130
    v_cvt_pk_bf16_f32 v120, v120, v121
    v_mfma_f32_16x16x32_bf16 v[136:139], a[224:227], v[12:15], 0
    v_exp_f32 v131, v131
    v_add_f32 v201, v201, v122
    v_mfma_f32_16x16x32_bf16 v[136:139], a[228:231], v[40:43], v[136:139]
    s_add_u32 m0, s29, 98304
    v_add_f32 v201, v201, v123
    v_cvt_pk_bf16_f32 v121, v122, v123
    v_add_f32 v201, v201, v124
    v_mfma_f32_16x16x32_bf16 v[136:139], a[232:235], v[68:71], v[136:139]
    s_waitcnt vmcnt(4)
    buffer_load_dwordx4 v249, s[16:19], s41 offen offset:0 nt lds
    v_add_f32 v201, v201, v125
    v_mfma_f32_16x16x32_bf16 v[136:139], a[236:239], v[96:99], v[136:139]
    v_cvt_pk_bf16_f32 v122, v124, v125
    v_add_f32 v201, v201, v126
    v_add_f32 v201, v201, v127
    v_mfma_f32_16x16x32_bf16 v[140:143], a[240:243], v[12:15], 0
    v_cvt_pk_bf16_f32 v123, v126, v127
    v_add_f32 v202, v202, v128
    v_mfma_f32_16x16x32_bf16 v[140:143], a[244:247], v[40:43], v[140:143]
    v_exp_f32 v132, v132
    v_mfma_f32_16x16x32_bf16 v[140:143], a[248:251], v[68:71], v[140:143]
    s_waitcnt vmcnt(4)
    buffer_load_dwordx4 v250, s[16:19], s41 offen offset:1024 nt lds
    v_mfma_f32_16x16x32_bf16 v[140:143], a[252:255], v[96:99], v[140:143]
    v_exp_f32 v133, v133
    v_mfma_f32_16x16x32_bf16 a[32:35], v[168:171], v[120:123], a[32:35]
    v_exp_f32 v134, v134
    v_mfma_f32_16x16x32_bf16 a[36:39], v[172:175], v[120:123], a[36:39]
    v_exp_f32 v135, v135
    v_mfma_f32_16x16x32_bf16 a[40:43], v[176:179], v[120:123], a[40:43]
    buffer_atomic_add v218, v217, s[56:59], 0 offen sc1
    v_mfma_f32_16x16x32_bf16 a[44:47], v[180:183], v[120:123], a[44:47]
    v_exp_f32 v136, v136
    v_mfma_f32_16x16x32_bf16 a[48:51], v[184:187], v[120:123], a[48:51]
    v_exp_f32 v137, v137
    v_mfma_f32_16x16x32_bf16 a[52:55], v[188:191], v[120:123], a[52:55]
    v_exp_f32 v138, v138
    v_mfma_f32_16x16x32_bf16 a[56:59], v[192:195], v[120:123], a[56:59]
    v_exp_f32 v139, v139
    v_mfma_f32_16x16x32_bf16 a[60:63], v[196:199], v[120:123], a[60:63]
    v_exp_f32 v140, v140
    v_add_f32 v202, v202, v129
    v_mfma_f32_16x16x32_bf16 v[144:147], a[224:227], v[16:19], 0
    v_exp_f32 v141, v141
    v_cvt_pk_bf16_f32 v128, v128, v129
    v_mfma_f32_16x16x32_bf16 v[144:147], a[228:231], v[44:47], v[144:147]
    v_add_f32 v202, v202, v130
    v_add_f32 v202, v202, v131
    v_cvt_pk_bf16_f32 v129, v130, v131
    v_mfma_f32_16x16x32_bf16 v[144:147], a[232:235], v[72:75], v[144:147]
    s_waitcnt vmcnt(5)
    buffer_load_dwordx4 v251, s[16:19], s41 offen offset:2048 nt lds
    v_add_f32 v202, v202, v132
    v_mfma_f32_16x16x32_bf16 v[144:147], a[236:239], v[100:103], v[144:147]
    v_add_f32 v202, v202, v133
    v_cvt_pk_bf16_f32 v130, v132, v133
    v_mfma_f32_16x16x32_bf16 v[148:151], a[240:243], v[16:19], 0
    v_add_f32 v202, v202, v134
    v_add_f32 v202, v202, v135
    v_mfma_f32_16x16x32_bf16 v[148:151], a[244:247], v[44:47], v[148:151]
    v_cvt_pk_bf16_f32 v131, v134, v135
    v_add_f32 v203, v203, v136
    v_mfma_f32_16x16x32_bf16 v[148:151], a[248:251], v[72:75], v[148:151]
    v_exp_f32 v142, v142
    v_mfma_f32_16x16x32_bf16 v[148:151], a[252:255], v[100:103], v[148:151]
    v_exp_f32 v143, v143
    v_mfma_f32_16x16x32_bf16 a[64:67], v[168:171], v[128:131], a[64:67]
    v_exp_f32 v144, v144
    v_mfma_f32_16x16x32_bf16 a[68:71], v[172:175], v[128:131], a[68:71]
    v_exp_f32 v145, v145
    v_mfma_f32_16x16x32_bf16 a[72:75], v[176:179], v[128:131], a[72:75]
    v_exp_f32 v146, v146
    v_mfma_f32_16x16x32_bf16 a[76:79], v[180:183], v[128:131], a[76:79]
    v_exp_f32 v147, v147
    v_mfma_f32_16x16x32_bf16 a[80:83], v[184:187], v[128:131], a[80:83]
    v_exp_f32 v148, v148
    v_mfma_f32_16x16x32_bf16 a[84:87], v[188:191], v[128:131], a[84:87]
    v_exp_f32 v149, v149
    v_mfma_f32_16x16x32_bf16 a[88:91], v[192:195], v[128:131], a[88:91]
    v_exp_f32 v150, v150
    v_mfma_f32_16x16x32_bf16 a[92:95], v[196:199], v[128:131], a[92:95]
    v_exp_f32 v151, v151
    v_add_f32 v203, v203, v137
    v_mfma_f32_16x16x32_bf16 v[152:155], a[224:227], v[20:23], 0
    v_cvt_pk_bf16_f32 v136, v136, v137
    v_add_f32 v203, v203, v138
    v_add_f32 v203, v203, v139
    v_mfma_f32_16x16x32_bf16 v[152:155], a[228:231], v[48:51], v[152:155]
    v_cvt_pk_bf16_f32 v137, v138, v139
    v_add_f32 v203, v203, v140
    v_mfma_f32_16x16x32_bf16 v[152:155], a[232:235], v[76:79], v[152:155]
    v_add_f32 v203, v203, v141
    v_cvt_pk_bf16_f32 v138, v140, v141
    v_mfma_f32_16x16x32_bf16 v[152:155], a[236:239], v[104:107], v[152:155]
    v_add_f32 v203, v203, v142
    v_add_f32 v203, v203, v143
    v_mfma_f32_16x16x32_bf16 v[156:159], a[240:243], v[20:23], 0
    s_waitcnt vmcnt(5)
    buffer_load_dwordx4 v252, s[16:19], s41 offen offset:3072 nt lds
    v_mfma_f32_16x16x32_bf16 v[156:159], a[244:247], v[48:51], v[156:159]
    v_cvt_pk_bf16_f32 v139, v142, v143
    v_add_f32 v204, v204, v144
    v_mfma_f32_16x16x32_bf16 v[156:159], a[248:251], v[76:79], v[156:159]
    v_add_f32 v204, v204, v145
    v_cvt_pk_bf16_f32 v144, v144, v145
    v_mfma_f32_16x16x32_bf16 v[156:159], a[252:255], v[104:107], v[156:159]
    v_exp_f32 v152, v152
    v_mfma_f32_16x16x32_bf16 a[96:99], v[168:171], v[136:139], a[96:99]
    v_exp_f32 v153, v153
    v_mfma_f32_16x16x32_bf16 a[100:103], v[172:175], v[136:139], a[100:103]
    v_exp_f32 v154, v154
    v_mfma_f32_16x16x32_bf16 a[104:107], v[176:179], v[136:139], a[104:107]
    v_exp_f32 v155, v155
    v_mfma_f32_16x16x32_bf16 a[108:111], v[180:183], v[136:139], a[108:111]
    v_exp_f32 v156, v156
    v_mfma_f32_16x16x32_bf16 a[112:115], v[184:187], v[136:139], a[112:115]
    v_exp_f32 v157, v157
    v_mfma_f32_16x16x32_bf16 a[116:119], v[188:191], v[136:139], a[116:119]
    v_exp_f32 v158, v158
    v_mfma_f32_16x16x32_bf16 a[120:123], v[192:195], v[136:139], a[120:123]
    v_exp_f32 v159, v159
    v_add_f32 v204, v204, v146
    v_mfma_f32_16x16x32_bf16 a[124:127], v[196:199], v[136:139], a[124:127]
    v_add_f32 v204, v204, v147
    v_cvt_pk_bf16_f32 v145, v146, v147
    v_add_f32 v204, v204, v148
    v_mfma_f32_16x16x32_bf16 v[160:163], a[224:227], v[24:27], 0
    v_add_f32 v204, v204, v149
    v_cvt_pk_bf16_f32 v146, v148, v149
    v_mfma_f32_16x16x32_bf16 v[160:163], a[228:231], v[52:55], v[160:163]
    ds_read_b128 a[224:227], v224 offset:0
    v_add_f32 v204, v204, v150
    v_mfma_f32_16x16x32_bf16 v[160:163], a[232:235], v[80:83], v[160:163]
    ds_read_b128 a[228:231], v225 offset:0
    v_add_f32 v204, v204, v151
    v_mfma_f32_16x16x32_bf16 v[160:163], a[236:239], v[108:111], v[160:163]
    ds_read_b128 a[232:235], v226 offset:0
    v_cvt_pk_bf16_f32 v147, v150, v151
    v_mfma_f32_16x16x32_bf16 v[164:167], a[240:243], v[24:27], 0
    ds_read_b128 a[236:239], v227 offset:0
    v_add_f32 v205, v205, v152
    v_mfma_f32_16x16x32_bf16 v[164:167], a[244:247], v[52:55], v[164:167]
    ds_read_b128 a[240:243], v224 offset:4096
    v_add_f32 v205, v205, v153
    v_mfma_f32_16x16x32_bf16 v[164:167], a[248:251], v[80:83], v[164:167]
    ds_read_b128 a[244:247], v225 offset:4096
    v_cvt_pk_bf16_f32 v152, v152, v153
    v_mfma_f32_16x16x32_bf16 v[164:167], a[252:255], v[108:111], v[164:167]
    ds_read_b128 a[248:251], v226 offset:4096
    v_add_f32 v205, v205, v154
    v_mfma_f32_16x16x32_bf16 a[128:131], v[168:171], v[144:147], a[128:131]
    ds_read_b128 a[252:255], v227 offset:4096
    v_add_f32 v205, v205, v155
    v_mfma_f32_16x16x32_bf16 a[132:135], v[172:175], v[144:147], a[132:135]
    s_add_u32 s41, s43, 73728
    v_exp_f32 v160, v160
    v_mfma_f32_16x16x32_bf16 a[136:139], v[176:179], v[144:147], a[136:139]
    s_add_u32 m0, s29, 24576
    v_exp_f32 v161, v161
    v_mfma_f32_16x16x32_bf16 a[140:143], v[180:183], v[144:147], a[140:143]
    s_waitcnt vmcnt(5)
    buffer_load_dwordx4 v249, s[12:15], s41 offen offset:0 nt lds
    v_mfma_f32_16x16x32_bf16 a[144:147], v[184:187], v[144:147], a[144:147]
    v_exp_f32 v162, v162
    v_mfma_f32_16x16x32_bf16 a[148:151], v[188:191], v[144:147], a[148:151]
    v_exp_f32 v163, v163
    v_mfma_f32_16x16x32_bf16 a[152:155], v[192:195], v[144:147], a[152:155]
    s_waitcnt lgkmcnt(4)
    v_exp_f32 v164, v164
    v_mfma_f32_16x16x32_bf16 a[156:159], v[196:199], v[144:147], a[156:159]
    v_exp_f32 v165, v165
    v_mfma_f32_16x16x32_bf16 v[112:115], a[224:227], v[0:3], 0
    v_exp_f32 v166, v166
    v_mfma_f32_16x16x32_bf16 v[112:115], a[228:231], v[28:31], v[112:115]
    v_cvt_pk_bf16_f32 v153, v154, v155
    v_add_f32 v205, v205, v156
    v_mfma_f32_16x16x32_bf16 v[112:115], a[232:235], v[56:59], v[112:115]
    s_waitcnt lgkmcnt(0)
    v_add_f32 v205, v205, v157
    v_cvt_pk_bf16_f32 v154, v156, v157
    v_mfma_f32_16x16x32_bf16 v[112:115], a[236:239], v[84:87], v[112:115]
    v_add_f32 v205, v205, v158
    v_add_f32 v205, v205, v159
    v_mfma_f32_16x16x32_bf16 v[116:119], a[240:243], v[0:3], 0
    v_cvt_pk_bf16_f32 v155, v158, v159
    v_add_f32 v206, v206, v160
    v_mfma_f32_16x16x32_bf16 v[116:119], a[244:247], v[28:31], v[116:119]
    v_exp_f32 v167, v167
    v_mfma_f32_16x16x32_bf16 v[116:119], a[248:251], v[56:59], v[116:119]
    s_waitcnt vmcnt(5)
    buffer_load_dwordx4 v250, s[12:15], s41 offen offset:1024 nt lds
    v_mfma_f32_16x16x32_bf16 v[116:119], a[252:255], v[84:87], v[116:119]
    v_exp_f32 v112, v112
    v_mfma_f32_16x16x32_bf16 a[160:163], v[168:171], v[152:155], a[160:163]
    v_exp_f32 v113, v113
    v_mfma_f32_16x16x32_bf16 a[164:167], v[172:175], v[152:155], a[164:167]
    v_exp_f32 v114, v114
    v_mfma_f32_16x16x32_bf16 a[168:171], v[176:179], v[152:155], a[168:171]
    v_exp_f32 v115, v115
    v_mfma_f32_16x16x32_bf16 a[172:175], v[180:183], v[152:155], a[172:175]
    v_exp_f32 v116, v116
    v_mfma_f32_16x16x32_bf16 a[176:179], v[184:187], v[152:155], a[176:179]
    v_exp_f32 v117, v117
    v_mfma_f32_16x16x32_bf16 a[180:183], v[188:191], v[152:155], a[180:183]
    v_exp_f32 v118, v118
    v_mfma_f32_16x16x32_bf16 a[184:187], v[192:195], v[152:155], a[184:187]
    v_exp_f32 v119, v119
    v_mfma_f32_16x16x32_bf16 a[188:191], v[196:199], v[152:155], a[188:191]
    v_add_f32 v206, v206, v161
    v_cvt_pk_bf16_f32 v160, v160, v161
    v_mfma_f32_16x16x32_bf16 v[120:123], a[224:227], v[4:7], 0
    v_add_f32 v206, v206, v162
    v_add_f32 v206, v206, v163
    v_mfma_f32_16x16x32_bf16 v[120:123], a[228:231], v[32:35], v[120:123]
    v_cvt_pk_bf16_f32 v161, v162, v163
    v_add_f32 v206, v206, v164
    v_mfma_f32_16x16x32_bf16 v[120:123], a[232:235], v[60:63], v[120:123]
    v_add_f32 v206, v206, v165
    v_cvt_pk_bf16_f32 v162, v164, v165
    v_mfma_f32_16x16x32_bf16 v[120:123], a[236:239], v[88:91], v[120:123]
    v_add_f32 v206, v206, v166
    v_add_f32 v206, v206, v167
    v_mfma_f32_16x16x32_bf16 v[124:127], a[240:243], v[4:7], 0
    v_cvt_pk_bf16_f32 v163, v166, v167
    v_add_f32 v200, v200, v112
    v_mfma_f32_16x16x32_bf16 v[124:127], a[244:247], v[32:35], v[124:127]
    v_add_f32 v200, v200, v113
    v_cvt_pk_bf16_f32 v112, v112, v113
    v_mfma_f32_16x16x32_bf16 v[124:127], a[248:251], v[60:63], v[124:127]
    v_add_f32 v200, v200, v114
    v_add_f32 v200, v200, v115
    v_mfma_f32_16x16x32_bf16 v[124:127], a[252:255], v[88:91], v[124:127]
    s_waitcnt vmcnt(5)
    buffer_load_dwordx4 v251, s[12:15], s41 offen offset:2048 nt lds
    v_mfma_f32_16x16x32_bf16 a[192:195], v[168:171], v[160:163], a[192:195]
    ds_read_b64_tr_b16 v[168:169], v228 offset:0
    v_cvt_pk_bf16_f32 v113, v114, v115
    v_mfma_f32_16x16x32_bf16 a[196:199], v[172:175], v[160:163], a[196:199]
    ds_read_b64_tr_b16 v[170:171], v228 offset:4096
    v_add_f32 v200, v200, v116
    v_mfma_f32_16x16x32_bf16 a[200:203], v[176:179], v[160:163], a[200:203]
    ds_read_b64_tr_b16 v[172:173], v229 offset:0
    v_add_f32 v200, v200, v117
    v_mfma_f32_16x16x32_bf16 a[204:207], v[180:183], v[160:163], a[204:207]
    ds_read_b64_tr_b16 v[174:175], v229 offset:4096
    v_cvt_pk_bf16_f32 v114, v116, v117
    v_mfma_f32_16x16x32_bf16 a[208:211], v[184:187], v[160:163], a[208:211]
    ds_read_b64_tr_b16 v[176:177], v230 offset:0
    v_add_f32 v200, v200, v118
    v_mfma_f32_16x16x32_bf16 a[212:215], v[188:191], v[160:163], a[212:215]
    ds_read_b64_tr_b16 v[178:179], v230 offset:4096
    v_add_f32 v200, v200, v119
    v_mfma_f32_16x16x32_bf16 a[216:219], v[192:195], v[160:163], a[216:219]
    ds_read_b64_tr_b16 v[180:181], v231 offset:0
    v_cvt_pk_bf16_f32 v115, v118, v119
    v_mfma_f32_16x16x32_bf16 a[220:223], v[196:199], v[160:163], a[220:223]
    ds_read_b64_tr_b16 v[182:183], v231 offset:4096
    v_mfma_f32_16x16x32_bf16 v[128:131], a[224:227], v[8:11], 0
    ds_read_b64_tr_b16 v[184:185], v232 offset:0
    v_mfma_f32_16x16x32_bf16 v[128:131], a[228:231], v[36:39], v[128:131]
    ds_read_b64_tr_b16 v[186:187], v232 offset:4096
    v_mfma_f32_16x16x32_bf16 v[128:131], a[232:235], v[64:67], v[128:131]
    ds_read_b64_tr_b16 v[188:189], v233 offset:0
    v_mfma_f32_16x16x32_bf16 v[128:131], a[236:239], v[92:95], v[128:131]
    ds_read_b64_tr_b16 v[190:191], v233 offset:4096
    v_mfma_f32_16x16x32_bf16 v[132:135], a[240:243], v[8:11], 0
    ds_read_b64_tr_b16 v[192:193], v234 offset:0
    ds_read_b64_tr_b16 v[194:195], v234 offset:4096
    v_mfma_f32_16x16x32_bf16 v[132:135], a[244:247], v[36:39], v[132:135]
    ds_read_b64_tr_b16 v[196:197], v235 offset:0
    ds_read_b64_tr_b16 v[198:199], v235 offset:4096
    v_mfma_f32_16x16x32_bf16 v[132:135], a[248:251], v[64:67], v[132:135]
    v_exp_f32 v120, v120
    v_mfma_f32_16x16x32_bf16 v[132:135], a[252:255], v[92:95], v[132:135]
    s_waitcnt lgkmcnt(12)
    v_exp_f32 v121, v121
    v_mfma_f32_16x16x32_bf16 a[0:3], v[168:171], v[112:115], a[0:3]
    v_exp_f32 v122, v122
    v_mfma_f32_16x16x32_bf16 a[4:7], v[172:175], v[112:115], a[4:7]
    s_waitcnt lgkmcnt(8)
    v_exp_f32 v123, v123
    v_mfma_f32_16x16x32_bf16 a[8:11], v[176:179], v[112:115], a[8:11]
    v_exp_f32 v124, v124
    v_mfma_f32_16x16x32_bf16 a[12:15], v[180:183], v[112:115], a[12:15]
    s_waitcnt lgkmcnt(4)
    v_exp_f32 v125, v125
    v_mfma_f32_16x16x32_bf16 a[16:19], v[184:187], v[112:115], a[16:19]
    v_exp_f32 v126, v126
    v_mfma_f32_16x16x32_bf16 a[20:23], v[188:191], v[112:115], a[20:23]
    s_waitcnt lgkmcnt(0)
    v_exp_f32 v127, v127
    v_mfma_f32_16x16x32_bf16 a[24:27], v[192:195], v[112:115], a[24:27]
    v_exp_f32 v128, v128
    v_add_f32 v201, v201, v120
    v_mfma_f32_16x16x32_bf16 a[28:31], v[196:199], v[112:115], a[28:31]
    v_exp_f32 v129, v129
    v_add_f32 v201, v201, v121
    v_mfma_f32_16x16x32_bf16 v[136:139], a[224:227], v[12:15], 0
    s_waitcnt vmcnt(4)
    buffer_load_dwordx4 v252, s[12:15], s41 offen offset:3072 nt lds
    v_cvt_pk_bf16_f32 v120, v120, v121
    v_mfma_f32_16x16x32_bf16 v[136:139], a[228:231], v[40:43], v[136:139]
    v_add_f32 v201, v201, v122
    v_add_f32 v201, v201, v123
    v_mfma_f32_16x16x32_bf16 v[136:139], a[232:235], v[68:71], v[136:139]
    v_cvt_pk_bf16_f32 v121, v122, v123
    v_add_f32 v201, v201, v124
    v_mfma_f32_16x16x32_bf16 v[136:139], a[236:239], v[96:99], v[136:139]
    v_add_f32 v201, v201, v125
    v_cvt_pk_bf16_f32 v122, v124, v125
    v_mfma_f32_16x16x32_bf16 v[140:143], a[240:243], v[12:15], 0
    v_add_f32 v201, v201, v126
    v_add_f32 v201, v201, v127
    v_mfma_f32_16x16x32_bf16 v[140:143], a[244:247], v[40:43], v[140:143]
    v_cvt_pk_bf16_f32 v123, v126, v127
    v_add_f32 v202, v202, v128
    v_mfma_f32_16x16x32_bf16 v[140:143], a[248:251], v[68:71], v[140:143]
    v_exp_f32 v130, v130
    v_mfma_f32_16x16x32_bf16 v[140:143], a[252:255], v[96:99], v[140:143]
    v_exp_f32 v131, v131
    v_mfma_f32_16x16x32_bf16 a[32:35], v[168:171], v[120:123], a[32:35]
    s_add_u32 m0, s29, 106496
    v_exp_f32 v132, v132
    v_mfma_f32_16x16x32_bf16 a[36:39], v[172:175], v[120:123], a[36:39]
    s_waitcnt vmcnt(4)
    buffer_load_dwordx4 v249, s[16:19], s41 offen offset:0 nt lds
    v_mfma_f32_16x16x32_bf16 a[40:43], v[176:179], v[120:123], a[40:43]
    v_exp_f32 v133, v133
    v_mfma_f32_16x16x32_bf16 a[44:47], v[180:183], v[120:123], a[44:47]
    v_exp_f32 v134, v134
    v_mfma_f32_16x16x32_bf16 a[48:51], v[184:187], v[120:123], a[48:51]
    v_exp_f32 v135, v135
    v_mfma_f32_16x16x32_bf16 a[52:55], v[188:191], v[120:123], a[52:55]
    v_exp_f32 v136, v136
    v_mfma_f32_16x16x32_bf16 a[56:59], v[192:195], v[120:123], a[56:59]
    v_exp_f32 v137, v137
    v_mfma_f32_16x16x32_bf16 a[60:63], v[196:199], v[120:123], a[60:63]
    v_exp_f32 v138, v138
    v_mfma_f32_16x16x32_bf16 v[144:147], a[224:227], v[16:19], 0
    v_exp_f32 v139, v139
    v_add_f32 v202, v202, v129
    v_mfma_f32_16x16x32_bf16 v[144:147], a[228:231], v[44:47], v[144:147]
    v_cvt_pk_bf16_f32 v128, v128, v129
    v_add_f32 v202, v202, v130
    v_add_f32 v202, v202, v131
    v_mfma_f32_16x16x32_bf16 v[144:147], a[232:235], v[72:75], v[144:147]
    v_cvt_pk_bf16_f32 v129, v130, v131
    v_add_f32 v202, v202, v132
    v_mfma_f32_16x16x32_bf16 v[144:147], a[236:239], v[100:103], v[144:147]
    v_add_f32 v202, v202, v133
    v_cvt_pk_bf16_f32 v130, v132, v133
    v_mfma_f32_16x16x32_bf16 v[148:151], a[240:243], v[16:19], 0
    v_add_f32 v202, v202, v134
    v_add_f32 v202, v202, v135
    v_mfma_f32_16x16x32_bf16 v[148:151], a[244:247], v[44:47], v[148:151]
    v_cvt_pk_bf16_f32 v131, v134, v135
    v_add_f32 v203, v203, v136
    v_mfma_f32_16x16x32_bf16 v[148:151], a[248:251], v[72:75], v[148:151]
    v_exp_f32 v140, v140
    v_mfma_f32_16x16x32_bf16 v[148:151], a[252:255], v[100:103], v[148:151]
    v_exp_f32 v141, v141
    v_mfma_f32_16x16x32_bf16 a[64:67], v[168:171], v[128:131], a[64:67]
    v_exp_f32 v142, v142
    v_mfma_f32_16x16x32_bf16 a[68:71], v[172:175], v[128:131], a[68:71]
    v_exp_f32 v143, v143
    v_mfma_f32_16x16x32_bf16 a[72:75], v[176:179], v[128:131], a[72:75]
    s_waitcnt vmcnt(4)
    buffer_load_dwordx4 v250, s[16:19], s41 offen offset:1024 nt lds
    v_mfma_f32_16x16x32_bf16 a[76:79], v[180:183], v[128:131], a[76:79]
    v_exp_f32 v144, v144
    v_mfma_f32_16x16x32_bf16 a[80:83], v[184:187], v[128:131], a[80:83]
    v_exp_f32 v145, v145
    v_mfma_f32_16x16x32_bf16 a[84:87], v[188:191], v[128:131], a[84:87]
    v_exp_f32 v146, v146
    v_mfma_f32_16x16x32_bf16 a[88:91], v[192:195], v[128:131], a[88:91]
    v_exp_f32 v147, v147
    v_mfma_f32_16x16x32_bf16 a[92:95], v[196:199], v[128:131], a[92:95]
    v_exp_f32 v148, v148
    v_mfma_f32_16x16x32_bf16 v[152:155], a[224:227], v[20:23], 0
    v_exp_f32 v149, v149
    v_add_f32 v203, v203, v137
    v_mfma_f32_16x16x32_bf16 v[152:155], a[228:231], v[48:51], v[152:155]
    v_cvt_pk_bf16_f32 v136, v136, v137
    v_add_f32 v203, v203, v138
    v_add_f32 v203, v203, v139
    v_mfma_f32_16x16x32_bf16 v[152:155], a[232:235], v[76:79], v[152:155]
    v_cvt_pk_bf16_f32 v137, v138, v139
    v_add_f32 v203, v203, v140
    v_mfma_f32_16x16x32_bf16 v[152:155], a[236:239], v[104:107], v[152:155]
    v_add_f32 v203, v203, v141
    v_cvt_pk_bf16_f32 v138, v140, v141
    v_mfma_f32_16x16x32_bf16 v[156:159], a[240:243], v[20:23], 0
    v_add_f32 v203, v203, v142
    v_add_f32 v203, v203, v143
    v_mfma_f32_16x16x32_bf16 v[156:159], a[244:247], v[48:51], v[156:159]
    v_cvt_pk_bf16_f32 v139, v142, v143
    v_add_f32 v204, v204, v144
    v_mfma_f32_16x16x32_bf16 v[156:159], a[248:251], v[76:79], v[156:159]
    v_exp_f32 v150, v150
    v_mfma_f32_16x16x32_bf16 v[156:159], a[252:255], v[104:107], v[156:159]
    v_exp_f32 v151, v151
    v_mfma_f32_16x16x32_bf16 a[96:99], v[168:171], v[136:139], a[96:99]
    v_exp_f32 v152, v152
    v_mfma_f32_16x16x32_bf16 a[100:103], v[172:175], v[136:139], a[100:103]
    v_exp_f32 v153, v153
    v_mfma_f32_16x16x32_bf16 a[104:107], v[176:179], v[136:139], a[104:107]
    v_exp_f32 v154, v154
    v_mfma_f32_16x16x32_bf16 a[108:111], v[180:183], v[136:139], a[108:111]
    s_waitcnt vmcnt(4)
    buffer_load_dwordx4 v251, s[16:19], s41 offen offset:2048 nt lds
    v_mfma_f32_16x16x32_bf16 a[112:115], v[184:187], v[136:139], a[112:115]
Lpg8:
    s_cbranch_execz Lpg9
    s_waitcnt vmcnt(16)
    v_exp_f32 v155, v155
    v_mfma_f32_16x16x32_bf16 a[116:119], v[188:191], v[136:139], a[116:119]
    s_barrier
    v_exp_f32 v156, v156
    v_add_f32 v204, v204, v145
    v_mfma_f32_16x16x32_bf16 a[120:123], v[192:195], v[136:139], a[120:123]
    v_exp_f32 v157, v157
    v_cvt_pk_bf16_f32 v144, v144, v145
    v_mfma_f32_16x16x32_bf16 a[124:127], v[196:199], v[136:139], a[124:127]
    v_exp_f32 v158, v158
    v_add_f32 v204, v204, v146
    v_mfma_f32_16x16x32_bf16 v[160:163], a[224:227], v[24:27], 0
    v_exp_f32 v159, v159
    v_add_f32 v204, v204, v147
    v_mfma_f32_16x16x32_bf16 v[160:163], a[228:231], v[52:55], v[160:163]
    ds_read_b128 a[224:227], v224 offset:8192
    v_cvt_pk_bf16_f32 v145, v146, v147
    v_add_f32 v204, v204, v148
    v_mfma_f32_16x16x32_bf16 v[160:163], a[232:235], v[80:83], v[160:163]
    ds_read_b128 a[228:231], v225 offset:8192
    v_add_f32 v204, v204, v149
    v_cvt_pk_bf16_f32 v146, v148, v149
    v_mfma_f32_16x16x32_bf16 v[160:163], a[236:239], v[108:111], v[160:163]
    ds_read_b128 a[232:235], v226 offset:8192
    v_add_f32 v204, v204, v150
    v_add_f32 v204, v204, v151
    v_mfma_f32_16x16x32_bf16 v[164:167], a[240:243], v[24:27], 0
    ds_read_b128 a[236:239], v227 offset:8192
    v_cvt_pk_bf16_f32 v147, v150, v151
    v_mfma_f32_16x16x32_bf16 v[164:167], a[244:247], v[52:55], v[164:167]
    ds_read_b128 a[240:243], v224 offset:12288
    v_add_f32 v205, v205, v152
    v_mfma_f32_16x16x32_bf16 v[164:167], a[248:251], v[80:83], v[164:167]
    ds_read_b128 a[244:247], v225 offset:12288
    v_add_f32 v205, v205, v153
    v_mfma_f32_16x16x32_bf16 v[164:167], a[252:255], v[108:111], v[164:167]
    ds_read_b128 a[248:251], v226 offset:12288
    v_cvt_pk_bf16_f32 v152, v152, v153
    v_mfma_f32_16x16x32_bf16 a[128:131], v[168:171], v[144:147], a[128:131]
    ds_read_b128 a[252:255], v227 offset:12288
    v_add_f32 v205, v205, v154
    v_mfma_f32_16x16x32_bf16 a[132:135], v[172:175], v[144:147], a[132:135]
    v_exp_f32 v160, v160
    v_mfma_f32_16x16x32_bf16 a[136:139], v[176:179], v[144:147], a[136:139]
    v_exp_f32 v161, v161
    v_mfma_f32_16x16x32_bf16 a[140:143], v[180:183], v[144:147], a[140:143]
    v_exp_f32 v162, v162
    v_mfma_f32_16x16x32_bf16 a[144:147], v[184:187], v[144:147], a[144:147]
    s_waitcnt vmcnt(4)
    buffer_load_dwordx4 v252, s[16:19], s41 offen offset:3072 nt lds
    v_mfma_f32_16x16x32_bf16 a[148:151], v[188:191], v[144:147], a[148:151]
    v_exp_f32 v163, v163
    v_mfma_f32_16x16x32_bf16 a[152:155], v[192:195], v[144:147], a[152:155]
    s_waitcnt lgkmcnt(4)
    v_exp_f32 v164, v164
    v_mfma_f32_16x16x32_bf16 a[156:159], v[196:199], v[144:147], a[156:159]
    v_exp_f32 v165, v165
    v_mfma_f32_16x16x32_bf16 v[112:115], a[224:227], v[0:3], 0
    v_exp_f32 v166, v166
    v_mfma_f32_16x16x32_bf16 v[112:115], a[228:231], v[28:31], v[112:115]
    v_add_f32 v205, v205, v155
    v_cvt_pk_bf16_f32 v153, v154, v155
    v_mfma_f32_16x16x32_bf16 v[112:115], a[232:235], v[56:59], v[112:115]
    s_waitcnt lgkmcnt(0)
    v_add_f32 v205, v205, v156
    v_add_f32 v205, v205, v157
    v_mfma_f32_16x16x32_bf16 v[112:115], a[236:239], v[84:87], v[112:115]
    v_cvt_pk_bf16_f32 v154, v156, v157
    v_add_f32 v205, v205, v158
    v_mfma_f32_16x16x32_bf16 v[116:119], a[240:243], v[0:3], 0
    v_add_f32 v205, v205, v159
    v_cvt_pk_bf16_f32 v155, v158, v159
    v_mfma_f32_16x16x32_bf16 v[116:119], a[244:247], v[28:31], v[116:119]
    v_exp_f32 v167, v167
    v_mfma_f32_16x16x32_bf16 v[116:119], a[248:251], v[56:59], v[116:119]
    v_add_f32 v206, v206, v160
    v_add_f32 v206, v206, v161
    v_mfma_f32_16x16x32_bf16 v[116:119], a[252:255], v[84:87], v[116:119]
    v_exp_f32 v112, v112
    v_mfma_f32_16x16x32_bf16 a[160:163], v[168:171], v[152:155], a[160:163]
    v_exp_f32 v113, v113
    v_mfma_f32_16x16x32_bf16 a[164:167], v[172:175], v[152:155], a[164:167]
    v_exp_f32 v114, v114
    v_mfma_f32_16x16x32_bf16 a[168:171], v[176:179], v[152:155], a[168:171]
    v_exp_f32 v115, v115
    v_mfma_f32_16x16x32_bf16 a[172:175], v[180:183], v[152:155], a[172:175]
    s_add_u32 s41, s43, 81920
    v_exp_f32 v116, v116
    v_mfma_f32_16x16x32_bf16 a[176:179], v[184:187], v[152:155], a[176:179]
    s_add_u32 m0, s29, 32768
    v_exp_f32 v117, v117
    v_mfma_f32_16x16x32_bf16 a[180:183], v[188:191], v[152:155], a[180:183]
    s_waitcnt vmcnt(4)
    buffer_load_dwordx4 v249, s[12:15], s41 offen offset:0 nt lds
    v_mfma_f32_16x16x32_bf16 a[184:187], v[192:195], v[152:155], a[184:187]
    v_exp_f32 v118, v118
    v_mfma_f32_16x16x32_bf16 a[188:191], v[196:199], v[152:155], a[188:191]
    v_exp_f32 v119, v119
    v_mfma_f32_16x16x32_bf16 v[120:123], a[224:227], v[4:7], 0
    v_cvt_pk_bf16_f32 v160, v160, v161
    v_add_f32 v206, v206, v162
    v_mfma_f32_16x16x32_bf16 v[120:123], a[228:231], v[32:35], v[120:123]
    v_add_f32 v206, v206, v163
    v_cvt_pk_bf16_f32 v161, v162, v163
    v_mfma_f32_16x16x32_bf16 v[120:123], a[232:235], v[60:63], v[120:123]
    v_add_f32 v206, v206, v164
    v_add_f32 v206, v206, v165
    v_mfma_f32_16x16x32_bf16 v[120:123], a[236:239], v[88:91], v[120:123]
    v_cvt_pk_bf16_f32 v162, v164, v165
    v_add_f32 v206, v206, v166
    v_mfma_f32_16x16x32_bf16 v[124:127], a[240:243], v[4:7], 0
    v_add_f32 v206, v206, v167
    v_cvt_pk_bf16_f32 v163, v166, v167
    v_mfma_f32_16x16x32_bf16 v[124:127], a[244:247], v[32:35], v[124:127]
    v_add_f32 v200, v200, v112
    v_add_f32 v200, v200, v113
    v_mfma_f32_16x16x32_bf16 v[124:127], a[248:251], v[60:63], v[124:127]
    v_cvt_pk_bf16_f32 v112, v112, v113
    v_add_f32 v200, v200, v114
    v_mfma_f32_16x16x32_bf16 v[124:127], a[252:255], v[88:91], v[124:127]
    v_exp_f32 v120, v120
    v_mfma_f32_16x16x32_bf16 a[192:195], v[168:171], v[160:163], a[192:195]
    ds_read_b64_tr_b16 v[168:169], v228 offset:8192
    v_add_f32 v200, v200, v115
    v_mfma_f32_16x16x32_bf16 a[196:199], v[172:175], v[160:163], a[196:199]
    ds_read_b64_tr_b16 v[170:171], v228 offset:12288
    v_cvt_pk_bf16_f32 v113, v114, v115
    v_mfma_f32_16x16x32_bf16 a[200:203], v[176:179], v[160:163], a[200:203]
    ds_read_b64_tr_b16 v[172:173], v229 offset:8192
    v_add_f32 v200, v200, v116
    v_mfma_f32_16x16x32_bf16 a[204:207], v[180:183], v[160:163], a[204:207]
    ds_read_b64_tr_b16 v[174:175], v229 offset:12288
    v_add_f32 v200, v200, v117
    v_mfma_f32_16x16x32_bf16 a[208:211], v[184:187], v[160:163], a[208:211]
    ds_read_b64_tr_b16 v[176:177], v230 offset:8192
    v_cvt_pk_bf16_f32 v114, v116, v117
    v_mfma_f32_16x16x32_bf16 a[212:215], v[188:191], v[160:163], a[212:215]
    ds_read_b64_tr_b16 v[178:179], v230 offset:12288
    v_add_f32 v200, v200, v118
    v_mfma_f32_16x16x32_bf16 a[216:219], v[192:195], v[160:163], a[216:219]
    ds_read_b64_tr_b16 v[180:181], v231 offset:8192
    v_add_f32 v200, v200, v119
    v_mfma_f32_16x16x32_bf16 a[220:223], v[196:199], v[160:163], a[220:223]
    ds_read_b64_tr_b16 v[182:183], v231 offset:12288
    v_cvt_pk_bf16_f32 v115, v118, v119
    v_mfma_f32_16x16x32_bf16 v[128:131], a[224:227], v[8:11], 0
    ds_read_b64_tr_b16 v[184:185], v232 offset:8192
    v_add_f32 v201, v201, v120
    v_mfma_f32_16x16x32_bf16 v[128:131], a[228:231], v[36:39], v[128:131]
    ds_read_b64_tr_b16 v[186:187], v232 offset:12288
    v_mfma_f32_16x16x32_bf16 v[128:131], a[232:235], v[64:67], v[128:131]
    ds_read_b64_tr_b16 v[188:189], v233 offset:8192
    v_mfma_f32_16x16x32_bf16 v[128:131], a[236:239], v[92:95], v[128:131]
    ds_read_b64_tr_b16 v[190:191], v233 offset:12288
    v_mfma_f32_16x16x32_bf16 v[132:135], a[240:243], v[8:11], 0
    ds_read_b64_tr_b16 v[192:193], v234 offset:8192
    ds_read_b64_tr_b16 v[194:195], v234 offset:12288
    v_mfma_f32_16x16x32_bf16 v[132:135], a[244:247], v[36:39], v[132:135]
    ds_read_b64_tr_b16 v[196:197], v235 offset:8192
    ds_read_b64_tr_b16 v[198:199], v235 offset:12288
    v_mfma_f32_16x16x32_bf16 v[132:135], a[248:251], v[64:67], v[132:135]
    v_exp_f32 v121, v121
    v_mfma_f32_16x16x32_bf16 v[132:135], a[252:255], v[92:95], v[132:135]
    s_waitcnt lgkmcnt(12)
    v_exp_f32 v122, v122
    v_mfma_f32_16x16x32_bf16 a[0:3], v[168:171], v[112:115], a[0:3]
    v_exp_f32 v123, v123
    v_mfma_f32_16x16x32_bf16 a[4:7], v[172:175], v[112:115], a[4:7]
    s_waitcnt lgkmcnt(8)
    v_exp_f32 v124, v124
    v_mfma_f32_16x16x32_bf16 a[8:11], v[176:179], v[112:115], a[8:11]
    v_exp_f32 v125, v125
    v_mfma_f32_16x16x32_bf16 a[12:15], v[180:183], v[112:115], a[12:15]
    s_waitcnt lgkmcnt(4)
    v_exp_f32 v126, v126
    v_mfma_f32_16x16x32_bf16 a[16:19], v[184:187], v[112:115], a[16:19]
    v_exp_f32 v127, v127
    v_mfma_f32_16x16x32_bf16 a[20:23], v[188:191], v[112:115], a[20:23]
    s_waitcnt lgkmcnt(0)
    v_exp_f32 v128, v128
    v_mfma_f32_16x16x32_bf16 a[24:27], v[192:195], v[112:115], a[24:27]
    v_exp_f32 v129, v129
    v_add_f32 v201, v201, v121
    v_mfma_f32_16x16x32_bf16 a[28:31], v[196:199], v[112:115], a[28:31]
    v_exp_f32 v130, v130
    v_cvt_pk_bf16_f32 v120, v120, v121
    v_mfma_f32_16x16x32_bf16 v[136:139], a[224:227], v[12:15], 0
    s_waitcnt vmcnt(4)
    buffer_load_dwordx4 v250, s[12:15], s41 offen offset:1024 nt lds
    v_add_f32 v201, v201, v122
    v_mfma_f32_16x16x32_bf16 v[136:139], a[228:231], v[40:43], v[136:139]
    v_add_f32 v201, v201, v123
    v_cvt_pk_bf16_f32 v121, v122, v123
    v_add_f32 v201, v201, v124
    v_mfma_f32_16x16x32_bf16 v[136:139], a[232:235], v[68:71], v[136:139]
    v_add_f32 v201, v201, v125
    v_cvt_pk_bf16_f32 v122, v124, v125
    v_mfma_f32_16x16x32_bf16 v[136:139], a[236:239], v[96:99], v[136:139]
    v_add_f32 v201, v201, v126
    v_add_f32 v201, v201, v127
    v_mfma_f32_16x16x32_bf16 v[140:143], a[240:243], v[12:15], 0
    s_waitcnt vmcnt(4)
    buffer_load_dwordx4 v251, s[12:15], s41 offen offset:2048 nt lds
    v_mfma_f32_16x16x32_bf16 v[140:143], a[244:247], v[40:43], v[140:143]
    v_cvt_pk_bf16_f32 v123, v126, v127
    v_add_f32 v202, v202, v128
    v_mfma_f32_16x16x32_bf16 v[140:143], a[248:251], v[68:71], v[140:143]
    v_exp_f32 v131, v131
    v_mfma_f32_16x16x32_bf16 v[140:143], a[252:255], v[96:99], v[140:143]
    v_exp_f32 v132, v132
    v_mfma_f32_16x16x32_bf16 a[32:35], v[168:171], v[120:123], a[32:35]
    v_exp_f32 v133, v133
    v_mfma_f32_16x16x32_bf16 a[36:39], v[172:175], v[120:123], a[36:39]
    v_exp_f32 v134, v134
    v_mfma_f32_16x16x32_bf16 a[40:43], v[176:179], v[120:123], a[40:43]
    v_exp_f32 v135, v135
    v_mfma_f32_16x16x32_bf16 a[44:47], v[180:183], v[120:123], a[44:47]
    v_exp_f32 v136, v136
    v_mfma_f32_16x16x32_bf16 a[48:51], v[184:187], v[120:123], a[48:51]
    v_exp_f32 v137, v137
    v_mfma_f32_16x16x32_bf16 a[52:55], v[188:191], v[120:123], a[52:55]
    v_exp_f32 v138, v138
    v_mfma_f32_16x16x32_bf16 a[56:59], v[192:195], v[120:123], a[56:59]
    v_exp_f32 v139, v139
    v_mfma_f32_16x16x32_bf16 a[60:63], v[196:199], v[120:123], a[60:63]
    v_exp_f32 v140, v140
    v_add_f32 v202, v202, v129
    v_mfma_f32_16x16x32_bf16 v[144:147], a[224:227], v[16:19], 0
    s_waitcnt vmcnt(4)
    buffer_load_dwordx4 v252, s[12:15], s41 offen offset:3072 nt lds
    v_cvt_pk_bf16_f32 v128, v128, v129
    v_mfma_f32_16x16x32_bf16 v[144:147], a[228:231], v[44:47], v[144:147]
    v_add_f32 v202, v202, v130
    v_add_f32 v202, v202, v131
    v_mfma_f32_16x16x32_bf16 v[144:147], a[232:235], v[72:75], v[144:147]
    v_cvt_pk_bf16_f32 v129, v130, v131
    v_add_f32 v202, v202, v132
    v_mfma_f32_16x16x32_bf16 v[144:147], a[236:239], v[100:103], v[144:147]
    v_add_f32 v202, v202, v133
    v_cvt_pk_bf16_f32 v130, v132, v133
    v_mfma_f32_16x16x32_bf16 v[148:151], a[240:243], v[16:19], 0
    v_add_f32 v202, v202, v134
    v_add_f32 v202, v202, v135
    v_mfma_f32_16x16x32_bf16 v[148:151], a[244:247], v[44:47], v[148:151]
    v_cvt_pk_bf16_f32 v131, v134, v135
    v_add_f32 v203, v203, v136
    v_mfma_f32_16x16x32_bf16 v[148:151], a[248:251], v[72:75], v[148:151]
    v_exp_f32 v141, v141
    v_mfma_f32_16x16x32_bf16 v[148:151], a[252:255], v[100:103], v[148:151]
    v_exp_f32 v142, v142
    v_mfma_f32_16x16x32_bf16 a[64:67], v[168:171], v[128:131], a[64:67]
    v_exp_f32 v143, v143
    v_mfma_f32_16x16x32_bf16 a[68:71], v[172:175], v[128:131], a[68:71]
    v_exp_f32 v144, v144
    v_mfma_f32_16x16x32_bf16 a[72:75], v[176:179], v[128:131], a[72:75]
    v_exp_f32 v145, v145
    v_mfma_f32_16x16x32_bf16 a[76:79], v[180:183], v[128:131], a[76:79]
    v_exp_f32 v146, v146
    v_mfma_f32_16x16x32_bf16 a[80:83], v[184:187], v[128:131], a[80:83]
    v_exp_f32 v147, v147
    v_mfma_f32_16x16x32_bf16 a[84:87], v[188:191], v[128:131], a[84:87]
    v_exp_f32 v148, v148
    v_mfma_f32_16x16x32_bf16 a[88:91], v[192:195], v[128:131], a[88:91]
    v_exp_f32 v149, v149
    v_mfma_f32_16x16x32_bf16 a[92:95], v[196:199], v[128:131], a[92:95]
    s_add_u32 m0, s29, 114688
    v_exp_f32 v150, v150
    v_add_f32 v203, v203, v137
    v_mfma_f32_16x16x32_bf16 v[152:155], a[224:227], v[20:23], 0
    s_waitcnt vmcnt(4)
    buffer_load_dwordx4 v249, s[16:19], s41 offen offset:0 nt lds
    v_cvt_pk_bf16_f32 v136, v136, v137
    v_mfma_f32_16x16x32_bf16 v[152:155], a[228:231], v[48:51], v[152:155]
    v_add_f32 v203, v203, v138
    v_add_f32 v203, v203, v139
    v_mfma_f32_16x16x32_bf16 v[152:155], a[232:235], v[76:79], v[152:155]
    v_cvt_pk_bf16_f32 v137, v138, v139
    v_add_f32 v203, v203, v140
    v_mfma_f32_16x16x32_bf16 v[152:155], a[236:239], v[104:107], v[152:155]
    v_add_f32 v203, v203, v141
    v_cvt_pk_bf16_f32 v138, v140, v141
    v_mfma_f32_16x16x32_bf16 v[156:159], a[240:243], v[20:23], 0
    v_add_f32 v203, v203, v142
    v_add_f32 v203, v203, v143
    v_mfma_f32_16x16x32_bf16 v[156:159], a[244:247], v[48:51], v[156:159]
    v_cvt_pk_bf16_f32 v139, v142, v143
    v_add_f32 v204, v204, v144
    v_mfma_f32_16x16x32_bf16 v[156:159], a[248:251], v[76:79], v[156:159]
    v_exp_f32 v151, v151
    v_mfma_f32_16x16x32_bf16 v[156:159], a[252:255], v[104:107], v[156:159]
    v_exp_f32 v152, v152
    v_mfma_f32_16x16x32_bf16 a[96:99], v[168:171], v[136:139], a[96:99]
    v_exp_f32 v153, v153
    v_mfma_f32_16x16x32_bf16 a[100:103], v[172:175], v[136:139], a[100:103]
    v_exp_f32 v154, v154
    v_mfma_f32_16x16x32_bf16 a[104:107], v[176:179], v[136:139], a[104:107]
    v_exp_f32 v155, v155
    v_mfma_f32_16x16x32_bf16 a[108:111], v[180:183], v[136:139], a[108:111]
    v_exp_f32 v156, v156
    v_mfma_f32_16x16x32_bf16 a[112:115], v[184:187], v[136:139], a[112:115]
    s_waitcnt vmcnt(13)
    v_exp_f32 v157, v157
    v_mfma_f32_16x16x32_bf16 a[116:119], v[188:191], v[136:139], a[116:119]
    s_barrier
    v_exp_f32 v158, v158
    v_add_f32 v204, v204, v145
    v_mfma_f32_16x16x32_bf16 a[120:123], v[192:195], v[136:139], a[120:123]
    v_exp_f32 v159, v159
    v_cvt_pk_bf16_f32 v144, v144, v145
    v_mfma_f32_16x16x32_bf16 a[124:127], v[196:199], v[136:139], a[124:127]
    v_add_f32 v204, v204, v146
    v_add_f32 v204, v204, v147
    v_cvt_pk_bf16_f32 v145, v146, v147
    v_mfma_f32_16x16x32_bf16 v[160:163], a[224:227], v[24:27], 0
    v_add_f32 v204, v204, v148
    v_add_f32 v204, v204, v149
    v_cvt_pk_bf16_f32 v146, v148, v149
    v_mfma_f32_16x16x32_bf16 v[160:163], a[228:231], v[52:55], v[160:163]
    ds_read_b128 a[224:227], v224 offset:16384
    v_add_f32 v204, v204, v150
    v_mfma_f32_16x16x32_bf16 v[160:163], a[232:235], v[80:83], v[160:163]
    ds_read_b128 a[228:231], v225 offset:16384
    v_add_f32 v204, v204, v151
    v_mfma_f32_16x16x32_bf16 v[160:163], a[236:239], v[108:111], v[160:163]
    ds_read_b128 a[232:235], v226 offset:16384
    v_cvt_pk_bf16_f32 v147, v150, v151
    v_mfma_f32_16x16x32_bf16 v[164:167], a[240:243], v[24:27], 0
    ds_read_b128 a[236:239], v227 offset:16384
    v_add_f32 v205, v205, v152
    v_mfma_f32_16x16x32_bf16 v[164:167], a[244:247], v[52:55], v[164:167]
    ds_read_b128 a[240:243], v224 offset:20480
    v_add_f32 v205, v205, v153
    v_mfma_f32_16x16x32_bf16 v[164:167], a[248:251], v[80:83], v[164:167]
    ds_read_b128 a[244:247], v225 offset:20480
    v_cvt_pk_bf16_f32 v152, v152, v153
    v_mfma_f32_16x16x32_bf16 v[164:167], a[252:255], v[108:111], v[164:167]
    ds_read_b128 a[248:251], v226 offset:20480
    v_add_f32 v205, v205, v154
    v_mfma_f32_16x16x32_bf16 a[128:131], v[168:171], v[144:147], a[128:131]
    ds_read_b128 a[252:255], v227 offset:20480
    v_add_f32 v205, v205, v155
    v_mfma_f32_16x16x32_bf16 a[132:135], v[172:175], v[144:147], a[132:135]
    v_exp_f32 v160, v160
    v_mfma_f32_16x16x32_bf16 a[136:139], v[176:179], v[144:147], a[136:139]
    v_exp_f32 v161, v161
    v_mfma_f32_16x16x32_bf16 a[140:143], v[180:183], v[144:147], a[140:143]
    s_waitcnt vmcnt(4)
    buffer_load_dwordx4 v250, s[16:19], s41 offen offset:1024 nt lds
    v_mfma_f32_16x16x32_bf16 a[144:147], v[184:187], v[144:147], a[144:147]
    v_exp_f32 v162, v162
    v_mfma_f32_16x16x32_bf16 a[148:151], v[188:191], v[144:147], a[148:151]
    v_exp_f32 v163, v163
    v_mfma_f32_16x16x32_bf16 a[152:155], v[192:195], v[144:147], a[152:155]
    s_waitcnt lgkmcnt(4)
    v_exp_f32 v164, v164
    v_mfma_f32_16x16x32_bf16 a[156:159], v[196:199], v[144:147], a[156:159]
    v_exp_f32 v165, v165
    v_mfma_f32_16x16x32_bf16 v[112:115], a[224:227], v[0:3], 0
    v_exp_f32 v166, v166
    v_mfma_f32_16x16x32_bf16 v[112:115], a[228:231], v[28:31], v[112:115]
    v_cvt_pk_bf16_f32 v153, v154, v155
    v_add_f32 v205, v205, v156
    v_mfma_f32_16x16x32_bf16 v[112:115], a[232:235], v[56:59], v[112:115]
    s_waitcnt lgkmcnt(0)
    v_add_f32 v205, v205, v157
    v_cvt_pk_bf16_f32 v154, v156, v157
    v_mfma_f32_16x16x32_bf16 v[112:115], a[236:239], v[84:87], v[112:115]
    v_add_f32 v205, v205, v158
    v_add_f32 v205, v205, v159
    v_mfma_f32_16x16x32_bf16 v[116:119], a[240:243], v[0:3], 0
    v_cvt_pk_bf16_f32 v155, v158, v159
    v_add_f32 v206, v206, v160
    v_mfma_f32_16x16x32_bf16 v[116:119], a[244:247], v[28:31], v[116:119]
    s_waitcnt vmcnt(4)
    buffer_load_dwordx4 v251, s[16:19], s41 offen offset:2048 nt lds
    v_mfma_f32_16x16x32_bf16 v[116:119], a[248:251], v[56:59], v[116:119]
    v_exp_f32 v167, v167
    v_mfma_f32_16x16x32_bf16 v[116:119], a[252:255], v[84:87], v[116:119]
    v_exp_f32 v112, v112
    v_mfma_f32_16x16x32_bf16 a[160:163], v[168:171], v[152:155], a[160:163]
    v_exp_f32 v113, v113
    v_mfma_f32_16x16x32_bf16 a[164:167], v[172:175], v[152:155], a[164:167]
    v_exp_f32 v114, v114
    v_mfma_f32_16x16x32_bf16 a[168:171], v[176:179], v[152:155], a[168:171]
    v_exp_f32 v115, v115
    v_mfma_f32_16x16x32_bf16 a[172:175], v[180:183], v[152:155], a[172:175]
    v_exp_f32 v116, v116
    v_mfma_f32_16x16x32_bf16 a[176:179], v[184:187], v[152:155], a[176:179]
    v_exp_f32 v117, v117
    v_mfma_f32_16x16x32_bf16 a[180:183], v[188:191], v[152:155], a[180:183]
    v_exp_f32 v118, v118
    v_mfma_f32_16x16x32_bf16 a[184:187], v[192:195], v[152:155], a[184:187]
    v_exp_f32 v119, v119
    v_mfma_f32_16x16x32_bf16 a[188:191], v[196:199], v[152:155], a[188:191]
    v_add_f32 v206, v206, v161
    v_cvt_pk_bf16_f32 v160, v160, v161
    v_mfma_f32_16x16x32_bf16 v[120:123], a[224:227], v[4:7], 0
    v_add_f32 v206, v206, v162
    v_add_f32 v206, v206, v163
    v_mfma_f32_16x16x32_bf16 v[120:123], a[228:231], v[32:35], v[120:123]
    v_cvt_pk_bf16_f32 v161, v162, v163
    v_add_f32 v206, v206, v164
    v_mfma_f32_16x16x32_bf16 v[120:123], a[232:235], v[60:63], v[120:123]
    s_waitcnt vmcnt(4)
    buffer_load_dwordx4 v252, s[16:19], s41 offen offset:3072 nt lds
    v_mfma_f32_16x16x32_bf16 v[120:123], a[236:239], v[88:91], v[120:123]
    v_add_f32 v206, v206, v165
    v_cvt_pk_bf16_f32 v162, v164, v165
    v_mfma_f32_16x16x32_bf16 v[124:127], a[240:243], v[4:7], 0
    v_add_f32 v206, v206, v166
    v_add_f32 v206, v206, v167
    v_mfma_f32_16x16x32_bf16 v[124:127], a[244:247], v[32:35], v[124:127]
    v_cvt_pk_bf16_f32 v163, v166, v167
    v_add_f32 v200, v200, v112
    v_mfma_f32_16x16x32_bf16 v[124:127], a[248:251], v[60:63], v[124:127]
    v_add_f32 v200, v200, v113
    v_cvt_pk_bf16_f32 v112, v112, v113
    v_mfma_f32_16x16x32_bf16 v[124:127], a[252:255], v[88:91], v[124:127]
    v_exp_f32 v120, v120
    v_mfma_f32_16x16x32_bf16 a[192:195], v[168:171], v[160:163], a[192:195]
    ds_read_b64_tr_b16 v[168:169], v228 offset:16384
    v_add_f32 v200, v200, v114
    v_mfma_f32_16x16x32_bf16 a[196:199], v[172:175], v[160:163], a[196:199]
    ds_read_b64_tr_b16 v[170:171], v228 offset:20480
    v_add_f32 v200, v200, v115
    v_mfma_f32_16x16x32_bf16 a[200:203], v[176:179], v[160:163], a[200:203]
    ds_read_b64_tr_b16 v[172:173], v229 offset:16384
    v_cvt_pk_bf16_f32 v113, v114, v115
    v_mfma_f32_16x16x32_bf16 a[204:207], v[180:183], v[160:163], a[204:207]
    ds_read_b64_tr_b16 v[174:175], v229 offset:20480
    v_add_f32 v200, v200, v116
    v_mfma_f32_16x16x32_bf16 a[208:211], v[184:187], v[160:163], a[208:211]
    ds_read_b64_tr_b16 v[176:177], v230 offset:16384
    v_add_f32 v200, v200, v117
    v_mfma_f32_16x16x32_bf16 a[212:215], v[188:191], v[160:163], a[212:215]
    ds_read_b64_tr_b16 v[178:179], v230 offset:20480
    v_cvt_pk_bf16_f32 v114, v116, v117
    v_mfma_f32_16x16x32_bf16 a[216:219], v[192:195], v[160:163], a[216:219]
    ds_read_b64_tr_b16 v[180:181], v231 offset:16384
    v_add_f32 v200, v200, v118
    v_mfma_f32_16x16x32_bf16 a[220:223], v[196:199], v[160:163], a[220:223]
    ds_read_b64_tr_b16 v[182:183], v231 offset:20480
    v_add_f32 v200, v200, v119
    v_mfma_f32_16x16x32_bf16 v[128:131], a[224:227], v[8:11], 0
    ds_read_b64_tr_b16 v[184:185], v232 offset:16384
    v_cvt_pk_bf16_f32 v115, v118, v119
    v_mfma_f32_16x16x32_bf16 v[128:131], a[228:231], v[36:39], v[128:131]
    ds_read_b64_tr_b16 v[186:187], v232 offset:20480
    v_add_f32 v201, v201, v120
    v_mfma_f32_16x16x32_bf16 v[128:131], a[232:235], v[64:67], v[128:131]
    ds_read_b64_tr_b16 v[188:189], v233 offset:16384
    v_mfma_f32_16x16x32_bf16 v[128:131], a[236:239], v[92:95], v[128:131]
    ds_read_b64_tr_b16 v[190:191], v233 offset:20480
    v_mfma_f32_16x16x32_bf16 v[132:135], a[240:243], v[8:11], 0
    ds_read_b64_tr_b16 v[192:193], v234 offset:16384
    ds_read_b64_tr_b16 v[194:195], v234 offset:20480
    v_mfma_f32_16x16x32_bf16 v[132:135], a[244:247], v[36:39], v[132:135]
    ds_read_b64_tr_b16 v[196:197], v235 offset:16384
    ds_read_b64_tr_b16 v[198:199], v235 offset:20480
    v_mfma_f32_16x16x32_bf16 v[132:135], a[248:251], v[64:67], v[132:135]
    v_exp_f32 v121, v121
    v_mfma_f32_16x16x32_bf16 v[132:135], a[252:255], v[92:95], v[132:135]
    s_waitcnt lgkmcnt(12)
    v_exp_f32 v122, v122
    v_mfma_f32_16x16x32_bf16 a[0:3], v[168:171], v[112:115], a[0:3]
    v_exp_f32 v123, v123
    v_mfma_f32_16x16x32_bf16 a[4:7], v[172:175], v[112:115], a[4:7]
    s_waitcnt lgkmcnt(8)
    v_exp_f32 v124, v124
    v_mfma_f32_16x16x32_bf16 a[8:11], v[176:179], v[112:115], a[8:11]
    v_exp_f32 v125, v125
    v_mfma_f32_16x16x32_bf16 a[12:15], v[180:183], v[112:115], a[12:15]
    s_waitcnt lgkmcnt(4)
    v_exp_f32 v126, v126
    v_mfma_f32_16x16x32_bf16 a[16:19], v[184:187], v[112:115], a[16:19]
    v_exp_f32 v127, v127
    v_mfma_f32_16x16x32_bf16 a[20:23], v[188:191], v[112:115], a[20:23]
    s_waitcnt lgkmcnt(0)
    v_exp_f32 v128, v128
    v_mfma_f32_16x16x32_bf16 a[24:27], v[192:195], v[112:115], a[24:27]
    s_add_u32 s41, s43, 90112
    v_exp_f32 v129, v129
    v_add_f32 v201, v201, v121
    v_mfma_f32_16x16x32_bf16 a[28:31], v[196:199], v[112:115], a[28:31]
    s_add_u32 m0, s29, 0
    v_exp_f32 v130, v130
    v_cvt_pk_bf16_f32 v120, v120, v121
    v_mfma_f32_16x16x32_bf16 v[136:139], a[224:227], v[12:15], 0
    s_waitcnt vmcnt(4)
    buffer_load_dwordx4 v249, s[12:15], s41 offen offset:0 nt lds
    v_add_f32 v201, v201, v122
    v_mfma_f32_16x16x32_bf16 v[136:139], a[228:231], v[40:43], v[136:139]
    v_add_f32 v201, v201, v123
    v_cvt_pk_bf16_f32 v121, v122, v123
    v_add_f32 v201, v201, v124
    v_mfma_f32_16x16x32_bf16 v[136:139], a[232:235], v[68:71], v[136:139]
    v_add_f32 v201, v201, v125
    v_cvt_pk_bf16_f32 v122, v124, v125
    v_mfma_f32_16x16x32_bf16 v[136:139], a[236:239], v[96:99], v[136:139]
    v_add_f32 v201, v201, v126
    v_add_f32 v201, v201, v127
    v_mfma_f32_16x16x32_bf16 v[140:143], a[240:243], v[12:15], 0
    s_waitcnt vmcnt(4)
    buffer_load_dwordx4 v250, s[12:15], s41 offen offset:1024 nt lds
    v_mfma_f32_16x16x32_bf16 v[140:143], a[244:247], v[40:43], v[140:143]
    v_cvt_pk_bf16_f32 v123, v126, v127
    v_add_f32 v202, v202, v128
    v_mfma_f32_16x16x32_bf16 v[140:143], a[248:251], v[68:71], v[140:143]
    v_exp_f32 v131, v131
    v_mfma_f32_16x16x32_bf16 v[140:143], a[252:255], v[96:99], v[140:143]
    v_exp_f32 v132, v132
    v_mfma_f32_16x16x32_bf16 a[32:35], v[168:171], v[120:123], a[32:35]
    v_exp_f32 v133, v133
    v_mfma_f32_16x16x32_bf16 a[36:39], v[172:175], v[120:123], a[36:39]
    v_exp_f32 v134, v134
    v_mfma_f32_16x16x32_bf16 a[40:43], v[176:179], v[120:123], a[40:43]
    v_exp_f32 v135, v135
    v_mfma_f32_16x16x32_bf16 a[44:47], v[180:183], v[120:123], a[44:47]
    v_exp_f32 v136, v136
    v_mfma_f32_16x16x32_bf16 a[48:51], v[184:187], v[120:123], a[48:51]
    v_exp_f32 v137, v137
    v_mfma_f32_16x16x32_bf16 a[52:55], v[188:191], v[120:123], a[52:55]
    v_exp_f32 v138, v138
    v_mfma_f32_16x16x32_bf16 a[56:59], v[192:195], v[120:123], a[56:59]
    v_exp_f32 v139, v139
    v_mfma_f32_16x16x32_bf16 a[60:63], v[196:199], v[120:123], a[60:63]
    v_exp_f32 v140, v140
    v_add_f32 v202, v202, v129
    v_mfma_f32_16x16x32_bf16 v[144:147], a[224:227], v[16:19], 0
    v_exp_f32 v141, v141
    v_cvt_pk_bf16_f32 v128, v128, v129
    v_mfma_f32_16x16x32_bf16 v[144:147], a[228:231], v[44:47], v[144:147]
    v_add_f32 v202, v202, v130
    v_add_f32 v202, v202, v131
    v_cvt_pk_bf16_f32 v129, v130, v131
    v_mfma_f32_16x16x32_bf16 v[144:147], a[232:235], v[72:75], v[144:147]
    v_add_f32 v202, v202, v132
    v_add_f32 v202, v202, v133
    v_cvt_pk_bf16_f32 v130, v132, v133
    v_mfma_f32_16x16x32_bf16 v[144:147], a[236:239], v[100:103], v[144:147]
    v_add_f32 v202, v202, v134
    v_add_f32 v202, v202, v135
    v_mfma_f32_16x16x32_bf16 v[148:151], a[240:243], v[16:19], 0
    s_waitcnt vmcnt(4)
    buffer_load_dwordx4 v251, s[12:15], s41 offen offset:2048 nt lds
    v_mfma_f32_16x16x32_bf16 v[148:151], a[244:247], v[44:47], v[148:151]
    v_cvt_pk_bf16_f32 v131, v134, v135
    v_add_f32 v203, v203, v136
    v_mfma_f32_16x16x32_bf16 v[148:151], a[248:251], v[72:75], v[148:151]
    v_exp_f32 v142, v142
    v_mfma_f32_16x16x32_bf16 v[148:151], a[252:255], v[100:103], v[148:151]
    v_exp_f32 v143, v143
    v_mfma_f32_16x16x32_bf16 a[64:67], v[168:171], v[128:131], a[64:67]
    v_exp_f32 v144, v144
    v_mfma_f32_16x16x32_bf16 a[68:71], v[172:175], v[128:131], a[68:71]
    v_exp_f32 v145, v145
    v_mfma_f32_16x16x32_bf16 a[72:75], v[176:179], v[128:131], a[72:75]
    v_exp_f32 v146, v146
    v_mfma_f32_16x16x32_bf16 a[76:79], v[180:183], v[128:131], a[76:79]
    v_exp_f32 v147, v147
    v_mfma_f32_16x16x32_bf16 a[80:83], v[184:187], v[128:131], a[80:83]
    v_exp_f32 v148, v148
    v_mfma_f32_16x16x32_bf16 a[84:87], v[188:191], v[128:131], a[84:87]
    v_exp_f32 v149, v149
    v_mfma_f32_16x16x32_bf16 a[88:91], v[192:195], v[128:131], a[88:91]
    v_exp_f32 v150, v150
    v_mfma_f32_16x16x32_bf16 a[92:95], v[196:199], v[128:131], a[92:95]
    v_exp_f32 v151, v151
    v_add_f32 v203, v203, v137
    v_mfma_f32_16x16x32_bf16 v[152:155], a[224:227], v[20:23], 0
    v_cvt_pk_bf16_f32 v136, v136, v137
    v_add_f32 v203, v203, v138
    v_add_f32 v203, v203, v139
    v_mfma_f32_16x16x32_bf16 v[152:155], a[228:231], v[48:51], v[152:155]
    v_cvt_pk_bf16_f32 v137, v138, v139
    v_add_f32 v203, v203, v140
    v_mfma_f32_16x16x32_bf16 v[152:155], a[232:235], v[76:79], v[152:155]
    v_add_f32 v203, v203, v141
    v_cvt_pk_bf16_f32 v138, v140, v141
    v_mfma_f32_16x16x32_bf16 v[152:155], a[236:239], v[104:107], v[152:155]
    v_add_f32 v203, v203, v142
    v_add_f32 v203, v203, v143
    v_mfma_f32_16x16x32_bf16 v[156:159], a[240:243], v[20:23], 0
    s_waitcnt vmcnt(4)
    buffer_load_dwordx4 v252, s[12:15], s41 offen offset:3072 nt lds
    v_mfma_f32_16x16x32_bf16 v[156:159], a[244:247], v[48:51], v[156:159]
    v_cvt_pk_bf16_f32 v139, v142, v143
    v_add_f32 v204, v204, v144
    v_mfma_f32_16x16x32_bf16 v[156:159], a[248:251], v[76:79], v[156:159]
    v_add_f32 v204, v204, v145
    v_cvt_pk_bf16_f32 v144, v144, v145
    v_mfma_f32_16x16x32_bf16 v[156:159], a[252:255], v[104:107], v[156:159]
    v_exp_f32 v152, v152
    v_mfma_f32_16x16x32_bf16 a[96:99], v[168:171], v[136:139], a[96:99]
    v_exp_f32 v153, v153
    v_mfma_f32_16x16x32_bf16 a[100:103], v[172:175], v[136:139], a[100:103]
    v_exp_f32 v154, v154
    v_mfma_f32_16x16x32_bf16 a[104:107], v[176:179], v[136:139], a[104:107]
    v_exp_f32 v155, v155
    v_mfma_f32_16x16x32_bf16 a[108:111], v[180:183], v[136:139], a[108:111]
    v_exp_f32 v156, v156
    v_mfma_f32_16x16x32_bf16 a[112:115], v[184:187], v[136:139], a[112:115]
    s_waitcnt vmcnt(12)
    v_exp_f32 v157, v157
    v_mfma_f32_16x16x32_bf16 a[116:119], v[188:191], v[136:139], a[116:119]
    s_barrier
    v_exp_f32 v158, v158
    v_mfma_f32_16x16x32_bf16 a[120:123], v[192:195], v[136:139], a[120:123]
    v_exp_f32 v159, v159
    v_add_f32 v204, v204, v146
    v_mfma_f32_16x16x32_bf16 a[124:127], v[196:199], v[136:139], a[124:127]
    v_add_f32 v204, v204, v147
    v_cvt_pk_bf16_f32 v145, v146, v147
    v_add_f32 v204, v204, v148
    v_mfma_f32_16x16x32_bf16 v[160:163], a[224:227], v[24:27], 0
    v_add_f32 v204, v204, v149
    v_cvt_pk_bf16_f32 v146, v148, v149
    v_mfma_f32_16x16x32_bf16 v[160:163], a[228:231], v[52:55], v[160:163]
    ds_read_b128 a[224:227], v224 offset:24576
    v_add_f32 v204, v204, v150
    v_mfma_f32_16x16x32_bf16 v[160:163], a[232:235], v[80:83], v[160:163]
    ds_read_b128 a[228:231], v225 offset:24576
    v_add_f32 v204, v204, v151
    v_mfma_f32_16x16x32_bf16 v[160:163], a[236:239], v[108:111], v[160:163]
    ds_read_b128 a[232:235], v226 offset:24576
    v_cvt_pk_bf16_f32 v147, v150, v151
    v_mfma_f32_16x16x32_bf16 v[164:167], a[240:243], v[24:27], 0
    ds_read_b128 a[236:239], v227 offset:24576
    v_add_f32 v205, v205, v152
    v_mfma_f32_16x16x32_bf16 v[164:167], a[244:247], v[52:55], v[164:167]
    ds_read_b128 a[240:243], v224 offset:28672
    v_add_f32 v205, v205, v153
    v_mfma_f32_16x16x32_bf16 v[164:167], a[248:251], v[80:83], v[164:167]
    ds_read_b128 a[244:247], v225 offset:28672
    v_cvt_pk_bf16_f32 v152, v152, v153
    v_mfma_f32_16x16x32_bf16 v[164:167], a[252:255], v[108:111], v[164:167]
    ds_read_b128 a[248:251], v226 offset:28672
    v_add_f32 v205, v205, v154
    v_mfma_f32_16x16x32_bf16 a[128:131], v[168:171], v[144:147], a[128:131]
    ds_read_b128 a[252:255], v227 offset:28672
    v_add_f32 v205, v205, v155
    v_mfma_f32_16x16x32_bf16 a[132:135], v[172:175], v[144:147], a[132:135]
    v_exp_f32 v160, v160
    v_mfma_f32_16x16x32_bf16 a[136:139], v[176:179], v[144:147], a[136:139]
    s_add_u32 m0, s29, 81920
    v_exp_f32 v161, v161
    v_mfma_f32_16x16x32_bf16 a[140:143], v[180:183], v[144:147], a[140:143]
    s_waitcnt vmcnt(4)
Lpg9:
    s_cbranch_execz Lpg10
    buffer_load_dwordx4 v249, s[16:19], s41 offen offset:0 nt lds
    v_mfma_f32_16x16x32_bf16 a[144:147], v[184:187], v[144:147], a[144:147]
    v_exp_f32 v162, v162
    v_mfma_f32_16x16x32_bf16 a[148:151], v[188:191], v[144:147], a[148:151]
    v_exp_f32 v163, v163
    v_mfma_f32_16x16x32_bf16 a[152:155], v[192:195], v[144:147], a[152:155]
    s_waitcnt lgkmcnt(4)
    v_exp_f32 v164, v164
    v_mfma_f32_16x16x32_bf16 a[156:159], v[196:199], v[144:147], a[156:159]
    v_exp_f32 v165, v165
    v_mfma_f32_16x16x32_bf16 v[112:115], a[224:227], v[0:3], 0
    v_exp_f32 v166, v166
    v_mfma_f32_16x16x32_bf16 v[112:115], a[228:231], v[28:31], v[112:115]
    v_cvt_pk_bf16_f32 v153, v154, v155
    v_add_f32 v205, v205, v156
    v_mfma_f32_16x16x32_bf16 v[112:115], a[232:235], v[56:59], v[112:115]
    s_waitcnt lgkmcnt(0)
    v_add_f32 v205, v205, v157
    v_cvt_pk_bf16_f32 v154, v156, v157
    v_mfma_f32_16x16x32_bf16 v[112:115], a[236:239], v[84:87], v[112:115]
    v_add_f32 v205, v205, v158
    v_add_f32 v205, v205, v159
    v_mfma_f32_16x16x32_bf16 v[116:119], a[240:243], v[0:3], 0
    v_cvt_pk_bf16_f32 v155, v158, v159
    v_add_f32 v206, v206, v160
    v_mfma_f32_16x16x32_bf16 v[116:119], a[244:247], v[28:31], v[116:119]
    s_waitcnt vmcnt(4)
    buffer_load_dwordx4 v250, s[16:19], s41 offen offset:1024 nt lds
    v_mfma_f32_16x16x32_bf16 v[116:119], a[248:251], v[56:59], v[116:119]
    v_exp_f32 v167, v167
    v_mfma_f32_16x16x32_bf16 v[116:119], a[252:255], v[84:87], v[116:119]
    v_exp_f32 v112, v112
    v_mfma_f32_16x16x32_bf16 a[160:163], v[168:171], v[152:155], a[160:163]
    v_exp_f32 v113, v113
    v_mfma_f32_16x16x32_bf16 a[164:167], v[172:175], v[152:155], a[164:167]
    v_exp_f32 v114, v114
    v_mfma_f32_16x16x32_bf16 a[168:171], v[176:179], v[152:155], a[168:171]
    v_exp_f32 v115, v115
    v_mfma_f32_16x16x32_bf16 a[172:175], v[180:183], v[152:155], a[172:175]
    v_exp_f32 v116, v116
    v_mfma_f32_16x16x32_bf16 a[176:179], v[184:187], v[152:155], a[176:179]
    v_exp_f32 v117, v117
    v_mfma_f32_16x16x32_bf16 a[180:183], v[188:191], v[152:155], a[180:183]
    v_exp_f32 v118, v118
    v_mfma_f32_16x16x32_bf16 a[184:187], v[192:195], v[152:155], a[184:187]
    v_exp_f32 v119, v119
    v_mfma_f32_16x16x32_bf16 a[188:191], v[196:199], v[152:155], a[188:191]
    v_add_f32 v206, v206, v161
    v_cvt_pk_bf16_f32 v160, v160, v161
    v_mfma_f32_16x16x32_bf16 v[120:123], a[224:227], v[4:7], 0
    v_add_f32 v206, v206, v162
    v_add_f32 v206, v206, v163
    v_mfma_f32_16x16x32_bf16 v[120:123], a[228:231], v[32:35], v[120:123]
    v_cvt_pk_bf16_f32 v161, v162, v163
    v_add_f32 v206, v206, v164
    v_mfma_f32_16x16x32_bf16 v[120:123], a[232:235], v[60:63], v[120:123]
    v_add_f32 v206, v206, v165
    v_cvt_pk_bf16_f32 v162, v164, v165
    v_mfma_f32_16x16x32_bf16 v[120:123], a[236:239], v[88:91], v[120:123]
    v_add_f32 v206, v206, v166
    v_add_f32 v206, v206, v167
    v_mfma_f32_16x16x32_bf16 v[124:127], a[240:243], v[4:7], 0
    v_cvt_pk_bf16_f32 v163, v166, v167
    v_add_f32 v200, v200, v112
    v_mfma_f32_16x16x32_bf16 v[124:127], a[244:247], v[32:35], v[124:127]
    v_add_f32 v200, v200, v113
    v_cvt_pk_bf16_f32 v112, v112, v113
    v_mfma_f32_16x16x32_bf16 v[124:127], a[248:251], v[60:63], v[124:127]
    s_waitcnt vmcnt(4)
    buffer_load_dwordx4 v251, s[16:19], s41 offen offset:2048 nt lds
    v_mfma_f32_16x16x32_bf16 v[124:127], a[252:255], v[88:91], v[124:127]
    v_exp_f32 v120, v120
    v_mfma_f32_16x16x32_bf16 a[192:195], v[168:171], v[160:163], a[192:195]
    ds_read_b64_tr_b16 v[168:169], v228 offset:24576
    v_add_f32 v200, v200, v114
    v_mfma_f32_16x16x32_bf16 a[196:199], v[172:175], v[160:163], a[196:199]
    ds_read_b64_tr_b16 v[170:171], v228 offset:28672
    v_add_f32 v200, v200, v115
    v_mfma_f32_16x16x32_bf16 a[200:203], v[176:179], v[160:163], a[200:203]
    ds_read_b64_tr_b16 v[172:173], v229 offset:24576
    v_cvt_pk_bf16_f32 v113, v114, v115
    v_mfma_f32_16x16x32_bf16 a[204:207], v[180:183], v[160:163], a[204:207]
    ds_read_b64_tr_b16 v[174:175], v229 offset:28672
    v_add_f32 v200, v200, v116
    v_mfma_f32_16x16x32_bf16 a[208:211], v[184:187], v[160:163], a[208:211]
    ds_read_b64_tr_b16 v[176:177], v230 offset:24576
    v_add_f32 v200, v200, v117
    v_mfma_f32_16x16x32_bf16 a[212:215], v[188:191], v[160:163], a[212:215]
    ds_read_b64_tr_b16 v[178:179], v230 offset:28672
    v_cvt_pk_bf16_f32 v114, v116, v117
    v_mfma_f32_16x16x32_bf16 a[216:219], v[192:195], v[160:163], a[216:219]
    ds_read_b64_tr_b16 v[180:181], v231 offset:24576
    v_add_f32 v200, v200, v118
    v_mfma_f32_16x16x32_bf16 a[220:223], v[196:199], v[160:163], a[220:223]
    ds_read_b64_tr_b16 v[182:183], v231 offset:28672
    v_add_f32 v200, v200, v119
    v_mfma_f32_16x16x32_bf16 v[128:131], a[224:227], v[8:11], 0
    ds_read_b64_tr_b16 v[184:185], v232 offset:24576
    v_cvt_pk_bf16_f32 v115, v118, v119
    v_mfma_f32_16x16x32_bf16 v[128:131], a[228:231], v[36:39], v[128:131]
    ds_read_b64_tr_b16 v[186:187], v232 offset:28672
    v_add_f32 v201, v201, v120
    v_mfma_f32_16x16x32_bf16 v[128:131], a[232:235], v[64:67], v[128:131]
    ds_read_b64_tr_b16 v[188:189], v233 offset:24576
    v_mfma_f32_16x16x32_bf16 v[128:131], a[236:239], v[92:95], v[128:131]
    ds_read_b64_tr_b16 v[190:191], v233 offset:28672
    v_mfma_f32_16x16x32_bf16 v[132:135], a[240:243], v[8:11], 0
    ds_read_b64_tr_b16 v[192:193], v234 offset:24576
    ds_read_b64_tr_b16 v[194:195], v234 offset:28672
    v_mfma_f32_16x16x32_bf16 v[132:135], a[244:247], v[36:39], v[132:135]
    ds_read_b64_tr_b16 v[196:197], v235 offset:24576
    ds_read_b64_tr_b16 v[198:199], v235 offset:28672
    v_mfma_f32_16x16x32_bf16 v[132:135], a[248:251], v[64:67], v[132:135]
    v_exp_f32 v121, v121
    v_mfma_f32_16x16x32_bf16 v[132:135], a[252:255], v[92:95], v[132:135]
    s_waitcnt lgkmcnt(12)
    v_exp_f32 v122, v122
    v_mfma_f32_16x16x32_bf16 a[0:3], v[168:171], v[112:115], a[0:3]
    v_exp_f32 v123, v123
    v_mfma_f32_16x16x32_bf16 a[4:7], v[172:175], v[112:115], a[4:7]
    s_waitcnt lgkmcnt(8)
    v_exp_f32 v124, v124
    v_mfma_f32_16x16x32_bf16 a[8:11], v[176:179], v[112:115], a[8:11]
    v_exp_f32 v125, v125
    v_mfma_f32_16x16x32_bf16 a[12:15], v[180:183], v[112:115], a[12:15]
    s_waitcnt lgkmcnt(4)
    v_exp_f32 v126, v126
    v_mfma_f32_16x16x32_bf16 a[16:19], v[184:187], v[112:115], a[16:19]
    v_exp_f32 v127, v127
    v_mfma_f32_16x16x32_bf16 a[20:23], v[188:191], v[112:115], a[20:23]
    s_waitcnt lgkmcnt(0)
    v_exp_f32 v128, v128
    v_mfma_f32_16x16x32_bf16 a[24:27], v[192:195], v[112:115], a[24:27]
    v_exp_f32 v129, v129
    v_add_f32 v201, v201, v121
    v_mfma_f32_16x16x32_bf16 a[28:31], v[196:199], v[112:115], a[28:31]
    v_exp_f32 v130, v130
    v_cvt_pk_bf16_f32 v120, v120, v121
    v_mfma_f32_16x16x32_bf16 v[136:139], a[224:227], v[12:15], 0
    s_waitcnt vmcnt(4)
    buffer_load_dwordx4 v252, s[16:19], s41 offen offset:3072 nt lds
    v_add_f32 v201, v201, v122
    v_mfma_f32_16x16x32_bf16 v[136:139], a[228:231], v[40:43], v[136:139]
    v_add_f32 v201, v201, v123
    v_cvt_pk_bf16_f32 v121, v122, v123
    v_add_f32 v201, v201, v124
    v_mfma_f32_16x16x32_bf16 v[136:139], a[232:235], v[68:71], v[136:139]
    v_add_f32 v201, v201, v125
    v_cvt_pk_bf16_f32 v122, v124, v125
    v_mfma_f32_16x16x32_bf16 v[136:139], a[236:239], v[96:99], v[136:139]
    v_add_f32 v201, v201, v126
    v_add_f32 v201, v201, v127
    v_mfma_f32_16x16x32_bf16 v[140:143], a[240:243], v[12:15], 0
    s_add_u32 s41, s43, 98304
    v_cvt_pk_bf16_f32 v123, v126, v127
    v_add_f32 v202, v202, v128
    v_mfma_f32_16x16x32_bf16 v[140:143], a[244:247], v[40:43], v[140:143]
    s_add_u32 m0, s29, 8192
    v_exp_f32 v131, v131
    v_mfma_f32_16x16x32_bf16 v[140:143], a[248:251], v[68:71], v[140:143]
    s_waitcnt vmcnt(4)
    buffer_load_dwordx4 v249, s[12:15], s41 offen offset:0 nt lds
    v_mfma_f32_16x16x32_bf16 v[140:143], a[252:255], v[96:99], v[140:143]
    v_exp_f32 v132, v132
    v_mfma_f32_16x16x32_bf16 a[32:35], v[168:171], v[120:123], a[32:35]
    v_exp_f32 v133, v133
    v_mfma_f32_16x16x32_bf16 a[36:39], v[172:175], v[120:123], a[36:39]
    v_exp_f32 v134, v134
    v_mfma_f32_16x16x32_bf16 a[40:43], v[176:179], v[120:123], a[40:43]
    v_exp_f32 v135, v135
    v_mfma_f32_16x16x32_bf16 a[44:47], v[180:183], v[120:123], a[44:47]
    v_exp_f32 v136, v136
    v_mfma_f32_16x16x32_bf16 a[48:51], v[184:187], v[120:123], a[48:51]
    v_exp_f32 v137, v137
    v_mfma_f32_16x16x32_bf16 a[52:55], v[188:191], v[120:123], a[52:55]
    v_exp_f32 v138, v138
    v_mfma_f32_16x16x32_bf16 a[56:59], v[192:195], v[120:123], a[56:59]
    v_exp_f32 v139, v139
    v_mfma_f32_16x16x32_bf16 a[60:63], v[196:199], v[120:123], a[60:63]
    v_exp_f32 v140, v140
    v_mfma_f32_16x16x32_bf16 v[144:147], a[224:227], v[16:19], 0
    v_exp_f32 v141, v141
    v_add_f32 v202, v202, v129
    v_mfma_f32_16x16x32_bf16 v[144:147], a[228:231], v[44:47], v[144:147]
    v_cvt_pk_bf16_f32 v128, v128, v129
    v_add_f32 v202, v202, v130
    v_add_f32 v202, v202, v131
    v_mfma_f32_16x16x32_bf16 v[144:147], a[232:235], v[72:75], v[144:147]
    v_cvt_pk_bf16_f32 v129, v130, v131
    v_add_f32 v202, v202, v132
    v_mfma_f32_16x16x32_bf16 v[144:147], a[236:239], v[100:103], v[144:147]
    v_add_f32 v202, v202, v133
    v_cvt_pk_bf16_f32 v130, v132, v133
    v_mfma_f32_16x16x32_bf16 v[148:151], a[240:243], v[16:19], 0
    v_add_f32 v202, v202, v134
    v_add_f32 v202, v202, v135
    v_mfma_f32_16x16x32_bf16 v[148:151], a[244:247], v[44:47], v[148:151]
    v_cvt_pk_bf16_f32 v131, v134, v135
    v_add_f32 v203, v203, v136
    v_mfma_f32_16x16x32_bf16 v[148:151], a[248:251], v[72:75], v[148:151]
    v_exp_f32 v142, v142
    v_mfma_f32_16x16x32_bf16 v[148:151], a[252:255], v[100:103], v[148:151]
    s_waitcnt vmcnt(4)
    buffer_load_dwordx4 v250, s[12:15], s41 offen offset:1024 nt lds
    v_mfma_f32_16x16x32_bf16 a[64:67], v[168:171], v[128:131], a[64:67]
    v_exp_f32 v143, v143
    v_mfma_f32_16x16x32_bf16 a[68:71], v[172:175], v[128:131], a[68:71]
    v_exp_f32 v144, v144
    v_mfma_f32_16x16x32_bf16 a[72:75], v[176:179], v[128:131], a[72:75]
    v_exp_f32 v145, v145
    v_mfma_f32_16x16x32_bf16 a[76:79], v[180:183], v[128:131], a[76:79]
    v_exp_f32 v146, v146
    v_mfma_f32_16x16x32_bf16 a[80:83], v[184:187], v[128:131], a[80:83]
    v_exp_f32 v147, v147
    v_mfma_f32_16x16x32_bf16 a[84:87], v[188:191], v[128:131], a[84:87]
    v_exp_f32 v148, v148
    v_mfma_f32_16x16x32_bf16 a[88:91], v[192:195], v[128:131], a[88:91]
    v_exp_f32 v149, v149
    v_mfma_f32_16x16x32_bf16 a[92:95], v[196:199], v[128:131], a[92:95]
    v_exp_f32 v150, v150
    v_mfma_f32_16x16x32_bf16 v[152:155], a[224:227], v[20:23], 0
    v_exp_f32 v151, v151
    v_add_f32 v203, v203, v137
    v_mfma_f32_16x16x32_bf16 v[152:155], a[228:231], v[48:51], v[152:155]
    v_cvt_pk_bf16_f32 v136, v136, v137
    v_add_f32 v203, v203, v138
    v_add_f32 v203, v203, v139
    v_mfma_f32_16x16x32_bf16 v[152:155], a[232:235], v[76:79], v[152:155]
    v_cvt_pk_bf16_f32 v137, v138, v139
    v_add_f32 v203, v203, v140
    v_mfma_f32_16x16x32_bf16 v[152:155], a[236:239], v[104:107], v[152:155]
    v_add_f32 v203, v203, v141
    v_cvt_pk_bf16_f32 v138, v140, v141
    v_mfma_f32_16x16x32_bf16 v[156:159], a[240:243], v[20:23], 0
    v_add_f32 v203, v203, v142
    v_add_f32 v203, v203, v143
    v_mfma_f32_16x16x32_bf16 v[156:159], a[244:247], v[48:51], v[156:159]
    v_cvt_pk_bf16_f32 v139, v142, v143
    v_add_f32 v204, v204, v144
    v_mfma_f32_16x16x32_bf16 v[156:159], a[248:251], v[76:79], v[156:159]
    v_add_f32 v204, v204, v145
    v_cvt_pk_bf16_f32 v144, v144, v145
    v_mfma_f32_16x16x32_bf16 v[156:159], a[252:255], v[104:107], v[156:159]
    s_waitcnt vmcnt(4)
    buffer_load_dwordx4 v251, s[12:15], s41 offen offset:2048 nt lds
    v_mfma_f32_16x16x32_bf16 a[96:99], v[168:171], v[136:139], a[96:99]
    v_exp_f32 v152, v152
    v_mfma_f32_16x16x32_bf16 a[100:103], v[172:175], v[136:139], a[100:103]
    v_exp_f32 v153, v153
    v_mfma_f32_16x16x32_bf16 a[104:107], v[176:179], v[136:139], a[104:107]
    v_exp_f32 v154, v154
    v_mfma_f32_16x16x32_bf16 a[108:111], v[180:183], v[136:139], a[108:111]
    v_exp_f32 v155, v155
    v_mfma_f32_16x16x32_bf16 a[112:115], v[184:187], v[136:139], a[112:115]
    s_waitcnt vmcnt(11)
    v_exp_f32 v156, v156
    v_mfma_f32_16x16x32_bf16 a[116:119], v[188:191], v[136:139], a[116:119]
    s_barrier
    v_exp_f32 v157, v157
    v_mfma_f32_16x16x32_bf16 a[120:123], v[192:195], v[136:139], a[120:123]
    v_exp_f32 v158, v158
    v_add_f32 v204, v204, v146
    v_mfma_f32_16x16x32_bf16 a[124:127], v[196:199], v[136:139], a[124:127]
    v_exp_f32 v159, v159
    v_add_f32 v204, v204, v147
    v_mfma_f32_16x16x32_bf16 v[160:163], a[224:227], v[24:27], 0
    v_cvt_pk_bf16_f32 v145, v146, v147
    v_add_f32 v204, v204, v148
    v_add_f32 v204, v204, v149
    v_mfma_f32_16x16x32_bf16 v[160:163], a[228:231], v[52:55], v[160:163]
    ds_read_b128 a[224:227], v224 offset:32768
    v_cvt_pk_bf16_f32 v146, v148, v149
    v_add_f32 v204, v204, v150
    v_mfma_f32_16x16x32_bf16 v[160:163], a[232:235], v[80:83], v[160:163]
    ds_read_b128 a[228:231], v225 offset:32768
    v_add_f32 v204, v204, v151
    v_mfma_f32_16x16x32_bf16 v[160:163], a[236:239], v[108:111], v[160:163]
    ds_read_b128 a[232:235], v226 offset:32768
    v_cvt_pk_bf16_f32 v147, v150, v151
    v_mfma_f32_16x16x32_bf16 v[164:167], a[240:243], v[24:27], 0
    ds_read_b128 a[236:239], v227 offset:32768
    v_add_f32 v205, v205, v152
    v_mfma_f32_16x16x32_bf16 v[164:167], a[244:247], v[52:55], v[164:167]
    ds_read_b128 a[240:243], v224 offset:36864
    v_add_f32 v205, v205, v153
    v_mfma_f32_16x16x32_bf16 v[164:167], a[248:251], v[80:83], v[164:167]
    ds_read_b128 a[244:247], v225 offset:36864
    v_cvt_pk_bf16_f32 v152, v152, v153
    v_mfma_f32_16x16x32_bf16 v[164:167], a[252:255], v[108:111], v[164:167]
    ds_read_b128 a[248:251], v226 offset:36864
    v_add_f32 v205, v205, v154
    v_mfma_f32_16x16x32_bf16 a[128:131], v[168:171], v[144:147], a[128:131]
    ds_read_b128 a[252:255], v227 offset:36864
    v_add_f32 v205, v205, v155
    v_mfma_f32_16x16x32_bf16 a[132:135], v[172:175], v[144:147], a[132:135]
    v_exp_f32 v160, v160
    v_mfma_f32_16x16x32_bf16 a[136:139], v[176:179], v[144:147], a[136:139]
    v_exp_f32 v161, v161
    v_mfma_f32_16x16x32_bf16 a[140:143], v[180:183], v[144:147], a[140:143]
    s_waitcnt vmcnt(4)
    buffer_load_dwordx4 v252, s[12:15], s41 offen offset:3072 nt lds
    v_mfma_f32_16x16x32_bf16 a[144:147], v[184:187], v[144:147], a[144:147]
    v_exp_f32 v162, v162
    v_mfma_f32_16x16x32_bf16 a[148:151], v[188:191], v[144:147], a[148:151]
    v_exp_f32 v163, v163
    v_mfma_f32_16x16x32_bf16 a[152:155], v[192:195], v[144:147], a[152:155]
    s_waitcnt lgkmcnt(4)
    v_exp_f32 v164, v164
    v_mfma_f32_16x16x32_bf16 a[156:159], v[196:199], v[144:147], a[156:159]
    v_exp_f32 v165, v165
    v_mfma_f32_16x16x32_bf16 v[112:115], a[224:227], v[0:3], 0
    v_exp_f32 v166, v166
    v_mfma_f32_16x16x32_bf16 v[112:115], a[228:231], v[28:31], v[112:115]
    v_cvt_pk_bf16_f32 v153, v154, v155
    v_add_f32 v205, v205, v156
    v_mfma_f32_16x16x32_bf16 v[112:115], a[232:235], v[56:59], v[112:115]
    s_waitcnt lgkmcnt(0)
    v_add_f32 v205, v205, v157
    v_cvt_pk_bf16_f32 v154, v156, v157
    v_mfma_f32_16x16x32_bf16 v[112:115], a[236:239], v[84:87], v[112:115]
    v_add_f32 v205, v205, v158
    v_add_f32 v205, v205, v159
    v_mfma_f32_16x16x32_bf16 v[116:119], a[240:243], v[0:3], 0
    v_cvt_pk_bf16_f32 v155, v158, v159
    v_add_f32 v206, v206, v160
    v_mfma_f32_16x16x32_bf16 v[116:119], a[244:247], v[28:31], v[116:119]
    v_exp_f32 v167, v167
    v_mfma_f32_16x16x32_bf16 v[116:119], a[248:251], v[56:59], v[116:119]
    s_add_u32 m0, s29, 90112
    v_add_f32 v206, v206, v161
    v_cvt_pk_bf16_f32 v160, v160, v161
    v_mfma_f32_16x16x32_bf16 v[116:119], a[252:255], v[84:87], v[116:119]
    s_waitcnt vmcnt(4)
    buffer_load_dwordx4 v249, s[16:19], s41 offen offset:0 nt lds
    v_mfma_f32_16x16x32_bf16 a[160:163], v[168:171], v[152:155], a[160:163]
    v_exp_f32 v112, v112
    v_mfma_f32_16x16x32_bf16 a[164:167], v[172:175], v[152:155], a[164:167]
    v_exp_f32 v113, v113
    v_mfma_f32_16x16x32_bf16 a[168:171], v[176:179], v[152:155], a[168:171]
    v_exp_f32 v114, v114
    v_mfma_f32_16x16x32_bf16 a[172:175], v[180:183], v[152:155], a[172:175]
    v_exp_f32 v115, v115
    v_mfma_f32_16x16x32_bf16 a[176:179], v[184:187], v[152:155], a[176:179]
    v_exp_f32 v116, v116
    v_mfma_f32_16x16x32_bf16 a[180:183], v[188:191], v[152:155], a[180:183]
    v_exp_f32 v117, v117
    v_mfma_f32_16x16x32_bf16 a[184:187], v[192:195], v[152:155], a[184:187]
    v_exp_f32 v118, v118
    v_mfma_f32_16x16x32_bf16 a[188:191], v[196:199], v[152:155], a[188:191]
    v_exp_f32 v119, v119
    v_mfma_f32_16x16x32_bf16 v[120:123], a[224:227], v[4:7], 0
    v_add_f32 v206, v206, v162
    v_add_f32 v206, v206, v163
    v_mfma_f32_16x16x32_bf16 v[120:123], a[228:231], v[32:35], v[120:123]
    v_cvt_pk_bf16_f32 v161, v162, v163
    v_add_f32 v206, v206, v164
    v_mfma_f32_16x16x32_bf16 v[120:123], a[232:235], v[60:63], v[120:123]
    v_add_f32 v206, v206, v165
    v_cvt_pk_bf16_f32 v162, v164, v165
    v_mfma_f32_16x16x32_bf16 v[120:123], a[236:239], v[88:91], v[120:123]
    v_add_f32 v206, v206, v166
    v_add_f32 v206, v206, v167
    v_mfma_f32_16x16x32_bf16 v[124:127], a[240:243], v[4:7], 0
    v_cvt_pk_bf16_f32 v163, v166, v167
    v_add_f32 v200, v200, v112
    v_mfma_f32_16x16x32_bf16 v[124:127], a[244:247], v[32:35], v[124:127]
    v_add_f32 v200, v200, v113
    v_cvt_pk_bf16_f32 v112, v112, v113
    v_mfma_f32_16x16x32_bf16 v[124:127], a[248:251], v[60:63], v[124:127]
    v_add_f32 v200, v200, v114
    v_add_f32 v200, v200, v115
    v_mfma_f32_16x16x32_bf16 v[124:127], a[252:255], v[88:91], v[124:127]
    v_exp_f32 v120, v120
    v_mfma_f32_16x16x32_bf16 a[192:195], v[168:171], v[160:163], a[192:195]
    ds_read_b64_tr_b16 v[168:169], v228 offset:32768
    v_cvt_pk_bf16_f32 v113, v114, v115
    v_mfma_f32_16x16x32_bf16 a[196:199], v[172:175], v[160:163], a[196:199]
    ds_read_b64_tr_b16 v[170:171], v228 offset:36864
    v_add_f32 v200, v200, v116
    v_mfma_f32_16x16x32_bf16 a[200:203], v[176:179], v[160:163], a[200:203]
    ds_read_b64_tr_b16 v[172:173], v229 offset:32768
    v_add_f32 v200, v200, v117
    v_mfma_f32_16x16x32_bf16 a[204:207], v[180:183], v[160:163], a[204:207]
    ds_read_b64_tr_b16 v[174:175], v229 offset:36864
    v_cvt_pk_bf16_f32 v114, v116, v117
    v_mfma_f32_16x16x32_bf16 a[208:211], v[184:187], v[160:163], a[208:211]
    ds_read_b64_tr_b16 v[176:177], v230 offset:32768
    v_add_f32 v200, v200, v118
    v_mfma_f32_16x16x32_bf16 a[212:215], v[188:191], v[160:163], a[212:215]
    ds_read_b64_tr_b16 v[178:179], v230 offset:36864
    v_add_f32 v200, v200, v119
    v_mfma_f32_16x16x32_bf16 a[216:219], v[192:195], v[160:163], a[216:219]
    ds_read_b64_tr_b16 v[180:181], v231 offset:32768
    v_cvt_pk_bf16_f32 v115, v118, v119
    v_mfma_f32_16x16x32_bf16 a[220:223], v[196:199], v[160:163], a[220:223]
    ds_read_b64_tr_b16 v[182:183], v231 offset:36864
    v_add_f32 v201, v201, v120
    v_mfma_f32_16x16x32_bf16 v[128:131], a[224:227], v[8:11], 0
    ds_read_b64_tr_b16 v[184:185], v232 offset:32768
    v_mfma_f32_16x16x32_bf16 v[128:131], a[228:231], v[36:39], v[128:131]
    ds_read_b64_tr_b16 v[186:187], v232 offset:36864
    v_mfma_f32_16x16x32_bf16 v[128:131], a[232:235], v[64:67], v[128:131]
    ds_read_b64_tr_b16 v[188:189], v233 offset:32768
    v_mfma_f32_16x16x32_bf16 v[128:131], a[236:239], v[92:95], v[128:131]
    ds_read_b64_tr_b16 v[190:191], v233 offset:36864
    v_mfma_f32_16x16x32_bf16 v[132:135], a[240:243], v[8:11], 0
    ds_read_b64_tr_b16 v[192:193], v234 offset:32768
    ds_read_b64_tr_b16 v[194:195], v234 offset:36864
    v_mfma_f32_16x16x32_bf16 v[132:135], a[244:247], v[36:39], v[132:135]
    ds_read_b64_tr_b16 v[196:197], v235 offset:32768
    ds_read_b64_tr_b16 v[198:199], v235 offset:36864
    v_mfma_f32_16x16x32_bf16 v[132:135], a[248:251], v[64:67], v[132:135]
    v_exp_f32 v121, v121
    v_mfma_f32_16x16x32_bf16 v[132:135], a[252:255], v[92:95], v[132:135]
    s_waitcnt lgkmcnt(12)
    v_exp_f32 v122, v122
    v_mfma_f32_16x16x32_bf16 a[0:3], v[168:171], v[112:115], a[0:3]
    v_exp_f32 v123, v123
    v_mfma_f32_16x16x32_bf16 a[4:7], v[172:175], v[112:115], a[4:7]
    s_waitcnt lgkmcnt(8)
    v_exp_f32 v124, v124
    v_mfma_f32_16x16x32_bf16 a[8:11], v[176:179], v[112:115], a[8:11]
    v_exp_f32 v125, v125
    v_mfma_f32_16x16x32_bf16 a[12:15], v[180:183], v[112:115], a[12:15]
    s_waitcnt lgkmcnt(4)
    v_exp_f32 v126, v126
    v_mfma_f32_16x16x32_bf16 a[16:19], v[184:187], v[112:115], a[16:19]
    v_exp_f32 v127, v127
    v_mfma_f32_16x16x32_bf16 a[20:23], v[188:191], v[112:115], a[20:23]
    s_waitcnt lgkmcnt(0)
    v_exp_f32 v128, v128
    v_mfma_f32_16x16x32_bf16 a[24:27], v[192:195], v[112:115], a[24:27]
    v_exp_f32 v129, v129
    v_add_f32 v201, v201, v121
    v_mfma_f32_16x16x32_bf16 a[28:31], v[196:199], v[112:115], a[28:31]
    v_exp_f32 v130, v130
    v_cvt_pk_bf16_f32 v120, v120, v121
    v_mfma_f32_16x16x32_bf16 v[136:139], a[224:227], v[12:15], 0
    s_waitcnt vmcnt(4)
    buffer_load_dwordx4 v250, s[16:19], s41 offen offset:1024 nt lds
    v_add_f32 v201, v201, v122
    v_mfma_f32_16x16x32_bf16 v[136:139], a[228:231], v[40:43], v[136:139]
    v_add_f32 v201, v201, v123
    v_cvt_pk_bf16_f32 v121, v122, v123
    v_add_f32 v201, v201, v124
    v_mfma_f32_16x16x32_bf16 v[136:139], a[232:235], v[68:71], v[136:139]
    v_add_f32 v201, v201, v125
    v_cvt_pk_bf16_f32 v122, v124, v125
    v_mfma_f32_16x16x32_bf16 v[136:139], a[236:239], v[96:99], v[136:139]
    v_add_f32 v201, v201, v126
    v_add_f32 v201, v201, v127
    v_mfma_f32_16x16x32_bf16 v[140:143], a[240:243], v[12:15], 0
    s_waitcnt vmcnt(4)
    buffer_load_dwordx4 v251, s[16:19], s41 offen offset:2048 nt lds
    v_mfma_f32_16x16x32_bf16 v[140:143], a[244:247], v[40:43], v[140:143]
    v_cvt_pk_bf16_f32 v123, v126, v127
    v_add_f32 v202, v202, v128
    v_mfma_f32_16x16x32_bf16 v[140:143], a[248:251], v[68:71], v[140:143]
    v_exp_f32 v131, v131
    v_mfma_f32_16x16x32_bf16 v[140:143], a[252:255], v[96:99], v[140:143]
    v_exp_f32 v132, v132
    v_mfma_f32_16x16x32_bf16 a[32:35], v[168:171], v[120:123], a[32:35]
    s_waitcnt vmcnt(4)
    buffer_load_dwordx4 v252, s[16:19], s41 offen offset:3072 nt lds
    v_mfma_f32_16x16x32_bf16 a[36:39], v[172:175], v[120:123], a[36:39]
    v_exp_f32 v133, v133
    v_mfma_f32_16x16x32_bf16 a[40:43], v[176:179], v[120:123], a[40:43]
    v_exp_f32 v134, v134
    v_mfma_f32_16x16x32_bf16 a[44:47], v[180:183], v[120:123], a[44:47]
    v_exp_f32 v135, v135
    v_mfma_f32_16x16x32_bf16 a[48:51], v[184:187], v[120:123], a[48:51]
    v_exp_f32 v136, v136
    v_mfma_f32_16x16x32_bf16 a[52:55], v[188:191], v[120:123], a[52:55]
    v_exp_f32 v137, v137
    v_mfma_f32_16x16x32_bf16 a[56:59], v[192:195], v[120:123], a[56:59]
    v_exp_f32 v138, v138
    v_mfma_f32_16x16x32_bf16 a[60:63], v[196:199], v[120:123], a[60:63]
    v_exp_f32 v139, v139
    v_mfma_f32_16x16x32_bf16 v[144:147], a[224:227], v[16:19], 0
    v_exp_f32 v140, v140
    v_add_f32 v202, v202, v129
    v_mfma_f32_16x16x32_bf16 v[144:147], a[228:231], v[44:47], v[144:147]
    v_cvt_pk_bf16_f32 v128, v128, v129
    v_add_f32 v202, v202, v130
    v_add_f32 v202, v202, v131
    v_mfma_f32_16x16x32_bf16 v[144:147], a[232:235], v[72:75], v[144:147]
    v_cvt_pk_bf16_f32 v129, v130, v131
    v_add_f32 v202, v202, v132
    v_mfma_f32_16x16x32_bf16 v[144:147], a[236:239], v[100:103], v[144:147]
    v_add_f32 v202, v202, v133
    v_cvt_pk_bf16_f32 v130, v132, v133
    v_mfma_f32_16x16x32_bf16 v[148:151], a[240:243], v[16:19], 0
    v_add_f32 v202, v202, v134
    v_add_f32 v202, v202, v135
    v_mfma_f32_16x16x32_bf16 v[148:151], a[244:247], v[44:47], v[148:151]
    v_cvt_pk_bf16_f32 v131, v134, v135
    v_add_f32 v203, v203, v136
    v_mfma_f32_16x16x32_bf16 v[148:151], a[248:251], v[72:75], v[148:151]
    s_add_u32 s41, s43, 106496
    v_exp_f32 v141, v141
    v_mfma_f32_16x16x32_bf16 v[148:151], a[252:255], v[100:103], v[148:151]
    s_add_u32 m0, s29, 16384
    v_exp_f32 v142, v142
    v_mfma_f32_16x16x32_bf16 a[64:67], v[168:171], v[128:131], a[64:67]
    s_waitcnt vmcnt(4)
    buffer_load_dwordx4 v249, s[12:15], s41 offen offset:0 nt lds
    v_mfma_f32_16x16x32_bf16 a[68:71], v[172:175], v[128:131], a[68:71]
    v_exp_f32 v143, v143
    v_mfma_f32_16x16x32_bf16 a[72:75], v[176:179], v[128:131], a[72:75]
    v_exp_f32 v144, v144
    v_mfma_f32_16x16x32_bf16 a[76:79], v[180:183], v[128:131], a[76:79]
    v_exp_f32 v145, v145
    v_mfma_f32_16x16x32_bf16 a[80:83], v[184:187], v[128:131], a[80:83]
    v_exp_f32 v146, v146
    v_mfma_f32_16x16x32_bf16 a[84:87], v[188:191], v[128:131], a[84:87]
    v_exp_f32 v147, v147
    v_mfma_f32_16x16x32_bf16 a[88:91], v[192:195], v[128:131], a[88:91]
    v_exp_f32 v148, v148
    v_mfma_f32_16x16x32_bf16 a[92:95], v[196:199], v[128:131], a[92:95]
    v_exp_f32 v149, v149
    v_mfma_f32_16x16x32_bf16 v[152:155], a[224:227], v[20:23], 0
    v_exp_f32 v150, v150
    v_add_f32 v203, v203, v137
    v_mfma_f32_16x16x32_bf16 v[152:155], a[228:231], v[48:51], v[152:155]
    v_cvt_pk_bf16_f32 v136, v136, v137
    v_add_f32 v203, v203, v138
    v_add_f32 v203, v203, v139
    v_mfma_f32_16x16x32_bf16 v[152:155], a[232:235], v[76:79], v[152:155]
    v_cvt_pk_bf16_f32 v137, v138, v139
    v_add_f32 v203, v203, v140
    v_mfma_f32_16x16x32_bf16 v[152:155], a[236:239], v[104:107], v[152:155]
    v_add_f32 v203, v203, v141
    v_cvt_pk_bf16_f32 v138, v140, v141
    v_mfma_f32_16x16x32_bf16 v[156:159], a[240:243], v[20:23], 0
    v_add_f32 v203, v203, v142
    v_add_f32 v203, v203, v143
    v_mfma_f32_16x16x32_bf16 v[156:159], a[244:247], v[48:51], v[156:159]
    v_cvt_pk_bf16_f32 v139, v142, v143
    v_add_f32 v204, v204, v144
    v_mfma_f32_16x16x32_bf16 v[156:159], a[248:251], v[76:79], v[156:159]
    v_exp_f32 v151, v151
    v_mfma_f32_16x16x32_bf16 v[156:159], a[252:255], v[104:107], v[156:159]
    v_exp_f32 v152, v152
    v_mfma_f32_16x16x32_bf16 a[96:99], v[168:171], v[136:139], a[96:99]
    s_waitcnt vmcnt(4)
    buffer_load_dwordx4 v250, s[12:15], s41 offen offset:1024 nt lds
    v_mfma_f32_16x16x32_bf16 a[100:103], v[172:175], v[136:139], a[100:103]
    v_exp_f32 v153, v153
    v_mfma_f32_16x16x32_bf16 a[104:107], v[176:179], v[136:139], a[104:107]
    v_exp_f32 v154, v154
    v_mfma_f32_16x16x32_bf16 a[108:111], v[180:183], v[136:139], a[108:111]
    v_exp_f32 v155, v155
    v_mfma_f32_16x16x32_bf16 a[112:115], v[184:187], v[136:139], a[112:115]
    s_waitcnt vmcnt(10)
    v_exp_f32 v156, v156
    v_mfma_f32_16x16x32_bf16 a[116:119], v[188:191], v[136:139], a[116:119]
    s_barrier
    v_exp_f32 v157, v157
    v_add_f32 v204, v204, v145
    v_mfma_f32_16x16x32_bf16 a[120:123], v[192:195], v[136:139], a[120:123]
    v_exp_f32 v158, v158
    v_cvt_pk_bf16_f32 v144, v144, v145
    v_mfma_f32_16x16x32_bf16 a[124:127], v[196:199], v[136:139], a[124:127]
    v_exp_f32 v159, v159
    v_add_f32 v204, v204, v146
    v_mfma_f32_16x16x32_bf16 v[160:163], a[224:227], v[24:27], 0
    v_add_f32 v204, v204, v147
    v_cvt_pk_bf16_f32 v145, v146, v147
    v_add_f32 v204, v204, v148
    v_mfma_f32_16x16x32_bf16 v[160:163], a[228:231], v[52:55], v[160:163]
    ds_read_b128 a[224:227], v224 offset:0
    v_add_f32 v204, v204, v149
    v_cvt_pk_bf16_f32 v146, v148, v149
    v_mfma_f32_16x16x32_bf16 v[160:163], a[232:235], v[80:83], v[160:163]
    ds_read_b128 a[228:231], v225 offset:0
    v_add_f32 v204, v204, v150
    v_add_f32 v204, v204, v151
    v_mfma_f32_16x16x32_bf16 v[160:163], a[236:239], v[108:111], v[160:163]
    ds_read_b128 a[232:235], v226 offset:0
    v_cvt_pk_bf16_f32 v147, v150, v151
    v_mfma_f32_16x16x32_bf16 v[164:167], a[240:243], v[24:27], 0
    ds_read_b128 a[236:239], v227 offset:0
    v_add_f32 v205, v205, v152
    v_mfma_f32_16x16x32_bf16 v[164:167], a[244:247], v[52:55], v[164:167]
    ds_read_b128 a[240:243], v224 offset:4096
    v_add_f32 v205, v205, v153
    v_mfma_f32_16x16x32_bf16 v[164:167], a[248:251], v[80:83], v[164:167]
    ds_read_b128 a[244:247], v225 offset:4096
    v_cvt_pk_bf16_f32 v152, v152, v153
    v_mfma_f32_16x16x32_bf16 v[164:167], a[252:255], v[108:111], v[164:167]
    ds_read_b128 a[248:251], v226 offset:4096
    v_add_f32 v205, v205, v154
    v_mfma_f32_16x16x32_bf16 a[128:131], v[168:171], v[144:147], a[128:131]
    ds_read_b128 a[252:255], v227 offset:4096
    v_add_f32 v205, v205, v155
    v_mfma_f32_16x16x32_bf16 a[132:135], v[172:175], v[144:147], a[132:135]
    v_exp_f32 v160, v160
    v_mfma_f32_16x16x32_bf16 a[136:139], v[176:179], v[144:147], a[136:139]
    v_exp_f32 v161, v161
    v_mfma_f32_16x16x32_bf16 a[140:143], v[180:183], v[144:147], a[140:143]
    s_waitcnt vmcnt(4)
    buffer_load_dwordx4 v251, s[12:15], s41 offen offset:2048 nt lds
    v_mfma_f32_16x16x32_bf16 a[144:147], v[184:187], v[144:147], a[144:147]
    v_exp_f32 v162, v162
    v_mfma_f32_16x16x32_bf16 a[148:151], v[188:191], v[144:147], a[148:151]
    v_exp_f32 v163, v163
    v_mfma_f32_16x16x32_bf16 a[152:155], v[192:195], v[144:147], a[152:155]
    s_waitcnt lgkmcnt(4)
    v_exp_f32 v164, v164
    v_mfma_f32_16x16x32_bf16 a[156:159], v[196:199], v[144:147], a[156:159]
    v_exp_f32 v165, v165
    v_mfma_f32_16x16x32_bf16 v[112:115], a[224:227], v[0:3], 0
    v_exp_f32 v166, v166
    v_mfma_f32_16x16x32_bf16 v[112:115], a[228:231], v[28:31], v[112:115]
    v_cvt_pk_bf16_f32 v153, v154, v155
    v_add_f32 v205, v205, v156
    v_mfma_f32_16x16x32_bf16 v[112:115], a[232:235], v[56:59], v[112:115]
    s_waitcnt lgkmcnt(0)
    v_add_f32 v205, v205, v157
    v_cvt_pk_bf16_f32 v154, v156, v157
    v_mfma_f32_16x16x32_bf16 v[112:115], a[236:239], v[84:87], v[112:115]
    v_add_f32 v205, v205, v158
    v_add_f32 v205, v205, v159
    v_mfma_f32_16x16x32_bf16 v[116:119], a[240:243], v[0:3], 0
    v_cvt_pk_bf16_f32 v155, v158, v159
    v_add_f32 v206, v206, v160
    v_mfma_f32_16x16x32_bf16 v[116:119], a[244:247], v[28:31], v[116:119]
    v_exp_f32 v167, v167
    v_mfma_f32_16x16x32_bf16 v[116:119], a[248:251], v[56:59], v[116:119]
    v_add_f32 v206, v206, v161
    v_cvt_pk_bf16_f32 v160, v160, v161
    v_mfma_f32_16x16x32_bf16 v[116:119], a[252:255], v[84:87], v[116:119]
    v_exp_f32 v112, v112
    v_mfma_f32_16x16x32_bf16 a[160:163], v[168:171], v[152:155], a[160:163]
    s_waitcnt vmcnt(4)
    buffer_load_dwordx4 v252, s[12:15], s41 offen offset:3072 nt lds
    v_mfma_f32_16x16x32_bf16 a[164:167], v[172:175], v[152:155], a[164:167]
    v_exp_f32 v113, v113
    v_mfma_f32_16x16x32_bf16 a[168:171], v[176:179], v[152:155], a[168:171]
    v_exp_f32 v114, v114
    v_mfma_f32_16x16x32_bf16 a[172:175], v[180:183], v[152:155], a[172:175]
    v_exp_f32 v115, v115
    v_mfma_f32_16x16x32_bf16 a[176:179], v[184:187], v[152:155], a[176:179]
    v_exp_f32 v116, v116
    v_mfma_f32_16x16x32_bf16 a[180:183], v[188:191], v[152:155], a[180:183]
    v_exp_f32 v117, v117
    v_mfma_f32_16x16x32_bf16 a[184:187], v[192:195], v[152:155], a[184:187]
    v_exp_f32 v118, v118
    v_mfma_f32_16x16x32_bf16 a[188:191], v[196:199], v[152:155], a[188:191]
    v_exp_f32 v119, v119
Lpg10:
    s_cbranch_execz Ltch0
    v_mfma_f32_16x16x32_bf16 v[120:123], a[224:227], v[4:7], 0
    v_add_f32 v206, v206, v162
    v_add_f32 v206, v206, v163
    v_mfma_f32_16x16x32_bf16 v[120:123], a[228:231], v[32:35], v[120:123]
    v_cvt_pk_bf16_f32 v161, v162, v163
    v_add_f32 v206, v206, v164
    v_mfma_f32_16x16x32_bf16 v[120:123], a[232:235], v[60:63], v[120:123]
    v_add_f32 v206, v206, v165
    v_cvt_pk_bf16_f32 v162, v164, v165
    v_mfma_f32_16x16x32_bf16 v[120:123], a[236:239], v[88:91], v[120:123]
    v_add_f32 v206, v206, v166
    v_add_f32 v206, v206, v167
    v_mfma_f32_16x16x32_bf16 v[124:127], a[240:243], v[4:7], 0
    v_cvt_pk_bf16_f32 v163, v166, v167
    v_add_f32 v200, v200, v112
    v_mfma_f32_16x16x32_bf16 v[124:127], a[244:247], v[32:35], v[124:127]
    v_add_f32 v200, v200, v113
    v_cvt_pk_bf16_f32 v112, v112, v113
    v_mfma_f32_16x16x32_bf16 v[124:127], a[248:251], v[60:63], v[124:127]
    v_add_f32 v200, v200, v114
    v_add_f32 v200, v200, v115
    v_mfma_f32_16x16x32_bf16 v[124:127], a[252:255], v[88:91], v[124:127]
    v_exp_f32 v120, v120
    v_mfma_f32_16x16x32_bf16 a[192:195], v[168:171], v[160:163], a[192:195]
    ds_read_b64_tr_b16 v[168:169], v228 offset:0
    v_cvt_pk_bf16_f32 v113, v114, v115
    v_mfma_f32_16x16x32_bf16 a[196:199], v[172:175], v[160:163], a[196:199]
    ds_read_b64_tr_b16 v[170:171], v228 offset:4096
    v_add_f32 v200, v200, v116
    v_mfma_f32_16x16x32_bf16 a[200:203], v[176:179], v[160:163], a[200:203]
    ds_read_b64_tr_b16 v[172:173], v229 offset:0
    v_add_f32 v200, v200, v117
    v_mfma_f32_16x16x32_bf16 a[204:207], v[180:183], v[160:163], a[204:207]
    ds_read_b64_tr_b16 v[174:175], v229 offset:4096
    v_cvt_pk_bf16_f32 v114, v116, v117
    v_mfma_f32_16x16x32_bf16 a[208:211], v[184:187], v[160:163], a[208:211]
    ds_read_b64_tr_b16 v[176:177], v230 offset:0
    v_add_f32 v200, v200, v118
    v_mfma_f32_16x16x32_bf16 a[212:215], v[188:191], v[160:163], a[212:215]
    ds_read_b64_tr_b16 v[178:179], v230 offset:4096
    v_add_f32 v200, v200, v119
    v_mfma_f32_16x16x32_bf16 a[216:219], v[192:195], v[160:163], a[216:219]
    ds_read_b64_tr_b16 v[180:181], v231 offset:0
    v_cvt_pk_bf16_f32 v115, v118, v119
    v_mfma_f32_16x16x32_bf16 a[220:223], v[196:199], v[160:163], a[220:223]
    ds_read_b64_tr_b16 v[182:183], v231 offset:4096
    v_add_f32 v201, v201, v120
    v_mfma_f32_16x16x32_bf16 v[128:131], a[224:227], v[8:11], 0
    ds_read_b64_tr_b16 v[184:185], v232 offset:0
    v_mfma_f32_16x16x32_bf16 v[128:131], a[228:231], v[36:39], v[128:131]
    ds_read_b64_tr_b16 v[186:187], v232 offset:4096
    v_mfma_f32_16x16x32_bf16 v[128:131], a[232:235], v[64:67], v[128:131]
    ds_read_b64_tr_b16 v[188:189], v233 offset:0
    v_mfma_f32_16x16x32_bf16 v[128:131], a[236:239], v[92:95], v[128:131]
    ds_read_b64_tr_b16 v[190:191], v233 offset:4096
    v_mfma_f32_16x16x32_bf16 v[132:135], a[240:243], v[8:11], 0
    ds_read_b64_tr_b16 v[192:193], v234 offset:0
    ds_read_b64_tr_b16 v[194:195], v234 offset:4096
    v_mfma_f32_16x16x32_bf16 v[132:135], a[244:247], v[36:39], v[132:135]
    ds_read_b64_tr_b16 v[196:197], v235 offset:0
    ds_read_b64_tr_b16 v[198:199], v235 offset:4096
    v_mfma_f32_16x16x32_bf16 v[132:135], a[248:251], v[64:67], v[132:135]
    v_exp_f32 v121, v121
    v_mfma_f32_16x16x32_bf16 v[132:135], a[252:255], v[92:95], v[132:135]
    s_waitcnt lgkmcnt(12)
    v_exp_f32 v122, v122
    v_mfma_f32_16x16x32_bf16 a[0:3], v[168:171], v[112:115], a[0:3]
    v_exp_f32 v123, v123
    v_mfma_f32_16x16x32_bf16 a[4:7], v[172:175], v[112:115], a[4:7]
    s_waitcnt lgkmcnt(8)
    v_exp_f32 v124, v124
    v_mfma_f32_16x16x32_bf16 a[8:11], v[176:179], v[112:115], a[8:11]
    v_exp_f32 v125, v125
    v_mfma_f32_16x16x32_bf16 a[12:15], v[180:183], v[112:115], a[12:15]
    s_waitcnt lgkmcnt(4)
    v_exp_f32 v126, v126
    v_mfma_f32_16x16x32_bf16 a[16:19], v[184:187], v[112:115], a[16:19]
    v_exp_f32 v127, v127
    v_mfma_f32_16x16x32_bf16 a[20:23], v[188:191], v[112:115], a[20:23]
    s_waitcnt lgkmcnt(0)
    v_exp_f32 v128, v128
    v_mfma_f32_16x16x32_bf16 a[24:27], v[192:195], v[112:115], a[24:27]
    v_exp_f32 v129, v129
    v_add_f32 v201, v201, v121
    v_mfma_f32_16x16x32_bf16 a[28:31], v[196:199], v[112:115], a[28:31]
    s_add_u32 m0, s29, 98304
    v_exp_f32 v130, v130
    v_cvt_pk_bf16_f32 v120, v120, v121
    v_mfma_f32_16x16x32_bf16 v[136:139], a[224:227], v[12:15], 0
    s_waitcnt vmcnt(4)
    buffer_load_dwordx4 v249, s[16:19], s41 offen offset:0 nt lds
    v_add_f32 v201, v201, v122
    v_mfma_f32_16x16x32_bf16 v[136:139], a[228:231], v[40:43], v[136:139]
    v_add_f32 v201, v201, v123
    v_cvt_pk_bf16_f32 v121, v122, v123
    v_add_f32 v201, v201, v124
    v_mfma_f32_16x16x32_bf16 v[136:139], a[232:235], v[68:71], v[136:139]
    v_add_f32 v201, v201, v125
    v_cvt_pk_bf16_f32 v122, v124, v125
    v_mfma_f32_16x16x32_bf16 v[136:139], a[236:239], v[96:99], v[136:139]
    v_add_f32 v201, v201, v126
    v_add_f32 v201, v201, v127
    v_mfma_f32_16x16x32_bf16 v[140:143], a[240:243], v[12:15], 0
    s_waitcnt vmcnt(4)
    buffer_load_dwordx4 v250, s[16:19], s41 offen offset:1024 nt lds
    v_mfma_f32_16x16x32_bf16 v[140:143], a[244:247], v[40:43], v[140:143]
    v_cvt_pk_bf16_f32 v123, v126, v127
    v_add_f32 v202, v202, v128
    v_mfma_f32_16x16x32_bf16 v[140:143], a[248:251], v[68:71], v[140:143]
    v_exp_f32 v131, v131
    v_mfma_f32_16x16x32_bf16 v[140:143], a[252:255], v[96:99], v[140:143]
    v_exp_f32 v132, v132
    v_mfma_f32_16x16x32_bf16 a[32:35], v[168:171], v[120:123], a[32:35]
    s_waitcnt vmcnt(4)
    buffer_load_dwordx4 v251, s[16:19], s41 offen offset:2048 nt lds
    v_mfma_f32_16x16x32_bf16 a[36:39], v[172:175], v[120:123], a[36:39]
    v_exp_f32 v133, v133
    v_mfma_f32_16x16x32_bf16 a[40:43], v[176:179], v[120:123], a[40:43]
    v_exp_f32 v134, v134
    v_mfma_f32_16x16x32_bf16 a[44:47], v[180:183], v[120:123], a[44:47]
    v_exp_f32 v135, v135
    v_mfma_f32_16x16x32_bf16 a[48:51], v[184:187], v[120:123], a[48:51]
    buffer_load_dword v216, v214, s[56:59], 0 offen sc1
    v_mfma_f32_16x16x32_bf16 a[52:55], v[188:191], v[120:123], a[52:55]
    v_exp_f32 v136, v136
    v_mfma_f32_16x16x32_bf16 a[56:59], v[192:195], v[120:123], a[56:59]
    v_exp_f32 v137, v137
    v_mfma_f32_16x16x32_bf16 a[60:63], v[196:199], v[120:123], a[60:63]
    v_exp_f32 v138, v138
    v_mfma_f32_16x16x32_bf16 v[144:147], a[224:227], v[16:19], 0
    v_exp_f32 v139, v139
    v_add_f32 v202, v202, v129
    v_mfma_f32_16x16x32_bf16 v[144:147], a[228:231], v[44:47], v[144:147]
    v_cvt_pk_bf16_f32 v128, v128, v129
    v_add_f32 v202, v202, v130
    v_add_f32 v202, v202, v131
    v_mfma_f32_16x16x32_bf16 v[144:147], a[232:235], v[72:75], v[144:147]
    v_cvt_pk_bf16_f32 v129, v130, v131
    v_add_f32 v202, v202, v132
    v_mfma_f32_16x16x32_bf16 v[144:147], a[236:239], v[100:103], v[144:147]
    v_add_f32 v202, v202, v133
    v_cvt_pk_bf16_f32 v130, v132, v133
    v_mfma_f32_16x16x32_bf16 v[148:151], a[240:243], v[16:19], 0
    v_add_f32 v202, v202, v134
    v_add_f32 v202, v202, v135
    v_mfma_f32_16x16x32_bf16 v[148:151], a[244:247], v[44:47], v[148:151]
    v_cvt_pk_bf16_f32 v131, v134, v135
    v_add_f32 v203, v203, v136
    v_mfma_f32_16x16x32_bf16 v[148:151], a[248:251], v[72:75], v[148:151]
    v_exp_f32 v140, v140
    v_mfma_f32_16x16x32_bf16 v[148:151], a[252:255], v[100:103], v[148:151]
    v_exp_f32 v141, v141
    v_mfma_f32_16x16x32_bf16 a[64:67], v[168:171], v[128:131], a[64:67]
    s_waitcnt vmcnt(5)
    buffer_load_dwordx4 v252, s[16:19], s41 offen offset:3072 nt lds
    v_mfma_f32_16x16x32_bf16 a[68:71], v[172:175], v[128:131], a[68:71]
    v_exp_f32 v142, v142
    v_mfma_f32_16x16x32_bf16 a[72:75], v[176:179], v[128:131], a[72:75]
    v_exp_f32 v143, v143
    v_mfma_f32_16x16x32_bf16 a[76:79], v[180:183], v[128:131], a[76:79]
    v_exp_f32 v144, v144
    v_mfma_f32_16x16x32_bf16 a[80:83], v[184:187], v[128:131], a[80:83]
    v_exp_f32 v145, v145
    v_mfma_f32_16x16x32_bf16 a[84:87], v[188:191], v[128:131], a[84:87]
    v_exp_f32 v146, v146
    v_mfma_f32_16x16x32_bf16 a[88:91], v[192:195], v[128:131], a[88:91]
    v_exp_f32 v147, v147
    v_mfma_f32_16x16x32_bf16 a[92:95], v[196:199], v[128:131], a[92:95]
    v_exp_f32 v148, v148
    v_mfma_f32_16x16x32_bf16 v[152:155], a[224:227], v[20:23], 0
    v_exp_f32 v149, v149
    v_add_f32 v203, v203, v137
    v_mfma_f32_16x16x32_bf16 v[152:155], a[228:231], v[48:51], v[152:155]
    v_cvt_pk_bf16_f32 v136, v136, v137
    v_add_f32 v203, v203, v138
    v_add_f32 v203, v203, v139
    v_mfma_f32_16x16x32_bf16 v[152:155], a[232:235], v[76:79], v[152:155]
    v_cvt_pk_bf16_f32 v137, v138, v139
    v_add_f32 v203, v203, v140
    v_mfma_f32_16x16x32_bf16 v[152:155], a[236:239], v[104:107], v[152:155]
    v_add_f32 v203, v203, v141
    v_cvt_pk_bf16_f32 v138, v140, v141
    v_mfma_f32_16x16x32_bf16 v[156:159], a[240:243], v[20:23], 0
    v_add_f32 v203, v203, v142
    v_add_f32 v203, v203, v143
    v_mfma_f32_16x16x32_bf16 v[156:159], a[244:247], v[48:51], v[156:159]
    v_cvt_pk_bf16_f32 v139, v142, v143
    v_add_f32 v204, v204, v144
    v_mfma_f32_16x16x32_bf16 v[156:159], a[248:251], v[76:79], v[156:159]
    s_add_u32 s41, s43, 114688
    v_exp_f32 v150, v150
    v_mfma_f32_16x16x32_bf16 v[156:159], a[252:255], v[104:107], v[156:159]
    s_add_u32 m0, s29, 24576
    v_exp_f32 v151, v151
    v_mfma_f32_16x16x32_bf16 a[96:99], v[168:171], v[136:139], a[96:99]
    s_waitcnt vmcnt(5)
    buffer_load_dwordx4 v249, s[12:15], s41 offen offset:0 nt lds
    v_mfma_f32_16x16x32_bf16 a[100:103], v[172:175], v[136:139], a[100:103]
    v_exp_f32 v152, v152
    v_mfma_f32_16x16x32_bf16 a[104:107], v[176:179], v[136:139], a[104:107]
    v_exp_f32 v153, v153
    v_mfma_f32_16x16x32_bf16 a[108:111], v[180:183], v[136:139], a[108:111]
    v_exp_f32 v154, v154
    v_mfma_f32_16x16x32_bf16 a[112:115], v[184:187], v[136:139], a[112:115]
    s_waitcnt vmcnt(10)
    v_exp_f32 v155, v155
    v_mfma_f32_16x16x32_bf16 a[116:119], v[188:191], v[136:139], a[116:119]
    s_barrier
    v_exp_f32 v156, v156
    v_add_f32 v204, v204, v145
    v_mfma_f32_16x16x32_bf16 a[120:123], v[192:195], v[136:139], a[120:123]
    v_exp_f32 v157, v157
    v_cvt_pk_bf16_f32 v144, v144, v145
    v_mfma_f32_16x16x32_bf16 a[124:127], v[196:199], v[136:139], a[124:127]
    v_exp_f32 v158, v158
    v_add_f32 v204, v204, v146
    v_mfma_f32_16x16x32_bf16 v[160:163], a[224:227], v[24:27], 0
    v_exp_f32 v159, v159
    v_add_f32 v204, v204, v147
    v_mfma_f32_16x16x32_bf16 v[160:163], a[228:231], v[52:55], v[160:163]
    ds_read_b128 a[224:227], v224 offset:8192
    v_cvt_pk_bf16_f32 v145, v146, v147
    v_add_f32 v204, v204, v148
    v_mfma_f32_16x16x32_bf16 v[160:163], a[232:235], v[80:83], v[160:163]
    ds_read_b128 a[228:231], v225 offset:8192
    v_add_f32 v204, v204, v149
    v_cvt_pk_bf16_f32 v146, v148, v149
    v_mfma_f32_16x16x32_bf16 v[160:163], a[236:239], v[108:111], v[160:163]
    ds_read_b128 a[232:235], v226 offset:8192
    v_add_f32 v204, v204, v150
    v_add_f32 v204, v204, v151
    v_mfma_f32_16x16x32_bf16 v[164:167], a[240:243], v[24:27], 0
    ds_read_b128 a[236:239], v227 offset:8192
    v_cvt_pk_bf16_f32 v147, v150, v151
    v_mfma_f32_16x16x32_bf16 v[164:167], a[244:247], v[52:55], v[164:167]
    ds_read_b128 a[240:243], v224 offset:12288
    v_add_f32 v205, v205, v152
    v_mfma_f32_16x16x32_bf16 v[164:167], a[248:251], v[80:83], v[164:167]
    ds_read_b128 a[244:247], v225 offset:12288
    v_add_f32 v205, v205, v153
    v_mfma_f32_16x16x32_bf16 v[164:167], a[252:255], v[108:111], v[164:167]
    ds_read_b128 a[248:251], v226 offset:12288
    v_cvt_pk_bf16_f32 v152, v152, v153
    v_mfma_f32_16x16x32_bf16 a[128:131], v[168:171], v[144:147], a[128:131]
    ds_read_b128 a[252:255], v227 offset:12288
    v_add_f32 v205, v205, v154
    v_mfma_f32_16x16x32_bf16 a[132:135], v[172:175], v[144:147], a[132:135]
    v_exp_f32 v160, v160
    v_mfma_f32_16x16x32_bf16 a[136:139], v[176:179], v[144:147], a[136:139]
    v_exp_f32 v161, v161
    v_mfma_f32_16x16x32_bf16 a[140:143], v[180:183], v[144:147], a[140:143]
    s_waitcnt vmcnt(5)
    buffer_load_dwordx4 v250, s[12:15], s41 offen offset:1024 nt lds
    v_mfma_f32_16x16x32_bf16 a[144:147], v[184:187], v[144:147], a[144:147]
    v_exp_f32 v162, v162
    v_mfma_f32_16x16x32_bf16 a[148:151], v[188:191], v[144:147], a[148:151]
    v_exp_f32 v163, v163
    v_mfma_f32_16x16x32_bf16 a[152:155], v[192:195], v[144:147], a[152:155]
    s_waitcnt lgkmcnt(4)
    v_exp_f32 v164, v164
    v_mfma_f32_16x16x32_bf16 a[156:159], v[196:199], v[144:147], a[156:159]
    v_exp_f32 v165, v165
    v_mfma_f32_16x16x32_bf16 v[112:115], a[224:227], v[0:3], 0
    v_exp_f32 v166, v166
    v_mfma_f32_16x16x32_bf16 v[112:115], a[228:231], v[28:31], v[112:115]
    v_add_f32 v205, v205, v155
    v_cvt_pk_bf16_f32 v153, v154, v155
    v_mfma_f32_16x16x32_bf16 v[112:115], a[232:235], v[56:59], v[112:115]
    s_waitcnt lgkmcnt(0)
    v_add_f32 v205, v205, v156
    v_add_f32 v205, v205, v157
    v_mfma_f32_16x16x32_bf16 v[112:115], a[236:239], v[84:87], v[112:115]
    v_cvt_pk_bf16_f32 v154, v156, v157
    v_add_f32 v205, v205, v158
    v_mfma_f32_16x16x32_bf16 v[116:119], a[240:243], v[0:3], 0
    v_add_f32 v205, v205, v159
    v_cvt_pk_bf16_f32 v155, v158, v159
    v_mfma_f32_16x16x32_bf16 v[116:119], a[244:247], v[28:31], v[116:119]
    v_exp_f32 v167, v167
    v_mfma_f32_16x16x32_bf16 v[116:119], a[248:251], v[56:59], v[116:119]
    v_add_f32 v206, v206, v160
    v_add_f32 v206, v206, v161
    v_mfma_f32_16x16x32_bf16 v[116:119], a[252:255], v[84:87], v[116:119]
    v_exp_f32 v112, v112
    v_mfma_f32_16x16x32_bf16 a[160:163], v[168:171], v[152:155], a[160:163]
    s_waitcnt vmcnt(5)
    buffer_load_dwordx4 v251, s[12:15], s41 offen offset:2048 nt lds
    v_mfma_f32_16x16x32_bf16 a[164:167], v[172:175], v[152:155], a[164:167]
    v_exp_f32 v113, v113
    v_mfma_f32_16x16x32_bf16 a[168:171], v[176:179], v[152:155], a[168:171]
    s_add_u32 s41, s60, 0
    v_exp_f32 v114, v114
    v_mfma_f32_16x16x32_bf16 a[172:175], v[180:183], v[152:155], a[172:175]
    s_add_u32 m0, s35, 0
    v_exp_f32 v115, v115
    v_mfma_f32_16x16x32_bf16 a[176:179], v[184:187], v[152:155], a[176:179]
    buffer_load_dwordx4 v208, s[24:27], s41 offen offset:0 lds
    v_mfma_f32_16x16x32_bf16 a[180:183], v[188:191], v[152:155], a[180:183]
    v_exp_f32 v116, v116
    v_mfma_f32_16x16x32_bf16 a[184:187], v[192:195], v[152:155], a[184:187]
    v_exp_f32 v117, v117
    v_mfma_f32_16x16x32_bf16 a[188:191], v[196:199], v[152:155], a[188:191]
    v_exp_f32 v118, v118
    v_cvt_pk_bf16_f32 v160, v160, v161
    v_mfma_f32_16x16x32_bf16 v[120:123], a[224:227], v[4:7], 0
    v_exp_f32 v119, v119
    v_add_f32 v206, v206, v162
    v_mfma_f32_16x16x32_bf16 v[120:123], a[228:231], v[32:35], v[120:123]
    v_add_f32 v206, v206, v163
    v_cvt_pk_bf16_f32 v161, v162, v163
    v_add_f32 v206, v206, v164
    v_mfma_f32_16x16x32_bf16 v[120:123], a[232:235], v[60:63], v[120:123]
    buffer_load_dwordx4 v209, s[24:27], s41 offen offset:1024 lds
    v_mfma_f32_16x16x32_bf16 v[120:123], a[236:239], v[88:91], v[120:123]
    v_add_f32 v206, v206, v165
    v_cvt_pk_bf16_f32 v162, v164, v165
    v_mfma_f32_16x16x32_bf16 v[124:127], a[240:243], v[4:7], 0
    v_add_f32 v206, v206, v166
    v_add_f32 v206, v206, v167
    v_mfma_f32_16x16x32_bf16 v[124:127], a[244:247], v[32:35], v[124:127]
    v_cvt_pk_bf16_f32 v163, v166, v167
    v_add_f32 v200, v200, v112
    v_mfma_f32_16x16x32_bf16 v[124:127], a[248:251], v[60:63], v[124:127]
    v_add_f32 v200, v200, v113
    v_cvt_pk_bf16_f32 v112, v112, v113
    v_mfma_f32_16x16x32_bf16 v[124:127], a[252:255], v[88:91], v[124:127]
    v_exp_f32 v120, v120
    v_mfma_f32_16x16x32_bf16 a[192:195], v[168:171], v[160:163], a[192:195]
    ds_read_b64_tr_b16 v[168:169], v228 offset:8192
    v_add_f32 v200, v200, v114
    v_mfma_f32_16x16x32_bf16 a[196:199], v[172:175], v[160:163], a[196:199]
    ds_read_b64_tr_b16 v[170:171], v228 offset:12288
    v_add_f32 v200, v200, v115
    v_mfma_f32_16x16x32_bf16 a[200:203], v[176:179], v[160:163], a[200:203]
    ds_read_b64_tr_b16 v[172:173], v229 offset:8192
    v_cvt_pk_bf16_f32 v113, v114, v115
    v_mfma_f32_16x16x32_bf16 a[204:207], v[180:183], v[160:163], a[204:207]
    ds_read_b64_tr_b16 v[174:175], v229 offset:12288
    v_add_f32 v200, v200, v116
    v_mfma_f32_16x16x32_bf16 a[208:211], v[184:187], v[160:163], a[208:211]
    ds_read_b64_tr_b16 v[176:177], v230 offset:8192
    v_add_f32 v200, v200, v117
    v_mfma_f32_16x16x32_bf16 a[212:215], v[188:191], v[160:163], a[212:215]
    ds_read_b64_tr_b16 v[178:179], v230 offset:12288
    v_cvt_pk_bf16_f32 v114, v116, v117
    v_mfma_f32_16x16x32_bf16 a[216:219], v[192:195], v[160:163], a[216:219]
    ds_read_b64_tr_b16 v[180:181], v231 offset:8192
    v_add_f32 v200, v200, v118
    v_mfma_f32_16x16x32_bf16 a[220:223], v[196:199], v[160:163], a[220:223]
    ds_read_b64_tr_b16 v[182:183], v231 offset:12288
    v_add_f32 v200, v200, v119
    v_mfma_f32_16x16x32_bf16 v[128:131], a[224:227], v[8:11], 0
    ds_read_b64_tr_b16 v[184:185], v232 offset:8192
    v_cvt_pk_bf16_f32 v115, v118, v119
    v_mfma_f32_16x16x32_bf16 v[128:131], a[228:231], v[36:39], v[128:131]
    ds_read_b64_tr_b16 v[186:187], v232 offset:12288
    v_add_f32 v201, v201, v120
    v_mfma_f32_16x16x32_bf16 v[128:131], a[232:235], v[64:67], v[128:131]
    ds_read_b64_tr_b16 v[188:189], v233 offset:8192
    v_mfma_f32_16x16x32_bf16 v[128:131], a[236:239], v[92:95], v[128:131]
    ds_read_b64_tr_b16 v[190:191], v233 offset:12288
    v_mfma_f32_16x16x32_bf16 v[132:135], a[240:243], v[8:11], 0
    ds_read_b64_tr_b16 v[192:193], v234 offset:8192
    ds_read_b64_tr_b16 v[194:195], v234 offset:12288
    v_mfma_f32_16x16x32_bf16 v[132:135], a[244:247], v[36:39], v[132:135]
    ds_read_b64_tr_b16 v[196:197], v235 offset:8192
    ds_read_b64_tr_b16 v[198:199], v235 offset:12288
    v_mfma_f32_16x16x32_bf16 v[132:135], a[248:251], v[64:67], v[132:135]
    v_exp_f32 v121, v121
    v_mfma_f32_16x16x32_bf16 v[132:135], a[252:255], v[92:95], v[132:135]
    s_waitcnt lgkmcnt(12)
    v_exp_f32 v122, v122
    v_mfma_f32_16x16x32_bf16 a[0:3], v[168:171], v[112:115], a[0:3]
    v_exp_f32 v123, v123
    v_mfma_f32_16x16x32_bf16 a[4:7], v[172:175], v[112:115], a[4:7]
    s_waitcnt lgkmcnt(8)
    v_exp_f32 v124, v124
    v_mfma_f32_16x16x32_bf16 a[8:11], v[176:179], v[112:115], a[8:11]
    v_exp_f32 v125, v125
    v_mfma_f32_16x16x32_bf16 a[12:15], v[180:183], v[112:115], a[12:15]
    s_waitcnt lgkmcnt(4)
    v_exp_f32 v126, v126
    v_mfma_f32_16x16x32_bf16 a[16:19], v[184:187], v[112:115], a[16:19]
    v_exp_f32 v127, v127
    v_mfma_f32_16x16x32_bf16 a[20:23], v[188:191], v[112:115], a[20:23]
    s_waitcnt lgkmcnt(0)
    v_exp_f32 v128, v128
    v_mfma_f32_16x16x32_bf16 a[24:27], v[192:195], v[112:115], a[24:27]
    s_add_u32 s41, s43, 114688
    v_exp_f32 v129, v129
    v_add_f32 v201, v201, v121
    v_mfma_f32_16x16x32_bf16 a[28:31], v[196:199], v[112:115], a[28:31]
    s_add_u32 m0, s29, 24576
    v_exp_f32 v130, v130
    v_cvt_pk_bf16_f32 v120, v120, v121
    v_mfma_f32_16x16x32_bf16 v[136:139], a[224:227], v[12:15], 0
    s_waitcnt vmcnt(7)
    buffer_load_dwordx4 v252, s[12:15], s41 offen offset:3072 nt lds
    v_add_f32 v201, v201, v122
    v_mfma_f32_16x16x32_bf16 v[136:139], a[228:231], v[40:43], v[136:139]
    v_add_f32 v201, v201, v123
    v_cvt_pk_bf16_f32 v121, v122, v123
    v_add_f32 v201, v201, v124
    v_mfma_f32_16x16x32_bf16 v[136:139], a[232:235], v[68:71], v[136:139]
    v_add_f32 v201, v201, v125
    v_cvt_pk_bf16_f32 v122, v124, v125
    v_mfma_f32_16x16x32_bf16 v[136:139], a[236:239], v[96:99], v[136:139]
    s_add_u32 m0, s29, 106496
    v_add_f32 v201, v201, v126
    v_add_f32 v201, v201, v127
    v_mfma_f32_16x16x32_bf16 v[140:143], a[240:243], v[12:15], 0
    s_waitcnt vmcnt(6)
    buffer_load_dwordx4 v249, s[16:19], s41 offen offset:0 nt lds
    v_mfma_f32_16x16x32_bf16 v[140:143], a[244:247], v[40:43], v[140:143]
    v_cvt_pk_bf16_f32 v123, v126, v127
    v_add_f32 v202, v202, v128
    v_mfma_f32_16x16x32_bf16 v[140:143], a[248:251], v[68:71], v[140:143]
    v_exp_f32 v131, v131
    v_mfma_f32_16x16x32_bf16 v[140:143], a[252:255], v[96:99], v[140:143]
    v_exp_f32 v132, v132
    v_mfma_f32_16x16x32_bf16 a[32:35], v[168:171], v[120:123], a[32:35]
    s_waitcnt vmcnt(6)
    buffer_load_dwordx4 v250, s[16:19], s41 offen offset:1024 nt lds
    v_mfma_f32_16x16x32_bf16 a[36:39], v[172:175], v[120:123], a[36:39]
    v_exp_f32 v133, v133
    v_mfma_f32_16x16x32_bf16 a[40:43], v[176:179], v[120:123], a[40:43]
    s_add_u32 s41, s60, 0
    v_exp_f32 v134, v134
    v_mfma_f32_16x16x32_bf16 a[44:47], v[180:183], v[120:123], a[44:47]
    s_add_u32 m0, s35, 0
    v_exp_f32 v135, v135
    v_mfma_f32_16x16x32_bf16 a[48:51], v[184:187], v[120:123], a[48:51]
    buffer_load_dwordx4 v210, s[24:27], s41 offen offset:2048 lds
    v_mfma_f32_16x16x32_bf16 a[52:55], v[188:191], v[120:123], a[52:55]
    v_exp_f32 v136, v136
    v_mfma_f32_16x16x32_bf16 a[56:59], v[192:195], v[120:123], a[56:59]
    v_exp_f32 v137, v137
    v_mfma_f32_16x16x32_bf16 a[60:63], v[196:199], v[120:123], a[60:63]
    v_exp_f32 v138, v138
    v_add_f32 v202, v202, v129
    v_mfma_f32_16x16x32_bf16 v[144:147], a[224:227], v[16:19], 0
    v_exp_f32 v139, v139
    v_cvt_pk_bf16_f32 v128, v128, v129
    v_mfma_f32_16x16x32_bf16 v[144:147], a[228:231], v[44:47], v[144:147]
    v_add_f32 v202, v202, v130
    v_add_f32 v202, v202, v131
    v_cvt_pk_bf16_f32 v129, v130, v131
    v_mfma_f32_16x16x32_bf16 v[144:147], a[232:235], v[72:75], v[144:147]
    buffer_load_dwordx4 v211, s[24:27], s41 offen offset:3072 lds
    v_add_f32 v202, v202, v132
    v_mfma_f32_16x16x32_bf16 v[144:147], a[236:239], v[100:103], v[144:147]
    v_add_f32 v202, v202, v133
    v_cvt_pk_bf16_f32 v130, v132, v133
    v_mfma_f32_16x16x32_bf16 v[148:151], a[240:243], v[16:19], 0
    v_add_f32 v202, v202, v134
    v_add_f32 v202, v202, v135
    v_mfma_f32_16x16x32_bf16 v[148:151], a[244:247], v[44:47], v[148:151]
    s_add_u32 s41, s43, 114688
    v_cvt_pk_bf16_f32 v131, v134, v135
    v_add_f32 v203, v203, v136
    v_mfma_f32_16x16x32_bf16 v[148:151], a[248:251], v[72:75], v[148:151]
    s_add_u32 m0, s29, 106496
    v_exp_f32 v140, v140
    v_mfma_f32_16x16x32_bf16 v[148:151], a[252:255], v[100:103], v[148:151]
    s_waitcnt vmcnt(8)
    buffer_load_dwordx4 v251, s[16:19], s41 offen offset:2048 nt lds
    v_mfma_f32_16x16x32_bf16 a[64:67], v[168:171], v[128:131], a[64:67]
    v_exp_f32 v141, v141
    v_mfma_f32_16x16x32_bf16 a[68:71], v[172:175], v[128:131], a[68:71]
    s_add_u32 s41, s60, 163840
    v_exp_f32 v142, v142
    v_mfma_f32_16x16x32_bf16 a[72:75], v[176:179], v[128:131], a[72:75]
    s_add_u32 m0, s35, 40960
    v_exp_f32 v143, v143
    v_mfma_f32_16x16x32_bf16 a[76:79], v[180:183], v[128:131], a[76:79]
    buffer_load_dwordx4 v208, s[24:27], s41 offen offset:0 lds
    v_mfma_f32_16x16x32_bf16 a[80:83], v[184:187], v[128:131], a[80:83]
    v_exp_f32 v144, v144
    v_mfma_f32_16x16x32_bf16 a[84:87], v[188:191], v[128:131], a[84:87]
    v_exp_f32 v145, v145
    v_mfma_f32_16x16x32_bf16 a[88:91], v[192:195], v[128:131], a[88:91]
    v_exp_f32 v146, v146
    v_mfma_f32_16x16x32_bf16 a[92:95], v[196:199], v[128:131], a[92:95]
    v_exp_f32 v147, v147
    v_add_f32 v203, v203, v137
    v_mfma_f32_16x16x32_bf16 v[152:155], a[224:227], v[20:23], 0
    v_exp_f32 v148, v148
    v_cvt_pk_bf16_f32 v136, v136, v137
    v_mfma_f32_16x16x32_bf16 v[152:155], a[228:231], v[48:51], v[152:155]
    buffer_load_dwordx4 v209, s[24:27], s41 offen offset:1024 lds
    v_add_f32 v203, v203, v138
    v_mfma_f32_16x16x32_bf16 v[152:155], a[232:235], v[76:79], v[152:155]
    v_add_f32 v203, v203, v139
    v_cvt_pk_bf16_f32 v137, v138, v139
    v_add_f32 v203, v203, v140
    v_mfma_f32_16x16x32_bf16 v[152:155], a[236:239], v[104:107], v[152:155]
    v_add_f32 v203, v203, v141
    v_cvt_pk_bf16_f32 v138, v140, v141
    v_mfma_f32_16x16x32_bf16 v[156:159], a[240:243], v[20:23], 0
    v_add_f32 v203, v203, v142
    v_add_f32 v203, v203, v143
    v_mfma_f32_16x16x32_bf16 v[156:159], a[244:247], v[48:51], v[156:159]
    s_add_u32 s41, s43, 114688
    v_cvt_pk_bf16_f32 v139, v142, v143
    v_add_f32 v204, v204, v144
    v_mfma_f32_16x16x32_bf16 v[156:159], a[248:251], v[76:79], v[156:159]
    s_add_u32 m0, s29, 106496
    v_exp_f32 v149, v149
    v_mfma_f32_16x16x32_bf16 v[156:159], a[252:255], v[104:107], v[156:159]
    s_waitcnt vmcnt(10)
    buffer_load_dwordx4 v252, s[16:19], s41 offen offset:3072 nt lds
    v_mfma_f32_16x16x32_bf16 a[96:99], v[168:171], v[136:139], a[96:99]
    v_exp_f32 v150, v150
    v_mfma_f32_16x16x32_bf16 a[100:103], v[172:175], v[136:139], a[100:103]
    s_add_u32 s41, s60, 163840
    v_exp_f32 v151, v151
    v_mfma_f32_16x16x32_bf16 a[104:107], v[176:179], v[136:139], a[104:107]
    s_add_u32 m0, s35, 40960
    v_exp_f32 v152, v152
    v_mfma_f32_16x16x32_bf16 a[108:111], v[180:183], v[136:139], a[108:111]
    buffer_load_dwordx4 v210, s[24:27], s41 offen offset:2048 lds
    v_mfma_f32_16x16x32_bf16 a[112:115], v[184:187], v[136:139], a[112:115]
    s_waitcnt vmcnt(15)
    v_exp_f32 v153, v153
    v_mfma_f32_16x16x32_bf16 a[116:119], v[188:191], v[136:139], a[116:119]
    s_barrier
    v_exp_f32 v154, v154
    v_add_f32 v204, v204, v145
    v_mfma_f32_16x16x32_bf16 a[120:123], v[192:195], v[136:139], a[120:123]
    v_exp_f32 v155, v155
    v_cvt_pk_bf16_f32 v144, v144, v145
    v_mfma_f32_16x16x32_bf16 a[124:127], v[196:199], v[136:139], a[124:127]
    v_exp_f32 v156, v156
    v_add_f32 v204, v204, v146
    v_mfma_f32_16x16x32_bf16 v[160:163], a[224:227], v[24:27], 0
    v_exp_f32 v157, v157
    v_add_f32 v204, v204, v147
    v_mfma_f32_16x16x32_bf16 v[160:163], a[228:231], v[52:55], v[160:163]
    ds_read_b128 a[224:227], v224 offset:16384
    v_cvt_pk_bf16_f32 v145, v146, v147
    v_add_f32 v204, v204, v148
    v_mfma_f32_16x16x32_bf16 v[160:163], a[232:235], v[80:83], v[160:163]
    ds_read_b128 a[228:231], v225 offset:16384
    v_add_f32 v204, v204, v149
    v_cvt_pk_bf16_f32 v146, v148, v149
    v_mfma_f32_16x16x32_bf16 v[160:163], a[236:239], v[108:111], v[160:163]
    ds_read_b128 a[232:235], v226 offset:16384
    v_add_f32 v204, v204, v150
    v_add_f32 v204, v204, v151
    v_mfma_f32_16x16x32_bf16 v[164:167], a[240:243], v[24:27], 0
    ds_read_b128 a[236:239], v227 offset:16384
    v_cvt_pk_bf16_f32 v147, v150, v151
    v_mfma_f32_16x16x32_bf16 v[164:167], a[244:247], v[52:55], v[164:167]
    ds_read_b128 a[240:243], v224 offset:20480
    v_add_f32 v205, v205, v152
    v_mfma_f32_16x16x32_bf16 v[164:167], a[248:251], v[80:83], v[164:167]
    ds_read_b128 a[244:247], v225 offset:20480
    v_add_f32 v205, v205, v153
    v_mfma_f32_16x16x32_bf16 v[164:167], a[252:255], v[108:111], v[164:167]
    ds_read_b128 a[248:251], v226 offset:20480
    v_cvt_pk_bf16_f32 v152, v152, v153
    v_mfma_f32_16x16x32_bf16 a[128:131], v[168:171], v[144:147], a[128:131]
    ds_read_b128 a[252:255], v227 offset:20480
    v_add_f32 v205, v205, v154
    v_mfma_f32_16x16x32_bf16 a[132:135], v[172:175], v[144:147], a[132:135]
    s_add_u32 s41, s43, 122880
    v_exp_f32 v158, v158
    v_mfma_f32_16x16x32_bf16 a[136:139], v[176:179], v[144:147], a[136:139]
    s_add_u32 m0, s29, 32768
    v_exp_f32 v159, v159
    v_mfma_f32_16x16x32_bf16 a[140:143], v[180:183], v[144:147], a[140:143]
    s_waitcnt vmcnt(9)
    buffer_load_dwordx4 v249, s[12:15], s41 offen offset:0 nt lds
    v_mfma_f32_16x16x32_bf16 a[144:147], v[184:187], v[144:147], a[144:147]
    v_exp_f32 v160, v160
    v_mfma_f32_16x16x32_bf16 a[148:151], v[188:191], v[144:147], a[148:151]
    v_exp_f32 v161, v161
    v_mfma_f32_16x16x32_bf16 a[152:155], v[192:195], v[144:147], a[152:155]
    s_waitcnt lgkmcnt(4)
    v_exp_f32 v162, v162
    v_mfma_f32_16x16x32_bf16 a[156:159], v[196:199], v[144:147], a[156:159]
    v_exp_f32 v163, v163
    v_mfma_f32_16x16x32_bf16 v[112:115], a[224:227], v[0:3], 0
    v_exp_f32 v164, v164
    v_add_f32 v205, v205, v155
    v_mfma_f32_16x16x32_bf16 v[112:115], a[228:231], v[28:31], v[112:115]
    v_cvt_pk_bf16_f32 v153, v154, v155
    v_add_f32 v205, v205, v156
    v_mfma_f32_16x16x32_bf16 v[112:115], a[232:235], v[56:59], v[112:115]
    s_waitcnt lgkmcnt(0)
    v_add_f32 v205, v205, v157
    v_cvt_pk_bf16_f32 v154, v156, v157
    v_mfma_f32_16x16x32_bf16 v[112:115], a[236:239], v[84:87], v[112:115]
    v_add_f32 v205, v205, v158
    v_add_f32 v205, v205, v159
    v_mfma_f32_16x16x32_bf16 v[116:119], a[240:243], v[0:3], 0
    v_cvt_pk_bf16_f32 v155, v158, v159
    v_add_f32 v206, v206, v160
    v_add_f32 v206, v206, v161
    v_mfma_f32_16x16x32_bf16 v[116:119], a[244:247], v[28:31], v[116:119]
    v_exp_f32 v165, v165
    v_cvt_pk_bf16_f32 v160, v160, v161
    v_mfma_f32_16x16x32_bf16 v[116:119], a[248:251], v[56:59], v[116:119]
    s_waitcnt vmcnt(9)
    buffer_load_dwordx4 v250, s[12:15], s41 offen offset:1024 nt lds
    v_add_f32 v206, v206, v162
    v_mfma_f32_16x16x32_bf16 v[116:119], a[252:255], v[84:87], v[116:119]
    v_exp_f32 v166, v166
    v_add_f32 v206, v206, v163
    v_mfma_f32_16x16x32_bf16 a[160:163], v[168:171], v[152:155], a[160:163]
    s_add_u32 s41, s60, 163840
    v_exp_f32 v167, v167
    v_mfma_f32_16x16x32_bf16 a[164:167], v[172:175], v[152:155], a[164:167]
    s_add_u32 m0, s35, 40960
    v_exp_f32 v112, v112
    v_mfma_f32_16x16x32_bf16 a[168:171], v[176:179], v[152:155], a[168:171]
    buffer_load_dwordx4 v211, s[24:27], s41 offen offset:3072 lds
    v_mfma_f32_16x16x32_bf16 a[172:175], v[180:183], v[152:155], a[172:175]
    v_exp_f32 v113, v113
    v_mfma_f32_16x16x32_bf16 a[176:179], v[184:187], v[152:155], a[176:179]
    v_exp_f32 v114, v114
    v_mfma_f32_16x16x32_bf16 a[180:183], v[188:191], v[152:155], a[180:183]
    v_exp_f32 v115, v115
    v_mfma_f32_16x16x32_bf16 a[184:187], v[192:195], v[152:155], a[184:187]
    s_add_u32 s41, s60, 327680
    v_exp_f32 v116, v116
    v_mfma_f32_16x16x32_bf16 a[188:191], v[196:199], v[152:155], a[188:191]
    s_add_u32 m0, s35, 8192
    v_exp_f32 v117, v117
    v_mfma_f32_16x16x32_bf16 v[120:123], a[224:227], v[4:7], 0
    buffer_load_dwordx4 v208, s[24:27], s41 offen offset:0 lds
    v_mfma_f32_16x16x32_bf16 v[120:123], a[228:231], v[32:35], v[120:123]
    v_cvt_pk_bf16_f32 v161, v162, v163
    v_add_f32 v206, v206, v164
    v_mfma_f32_16x16x32_bf16 v[120:123], a[232:235], v[60:63], v[120:123]
    v_add_f32 v206, v206, v165
    v_cvt_pk_bf16_f32 v162, v164, v165
    v_mfma_f32_16x16x32_bf16 v[120:123], a[236:239], v[88:91], v[120:123]
    v_add_f32 v206, v206, v166
    v_add_f32 v206, v206, v167
    v_mfma_f32_16x16x32_bf16 v[124:127], a[240:243], v[4:7], 0
    s_add_u32 s41, s43, 122880
    v_cvt_pk_bf16_f32 v163, v166, v167
Lpg11:
    s_cbranch_execz Lpg12
    v_add_f32 v200, v200, v112
    v_mfma_f32_16x16x32_bf16 v[124:127], a[244:247], v[32:35], v[124:127]
    s_add_u32 m0, s29, 32768
    v_exp_f32 v118, v118
    v_mfma_f32_16x16x32_bf16 v[124:127], a[248:251], v[60:63], v[124:127]
    s_waitcnt vmcnt(11)
    buffer_load_dwordx4 v251, s[12:15], s41 offen offset:2048 nt lds
    v_mfma_f32_16x16x32_bf16 v[124:127], a[252:255], v[88:91], v[124:127]
    v_exp_f32 v119, v119
    v_mfma_f32_16x16x32_bf16 a[192:195], v[168:171], v[160:163], a[192:195]
    ds_read_b64_tr_b16 v[168:169], v228 offset:16384
    v_add_f32 v200, v200, v113
    v_mfma_f32_16x16x32_bf16 a[196:199], v[172:175], v[160:163], a[196:199]
    ds_read_b64_tr_b16 v[170:171], v228 offset:20480
    v_cvt_pk_bf16_f32 v112, v112, v113
    v_mfma_f32_16x16x32_bf16 a[200:203], v[176:179], v[160:163], a[200:203]
    ds_read_b64_tr_b16 v[172:173], v229 offset:16384
    v_add_f32 v200, v200, v114
    v_mfma_f32_16x16x32_bf16 a[204:207], v[180:183], v[160:163], a[204:207]
    ds_read_b64_tr_b16 v[174:175], v229 offset:20480
    v_add_f32 v200, v200, v115
    v_mfma_f32_16x16x32_bf16 a[208:211], v[184:187], v[160:163], a[208:211]
    ds_read_b64_tr_b16 v[176:177], v230 offset:16384
    v_cvt_pk_bf16_f32 v113, v114, v115
    v_mfma_f32_16x16x32_bf16 a[212:215], v[188:191], v[160:163], a[212:215]
    ds_read_b64_tr_b16 v[178:179], v230 offset:20480
    v_add_f32 v200, v200, v116
    v_mfma_f32_16x16x32_bf16 a[216:219], v[192:195], v[160:163], a[216:219]
    ds_read_b64_tr_b16 v[180:181], v231 offset:16384
    v_add_f32 v200, v200, v117
    v_mfma_f32_16x16x32_bf16 a[220:223], v[196:199], v[160:163], a[220:223]
    ds_read_b64_tr_b16 v[182:183], v231 offset:20480
    v_cvt_pk_bf16_f32 v114, v116, v117
    v_mfma_f32_16x16x32_bf16 v[128:131], a[224:227], v[8:11], 0
    ds_read_b64_tr_b16 v[184:185], v232 offset:16384
    v_add_f32 v200, v200, v118
    v_mfma_f32_16x16x32_bf16 v[128:131], a[228:231], v[36:39], v[128:131]
    ds_read_b64_tr_b16 v[186:187], v232 offset:20480
    v_add_f32 v200, v200, v119
    v_mfma_f32_16x16x32_bf16 v[128:131], a[232:235], v[64:67], v[128:131]
    ds_read_b64_tr_b16 v[188:189], v233 offset:16384
    v_cvt_pk_bf16_f32 v115, v118, v119
    v_mfma_f32_16x16x32_bf16 v[128:131], a[236:239], v[92:95], v[128:131]
    ds_read_b64_tr_b16 v[190:191], v233 offset:20480
    v_exp_f32 v120, v120
    v_mfma_f32_16x16x32_bf16 v[132:135], a[240:243], v[8:11], 0
    ds_read_b64_tr_b16 v[192:193], v234 offset:16384
    ds_read_b64_tr_b16 v[194:195], v234 offset:20480
    v_add_f32 v201, v201, v120
    v_mfma_f32_16x16x32_bf16 v[132:135], a[244:247], v[36:39], v[132:135]
    ds_read_b64_tr_b16 v[196:197], v235 offset:16384
    ds_read_b64_tr_b16 v[198:199], v235 offset:20480
    v_mfma_f32_16x16x32_bf16 v[132:135], a[248:251], v[64:67], v[132:135]
    v_exp_f32 v121, v121
    v_mfma_f32_16x16x32_bf16 v[132:135], a[252:255], v[92:95], v[132:135]
    s_waitcnt lgkmcnt(12)
    v_exp_f32 v122, v122
    v_mfma_f32_16x16x32_bf16 a[0:3], v[168:171], v[112:115], a[0:3]
    v_exp_f32 v123, v123
    v_mfma_f32_16x16x32_bf16 a[4:7], v[172:175], v[112:115], a[4:7]
    s_waitcnt lgkmcnt(8)
    v_exp_f32 v124, v124
    v_mfma_f32_16x16x32_bf16 a[8:11], v[176:179], v[112:115], a[8:11]
    v_exp_f32 v125, v125
    v_mfma_f32_16x16x32_bf16 a[12:15], v[180:183], v[112:115], a[12:15]
    s_waitcnt lgkmcnt(4)
    v_exp_f32 v126, v126
    v_mfma_f32_16x16x32_bf16 a[16:19], v[184:187], v[112:115], a[16:19]
    v_exp_f32 v127, v127
    v_mfma_f32_16x16x32_bf16 a[20:23], v[188:191], v[112:115], a[20:23]
    s_waitcnt lgkmcnt(0)
    v_exp_f32 v128, v128
    v_mfma_f32_16x16x32_bf16 a[24:27], v[192:195], v[112:115], a[24:27]
    v_exp_f32 v129, v129
    v_add_f32 v201, v201, v121
    v_mfma_f32_16x16x32_bf16 a[28:31], v[196:199], v[112:115], a[28:31]
    v_exp_f32 v130, v130
    v_cvt_pk_bf16_f32 v120, v120, v121
    v_mfma_f32_16x16x32_bf16 v[136:139], a[224:227], v[12:15], 0
    s_waitcnt vmcnt(9)
    buffer_load_dwordx4 v252, s[12:15], s41 offen offset:3072 nt lds
    v_add_f32 v201, v201, v122
    v_mfma_f32_16x16x32_bf16 v[136:139], a[228:231], v[40:43], v[136:139]
    v_add_f32 v201, v201, v123
    v_cvt_pk_bf16_f32 v121, v122, v123
    v_add_f32 v201, v201, v124
    v_mfma_f32_16x16x32_bf16 v[136:139], a[232:235], v[68:71], v[136:139]
    v_add_f32 v201, v201, v125
    v_cvt_pk_bf16_f32 v122, v124, v125
    v_mfma_f32_16x16x32_bf16 v[136:139], a[236:239], v[96:99], v[136:139]
    v_add_f32 v201, v201, v126
    v_add_f32 v201, v201, v127
    v_mfma_f32_16x16x32_bf16 v[140:143], a[240:243], v[12:15], 0
    s_add_u32 m0, s29, 114688
    v_cvt_pk_bf16_f32 v123, v126, v127
    v_add_f32 v202, v202, v128
    v_mfma_f32_16x16x32_bf16 v[140:143], a[244:247], v[40:43], v[140:143]
    s_waitcnt vmcnt(7)
    buffer_load_dwordx4 v249, s[16:19], s41 offen offset:0 nt lds
    v_mfma_f32_16x16x32_bf16 v[140:143], a[248:251], v[68:71], v[140:143]
    v_exp_f32 v131, v131
    v_mfma_f32_16x16x32_bf16 v[140:143], a[252:255], v[96:99], v[140:143]
    s_add_u32 s41, s60, 327680
    v_exp_f32 v132, v132
    v_mfma_f32_16x16x32_bf16 a[32:35], v[168:171], v[120:123], a[32:35]
    s_add_u32 m0, s35, 8192
    v_exp_f32 v133, v133
    v_mfma_f32_16x16x32_bf16 a[36:39], v[172:175], v[120:123], a[36:39]
    buffer_load_dwordx4 v209, s[24:27], s41 offen offset:1024 lds
    v_mfma_f32_16x16x32_bf16 a[40:43], v[176:179], v[120:123], a[40:43]
    v_exp_f32 v134, v134
    v_mfma_f32_16x16x32_bf16 a[44:47], v[180:183], v[120:123], a[44:47]
    v_exp_f32 v135, v135
    v_mfma_f32_16x16x32_bf16 a[48:51], v[184:187], v[120:123], a[48:51]
    v_exp_f32 v136, v136
    v_mfma_f32_16x16x32_bf16 a[52:55], v[188:191], v[120:123], a[52:55]
    v_exp_f32 v137, v137
    v_mfma_f32_16x16x32_bf16 a[56:59], v[192:195], v[120:123], a[56:59]
    v_exp_f32 v138, v138
    v_add_f32 v202, v202, v129
    v_mfma_f32_16x16x32_bf16 a[60:63], v[196:199], v[120:123], a[60:63]
    buffer_load_dwordx4 v210, s[24:27], s41 offen offset:2048 lds
    v_cvt_pk_bf16_f32 v128, v128, v129
    v_mfma_f32_16x16x32_bf16 v[144:147], a[224:227], v[16:19], 0
    v_exp_f32 v139, v139
    v_add_f32 v202, v202, v130
    v_mfma_f32_16x16x32_bf16 v[144:147], a[228:231], v[44:47], v[144:147]
    v_add_f32 v202, v202, v131
    v_cvt_pk_bf16_f32 v129, v130, v131
    v_add_f32 v202, v202, v132
    v_mfma_f32_16x16x32_bf16 v[144:147], a[232:235], v[72:75], v[144:147]
    v_add_f32 v202, v202, v133
    v_cvt_pk_bf16_f32 v130, v132, v133
    v_mfma_f32_16x16x32_bf16 v[144:147], a[236:239], v[100:103], v[144:147]
    s_add_u32 s41, s43, 122880
    v_add_f32 v202, v202, v134
    v_add_f32 v202, v202, v135
    v_mfma_f32_16x16x32_bf16 v[148:151], a[240:243], v[16:19], 0
    s_add_u32 m0, s29, 114688
    v_cvt_pk_bf16_f32 v131, v134, v135
    v_add_f32 v203, v203, v136
    v_mfma_f32_16x16x32_bf16 v[148:151], a[244:247], v[44:47], v[148:151]
    s_waitcnt vmcnt(8)
    buffer_load_dwordx4 v250, s[16:19], s41 offen offset:1024 nt lds
    v_mfma_f32_16x16x32_bf16 v[148:151], a[248:251], v[72:75], v[148:151]
    v_exp_f32 v140, v140
    v_mfma_f32_16x16x32_bf16 v[148:151], a[252:255], v[100:103], v[148:151]
    s_add_u32 s41, s60, 327680
    v_exp_f32 v141, v141
    v_mfma_f32_16x16x32_bf16 a[64:67], v[168:171], v[128:131], a[64:67]
    s_add_u32 m0, s35, 8192
    v_exp_f32 v142, v142
    v_mfma_f32_16x16x32_bf16 a[68:71], v[172:175], v[128:131], a[68:71]
    buffer_load_dwordx4 v211, s[24:27], s41 offen offset:3072 lds
    v_mfma_f32_16x16x32_bf16 a[72:75], v[176:179], v[128:131], a[72:75]
    v_exp_f32 v143, v143
    v_mfma_f32_16x16x32_bf16 a[76:79], v[180:183], v[128:131], a[76:79]
    v_exp_f32 v144, v144
    v_mfma_f32_16x16x32_bf16 a[80:83], v[184:187], v[128:131], a[80:83]
    v_exp_f32 v145, v145
    v_mfma_f32_16x16x32_bf16 a[84:87], v[188:191], v[128:131], a[84:87]
    s_add_u32 s41, s60, 491520
    v_exp_f32 v146, v146
    v_mfma_f32_16x16x32_bf16 a[88:91], v[192:195], v[128:131], a[88:91]
    s_add_u32 m0, s35, 49152
    v_exp_f32 v147, v147
    v_add_f32 v203, v203, v137
    v_mfma_f32_16x16x32_bf16 a[92:95], v[196:199], v[128:131], a[92:95]
    buffer_load_dwordx4 v208, s[24:27], s41 offen offset:0 lds
    v_cvt_pk_bf16_f32 v136, v136, v137
    v_mfma_f32_16x16x32_bf16 v[152:155], a[224:227], v[20:23], 0
    v_exp_f32 v148, v148
    v_add_f32 v203, v203, v138
    v_mfma_f32_16x16x32_bf16 v[152:155], a[228:231], v[48:51], v[152:155]
    v_add_f32 v203, v203, v139
    v_cvt_pk_bf16_f32 v137, v138, v139
    v_add_f32 v203, v203, v140
    v_mfma_f32_16x16x32_bf16 v[152:155], a[232:235], v[76:79], v[152:155]
    v_add_f32 v203, v203, v141
    v_cvt_pk_bf16_f32 v138, v140, v141
    v_mfma_f32_16x16x32_bf16 v[152:155], a[236:239], v[104:107], v[152:155]
    s_add_u32 s41, s43, 122880
    v_add_f32 v203, v203, v142
    v_add_f32 v203, v203, v143
    v_mfma_f32_16x16x32_bf16 v[156:159], a[240:243], v[20:23], 0
    s_add_u32 m0, s29, 114688
    v_cvt_pk_bf16_f32 v139, v142, v143
    v_add_f32 v204, v204, v144
    v_mfma_f32_16x16x32_bf16 v[156:159], a[244:247], v[48:51], v[156:159]
    s_waitcnt vmcnt(10)
    buffer_load_dwordx4 v251, s[16:19], s41 offen offset:2048 nt lds
    v_mfma_f32_16x16x32_bf16 v[156:159], a[248:251], v[76:79], v[156:159]
    v_exp_f32 v149, v149
    v_mfma_f32_16x16x32_bf16 v[156:159], a[252:255], v[104:107], v[156:159]
    s_add_u32 s41, s60, 491520
    v_exp_f32 v150, v150
    v_mfma_f32_16x16x32_bf16 a[96:99], v[168:171], v[136:139], a[96:99]
    s_add_u32 m0, s35, 49152
    v_exp_f32 v151, v151
    v_mfma_f32_16x16x32_bf16 a[100:103], v[172:175], v[136:139], a[100:103]
    buffer_load_dwordx4 v209, s[24:27], s41 offen offset:1024 lds
    v_mfma_f32_16x16x32_bf16 a[104:107], v[176:179], v[136:139], a[104:107]
    v_exp_f32 v152, v152
    v_mfma_f32_16x16x32_bf16 a[108:111], v[180:183], v[136:139], a[108:111]
    v_exp_f32 v153, v153
    v_mfma_f32_16x16x32_bf16 a[112:115], v[184:187], v[136:139], a[112:115]
    s_waitcnt vmcnt(15)
    v_exp_f32 v154, v154
    v_add_f32 v204, v204, v145
    v_mfma_f32_16x16x32_bf16 a[116:119], v[188:191], v[136:139], a[116:119]
    s_barrier
    v_exp_f32 v155, v155
    v_cvt_pk_bf16_f32 v144, v144, v145
    v_mfma_f32_16x16x32_bf16 a[120:123], v[192:195], v[136:139], a[120:123]
    v_exp_f32 v156, v156
    v_add_f32 v204, v204, v146
    v_mfma_f32_16x16x32_bf16 a[124:127], v[196:199], v[136:139], a[124:127]
    v_exp_f32 v157, v157
    v_add_f32 v204, v204, v147
    v_mfma_f32_16x16x32_bf16 v[160:163], a[224:227], v[24:27], 0
    buffer_load_dwordx4 v210, s[24:27], s41 offen offset:2048 lds
    v_cvt_pk_bf16_f32 v145, v146, v147
    v_mfma_f32_16x16x32_bf16 v[160:163], a[228:231], v[52:55], v[160:163]
    ds_read_b128 a[224:227], v224 offset:24576
    v_add_f32 v204, v204, v148
    v_add_f32 v204, v204, v149
    v_mfma_f32_16x16x32_bf16 v[160:163], a[232:235], v[80:83], v[160:163]
    ds_read_b128 a[228:231], v225 offset:24576
    v_cvt_pk_bf16_f32 v146, v148, v149
    v_add_f32 v204, v204, v150
    v_mfma_f32_16x16x32_bf16 v[160:163], a[236:239], v[108:111], v[160:163]
    ds_read_b128 a[232:235], v226 offset:24576
    v_add_f32 v204, v204, v151
    v_cvt_pk_bf16_f32 v147, v150, v151
    v_mfma_f32_16x16x32_bf16 v[164:167], a[240:243], v[24:27], 0
    ds_read_b128 a[236:239], v227 offset:24576
    v_add_f32 v205, v205, v152
    v_mfma_f32_16x16x32_bf16 v[164:167], a[244:247], v[52:55], v[164:167]
    ds_read_b128 a[240:243], v224 offset:28672
    v_add_f32 v205, v205, v153
    v_mfma_f32_16x16x32_bf16 v[164:167], a[248:251], v[80:83], v[164:167]
    ds_read_b128 a[244:247], v225 offset:28672
    v_cvt_pk_bf16_f32 v152, v152, v153
    v_mfma_f32_16x16x32_bf16 v[164:167], a[252:255], v[108:111], v[164:167]
    ds_read_b128 a[248:251], v226 offset:28672
    v_add_f32 v205, v205, v154
    v_mfma_f32_16x16x32_bf16 a[128:131], v[168:171], v[144:147], a[128:131]
    ds_read_b128 a[252:255], v227 offset:28672
    v_add_f32 v205, v205, v155
    v_mfma_f32_16x16x32_bf16 a[132:135], v[172:175], v[144:147], a[132:135]
    s_add_u32 s41, s43, 122880
    v_exp_f32 v158, v158
    v_mfma_f32_16x16x32_bf16 a[136:139], v[176:179], v[144:147], a[136:139]
    s_add_u32 m0, s29, 114688
    v_exp_f32 v159, v159
    v_mfma_f32_16x16x32_bf16 a[140:143], v[180:183], v[144:147], a[140:143]
    s_waitcnt vmcnt(10)
    buffer_load_dwordx4 v252, s[16:19], s41 offen offset:3072 nt lds
    v_mfma_f32_16x16x32_bf16 a[144:147], v[184:187], v[144:147], a[144:147]
    v_exp_f32 v160, v160
    v_mfma_f32_16x16x32_bf16 a[148:151], v[188:191], v[144:147], a[148:151]
    v_exp_f32 v161, v161
    v_mfma_f32_16x16x32_bf16 a[152:155], v[192:195], v[144:147], a[152:155]
    s_waitcnt lgkmcnt(4)
    v_exp_f32 v162, v162
    v_mfma_f32_16x16x32_bf16 a[156:159], v[196:199], v[144:147], a[156:159]
    v_exp_f32 v163, v163
    v_mfma_f32_16x16x32_bf16 v[112:115], a[224:227], v[0:3], 0
    v_exp_f32 v164, v164
    v_mfma_f32_16x16x32_bf16 v[112:115], a[228:231], v[28:31], v[112:115]
    v_cvt_pk_bf16_f32 v153, v154, v155
    v_add_f32 v205, v205, v156
    v_mfma_f32_16x16x32_bf16 v[112:115], a[232:235], v[56:59], v[112:115]
    s_waitcnt lgkmcnt(0)
    v_add_f32 v205, v205, v157
    v_cvt_pk_bf16_f32 v154, v156, v157
    v_mfma_f32_16x16x32_bf16 v[112:115], a[236:239], v[84:87], v[112:115]
    s_add_u32 s41, s60, 491520
    v_add_f32 v205, v205, v158
    v_add_f32 v205, v205, v159
    v_mfma_f32_16x16x32_bf16 v[116:119], a[240:243], v[0:3], 0
    s_add_u32 m0, s35, 49152
    v_cvt_pk_bf16_f32 v155, v158, v159
    v_add_f32 v206, v206, v160
    v_add_f32 v206, v206, v161
    v_mfma_f32_16x16x32_bf16 v[116:119], a[244:247], v[28:31], v[116:119]
    buffer_load_dwordx4 v211, s[24:27], s41 offen offset:3072 lds
    v_cvt_pk_bf16_f32 v160, v160, v161
    v_mfma_f32_16x16x32_bf16 v[116:119], a[248:251], v[56:59], v[116:119]
    v_exp_f32 v165, v165
    v_add_f32 v206, v206, v162
    v_mfma_f32_16x16x32_bf16 v[116:119], a[252:255], v[84:87], v[116:119]
    v_exp_f32 v166, v166
    v_add_f32 v206, v206, v163
    v_mfma_f32_16x16x32_bf16 a[160:163], v[168:171], v[152:155], a[160:163]
    v_exp_f32 v167, v167
    v_mfma_f32_16x16x32_bf16 a[164:167], v[172:175], v[152:155], a[164:167]
    s_add_u32 s41, s60, 655360
    v_exp_f32 v112, v112
    v_mfma_f32_16x16x32_bf16 a[168:171], v[176:179], v[152:155], a[168:171]
    s_add_u32 m0, s35, 16384
    v_exp_f32 v113, v113
    v_mfma_f32_16x16x32_bf16 a[172:175], v[180:183], v[152:155], a[172:175]
    buffer_load_dwordx4 v208, s[24:27], s41 offen offset:0 lds
    v_mfma_f32_16x16x32_bf16 a[176:179], v[184:187], v[152:155], a[176:179]
    v_exp_f32 v114, v114
    v_mfma_f32_16x16x32_bf16 a[180:183], v[188:191], v[152:155], a[180:183]
    v_exp_f32 v115, v115
    v_mfma_f32_16x16x32_bf16 a[184:187], v[192:195], v[152:155], a[184:187]
    v_exp_f32 v116, v116
    v_mfma_f32_16x16x32_bf16 a[188:191], v[196:199], v[152:155], a[188:191]
    v_exp_f32 v117, v117
    v_mfma_f32_16x16x32_bf16 v[120:123], a[224:227], v[4:7], 0
    v_exp_f32 v118, v118
    v_mfma_f32_16x16x32_bf16 v[120:123], a[228:231], v[32:35], v[120:123]
    buffer_load_dwordx4 v209, s[24:27], s41 offen offset:1024 lds
    v_mfma_f32_16x16x32_bf16 v[120:123], a[232:235], v[60:63], v[120:123]
    v_cvt_pk_bf16_f32 v161, v162, v163
    v_add_f32 v206, v206, v164
    v_mfma_f32_16x16x32_bf16 v[120:123], a[236:239], v[88:91], v[120:123]
    v_add_f32 v206, v206, v165
    v_cvt_pk_bf16_f32 v162, v164, v165
    v_mfma_f32_16x16x32_bf16 v[124:127], a[240:243], v[4:7], 0
    v_add_f32 v206, v206, v166
    v_add_f32 v206, v206, v167
    v_mfma_f32_16x16x32_bf16 v[124:127], a[244:247], v[32:35], v[124:127]
    v_cvt_pk_bf16_f32 v163, v166, v167
    v_add_f32 v200, v200, v112
    v_mfma_f32_16x16x32_bf16 v[124:127], a[248:251], v[60:63], v[124:127]
    v_exp_f32 v119, v119
    v_mfma_f32_16x16x32_bf16 v[124:127], a[252:255], v[88:91], v[124:127]
    buffer_load_dwordx4 v210, s[24:27], s41 offen offset:2048 lds
    v_mfma_f32_16x16x32_bf16 a[192:195], v[168:171], v[160:163], a[192:195]
    ds_read_b64_tr_b16 v[168:169], v228 offset:24576
    v_add_f32 v200, v200, v113
    v_mfma_f32_16x16x32_bf16 a[196:199], v[172:175], v[160:163], a[196:199]
    ds_read_b64_tr_b16 v[170:171], v228 offset:28672
    v_cvt_pk_bf16_f32 v112, v112, v113
    v_mfma_f32_16x16x32_bf16 a[200:203], v[176:179], v[160:163], a[200:203]
    ds_read_b64_tr_b16 v[172:173], v229 offset:24576
    v_add_f32 v200, v200, v114
    v_mfma_f32_16x16x32_bf16 a[204:207], v[180:183], v[160:163], a[204:207]
    ds_read_b64_tr_b16 v[174:175], v229 offset:28672
    v_add_f32 v200, v200, v115
    v_mfma_f32_16x16x32_bf16 a[208:211], v[184:187], v[160:163], a[208:211]
    ds_read_b64_tr_b16 v[176:177], v230 offset:24576
    v_cvt_pk_bf16_f32 v113, v114, v115
    v_mfma_f32_16x16x32_bf16 a[212:215], v[188:191], v[160:163], a[212:215]
    ds_read_b64_tr_b16 v[178:179], v230 offset:28672
    v_add_f32 v200, v200, v116
    v_mfma_f32_16x16x32_bf16 a[216:219], v[192:195], v[160:163], a[216:219]
    ds_read_b64_tr_b16 v[180:181], v231 offset:24576
    v_add_f32 v200, v200, v117
    v_mfma_f32_16x16x32_bf16 a[220:223], v[196:199], v[160:163], a[220:223]
    ds_read_b64_tr_b16 v[182:183], v231 offset:28672
    v_cvt_pk_bf16_f32 v114, v116, v117
    v_mfma_f32_16x16x32_bf16 v[128:131], a[224:227], v[8:11], 0
    ds_read_b64_tr_b16 v[184:185], v232 offset:24576
    v_add_f32 v200, v200, v118
    v_mfma_f32_16x16x32_bf16 v[128:131], a[228:231], v[36:39], v[128:131]
    ds_read_b64_tr_b16 v[186:187], v232 offset:28672
    v_add_f32 v200, v200, v119
    v_mfma_f32_16x16x32_bf16 v[128:131], a[232:235], v[64:67], v[128:131]
    ds_read_b64_tr_b16 v[188:189], v233 offset:24576
    v_cvt_pk_bf16_f32 v115, v118, v119
    v_mfma_f32_16x16x32_bf16 v[128:131], a[236:239], v[92:95], v[128:131]
    ds_read_b64_tr_b16 v[190:191], v233 offset:28672
    v_exp_f32 v120, v120
    v_mfma_f32_16x16x32_bf16 v[132:135], a[240:243], v[8:11], 0
    ds_read_b64_tr_b16 v[192:193], v234 offset:24576
    ds_read_b64_tr_b16 v[194:195], v234 offset:28672
    v_mfma_f32_16x16x32_bf16 v[132:135], a[244:247], v[36:39], v[132:135]
    ds_read_b64_tr_b16 v[196:197], v235 offset:24576
    ds_read_b64_tr_b16 v[198:199], v235 offset:28672
    v_mfma_f32_16x16x32_bf16 v[132:135], a[248:251], v[64:67], v[132:135]
    v_exp_f32 v121, v121
    v_mfma_f32_16x16x32_bf16 v[132:135], a[252:255], v[92:95], v[132:135]
    s_waitcnt lgkmcnt(12)
    v_exp_f32 v122, v122
    v_mfma_f32_16x16x32_bf16 a[0:3], v[168:171], v[112:115], a[0:3]
    v_exp_f32 v123, v123
    v_mfma_f32_16x16x32_bf16 a[4:7], v[172:175], v[112:115], a[4:7]
    s_waitcnt lgkmcnt(8)
    v_exp_f32 v124, v124
    v_mfma_f32_16x16x32_bf16 a[8:11], v[176:179], v[112:115], a[8:11]
    v_exp_f32 v125, v125
    v_mfma_f32_16x16x32_bf16 a[12:15], v[180:183], v[112:115], a[12:15]
    s_waitcnt lgkmcnt(4)
    v_exp_f32 v126, v126
    v_mfma_f32_16x16x32_bf16 a[16:19], v[184:187], v[112:115], a[16:19]
    v_exp_f32 v127, v127
    v_mfma_f32_16x16x32_bf16 a[20:23], v[188:191], v[112:115], a[20:23]
    s_waitcnt lgkmcnt(0)
    v_exp_f32 v128, v128
    v_add_f32 v201, v201, v120
    v_mfma_f32_16x16x32_bf16 a[24:27], v[192:195], v[112:115], a[24:27]
    v_exp_f32 v129, v129
    v_add_f32 v201, v201, v121
    v_mfma_f32_16x16x32_bf16 a[28:31], v[196:199], v[112:115], a[28:31]
    v_exp_f32 v130, v130
    v_cvt_pk_bf16_f32 v120, v120, v121
    v_mfma_f32_16x16x32_bf16 v[136:139], a[224:227], v[12:15], 0
    buffer_load_dwordx4 v211, s[24:27], s41 offen offset:3072 lds
    v_add_f32 v201, v201, v122
    v_mfma_f32_16x16x32_bf16 v[136:139], a[228:231], v[40:43], v[136:139]
    v_add_f32 v201, v201, v123
    v_cvt_pk_bf16_f32 v121, v122, v123
    v_add_f32 v201, v201, v124
    v_mfma_f32_16x16x32_bf16 v[136:139], a[232:235], v[68:71], v[136:139]
    v_add_f32 v201, v201, v125
    v_cvt_pk_bf16_f32 v122, v124, v125
    v_mfma_f32_16x16x32_bf16 v[136:139], a[236:239], v[96:99], v[136:139]
    v_add_f32 v201, v201, v126
    v_add_f32 v201, v201, v127
    v_mfma_f32_16x16x32_bf16 v[140:143], a[240:243], v[12:15], 0
    s_add_u32 s41, s60, 819200
    v_cvt_pk_bf16_f32 v123, v126, v127
    v_add_f32 v202, v202, v128
    v_mfma_f32_16x16x32_bf16 v[140:143], a[244:247], v[40:43], v[140:143]
    s_add_u32 m0, s35, 57344
    v_exp_f32 v131, v131
    v_mfma_f32_16x16x32_bf16 v[140:143], a[248:251], v[68:71], v[140:143]
    buffer_load_dwordx4 v208, s[24:27], s41 offen offset:0 lds
    v_mfma_f32_16x16x32_bf16 v[140:143], a[252:255], v[96:99], v[140:143]
    v_exp_f32 v132, v132
    v_mfma_f32_16x16x32_bf16 a[32:35], v[168:171], v[120:123], a[32:35]
    v_exp_f32 v133, v133
    v_mfma_f32_16x16x32_bf16 a[36:39], v[172:175], v[120:123], a[36:39]
    v_exp_f32 v134, v134
    v_mfma_f32_16x16x32_bf16 a[40:43], v[176:179], v[120:123], a[40:43]
    v_exp_f32 v135, v135
    v_mfma_f32_16x16x32_bf16 a[44:47], v[180:183], v[120:123], a[44:47]
    v_exp_f32 v136, v136
    v_mfma_f32_16x16x32_bf16 a[48:51], v[184:187], v[120:123], a[48:51]
    buffer_load_dwordx4 v209, s[24:27], s41 offen offset:1024 lds
    v_mfma_f32_16x16x32_bf16 a[52:55], v[188:191], v[120:123], a[52:55]
    v_exp_f32 v137, v137
    v_mfma_f32_16x16x32_bf16 a[56:59], v[192:195], v[120:123], a[56:59]
    v_exp_f32 v138, v138
    v_mfma_f32_16x16x32_bf16 a[60:63], v[196:199], v[120:123], a[60:63]
    v_exp_f32 v139, v139
    v_add_f32 v202, v202, v129
    v_mfma_f32_16x16x32_bf16 v[144:147], a[224:227], v[16:19], 0
    v_exp_f32 v140, v140
    v_cvt_pk_bf16_f32 v128, v128, v129
    v_mfma_f32_16x16x32_bf16 v[144:147], a[228:231], v[44:47], v[144:147]
    v_add_f32 v202, v202, v130
    v_add_f32 v202, v202, v131
    v_cvt_pk_bf16_f32 v129, v130, v131
    v_mfma_f32_16x16x32_bf16 v[144:147], a[232:235], v[72:75], v[144:147]
    buffer_load_dwordx4 v210, s[24:27], s41 offen offset:2048 lds
    v_add_f32 v202, v202, v132
    v_mfma_f32_16x16x32_bf16 v[144:147], a[236:239], v[100:103], v[144:147]
    v_add_f32 v202, v202, v133
    v_cvt_pk_bf16_f32 v130, v132, v133
    v_mfma_f32_16x16x32_bf16 v[148:151], a[240:243], v[16:19], 0
    v_add_f32 v202, v202, v134
    v_add_f32 v202, v202, v135
    v_mfma_f32_16x16x32_bf16 v[148:151], a[244:247], v[44:47], v[148:151]
    v_cvt_pk_bf16_f32 v131, v134, v135
    v_add_f32 v203, v203, v136
    v_mfma_f32_16x16x32_bf16 v[148:151], a[248:251], v[72:75], v[148:151]
    v_exp_f32 v141, v141
    v_mfma_f32_16x16x32_bf16 v[148:151], a[252:255], v[100:103], v[148:151]
    v_exp_f32 v142, v142
    v_mfma_f32_16x16x32_bf16 a[64:67], v[168:171], v[128:131], a[64:67]
    buffer_load_dwordx4 v211, s[24:27], s41 offen offset:3072 lds
    v_mfma_f32_16x16x32_bf16 a[68:71], v[172:175], v[128:131], a[68:71]
    v_exp_f32 v143, v143
    v_mfma_f32_16x16x32_bf16 a[72:75], v[176:179], v[128:131], a[72:75]
    v_exp_f32 v144, v144
    v_mfma_f32_16x16x32_bf16 a[76:79], v[180:183], v[128:131], a[76:79]
    v_exp_f32 v145, v145
    v_mfma_f32_16x16x32_bf16 a[80:83], v[184:187], v[128:131], a[80:83]
    v_exp_f32 v146, v146
    v_mfma_f32_16x16x32_bf16 a[84:87], v[188:191], v[128:131], a[84:87]
    v_exp_f32 v147, v147
    v_mfma_f32_16x16x32_bf16 a[88:91], v[192:195], v[128:131], a[88:91]
    v_exp_f32 v148, v148
    v_mfma_f32_16x16x32_bf16 a[92:95], v[196:199], v[128:131], a[92:95]
    v_exp_f32 v149, v149
    v_mfma_f32_16x16x32_bf16 v[152:155], a[224:227], v[20:23], 0
    v_exp_f32 v150, v150
    v_add_f32 v203, v203, v137
    v_mfma_f32_16x16x32_bf16 v[152:155], a[228:231], v[48:51], v[152:155]
    v_cvt_pk_bf16_f32 v136, v136, v137
    v_add_f32 v203, v203, v138
    v_add_f32 v203, v203, v139
    v_mfma_f32_16x16x32_bf16 v[152:155], a[232:235], v[76:79], v[152:155]
    v_cvt_pk_bf16_f32 v137, v138, v139
    v_add_f32 v203, v203, v140
    v_mfma_f32_16x16x32_bf16 v[152:155], a[236:239], v[104:107], v[152:155]
    v_add_f32 v203, v203, v141
    v_cvt_pk_bf16_f32 v138, v140, v141
    v_mfma_f32_16x16x32_bf16 v[156:159], a[240:243], v[20:23], 0
    v_add_f32 v203, v203, v142
    v_add_f32 v203, v203, v143
    v_mfma_f32_16x16x32_bf16 v[156:159], a[244:247], v[48:51], v[156:159]
    v_cvt_pk_bf16_f32 v139, v142, v143
    v_add_f32 v204, v204, v144
    v_mfma_f32_16x16x32_bf16 v[156:159], a[248:251], v[76:79], v[156:159]
    v_exp_f32 v151, v151
    v_mfma_f32_16x16x32_bf16 v[156:159], a[252:255], v[104:107], v[156:159]
    v_exp_f32 v152, v152
    v_mfma_f32_16x16x32_bf16 a[96:99], v[168:171], v[136:139], a[96:99]
    v_exp_f32 v153, v153
    v_mfma_f32_16x16x32_bf16 a[100:103], v[172:175], v[136:139], a[100:103]
    v_exp_f32 v154, v154
    v_mfma_f32_16x16x32_bf16 a[104:107], v[176:179], v[136:139], a[104:107]
    v_exp_f32 v155, v155
    v_mfma_f32_16x16x32_bf16 a[108:111], v[180:183], v[136:139], a[108:111]
    v_exp_f32 v156, v156
    v_mfma_f32_16x16x32_bf16 a[112:115], v[184:187], v[136:139], a[112:115]
    s_waitcnt vmcnt(9)
    v_exp_f32 v157, v157
    v_add_f32 v204, v204, v145
    v_mfma_f32_16x16x32_bf16 a[116:119], v[188:191], v[136:139], a[116:119]
    s_barrier
    v_exp_f32 v158, v158
    v_cvt_pk_bf16_f32 v144, v144, v145
    v_mfma_f32_16x16x32_bf16 a[120:123], v[192:195], v[136:139], a[120:123]
    s_add_u32 s41, s60, 983040
    v_exp_f32 v159, v159
    v_add_f32 v204, v204, v146
    v_mfma_f32_16x16x32_bf16 a[124:127], v[196:199], v[136:139], a[124:127]
    s_add_u32 m0, s35, 24576
    v_add_f32 v204, v204, v147
    v_cvt_pk_bf16_f32 v145, v146, v147
    v_add_f32 v204, v204, v148
    v_mfma_f32_16x16x32_bf16 v[160:163], a[224:227], v[24:27], 0
    buffer_load_dwordx4 v208, s[24:27], s41 offen offset:0 lds
    v_add_f32 v204, v204, v149
    v_mfma_f32_16x16x32_bf16 v[160:163], a[228:231], v[52:55], v[160:163]
    ds_read_b128 a[224:227], v224 offset:32768
    v_cvt_pk_bf16_f32 v146, v148, v149
    v_add_f32 v204, v204, v150
    v_mfma_f32_16x16x32_bf16 v[160:163], a[232:235], v[80:83], v[160:163]
    ds_read_b128 a[228:231], v225 offset:32768
    v_add_f32 v204, v204, v151
    v_mfma_f32_16x16x32_bf16 v[160:163], a[236:239], v[108:111], v[160:163]
    ds_read_b128 a[232:235], v226 offset:32768
    v_cvt_pk_bf16_f32 v147, v150, v151
    v_mfma_f32_16x16x32_bf16 v[164:167], a[240:243], v[24:27], 0
    ds_read_b128 a[236:239], v227 offset:32768
    v_add_f32 v205, v205, v152
    v_mfma_f32_16x16x32_bf16 v[164:167], a[244:247], v[52:55], v[164:167]
    ds_read_b128 a[240:243], v224 offset:36864
    v_add_f32 v205, v205, v153
    v_mfma_f32_16x16x32_bf16 v[164:167], a[248:251], v[80:83], v[164:167]
    ds_read_b128 a[244:247], v225 offset:36864
    v_cvt_pk_bf16_f32 v152, v152, v153
    v_mfma_f32_16x16x32_bf16 v[164:167], a[252:255], v[108:111], v[164:167]
    ds_read_b128 a[248:251], v226 offset:36864
    v_add_f32 v205, v205, v154
    v_mfma_f32_16x16x32_bf16 a[128:131], v[168:171], v[144:147], a[128:131]
    ds_read_b128 a[252:255], v227 offset:36864
    v_add_f32 v205, v205, v155
    v_mfma_f32_16x16x32_bf16 a[132:135], v[172:175], v[144:147], a[132:135]
    v_exp_f32 v160, v160
    v_mfma_f32_16x16x32_bf16 a[136:139], v[176:179], v[144:147], a[136:139]
    v_exp_f32 v161, v161
    v_mfma_f32_16x16x32_bf16 a[140:143], v[180:183], v[144:147], a[140:143]
    buffer_load_dwordx4 v209, s[24:27], s41 offen offset:1024 lds
    v_mfma_f32_16x16x32_bf16 a[144:147], v[184:187], v[144:147], a[144:147]
    v_exp_f32 v162, v162
    v_mfma_f32_16x16x32_bf16 a[148:151], v[188:191], v[144:147], a[148:151]
    v_exp_f32 v163, v163
    v_mfma_f32_16x16x32_bf16 a[152:155], v[192:195], v[144:147], a[152:155]
    s_waitcnt lgkmcnt(4)
    v_exp_f32 v164, v164
    v_mfma_f32_16x16x32_bf16 a[156:159], v[196:199], v[144:147], a[156:159]
    v_exp_f32 v165, v165
    v_mfma_f32_16x16x32_bf16 v[112:115], a[224:227], v[0:3], 0
    v_exp_f32 v166, v166
    v_mfma_f32_16x16x32_bf16 v[112:115], a[228:231], v[28:31], v[112:115]
    v_cvt_pk_bf16_f32 v153, v154, v155
    v_add_f32 v205, v205, v156
    v_mfma_f32_16x16x32_bf16 v[112:115], a[232:235], v[56:59], v[112:115]
    s_waitcnt lgkmcnt(0)
    v_add_f32 v205, v205, v157
    v_cvt_pk_bf16_f32 v154, v156, v157
    v_mfma_f32_16x16x32_bf16 v[112:115], a[236:239], v[84:87], v[112:115]
    v_add_f32 v205, v205, v158
    v_add_f32 v205, v205, v159
    v_mfma_f32_16x16x32_bf16 v[116:119], a[240:243], v[0:3], 0
    v_cvt_pk_bf16_f32 v155, v158, v159
    v_add_f32 v206, v206, v160
    v_mfma_f32_16x16x32_bf16 v[116:119], a[244:247], v[28:31], v[116:119]
    buffer_load_dwordx4 v210, s[24:27], s41 offen offset:2048 lds
    v_mfma_f32_16x16x32_bf16 v[116:119], a[248:251], v[56:59], v[116:119]
    v_exp_f32 v167, v167
    v_mfma_f32_16x16x32_bf16 v[116:119], a[252:255], v[84:87], v[116:119]
    v_exp_f32 v112, v112
    v_mfma_f32_16x16x32_bf16 a[160:163], v[168:171], v[152:155], a[160:163]
    v_exp_f32 v113, v113
    v_mfma_f32_16x16x32_bf16 a[164:167], v[172:175], v[152:155], a[164:167]
    v_exp_f32 v114, v114
    v_mfma_f32_16x16x32_bf16 a[168:171], v[176:179], v[152:155], a[168:171]
    v_exp_f32 v115, v115
    v_mfma_f32_16x16x32_bf16 a[172:175], v[180:183], v[152:155], a[172:175]
    buffer_load_dwordx4 v211, s[24:27], s41 offen offset:3072 lds
    v_mfma_f32_16x16x32_bf16 a[176:179], v[184:187], v[152:155], a[176:179]
    v_exp_f32 v116, v116
    v_mfma_f32_16x16x32_bf16 a[180:183], v[188:191], v[152:155], a[180:183]
    v_exp_f32 v117, v117
    v_mfma_f32_16x16x32_bf16 a[184:187], v[192:195], v[152:155], a[184:187]
    v_exp_f32 v118, v118
    v_mfma_f32_16x16x32_bf16 a[188:191], v[196:199], v[152:155], a[188:191]
    s_add_u32 s41, s60, 1146880
    v_exp_f32 v119, v119
    v_add_f32 v206, v206, v161
    v_mfma_f32_16x16x32_bf16 v[120:123], a[224:227], v[4:7], 0
    s_add_u32 m0, s35, 65536
    v_cvt_pk_bf16_f32 v160, v160, v161
    v_add_f32 v206, v206, v162
    v_add_f32 v206, v206, v163
    v_mfma_f32_16x16x32_bf16 v[120:123], a[228:231], v[32:35], v[120:123]
    buffer_load_dwordx4 v208, s[24:27], s41 offen offset:0 lds
    v_mfma_f32_16x16x32_bf16 v[120:123], a[232:235], v[60:63], v[120:123]
    v_cvt_pk_bf16_f32 v161, v162, v163
    v_add_f32 v206, v206, v164
    v_mfma_f32_16x16x32_bf16 v[120:123], a[236:239], v[88:91], v[120:123]
    v_add_f32 v206, v206, v165
    v_cvt_pk_bf16_f32 v162, v164, v165
    v_mfma_f32_16x16x32_bf16 v[124:127], a[240:243], v[4:7], 0
    v_add_f32 v206, v206, v166
    v_add_f32 v206, v206, v167
    v_mfma_f32_16x16x32_bf16 v[124:127], a[244:247], v[32:35], v[124:127]
    v_cvt_pk_bf16_f32 v163, v166, v167
    v_add_f32 v200, v200, v112
    v_mfma_f32_16x16x32_bf16 v[124:127], a[248:251], v[60:63], v[124:127]
    v_add_f32 v200, v200, v113
    v_cvt_pk_bf16_f32 v112, v112, v113
    v_mfma_f32_16x16x32_bf16 v[124:127], a[252:255], v[88:91], v[124:127]
    buffer_load_dwordx4 v209, s[24:27], s41 offen offset:1024 lds
    v_mfma_f32_16x16x32_bf16 a[192:195], v[168:171], v[160:163], a[192:195]
Lpg12:
    s_cbranch_execz Lpg13
    ds_read_b64_tr_b16 v[168:169], v228 offset:32768
    v_add_f32 v200, v200, v114
    v_mfma_f32_16x16x32_bf16 a[196:199], v[172:175], v[160:163], a[196:199]
    ds_read_b64_tr_b16 v[170:171], v228 offset:36864
    v_add_f32 v200, v200, v115
    v_mfma_f32_16x16x32_bf16 a[200:203], v[176:179], v[160:163], a[200:203]
    ds_read_b64_tr_b16 v[172:173], v229 offset:32768
    v_cvt_pk_bf16_f32 v113, v114, v115
    v_mfma_f32_16x16x32_bf16 a[204:207], v[180:183], v[160:163], a[204:207]
    ds_read_b64_tr_b16 v[174:175], v229 offset:36864
    v_add_f32 v200, v200, v116
    v_mfma_f32_16x16x32_bf16 a[208:211], v[184:187], v[160:163], a[208:211]
    ds_read_b64_tr_b16 v[176:177], v230 offset:32768
    v_add_f32 v200, v200, v117
    v_mfma_f32_16x16x32_bf16 a[212:215], v[188:191], v[160:163], a[212:215]
    ds_read_b64_tr_b16 v[178:179], v230 offset:36864
    v_cvt_pk_bf16_f32 v114, v116, v117
    v_mfma_f32_16x16x32_bf16 a[216:219], v[192:195], v[160:163], a[216:219]
    ds_read_b64_tr_b16 v[180:181], v231 offset:32768
    v_add_f32 v200, v200, v118
    v_mfma_f32_16x16x32_bf16 a[220:223], v[196:199], v[160:163], a[220:223]
    ds_read_b64_tr_b16 v[182:183], v231 offset:36864
    v_add_f32 v200, v200, v119
    v_mfma_f32_16x16x32_bf16 v[128:131], a[224:227], v[8:11], 0
    ds_read_b64_tr_b16 v[184:185], v232 offset:32768
    v_cvt_pk_bf16_f32 v115, v118, v119
    v_mfma_f32_16x16x32_bf16 v[128:131], a[228:231], v[36:39], v[128:131]
    ds_read_b64_tr_b16 v[186:187], v232 offset:36864
    v_mfma_f32_16x16x32_bf16 v[128:131], a[232:235], v[64:67], v[128:131]
    ds_read_b64_tr_b16 v[188:189], v233 offset:32768
    v_mfma_f32_16x16x32_bf16 v[128:131], a[236:239], v[92:95], v[128:131]
    ds_read_b64_tr_b16 v[190:191], v233 offset:36864
    v_exp_f32 v120, v120
    v_mfma_f32_16x16x32_bf16 v[132:135], a[240:243], v[8:11], 0
    ds_read_b64_tr_b16 v[192:193], v234 offset:32768
    ds_read_b64_tr_b16 v[194:195], v234 offset:36864
    v_mfma_f32_16x16x32_bf16 v[132:135], a[244:247], v[36:39], v[132:135]
    ds_read_b64_tr_b16 v[196:197], v235 offset:32768
    ds_read_b64_tr_b16 v[198:199], v235 offset:36864
    v_mfma_f32_16x16x32_bf16 v[132:135], a[248:251], v[64:67], v[132:135]
    v_exp_f32 v121, v121
    v_mfma_f32_16x16x32_bf16 v[132:135], a[252:255], v[92:95], v[132:135]
    s_waitcnt lgkmcnt(12)
    v_exp_f32 v122, v122
    v_mfma_f32_16x16x32_bf16 a[0:3], v[168:171], v[112:115], a[0:3]
    v_exp_f32 v123, v123
    v_mfma_f32_16x16x32_bf16 a[4:7], v[172:175], v[112:115], a[4:7]
    s_waitcnt lgkmcnt(8)
    v_exp_f32 v124, v124
    v_mfma_f32_16x16x32_bf16 a[8:11], v[176:179], v[112:115], a[8:11]
    v_exp_f32 v125, v125
    v_mfma_f32_16x16x32_bf16 a[12:15], v[180:183], v[112:115], a[12:15]
    s_waitcnt lgkmcnt(4)
    v_exp_f32 v126, v126
    v_mfma_f32_16x16x32_bf16 a[16:19], v[184:187], v[112:115], a[16:19]
    v_exp_f32 v127, v127
    v_mfma_f32_16x16x32_bf16 a[20:23], v[188:191], v[112:115], a[20:23]
    s_waitcnt lgkmcnt(0)
    v_exp_f32 v128, v128
    v_mfma_f32_16x16x32_bf16 a[24:27], v[192:195], v[112:115], a[24:27]
    s_nop 0
    v_exp_f32 v129, v129
    v_add_f32 v201, v201, v120
    v_mfma_f32_16x16x32_bf16 a[28:31], v[196:199], v[112:115], a[28:31]
    s_barrier
    v_exp_f32 v130, v130
    v_add_f32 v201, v201, v121
    v_mfma_f32_16x16x32_bf16 v[136:139], a[224:227], v[12:15], 0
    v_exp_f32 v131, v131
    v_cvt_pk_bf16_f32 v120, v120, v121
    v_mfma_f32_16x16x32_bf16 v[136:139], a[228:231], v[40:43], v[136:139]
    v_add_f32 v201, v201, v122
    v_add_f32 v201, v201, v123
    v_cvt_pk_bf16_f32 v121, v122, v123
    v_mfma_f32_16x16x32_bf16 v[136:139], a[232:235], v[68:71], v[136:139]
    buffer_load_dwordx4 v210, s[24:27], s41 offen offset:2048 lds
    v_add_f32 v201, v201, v124
    v_mfma_f32_16x16x32_bf16 v[136:139], a[236:239], v[96:99], v[136:139]
    v_add_f32 v201, v201, v125
    v_cvt_pk_bf16_f32 v122, v124, v125
    v_mfma_f32_16x16x32_bf16 v[140:143], a[240:243], v[12:15], 0
    v_add_f32 v201, v201, v126
    v_add_f32 v201, v201, v127
    v_mfma_f32_16x16x32_bf16 v[140:143], a[244:247], v[40:43], v[140:143]
    v_cvt_pk_bf16_f32 v123, v126, v127
    v_add_f32 v202, v202, v128
    v_mfma_f32_16x16x32_bf16 v[140:143], a[248:251], v[68:71], v[140:143]
    v_exp_f32 v132, v132
    v_mfma_f32_16x16x32_bf16 v[140:143], a[252:255], v[96:99], v[140:143]
    v_exp_f32 v133, v133
    v_mfma_f32_16x16x32_bf16 a[32:35], v[168:171], v[120:123], a[32:35]
    buffer_load_dwordx4 v211, s[24:27], s41 offen offset:3072 lds
    v_mfma_f32_16x16x32_bf16 a[36:39], v[172:175], v[120:123], a[36:39]
    v_exp_f32 v134, v134
    v_mfma_f32_16x16x32_bf16 a[40:43], v[176:179], v[120:123], a[40:43]
    v_exp_f32 v135, v135
    v_mfma_f32_16x16x32_bf16 a[44:47], v[180:183], v[120:123], a[44:47]
    v_exp_f32 v136, v136
    v_mfma_f32_16x16x32_bf16 a[48:51], v[184:187], v[120:123], a[48:51]
    s_add_u32 s41, s60, 40960
    v_exp_f32 v137, v137
    v_mfma_f32_16x16x32_bf16 a[52:55], v[188:191], v[120:123], a[52:55]
    s_add_u32 m0, s35, 32768
    v_exp_f32 v138, v138
    v_mfma_f32_16x16x32_bf16 a[56:59], v[192:195], v[120:123], a[56:59]
    buffer_load_dwordx4 v208, s[24:27], s41 offen offset:0 lds
    v_mfma_f32_16x16x32_bf16 a[60:63], v[196:199], v[120:123], a[60:63]
    v_exp_f32 v139, v139
    v_add_f32 v202, v202, v129
    v_mfma_f32_16x16x32_bf16 v[144:147], a[224:227], v[16:19], 0
    v_exp_f32 v140, v140
    v_cvt_pk_bf16_f32 v128, v128, v129
    v_mfma_f32_16x16x32_bf16 v[144:147], a[228:231], v[44:47], v[144:147]
    v_add_f32 v202, v202, v130
    v_add_f32 v202, v202, v131
    v_cvt_pk_bf16_f32 v129, v130, v131
    v_mfma_f32_16x16x32_bf16 v[144:147], a[232:235], v[72:75], v[144:147]
    v_add_f32 v202, v202, v132
    v_add_f32 v202, v202, v133
    v_cvt_pk_bf16_f32 v130, v132, v133
    v_mfma_f32_16x16x32_bf16 v[144:147], a[236:239], v[100:103], v[144:147]
    v_add_f32 v202, v202, v134
    v_add_f32 v202, v202, v135
    v_mfma_f32_16x16x32_bf16 v[148:151], a[240:243], v[16:19], 0
    buffer_load_dwordx4 v209, s[24:27], s41 offen offset:1024 lds
    v_mfma_f32_16x16x32_bf16 v[148:151], a[244:247], v[44:47], v[148:151]
    v_cvt_pk_bf16_f32 v131, v134, v135
    v_add_f32 v203, v203, v136
    v_mfma_f32_16x16x32_bf16 v[148:151], a[248:251], v[72:75], v[148:151]
    v_exp_f32 v141, v141
    v_mfma_f32_16x16x32_bf16 v[148:151], a[252:255], v[100:103], v[148:151]
    v_exp_f32 v142, v142
    v_mfma_f32_16x16x32_bf16 a[64:67], v[168:171], v[128:131], a[64:67]
    v_exp_f32 v143, v143
    v_mfma_f32_16x16x32_bf16 a[68:71], v[172:175], v[128:131], a[68:71]
    v_exp_f32 v144, v144
    v_mfma_f32_16x16x32_bf16 a[72:75], v[176:179], v[128:131], a[72:75]
    buffer_load_dwordx4 v210, s[24:27], s41 offen offset:2048 lds
    v_mfma_f32_16x16x32_bf16 a[76:79], v[180:183], v[128:131], a[76:79]
    v_exp_f32 v145, v145
    v_mfma_f32_16x16x32_bf16 a[80:83], v[184:187], v[128:131], a[80:83]
    v_exp_f32 v146, v146
    v_mfma_f32_16x16x32_bf16 a[84:87], v[188:191], v[128:131], a[84:87]
    v_exp_f32 v147, v147
    v_mfma_f32_16x16x32_bf16 a[88:91], v[192:195], v[128:131], a[88:91]
    v_exp_f32 v148, v148
    v_add_f32 v203, v203, v137
    v_mfma_f32_16x16x32_bf16 a[92:95], v[196:199], v[128:131], a[92:95]
    v_exp_f32 v149, v149
    v_cvt_pk_bf16_f32 v136, v136, v137
    v_mfma_f32_16x16x32_bf16 v[152:155], a[224:227], v[20:23], 0
    buffer_load_dwordx4 v211, s[24:27], s41 offen offset:3072 lds
    v_add_f32 v203, v203, v138
    v_mfma_f32_16x16x32_bf16 v[152:155], a[228:231], v[48:51], v[152:155]
    v_add_f32 v203, v203, v139
    v_cvt_pk_bf16_f32 v137, v138, v139
    v_add_f32 v203, v203, v140
    v_mfma_f32_16x16x32_bf16 v[152:155], a[232:235], v[76:79], v[152:155]
    v_add_f32 v203, v203, v141
    v_cvt_pk_bf16_f32 v138, v140, v141
    v_mfma_f32_16x16x32_bf16 v[152:155], a[236:239], v[104:107], v[152:155]
    v_add_f32 v203, v203, v142
    v_add_f32 v203, v203, v143
    v_mfma_f32_16x16x32_bf16 v[156:159], a[240:243], v[20:23], 0
    s_add_u32 s41, s60, 204800
    v_cvt_pk_bf16_f32 v139, v142, v143
    v_add_f32 v204, v204, v144
    v_add_f32 v204, v204, v145
    v_mfma_f32_16x16x32_bf16 v[156:159], a[244:247], v[48:51], v[156:159]
    s_add_u32 m0, s35, 73728
    v_exp_f32 v150, v150
    v_cvt_pk_bf16_f32 v144, v144, v145
    v_mfma_f32_16x16x32_bf16 v[156:159], a[248:251], v[76:79], v[156:159]
    buffer_load_dwordx4 v208, s[24:27], s41 offen offset:0 lds
    v_mfma_f32_16x16x32_bf16 v[156:159], a[252:255], v[104:107], v[156:159]
    v_exp_f32 v151, v151
    v_mfma_f32_16x16x32_bf16 a[96:99], v[168:171], v[136:139], a[96:99]
    v_exp_f32 v152, v152
    v_mfma_f32_16x16x32_bf16 a[100:103], v[172:175], v[136:139], a[100:103]
    v_exp_f32 v153, v153
    v_mfma_f32_16x16x32_bf16 a[104:107], v[176:179], v[136:139], a[104:107]
    v_exp_f32 v154, v154
    v_mfma_f32_16x16x32_bf16 a[108:111], v[180:183], v[136:139], a[108:111]
    v_exp_f32 v155, v155
    v_mfma_f32_16x16x32_bf16 a[112:115], v[184:187], v[136:139], a[112:115]
    buffer_load_dwordx4 v209, s[24:27], s41 offen offset:1024 lds
    v_mfma_f32_16x16x32_bf16 a[116:119], v[188:191], v[136:139], a[116:119]
    v_exp_f32 v156, v156
    v_mfma_f32_16x16x32_bf16 a[120:123], v[192:195], v[136:139], a[120:123]
    v_exp_f32 v157, v157
    v_mfma_f32_16x16x32_bf16 a[124:127], v[196:199], v[136:139], a[124:127]
    v_exp_f32 v158, v158
    v_mfma_f32_16x16x32_bf16 v[160:163], a[224:227], v[24:27], 0
    v_exp_f32 v159, v159
    v_add_f32 v204, v204, v146
    v_mfma_f32_16x16x32_bf16 v[160:163], a[228:231], v[52:55], v[160:163]
    v_add_f32 v204, v204, v147
    v_cvt_pk_bf16_f32 v145, v146, v147
    v_add_f32 v204, v204, v148
    v_mfma_f32_16x16x32_bf16 v[160:163], a[232:235], v[80:83], v[160:163]
    buffer_load_dwordx4 v210, s[24:27], s41 offen offset:2048 lds
    v_mfma_f32_16x16x32_bf16 v[160:163], a[236:239], v[108:111], v[160:163]
    v_add_f32 v204, v204, v149
    v_cvt_pk_bf16_f32 v146, v148, v149
    v_mfma_f32_16x16x32_bf16 v[164:167], a[240:243], v[24:27], 0
    v_add_f32 v204, v204, v150
    v_add_f32 v204, v204, v151
    v_mfma_f32_16x16x32_bf16 v[164:167], a[244:247], v[52:55], v[164:167]
    v_cvt_pk_bf16_f32 v147, v150, v151
    v_add_f32 v205, v205, v152
    v_add_f32 v205, v205, v153
    v_mfma_f32_16x16x32_bf16 v[164:167], a[248:251], v[80:83], v[164:167]
    v_cvt_pk_bf16_f32 v152, v152, v153
    v_add_f32 v205, v205, v154
    v_add_f32 v205, v205, v155
    v_mfma_f32_16x16x32_bf16 v[164:167], a[252:255], v[108:111], v[164:167]
    v_exp_f32 v160, v160
    v_cvt_pk_bf16_f32 v153, v154, v155
    v_mfma_f32_16x16x32_bf16 a[128:131], v[168:171], v[144:147], a[128:131]
    buffer_load_dwordx4 v211, s[24:27], s41 offen offset:3072 lds
    v_add_f32 v205, v205, v156
    v_mfma_f32_16x16x32_bf16 a[132:135], v[172:175], v[144:147], a[132:135]
    v_add_f32 v205, v205, v157
    v_cvt_pk_bf16_f32 v154, v156, v157
    v_add_f32 v205, v205, v158
    v_mfma_f32_16x16x32_bf16 a[136:139], v[176:179], v[144:147], a[136:139]
    v_add_f32 v205, v205, v159
    v_cvt_pk_bf16_f32 v155, v158, v159
    v_add_f32 v206, v206, v160
    v_mfma_f32_16x16x32_bf16 a[140:143], v[180:183], v[144:147], a[140:143]
    v_exp_f32 v161, v161
    v_mfma_f32_16x16x32_bf16 a[144:147], v[184:187], v[144:147], a[144:147]
    v_exp_f32 v162, v162
    v_add_f32 v206, v206, v161
    v_mfma_f32_16x16x32_bf16 a[148:151], v[188:191], v[144:147], a[148:151]
    v_exp_f32 v163, v163
    v_cvt_pk_bf16_f32 v160, v160, v161
    v_mfma_f32_16x16x32_bf16 a[152:155], v[192:195], v[144:147], a[152:155]
    v_exp_f32 v164, v164
    v_add_f32 v206, v206, v162
    v_exp_f32 v165, v165
    v_mfma_f32_16x16x32_bf16 a[156:159], v[196:199], v[144:147], a[156:159]
    v_exp_f32 v166, v166
    v_mfma_f32_16x16x32_bf16 a[160:163], v[168:171], v[152:155], a[160:163]
    v_exp_f32 v167, v167
    v_mfma_f32_16x16x32_bf16 a[164:167], v[172:175], v[152:155], a[164:167]
    v_add_f32 v206, v206, v163
    v_cvt_pk_bf16_f32 v161, v162, v163
    v_mfma_f32_16x16x32_bf16 a[168:171], v[176:179], v[152:155], a[168:171]
    v_add_f32 v206, v206, v164
    v_add_f32 v206, v206, v165
    v_mfma_f32_16x16x32_bf16 a[172:175], v[180:183], v[152:155], a[172:175]
    v_cvt_pk_bf16_f32 v162, v164, v165
    v_add_f32 v206, v206, v166
    v_mfma_f32_16x16x32_bf16 a[176:179], v[184:187], v[152:155], a[176:179]
    v_add_f32 v206, v206, v167
    v_cvt_pk_bf16_f32 v163, v166, v167
    v_mfma_f32_16x16x32_bf16 a[180:183], v[188:191], v[152:155], a[180:183]
    v_mov_b32 v112, v200
    v_mov_b32 v113, v201
    v_mfma_f32_16x16x32_bf16 a[184:187], v[192:195], v[152:155], a[184:187]
    v_mov_b32 v114, v202
    v_mov_b32 v115, v203
    v_mfma_f32_16x16x32_bf16 a[188:191], v[196:199], v[152:155], a[188:191]
    v_mov_b32 v116, v204
    v_mov_b32 v117, v205
    v_mfma_f32_16x16x32_bf16 a[192:195], v[168:171], v[160:163], a[192:195]
    v_mov_b32 v118, v206
    v_permlane16_swap_b32 v200, v112
    v_mfma_f32_16x16x32_bf16 a[196:199], v[172:175], v[160:163], a[196:199]
    v_permlane16_swap_b32 v201, v113
    v_permlane16_swap_b32 v202, v114
    v_mfma_f32_16x16x32_bf16 a[200:203], v[176:179], v[160:163], a[200:203]
    v_permlane16_swap_b32 v203, v115
    v_permlane16_swap_b32 v204, v116
    v_mfma_f32_16x16x32_bf16 a[204:207], v[180:183], v[160:163], a[204:207]
    v_permlane16_swap_b32 v205, v117
    v_permlane16_swap_b32 v206, v118
    v_mfma_f32_16x16x32_bf16 a[208:211], v[184:187], v[160:163], a[208:211]
    v_add_f32 v200, v200, v112
    v_add_f32 v201, v201, v113
    v_mfma_f32_16x16x32_bf16 a[212:215], v[188:191], v[160:163], a[212:215]
    v_add_f32 v202, v202, v114
    v_add_f32 v203, v203, v115
    v_mfma_f32_16x16x32_bf16 a[216:219], v[192:195], v[160:163], a[216:219]
    v_add_f32 v204, v204, v116
    v_add_f32 v205, v205, v117
    v_mfma_f32_16x16x32_bf16 a[220:223], v[196:199], v[160:163], a[220:223]
    v_add_f32 v206, v206, v118
    v_mov_b32 v112, v200
    v_mov_b32 v113, v201
    v_mov_b32 v114, v202
    v_mov_b32 v115, v203
    v_mov_b32 v116, v204
    v_mov_b32 v117, v205
    v_mov_b32 v118, v206
    v_permlane32_swap_b32 v200, v112
    v_permlane32_swap_b32 v201, v113
    v_permlane32_swap_b32 v202, v114
    v_permlane32_swap_b32 v203, v115
    v_permlane32_swap_b32 v204, v116
    v_permlane32_swap_b32 v205, v117
    v_permlane32_swap_b32 v206, v118
    v_add_f32 v200, v200, v112
    v_add_f32 v201, v201, v113
    v_add_f32 v202, v202, v114
    v_add_f32 v203, v203, v115
    v_add_f32 v204, v204, v116
    v_add_f32 v205, v205, v117
    v_add_f32 v206, v206, v118
    v_max3_u32 v112, v200, v201, v202
    v_max3_u32 v112, v112, v203, v204
    v_max3_u32 v112, v112, v205, v206
    v_min3_u32 v113, v200, v201, v202
    v_min3_u32 v113, v113, v203, v204
    v_min3_u32 v113, v113, v205, v206
    v_cmp_lt_u32 vcc, 0x4e000000, v112
    s_mov_b64 s[46:47], vcc
    v_cmp_gt_u32 vcc, 0x35800000, v113
    s_or_b64 vcc, vcc, s[46:47]
    s_cbranch_scc1 Lslow
Lsafe:
    v_rcp_f32 v200, v200
    v_rcp_f32 v201, v201
    v_rcp_f32 v202, v202
    v_rcp_f32 v203, v203
    v_rcp_f32 v204, v204
    v_rcp_f32 v205, v205
    v_rcp_f32 v206, v206
    v_accvgpr_read_b32 v0, a0
    v_accvgpr_read_b32 v1, a1
    v_accvgpr_read_b32 v2, a2
    v_accvgpr_read_b32 v3, a3
    v_accvgpr_read_b32 v4, a4
    v_accvgpr_read_b32 v5, a5
    v_accvgpr_read_b32 v6, a6
    v_accvgpr_read_b32 v7, a7
    v_pk_mul_f32 v[0:1], v[0:1], v[200:201] op_sel_hi:[1,0]
    v_pk_mul_f32 v[2:3], v[2:3], v[200:201] op_sel_hi:[1,0]
    v_pk_mul_f32 v[4:5], v[4:5], v[200:201] op_sel_hi:[1,0]
    v_pk_mul_f32 v[6:7], v[6:7], v[200:201] op_sel_hi:[1,0]
    v_cvt_pk_bf16_f32 v8, v0, v1
    v_cvt_pk_bf16_f32 v9, v2, v3
    v_cvt_pk_bf16_f32 v10, v4, v5
    v_cvt_pk_bf16_f32 v11, v6, v7
    s_add_u32 s40, s48, 0
    buffer_store_dwordx4 v[8:11], v248, s[20:23], s40 offen sc1
    v_accvgpr_read_b32 v16, a32
    v_accvgpr_read_b32 v17, a33
    v_accvgpr_read_b32 v18, a34
    v_accvgpr_read_b32 v19, a35
    v_accvgpr_read_b32 v20, a36
    v_accvgpr_read_b32 v21, a37
    v_accvgpr_read_b32 v22, a38
    v_accvgpr_read_b32 v23, a39
    v_pk_mul_f32 v[16:17], v[16:17], v[200:201] op_sel:[0,1]
    v_pk_mul_f32 v[18:19], v[18:19], v[200:201] op_sel:[0,1]
    v_pk_mul_f32 v[20:21], v[20:21], v[200:201] op_sel:[0,1]
    v_pk_mul_f32 v[22:23], v[22:23], v[200:201] op_sel:[0,1]
    v_cvt_pk_bf16_f32 v24, v16, v17
    v_cvt_pk_bf16_f32 v25, v18, v19
    v_cvt_pk_bf16_f32 v26, v20, v21
    v_cvt_pk_bf16_f32 v27, v22, v23
    s_add_u32 s40, s48, 1024
    buffer_store_dwordx4 v[24:27], v248, s[20:23], s40 offen sc1
    v_accvgpr_read_b32 v32, a64
    v_accvgpr_read_b32 v33, a65
    v_accvgpr_read_b32 v34, a66
    v_accvgpr_read_b32 v35, a67
    v_accvgpr_read_b32 v36, a68
    v_accvgpr_read_b32 v37, a69
    v_accvgpr_read_b32 v38, a70
    v_accvgpr_read_b32 v39, a71
    v_pk_mul_f32 v[32:33], v[32:33], v[202:203] op_sel_hi:[1,0]
    v_pk_mul_f32 v[34:35], v[34:35], v[202:203] op_sel_hi:[1,0]
    v_pk_mul_f32 v[36:37], v[36:37], v[202:203] op_sel_hi:[1,0]
    v_pk_mul_f32 v[38:39], v[38:39], v[202:203] op_sel_hi:[1,0]
    v_cvt_pk_bf16_f32 v40, v32, v33
    v_cvt_pk_bf16_f32 v41, v34, v35
    v_cvt_pk_bf16_f32 v42, v36, v37
    v_cvt_pk_bf16_f32 v43, v38, v39
    s_add_u32 s40, s48, 2048
    buffer_store_dwordx4 v[40:43], v248, s[20:23], s40 offen sc1
    v_accvgpr_read_b32 v48, a96
    v_accvgpr_read_b32 v49, a97
    v_accvgpr_read_b32 v50, a98
    v_accvgpr_read_b32 v51, a99
    v_accvgpr_read_b32 v52, a100
    v_accvgpr_read_b32 v53, a101
    v_accvgpr_read_b32 v54, a102
    v_accvgpr_read_b32 v55, a103
    v_pk_mul_f32 v[48:49], v[48:49], v[202:203] op_sel:[0,1]
    v_pk_mul_f32 v[50:51], v[50:51], v[202:203] op_sel:[0,1]
    v_pk_mul_f32 v[52:53], v[52:53], v[202:203] op_sel:[0,1]
    v_pk_mul_f32 v[54:55], v[54:55], v[202:203] op_sel:[0,1]
    v_cvt_pk_bf16_f32 v56, v48, v49
    v_cvt_pk_bf16_f32 v57, v50, v51
    v_cvt_pk_bf16_f32 v58, v52, v53
    v_cvt_pk_bf16_f32 v59, v54, v55
    s_add_u32 s40, s48, 3072
    buffer_store_dwordx4 v[56:59], v248, s[20:23], s40 offen sc1
    v_accvgpr_read_b32 v64, a128
    v_accvgpr_read_b32 v65, a129
    v_accvgpr_read_b32 v66, a130
    v_accvgpr_read_b32 v67, a131
    v_accvgpr_read_b32 v68, a132
    v_accvgpr_read_b32 v69, a133
    v_accvgpr_read_b32 v70, a134
    v_accvgpr_read_b32 v71, a135
    v_pk_mul_f32 v[64:65], v[64:65], v[204:205] op_sel_hi:[1,0]
    v_pk_mul_f32 v[66:67], v[66:67], v[204:205] op_sel_hi:[1,0]
    v_pk_mul_f32 v[68:69], v[68:69], v[204:205] op_sel_hi:[1,0]
    v_pk_mul_f32 v[70:71], v[70:71], v[204:205] op_sel_hi:[1,0]
    v_cvt_pk_bf16_f32 v72, v64, v65
    v_cvt_pk_bf16_f32 v73, v66, v67
    v_cvt_pk_bf16_f32 v74, v68, v69
    v_cvt_pk_bf16_f32 v75, v70, v71
    s_add_u32 s40, s48, 4096
    buffer_store_dwordx4 v[72:75], v248, s[20:23], s40 offen sc1
    v_accvgpr_read_b32 v80, a160
    v_accvgpr_read_b32 v81, a161
    v_accvgpr_read_b32 v82, a162
    v_accvgpr_read_b32 v83, a163
    v_accvgpr_read_b32 v84, a164
    v_accvgpr_read_b32 v85, a165
    v_accvgpr_read_b32 v86, a166
    v_accvgpr_read_b32 v87, a167
    v_pk_mul_f32 v[80:81], v[80:81], v[204:205] op_sel:[0,1]
    v_pk_mul_f32 v[82:83], v[82:83], v[204:205] op_sel:[0,1]
    v_pk_mul_f32 v[84:85], v[84:85], v[204:205] op_sel:[0,1]
    v_pk_mul_f32 v[86:87], v[86:87], v[204:205] op_sel:[0,1]
    v_cvt_pk_bf16_f32 v88, v80, v81
    v_cvt_pk_bf16_f32 v89, v82, v83
    v_cvt_pk_bf16_f32 v90, v84, v85
    v_cvt_pk_bf16_f32 v91, v86, v87
    s_add_u32 s40, s48, 5120
    buffer_store_dwordx4 v[88:91], v248, s[20:23], s40 offen sc1
    v_accvgpr_read_b32 v0, a192
    v_accvgpr_read_b32 v1, a193
    v_accvgpr_read_b32 v2, a194
    v_accvgpr_read_b32 v3, a195
    v_accvgpr_read_b32 v4, a196
    v_accvgpr_read_b32 v5, a197
    v_accvgpr_read_b32 v6, a198
    v_accvgpr_read_b32 v7, a199
    v_pk_mul_f32 v[0:1], v[0:1], v[206:207] op_sel_hi:[1,0]
    v_pk_mul_f32 v[2:3], v[2:3], v[206:207] op_sel_hi:[1,0]
    v_pk_mul_f32 v[4:5], v[4:5], v[206:207] op_sel_hi:[1,0]
    v_pk_mul_f32 v[6:7], v[6:7], v[206:207] op_sel_hi:[1,0]
    v_cvt_pk_bf16_f32 v8, v0, v1
    v_cvt_pk_bf16_f32 v9, v2, v3
    v_cvt_pk_bf16_f32 v10, v4, v5
    v_cvt_pk_bf16_f32 v11, v6, v7
    s_add_u32 s40, s48, 6144
    buffer_store_dwordx4 v[8:11], v248, s[20:23], s40 offen sc1
    v_accvgpr_read_b32 v16, a8
    v_accvgpr_read_b32 v17, a9
    v_accvgpr_read_b32 v18, a10
    v_accvgpr_read_b32 v19, a11
    v_accvgpr_read_b32 v20, a12
    v_accvgpr_read_b32 v21, a13
    v_accvgpr_read_b32 v22, a14
    v_accvgpr_read_b32 v23, a15
    v_pk_mul_f32 v[16:17], v[16:17], v[200:201] op_sel_hi:[1,0]
    v_pk_mul_f32 v[18:19], v[18:19], v[200:201] op_sel_hi:[1,0]
    v_pk_mul_f32 v[20:21], v[20:21], v[200:201] op_sel_hi:[1,0]
    v_pk_mul_f32 v[22:23], v[22:23], v[200:201] op_sel_hi:[1,0]
    v_cvt_pk_bf16_f32 v24, v16, v17
    v_cvt_pk_bf16_f32 v25, v18, v19
    v_cvt_pk_bf16_f32 v26, v20, v21
    v_cvt_pk_bf16_f32 v27, v22, v23
    s_add_u32 s40, s48, 14336
    buffer_store_dwordx4 v[24:27], v248, s[20:23], s40 offen sc1
    v_accvgpr_read_b32 v32, a40
    v_accvgpr_read_b32 v33, a41
    v_accvgpr_read_b32 v34, a42
    v_accvgpr_read_b32 v35, a43
    v_accvgpr_read_b32 v36, a44
    v_accvgpr_read_b32 v37, a45
    v_accvgpr_read_b32 v38, a46
    v_accvgpr_read_b32 v39, a47
    v_pk_mul_f32 v[32:33], v[32:33], v[200:201] op_sel:[0,1]
    v_pk_mul_f32 v[34:35], v[34:35], v[200:201] op_sel:[0,1]
    v_pk_mul_f32 v[36:37], v[36:37], v[200:201] op_sel:[0,1]
    v_pk_mul_f32 v[38:39], v[38:39], v[200:201] op_sel:[0,1]
    v_cvt_pk_bf16_f32 v40, v32, v33
    v_cvt_pk_bf16_f32 v41, v34, v35
    v_cvt_pk_bf16_f32 v42, v36, v37
    v_cvt_pk_bf16_f32 v43, v38, v39
    s_add_u32 s40, s48, 15360
    buffer_store_dwordx4 v[40:43], v248, s[20:23], s40 offen sc1
    v_accvgpr_read_b32 v48, a72
    v_accvgpr_read_b32 v49, a73
    v_accvgpr_read_b32 v50, a74
    v_accvgpr_read_b32 v51, a75
    v_accvgpr_read_b32 v52, a76
    v_accvgpr_read_b32 v53, a77
    v_accvgpr_read_b32 v54, a78
    v_accvgpr_read_b32 v55, a79
    v_pk_mul_f32 v[48:49], v[48:49], v[202:203] op_sel_hi:[1,0]
    v_pk_mul_f32 v[50:51], v[50:51], v[202:203] op_sel_hi:[1,0]
    v_pk_mul_f32 v[52:53], v[52:53], v[202:203] op_sel_hi:[1,0]
    v_pk_mul_f32 v[54:55], v[54:55], v[202:203] op_sel_hi:[1,0]
    v_cvt_pk_bf16_f32 v56, v48, v49
    v_cvt_pk_bf16_f32 v57, v50, v51
    v_cvt_pk_bf16_f32 v58, v52, v53
    v_cvt_pk_bf16_f32 v59, v54, v55
    s_add_u32 s40, s48, 16384
    buffer_store_dwordx4 v[56:59], v248, s[20:23], s40 offen sc1
    v_accvgpr_read_b32 v64, a104
    v_accvgpr_read_b32 v65, a105
    v_accvgpr_read_b32 v66, a106
    v_accvgpr_read_b32 v67, a107
    v_accvgpr_read_b32 v68, a108
    v_accvgpr_read_b32 v69, a109
    v_accvgpr_read_b32 v70, a110
    v_accvgpr_read_b32 v71, a111
    v_pk_mul_f32 v[64:65], v[64:65], v[202:203] op_sel:[0,1]
    v_pk_mul_f32 v[66:67], v[66:67], v[202:203] op_sel:[0,1]
    v_pk_mul_f32 v[68:69], v[68:69], v[202:203] op_sel:[0,1]
    v_pk_mul_f32 v[70:71], v[70:71], v[202:203] op_sel:[0,1]
    v_cvt_pk_bf16_f32 v72, v64, v65
    v_cvt_pk_bf16_f32 v73, v66, v67
    v_cvt_pk_bf16_f32 v74, v68, v69
    v_cvt_pk_bf16_f32 v75, v70, v71
    s_add_u32 s40, s48, 17408
    buffer_store_dwordx4 v[72:75], v248, s[20:23], s40 offen sc1
    v_accvgpr_read_b32 v80, a136
    v_accvgpr_read_b32 v81, a137
    v_accvgpr_read_b32 v82, a138
    v_accvgpr_read_b32 v83, a139
    v_accvgpr_read_b32 v84, a140
    v_accvgpr_read_b32 v85, a141
    v_accvgpr_read_b32 v86, a142
    v_accvgpr_read_b32 v87, a143
    v_pk_mul_f32 v[80:81], v[80:81], v[204:205] op_sel_hi:[1,0]
    v_pk_mul_f32 v[82:83], v[82:83], v[204:205] op_sel_hi:[1,0]
    v_pk_mul_f32 v[84:85], v[84:85], v[204:205] op_sel_hi:[1,0]
    v_pk_mul_f32 v[86:87], v[86:87], v[204:205] op_sel_hi:[1,0]
    v_cvt_pk_bf16_f32 v88, v80, v81
    v_cvt_pk_bf16_f32 v89, v82, v83
    v_cvt_pk_bf16_f32 v90, v84, v85
    v_cvt_pk_bf16_f32 v91, v86, v87
    s_add_u32 s40, s48, 18432
    buffer_store_dwordx4 v[88:91], v248, s[20:23], s40 offen sc1
    v_accvgpr_read_b32 v0, a168
    v_accvgpr_read_b32 v1, a169
    v_accvgpr_read_b32 v2, a170
    v_accvgpr_read_b32 v3, a171
    v_accvgpr_read_b32 v4, a172
    v_accvgpr_read_b32 v5, a173
    v_accvgpr_read_b32 v6, a174
    v_accvgpr_read_b32 v7, a175
    v_pk_mul_f32 v[0:1], v[0:1], v[204:205] op_sel:[0,1]
    v_pk_mul_f32 v[2:3], v[2:3], v[204:205] op_sel:[0,1]
    v_pk_mul_f32 v[4:5], v[4:5], v[204:205] op_sel:[0,1]
    v_pk_mul_f32 v[6:7], v[6:7], v[204:205] op_sel:[0,1]
    v_cvt_pk_bf16_f32 v8, v0, v1
    v_cvt_pk_bf16_f32 v9, v2, v3
    v_cvt_pk_bf16_f32 v10, v4, v5
    v_cvt_pk_bf16_f32 v11, v6, v7
    s_add_u32 s40, s48, 19456
    buffer_store_dwordx4 v[8:11], v248, s[20:23], s40 offen sc1
    v_accvgpr_read_b32 v16, a200
    v_accvgpr_read_b32 v17, a201
    v_accvgpr_read_b32 v18, a202
    v_accvgpr_read_b32 v19, a203
    v_accvgpr_read_b32 v20, a204
    v_accvgpr_read_b32 v21, a205
    v_accvgpr_read_b32 v22, a206
    v_accvgpr_read_b32 v23, a207
    v_pk_mul_f32 v[16:17], v[16:17], v[206:207] op_sel_hi:[1,0]
    v_pk_mul_f32 v[18:19], v[18:19], v[206:207] op_sel_hi:[1,0]
    v_pk_mul_f32 v[20:21], v[20:21], v[206:207] op_sel_hi:[1,0]
    v_pk_mul_f32 v[22:23], v[22:23], v[206:207] op_sel_hi:[1,0]
    v_cvt_pk_bf16_f32 v24, v16, v17
    v_cvt_pk_bf16_f32 v25, v18, v19
    v_cvt_pk_bf16_f32 v26, v20, v21
    v_cvt_pk_bf16_f32 v27, v22, v23
    s_add_u32 s40, s48, 20480
    buffer_store_dwordx4 v[24:27], v248, s[20:23], s40 offen sc1
    s_lshr_b32 s45, s28, 1
    s_sub_u32 s45, s45, 2
    s_mul_i32 s45, s45, 40960
    s_and_b32 s47, s44, 12
    s_lshl_b32 s47, s47, 4
    s_sub_u32 s46, 192, s47
    v_add_u32 v228, s45, v228
    v_add_u32 v229, s45, v229
    v_add_u32 v230, s45, v230
    v_add_u32 v231, s45, v231
    v_add_u32 v232, s45, v232
    v_add_u32 v233, s45, v233
    v_add_u32 v234, s45, v234
    v_add_u32 v235, s45, v235
    v_xor_b32 v228, s46, v228
    v_xor_b32 v229, s46, v229
    v_xor_b32 v230, s46, v230
    v_xor_b32 v231, s46, v231
    v_xor_b32 v232, s46, v232
    v_xor_b32 v233, s46, v233
    v_xor_b32 v234, s46, v234
    v_xor_b32 v235, s46, v235
Lpg13:
    s_cbranch_execz Ltch0
    v_add_u32 v224, 40960, v228
    v_add_u32 v225, 40960, v229
    v_add_u32 v226, 40960, v230
    v_add_u32 v227, 40960, v231
    v_add_u32 v241, 40960, v232
    v_add_u32 v242, 40960, v233
    v_add_u32 v243, 40960, v234
    v_add_u32 v244, 40960, v235
    s_cmp_eq_u32 s42, 2
    s_mov_b32 s46, 0x1000
    s_cselect_b32 s46, 0x10000000, s46
    v_mov_b32 v238, v248
    v_add_u32 v239, s46, v248
    v_and_b32 v212, 15, v247
    v_lshrrev_b32 v222, 4, v247
    v_mul_u32_u24 v207, 0xa00, v212
    v_and_b32 v220, 1, v222
    v_lshl_add_u32 v207, v220, 5, v207
    v_lshrrev_b32 v220, 1, v222
    v_lshl_add_u32 v207, v220, 4, v207
    v_add_u32 v240, s47, v207
    v_and_b32 v212, 3, v212
    v_lshl_add_u32 v217, v212, 2, s38
    s_mul_i32 s45, s28, 40960
    s_add_u32 s45, s45, 8192
    v_add_u32 v220, s45, v248
    s_xor_b32 s45, s28, 2
    s_mul_i32 s45, s45, 40960
    s_add_u32 s45, s45, 8192
    v_add_u32 v221, s45, v248
    v_accvgpr_read_b32 v32, a208
    v_accvgpr_read_b32 v33, a209
    v_accvgpr_read_b32 v34, a210
    v_accvgpr_read_b32 v35, a211
    v_accvgpr_read_b32 v36, a212
    v_accvgpr_read_b32 v37, a213
    v_accvgpr_read_b32 v38, a214
    v_accvgpr_read_b32 v39, a215
    v_pk_mul_f32 v[32:33], v[32:33], v[206:207] op_sel_hi:[1,0]
    v_pk_mul_f32 v[34:35], v[34:35], v[206:207] op_sel_hi:[1,0]
    v_pk_mul_f32 v[36:37], v[36:37], v[206:207] op_sel_hi:[1,0]
    v_pk_mul_f32 v[38:39], v[38:39], v[206:207] op_sel_hi:[1,0]
    v_cvt_pk_bf16_f32 v192, v32, v33
    v_cvt_pk_bf16_f32 v193, v34, v35
    v_cvt_pk_bf16_f32 v194, v36, v37
    v_cvt_pk_bf16_f32 v195, v38, v39
    v_accvgpr_read_b32 v48, a216
    v_accvgpr_read_b32 v49, a217
    v_accvgpr_read_b32 v50, a218
    v_accvgpr_read_b32 v51, a219
    v_accvgpr_read_b32 v52, a220
    v_accvgpr_read_b32 v53, a221
    v_accvgpr_read_b32 v54, a222
    v_accvgpr_read_b32 v55, a223
    v_pk_mul_f32 v[48:49], v[48:49], v[206:207] op_sel_hi:[1,0]
    v_pk_mul_f32 v[50:51], v[50:51], v[206:207] op_sel_hi:[1,0]
    v_pk_mul_f32 v[52:53], v[52:53], v[206:207] op_sel_hi:[1,0]
    v_pk_mul_f32 v[54:55], v[54:55], v[206:207] op_sel_hi:[1,0]
    v_cvt_pk_bf16_f32 v196, v48, v49
    v_cvt_pk_bf16_f32 v197, v50, v51
    v_cvt_pk_bf16_f32 v198, v52, v53
    v_cvt_pk_bf16_f32 v199, v54, v55
    v_accvgpr_read_b32 v64, a176
    v_accvgpr_read_b32 v65, a177
    v_accvgpr_read_b32 v66, a178
    v_accvgpr_read_b32 v67, a179
    v_accvgpr_read_b32 v68, a180
    v_accvgpr_read_b32 v69, a181
    v_accvgpr_read_b32 v70, a182
    v_accvgpr_read_b32 v71, a183
    v_pk_mul_f32 v[64:65], v[64:65], v[204:205] op_sel:[0,1]
    v_pk_mul_f32 v[66:67], v[66:67], v[204:205] op_sel:[0,1]
    v_pk_mul_f32 v[68:69], v[68:69], v[204:205] op_sel:[0,1]
    v_pk_mul_f32 v[70:71], v[70:71], v[204:205] op_sel:[0,1]
    v_cvt_pk_bf16_f32 v184, v64, v65
    v_cvt_pk_bf16_f32 v185, v66, v67
    v_cvt_pk_bf16_f32 v186, v68, v69
    v_cvt_pk_bf16_f32 v187, v70, v71
    s_waitcnt vmcnt(7)
    s_barrier
    buffer_store_dword v218, v219, s[20:23], 0 offen offset:0 sc1
    v_accvgpr_read_b32 v80, a184
    v_accvgpr_read_b32 v81, a185
    v_accvgpr_read_b32 v82, a186
    v_accvgpr_read_b32 v83, a187
    v_accvgpr_read_b32 v84, a188
    v_accvgpr_read_b32 v85, a189
    v_accvgpr_read_b32 v86, a190
    v_accvgpr_read_b32 v87, a191
    ds_read_b64_tr_b16 a[224:225], v224 offset:0
    v_pk_mul_f32 v[80:81], v[80:81], v[204:205] op_sel:[0,1]
    v_pk_mul_f32 v[82:83], v[82:83], v[204:205] op_sel:[0,1]
    v_pk_mul_f32 v[84:85], v[84:85], v[204:205] op_sel:[0,1]
    v_pk_mul_f32 v[86:87], v[86:87], v[204:205] op_sel:[0,1]
    ds_read_b64_tr_b16 a[226:227], v224 offset:4096
    v_cvt_pk_bf16_f32 v188, v80, v81
    v_cvt_pk_bf16_f32 v189, v82, v83
    v_cvt_pk_bf16_f32 v190, v84, v85
    v_cvt_pk_bf16_f32 v191, v86, v87
    v_accvgpr_read_b32 v0, a144
    v_accvgpr_read_b32 v1, a145
    v_accvgpr_read_b32 v2, a146
    v_accvgpr_read_b32 v3, a147
    v_accvgpr_read_b32 v4, a148
    v_accvgpr_read_b32 v5, a149
    v_accvgpr_read_b32 v6, a150
    v_accvgpr_read_b32 v7, a151
    ds_read_b64_tr_b16 a[228:229], v225 offset:0
    ds_read_b64_tr_b16 a[230:231], v225 offset:4096
    v_pk_mul_f32 v[0:1], v[0:1], v[204:205] op_sel_hi:[1,0]
    v_pk_mul_f32 v[2:3], v[2:3], v[204:205] op_sel_hi:[1,0]
    v_pk_mul_f32 v[4:5], v[4:5], v[204:205] op_sel_hi:[1,0]
    v_pk_mul_f32 v[6:7], v[6:7], v[204:205] op_sel_hi:[1,0]
    ds_read_b64_tr_b16 a[232:233], v226 offset:0
    ds_read_b64_tr_b16 a[234:235], v226 offset:4096
    ds_read_b64_tr_b16 a[236:237], v227 offset:0
    v_cvt_pk_bf16_f32 v176, v0, v1
    v_cvt_pk_bf16_f32 v177, v2, v3
    v_cvt_pk_bf16_f32 v178, v4, v5
    v_cvt_pk_bf16_f32 v179, v6, v7
    v_accvgpr_read_b32 v16, a152
    v_accvgpr_read_b32 v17, a153
    v_accvgpr_read_b32 v18, a154
    v_accvgpr_read_b32 v19, a155
    v_accvgpr_read_b32 v20, a156
    v_accvgpr_read_b32 v21, a157
    v_accvgpr_read_b32 v22, a158
    v_accvgpr_read_b32 v23, a159
    ds_read_b64_tr_b16 a[238:239], v227 offset:4096
    ds_read_b64_tr_b16 a[240:241], v241 offset:0
    v_pk_mul_f32 v[16:17], v[16:17], v[204:205] op_sel_hi:[1,0]
    v_pk_mul_f32 v[18:19], v[18:19], v[204:205] op_sel_hi:[1,0]
    v_pk_mul_f32 v[20:21], v[20:21], v[204:205] op_sel_hi:[1,0]
    v_pk_mul_f32 v[22:23], v[22:23], v[204:205] op_sel_hi:[1,0]
    ds_read_b64_tr_b16 a[242:243], v241 offset:4096
    ds_read_b64_tr_b16 a[244:245], v242 offset:0
    ds_read_b64_tr_b16 a[246:247], v242 offset:4096
    v_cvt_pk_bf16_f32 v180, v16, v17
    v_cvt_pk_bf16_f32 v181, v18, v19
    v_cvt_pk_bf16_f32 v182, v20, v21
    v_cvt_pk_bf16_f32 v183, v22, v23
    v_accvgpr_read_b32 v32, a112
    v_accvgpr_read_b32 v33, a113
    v_accvgpr_read_b32 v34, a114
    v_accvgpr_read_b32 v35, a115
    v_accvgpr_read_b32 v36, a116
    v_accvgpr_read_b32 v37, a117
    v_accvgpr_read_b32 v38, a118
    v_accvgpr_read_b32 v39, a119
    ds_read_b64_tr_b16 a[248:249], v243 offset:0
    ds_read_b64_tr_b16 a[250:251], v243 offset:4096
    v_pk_mul_f32 v[32:33], v[32:33], v[202:203] op_sel:[0,1]
    v_pk_mul_f32 v[34:35], v[34:35], v[202:203] op_sel:[0,1]
    v_pk_mul_f32 v[36:37], v[36:37], v[202:203] op_sel:[0,1]
    v_pk_mul_f32 v[38:39], v[38:39], v[202:203] op_sel:[0,1]
    ds_read_b64_tr_b16 a[252:253], v244 offset:0
    ds_read_b64_tr_b16 a[254:255], v244 offset:4096
    ds_read_b64_tr_b16 a[192:193], v228 offset:0
    v_cvt_pk_bf16_f32 v168, v32, v33
    v_cvt_pk_bf16_f32 v169, v34, v35
    v_cvt_pk_bf16_f32 v170, v36, v37
    v_cvt_pk_bf16_f32 v171, v38, v39
    v_accvgpr_read_b32 v48, a120
    v_accvgpr_read_b32 v49, a121
    v_accvgpr_read_b32 v50, a122
    v_accvgpr_read_b32 v51, a123
    v_accvgpr_read_b32 v52, a124
    v_accvgpr_read_b32 v53, a125
    v_accvgpr_read_b32 v54, a126
    v_accvgpr_read_b32 v55, a127
    ds_read_b64_tr_b16 a[194:195], v228 offset:4096
    ds_read_b64_tr_b16 a[196:197], v229 offset:0
    v_pk_mul_f32 v[48:49], v[48:49], v[202:203] op_sel:[0,1]
    v_pk_mul_f32 v[50:51], v[50:51], v[202:203] op_sel:[0,1]
    v_pk_mul_f32 v[52:53], v[52:53], v[202:203] op_sel:[0,1]
    v_pk_mul_f32 v[54:55], v[54:55], v[202:203] op_sel:[0,1]
    ds_read_b64_tr_b16 a[198:199], v229 offset:4096
    ds_read_b64_tr_b16 a[200:201], v230 offset:0
    ds_read_b64_tr_b16 a[202:203], v230 offset:4096
    v_cvt_pk_bf16_f32 v172, v48, v49
    v_cvt_pk_bf16_f32 v173, v50, v51
    v_cvt_pk_bf16_f32 v174, v52, v53
    v_cvt_pk_bf16_f32 v175, v54, v55
    v_accvgpr_read_b32 v64, a80
    v_accvgpr_read_b32 v65, a81
    v_accvgpr_read_b32 v66, a82
    v_accvgpr_read_b32 v67, a83
    v_accvgpr_read_b32 v68, a84
    v_accvgpr_read_b32 v69, a85
    v_accvgpr_read_b32 v70, a86
    v_accvgpr_read_b32 v71, a87
    ds_read_b64_tr_b16 a[204:205], v231 offset:0
    ds_read_b64_tr_b16 a[206:207], v231 offset:4096
    v_pk_mul_f32 v[64:65], v[64:65], v[202:203] op_sel_hi:[1,0]
    v_pk_mul_f32 v[66:67], v[66:67], v[202:203] op_sel_hi:[1,0]
    v_pk_mul_f32 v[68:69], v[68:69], v[202:203] op_sel_hi:[1,0]
    v_pk_mul_f32 v[70:71], v[70:71], v[202:203] op_sel_hi:[1,0]
    ds_read_b64_tr_b16 a[208:209], v232 offset:0
    ds_read_b64_tr_b16 a[210:211], v232 offset:4096
    ds_read_b64_tr_b16 a[212:213], v233 offset:0
    v_cvt_pk_bf16_f32 v160, v64, v65
    v_cvt_pk_bf16_f32 v161, v66, v67
    v_cvt_pk_bf16_f32 v162, v68, v69
    v_cvt_pk_bf16_f32 v163, v70, v71
    v_accvgpr_read_b32 v80, a88
    v_accvgpr_read_b32 v81, a89
    v_accvgpr_read_b32 v82, a90
    v_accvgpr_read_b32 v83, a91
    v_accvgpr_read_b32 v84, a92
    v_accvgpr_read_b32 v85, a93
    v_accvgpr_read_b32 v86, a94
    v_accvgpr_read_b32 v87, a95
    ds_read_b64_tr_b16 a[214:215], v233 offset:4096
    ds_read_b64_tr_b16 a[216:217], v234 offset:0
    v_pk_mul_f32 v[80:81], v[80:81], v[202:203] op_sel_hi:[1,0]
    v_pk_mul_f32 v[82:83], v[82:83], v[202:203] op_sel_hi:[1,0]
    v_pk_mul_f32 v[84:85], v[84:85], v[202:203] op_sel_hi:[1,0]
    v_pk_mul_f32 v[86:87], v[86:87], v[202:203] op_sel_hi:[1,0]
    ds_read_b64_tr_b16 a[218:219], v234 offset:4096
    ds_read_b64_tr_b16 a[220:221], v235 offset:0
    ds_read_b64_tr_b16 a[222:223], v235 offset:4096
    v_cvt_pk_bf16_f32 v164, v80, v81
    v_cvt_pk_bf16_f32 v165, v82, v83
    v_cvt_pk_bf16_f32 v166, v84, v85
    v_cvt_pk_bf16_f32 v167, v86, v87
    v_accvgpr_read_b32 v0, a48
    v_accvgpr_read_b32 v1, a49
    v_accvgpr_read_b32 v2, a50
    v_accvgpr_read_b32 v3, a51
    v_accvgpr_read_b32 v4, a52
    v_accvgpr_read_b32 v5, a53
    v_accvgpr_read_b32 v6, a54
    v_accvgpr_read_b32 v7, a55
    ds_read_b64_tr_b16 a[160:161], v228 offset:8192
    ds_read_b64_tr_b16 a[162:163], v228 offset:12288
    v_pk_mul_f32 v[0:1], v[0:1], v[200:201] op_sel:[0,1]
    v_pk_mul_f32 v[2:3], v[2:3], v[200:201] op_sel:[0,1]
    v_pk_mul_f32 v[4:5], v[4:5], v[200:201] op_sel:[0,1]
    v_pk_mul_f32 v[6:7], v[6:7], v[200:201] op_sel:[0,1]
    ds_read_b64_tr_b16 a[164:165], v229 offset:8192
    ds_read_b64_tr_b16 a[166:167], v229 offset:12288
    ds_read_b64_tr_b16 a[168:169], v230 offset:8192
    v_cvt_pk_bf16_f32 v152, v0, v1
    v_cvt_pk_bf16_f32 v153, v2, v3
    v_cvt_pk_bf16_f32 v154, v4, v5
    v_cvt_pk_bf16_f32 v155, v6, v7
    v_accvgpr_read_b32 v16, a56
    v_accvgpr_read_b32 v17, a57
    v_accvgpr_read_b32 v18, a58
    v_accvgpr_read_b32 v19, a59
    v_accvgpr_read_b32 v20, a60
    v_accvgpr_read_b32 v21, a61
    v_accvgpr_read_b32 v22, a62
    v_accvgpr_read_b32 v23, a63
    ds_read_b64_tr_b16 a[170:171], v230 offset:12288
    ds_read_b64_tr_b16 a[172:173], v231 offset:8192
    v_pk_mul_f32 v[16:17], v[16:17], v[200:201] op_sel:[0,1]
    v_pk_mul_f32 v[18:19], v[18:19], v[200:201] op_sel:[0,1]
    v_pk_mul_f32 v[20:21], v[20:21], v[200:201] op_sel:[0,1]
    v_pk_mul_f32 v[22:23], v[22:23], v[200:201] op_sel:[0,1]
    ds_read_b64_tr_b16 a[174:175], v231 offset:12288
    ds_read_b64_tr_b16 a[176:177], v232 offset:8192
    ds_read_b64_tr_b16 a[178:179], v232 offset:12288
    v_cvt_pk_bf16_f32 v156, v16, v17
    v_cvt_pk_bf16_f32 v157, v18, v19
    v_cvt_pk_bf16_f32 v158, v20, v21
    v_cvt_pk_bf16_f32 v159, v22, v23
    v_accvgpr_read_b32 v32, a16
    v_accvgpr_read_b32 v33, a17
    v_accvgpr_read_b32 v34, a18
    v_accvgpr_read_b32 v35, a19
    v_accvgpr_read_b32 v36, a20
    v_accvgpr_read_b32 v37, a21
    v_accvgpr_read_b32 v38, a22
    v_accvgpr_read_b32 v39, a23
    ds_read_b64_tr_b16 a[180:181], v233 offset:8192
    ds_read_b64_tr_b16 a[182:183], v233 offset:12288
    v_pk_mul_f32 v[32:33], v[32:33], v[200:201] op_sel_hi:[1,0]
    v_pk_mul_f32 v[34:35], v[34:35], v[200:201] op_sel_hi:[1,0]
    v_pk_mul_f32 v[36:37], v[36:37], v[200:201] op_sel_hi:[1,0]
    v_pk_mul_f32 v[38:39], v[38:39], v[200:201] op_sel_hi:[1,0]
    ds_read_b64_tr_b16 a[184:185], v234 offset:8192
    ds_read_b64_tr_b16 a[186:187], v234 offset:12288
    ds_read_b64_tr_b16 a[188:189], v235 offset:8192
    v_cvt_pk_bf16_f32 v144, v32, v33
    v_cvt_pk_bf16_f32 v145, v34, v35
    v_cvt_pk_bf16_f32 v146, v36, v37
    v_cvt_pk_bf16_f32 v147, v38, v39
    v_accvgpr_read_b32 v48, a24
    v_accvgpr_read_b32 v49, a25
    v_accvgpr_read_b32 v50, a26
    v_accvgpr_read_b32 v51, a27
    v_accvgpr_read_b32 v52, a28
    v_accvgpr_read_b32 v53, a29
    v_accvgpr_read_b32 v54, a30
    v_accvgpr_read_b32 v55, a31
    ds_read_b64_tr_b16 a[190:191], v235 offset:12288
    v_pk_mul_f32 v[48:49], v[48:49], v[200:201] op_sel_hi:[1,0]
    v_pk_mul_f32 v[50:51], v[50:51], v[200:201] op_sel_hi:[1,0]
    v_pk_mul_f32 v[52:53], v[52:53], v[200:201] op_sel_hi:[1,0]
    v_pk_mul_f32 v[54:55], v[54:55], v[200:201] op_sel_hi:[1,0]
    v_cvt_pk_bf16_f32 v148, v48, v49
    v_cvt_pk_bf16_f32 v149, v50, v51
    v_cvt_pk_bf16_f32 v150, v52, v53
    v_cvt_pk_bf16_f32 v151, v54, v55
    s_cmp_eq_u32 s34, 1
    s_cbranch_scc1 Lt15
    v_cmp_le_u32 vcc, 16, v216
    s_cmp_eq_u32 vcc_lo, -1
    s_cbranch_scc0 Lrst
Lrst_ok:
    s_waitcnt vmcnt(0) lgkmcnt(0)
    s_barrier
    buffer_load_dword v215, v217, s[20:23], 0 offen offset:0 sc1
    buffer_store_dword v218, v219, s[20:23], 0 offen offset:1792 sc1
    s_add_u32 s41, s60, 368640
    s_add_u32 m0, s35, 0
    s_nop 0
    buffer_load_dwordx4 v208, s[24:27], s41 offen offset:0 lds
    buffer_load_dwordx4 v209, s[24:27], s41 offen offset:1024 lds
    buffer_load_dwordx4 v210, s[24:27], s41 offen offset:2048 lds
    buffer_load_dwordx4 v211, s[24:27], s41 offen offset:3072 lds
    s_add_u32 s41, s60, 532480
    s_add_u32 m0, s35, 40960
    s_nop 0
    buffer_load_dwordx4 v208, s[24:27], s41 offen offset:0 lds
    buffer_load_dwordx4 v209, s[24:27], s41 offen offset:1024 lds
    buffer_load_dwordx4 v210, s[24:27], s41 offen offset:2048 lds
    buffer_load_dwordx4 v211, s[24:27], s41 offen offset:3072 lds
    s_add_u32 s41, s60, 696320
    s_add_u32 m0, s35, 8192
    s_nop 0
    buffer_load_dwordx4 v208, s[24:27], s41 offen offset:0 lds
    buffer_load_dwordx4 v209, s[24:27], s41 offen offset:1024 lds
    buffer_load_dwordx4 v210, s[24:27], s41 offen offset:2048 lds
    buffer_load_dwordx4 v211, s[24:27], s41 offen offset:3072 lds
    s_mov_b64 exec, 0
    s_cmp_eq_u32 s28, 0
    s_cbranch_scc1 Lpg14
    s_cmp_eq_u32 s28, 1
    s_cbranch_scc1 Lpg16
    s_cmp_eq_u32 s28, 2
    s_cbranch_scc1 Lpg18
    s_branch Lpg20
Ltch1:
    s_mov_b64 exec, -1
    s_waitcnt vmcnt(13)
    v_cmp_eq_u32 vcc, 1, v215
    s_cmp_eq_u32 vcc_lo, -1
    s_cbranch_scc0 Lspin0
Lback0:
    s_add_u32 s47, s61, 0
    buffer_load_dwordx4 v[0:3], v238, s[20:23], s47 offen offset:0 sc1
    buffer_load_dwordx4 v[4:7], v238, s[20:23], s47 offen offset:1024 sc1
    buffer_load_dwordx4 v[8:11], v238, s[20:23], s47 offen offset:2048 sc1
    buffer_load_dwordx4 v[12:15], v238, s[20:23], s47 offen offset:3072 sc1
    buffer_load_dwordx4 v[16:19], v239, s[20:23], s47 offen offset:0 sc1
    s_add_u32 s47, s61, 57344
    buffer_load_dwordx4 v[20:23], v238, s[20:23], s47 offen offset:0 sc1
    buffer_load_dwordx4 v[24:27], v238, s[20:23], s47 offen offset:1024 sc1
    buffer_load_dwordx4 v[28:31], v238, s[20:23], s47 offen offset:2048 sc1
    buffer_load_dwordx4 v[32:35], v238, s[20:23], s47 offen offset:3072 sc1
    buffer_load_dwordx4 v[36:39], v239, s[20:23], s47 offen offset:0 sc1
    s_add_u32 s47, s61, 114688
    buffer_load_dwordx4 v[40:43], v238, s[20:23], s47 offen offset:0 sc1
    buffer_load_dwordx4 v[44:47], v238, s[20:23], s47 offen offset:1024 sc1
    buffer_load_dwordx4 v[48:51], v238, s[20:23], s47 offen offset:2048 sc1
    buffer_load_dwordx4 v[52:55], v238, s[20:23], s47 offen offset:3072 sc1
    buffer_load_dwordx4 v[56:59], v239, s[20:23], s47 offen offset:0 sc1
    s_add_u32 s47, s61, 172032
    buffer_load_dwordx4 v[60:63], v238, s[20:23], s47 offen offset:0 sc1
    buffer_load_dwordx4 v[64:67], v238, s[20:23], s47 offen offset:1024 sc1
    buffer_load_dwordx4 v[68:71], v238, s[20:23], s47 offen offset:2048 sc1
    buffer_load_dwordx4 v[72:75], v238, s[20:23], s47 offen offset:3072 sc1
    buffer_load_dwordx4 v[76:79], v239, s[20:23], s47 offen offset:0 sc1
    s_add_u32 s47, s61, 229376
    s_waitcnt vmcnt(15)
    v_mfma_f32_16x16x32_bf16 a[0:3], a[192:195], v[0:3], 0
    buffer_load_dwordx4 v[80:83], v238, s[20:23], s47 offen offset:0 sc1
    v_mfma_f32_16x16x32_bf16 a[4:7], a[192:195], v[4:7], 0
    s_add_u32 s40, s48, 28672
    v_mfma_f32_16x16x32_bf16 a[8:11], a[192:195], v[8:11], 0
    buffer_store_dwordx4 v[144:147], v248, s[20:23], s40 offen sc1
    v_mfma_f32_16x16x32_bf16 a[12:15], a[192:195], v[12:15], 0
    v_mfma_f32_16x16x32_bf16 a[16:19], a[192:195], v[16:19], 0
    buffer_load_dwordx4 v[84:87], v238, s[20:23], s47 offen offset:1024 sc1
    v_mfma_f32_16x16x32_bf16 a[20:23], a[196:199], v[0:3], 0
    v_mfma_f32_16x16x32_bf16 a[24:27], a[196:199], v[4:7], 0
    s_waitcnt vmcnt(35)
    s_barrier
    v_mfma_f32_16x16x32_bf16 a[28:31], a[196:199], v[8:11], 0
    v_mfma_f32_16x16x32_bf16 a[32:35], a[196:199], v[12:15], 0
    v_mfma_f32_16x16x32_bf16 a[36:39], a[196:199], v[16:19], 0
    v_mfma_f32_16x16x32_bf16 a[40:43], a[200:203], v[0:3], 0
    v_mfma_f32_16x16x32_bf16 a[44:47], a[200:203], v[4:7], 0
    v_mfma_f32_16x16x32_bf16 a[48:51], a[200:203], v[8:11], 0
    v_mfma_f32_16x16x32_bf16 a[52:55], a[200:203], v[12:15], 0
    v_mfma_f32_16x16x32_bf16 a[56:59], a[200:203], v[16:19], 0
    s_add_u32 s40, s48, 43008
    v_mfma_f32_16x16x32_bf16 a[60:63], a[204:207], v[0:3], 0
    buffer_store_dwordx4 v[148:151], v248, s[20:23], s40 offen sc1
    v_mfma_f32_16x16x32_bf16 a[64:67], a[204:207], v[4:7], 0
    v_mfma_f32_16x16x32_bf16 a[68:71], a[204:207], v[8:11], 0
    buffer_load_dwordx4 v[88:91], v238, s[20:23], s47 offen offset:2048 sc1
    v_mfma_f32_16x16x32_bf16 a[72:75], a[204:207], v[12:15], 0
    v_mfma_f32_16x16x32_bf16 a[76:79], a[204:207], v[16:19], 0
    s_add_u32 s40, s48, 29696
    v_mfma_f32_16x16x32_bf16 a[80:83], a[208:211], v[0:3], 0
    buffer_store_dwordx4 v[152:155], v248, s[20:23], s40 offen sc1
    v_mfma_f32_16x16x32_bf16 a[84:87], a[208:211], v[4:7], 0
    v_mfma_f32_16x16x32_bf16 a[88:91], a[208:211], v[8:11], 0
    v_mfma_f32_16x16x32_bf16 a[92:95], a[208:211], v[12:15], 0
    v_mfma_f32_16x16x32_bf16 a[96:99], a[208:211], v[16:19], 0
    v_mfma_f32_16x16x32_bf16 a[100:103], a[212:215], v[0:3], 0
    v_mfma_f32_16x16x32_bf16 a[104:107], a[212:215], v[4:7], 0
    v_mfma_f32_16x16x32_bf16 a[108:111], a[212:215], v[8:11], 0
    buffer_load_dwordx4 v[92:95], v238, s[20:23], s47 offen offset:3072 sc1
    v_mfma_f32_16x16x32_bf16 a[112:115], a[212:215], v[12:15], 0
    v_mfma_f32_16x16x32_bf16 a[116:119], a[212:215], v[16:19], 0
    s_add_u32 s40, s48, 44032
    v_mfma_f32_16x16x32_bf16 a[120:123], a[216:219], v[0:3], 0
    buffer_store_dwordx4 v[156:159], v248, s[20:23], s40 offen sc1
    v_mfma_f32_16x16x32_bf16 a[124:127], a[216:219], v[4:7], 0
    v_mfma_f32_16x16x32_bf16 a[128:131], a[216:219], v[8:11], 0
    v_mfma_f32_16x16x32_bf16 a[132:135], a[216:219], v[12:15], 0
    v_mfma_f32_16x16x32_bf16 a[136:139], a[216:219], v[16:19], 0
    v_mfma_f32_16x16x32_bf16 a[140:143], a[220:223], v[0:3], 0
    v_mfma_f32_16x16x32_bf16 a[144:147], a[220:223], v[4:7], 0
    v_mfma_f32_16x16x32_bf16 a[148:151], a[220:223], v[8:11], 0
    buffer_load_dwordx4 v[96:99], v239, s[20:23], s47 offen offset:0 sc1
    v_mfma_f32_16x16x32_bf16 a[152:155], a[220:223], v[12:15], 0
    s_add_u32 s47, s61, 286720
    v_mfma_f32_16x16x32_bf16 a[156:159], a[220:223], v[16:19], 0
    s_waitcnt vmcnt(19)
    v_mfma_f32_16x16x32_bf16 a[0:3], a[224:227], v[20:23], a[0:3]
    buffer_load_dwordx4 v[100:103], v238, s[20:23], s47 offen offset:0 sc1
    v_mfma_f32_16x16x32_bf16 a[4:7], a[224:227], v[24:27], a[4:7]
    s_add_u32 s40, s48, 30720
    v_mfma_f32_16x16x32_bf16 a[8:11], a[224:227], v[28:31], a[8:11]
    buffer_store_dwordx4 v[160:163], v248, s[20:23], s40 offen sc1
    v_mfma_f32_16x16x32_bf16 a[12:15], a[224:227], v[32:35], a[12:15]
    v_mfma_f32_16x16x32_bf16 a[16:19], a[224:227], v[36:39], a[16:19]
    buffer_load_dwordx4 v[104:107], v238, s[20:23], s47 offen offset:1024 sc1
    v_mfma_f32_16x16x32_bf16 a[20:23], a[228:231], v[20:23], a[20:23]
    v_mfma_f32_16x16x32_bf16 a[24:27], a[228:231], v[24:27], a[24:27]
    v_mfma_f32_16x16x32_bf16 a[28:31], a[228:231], v[28:31], a[28:31]
    v_mfma_f32_16x16x32_bf16 a[32:35], a[228:231], v[32:35], a[32:35]
    v_mfma_f32_16x16x32_bf16 a[36:39], a[228:231], v[36:39], a[36:39]
    v_mfma_f32_16x16x32_bf16 a[40:43], a[232:235], v[20:23], a[40:43]
    v_mfma_f32_16x16x32_bf16 a[44:47], a[232:235], v[24:27], a[44:47]
    v_mfma_f32_16x16x32_bf16 a[48:51], a[232:235], v[28:31], a[48:51]
    v_mfma_f32_16x16x32_bf16 a[52:55], a[232:235], v[32:35], a[52:55]
    v_mfma_f32_16x16x32_bf16 a[56:59], a[232:235], v[36:39], a[56:59]
    s_add_u32 s40, s48, 45056
    v_mfma_f32_16x16x32_bf16 a[60:63], a[236:239], v[20:23], a[60:63]
    buffer_store_dwordx4 v[164:167], v248, s[20:23], s40 offen sc1
    v_mfma_f32_16x16x32_bf16 a[64:67], a[236:239], v[24:27], a[64:67]
    v_mfma_f32_16x16x32_bf16 a[68:71], a[236:239], v[28:31], a[68:71]
    buffer_load_dwordx4 v[108:111], v238, s[20:23], s47 offen offset:2048 sc1
    v_mfma_f32_16x16x32_bf16 a[72:75], a[236:239], v[32:35], a[72:75]
    v_mfma_f32_16x16x32_bf16 a[76:79], a[236:239], v[36:39], a[76:79]
    s_add_u32 s40, s48, 31744
    v_mfma_f32_16x16x32_bf16 a[80:83], a[240:243], v[20:23], a[80:83]
    buffer_store_dwordx4 v[168:171], v248, s[20:23], s40 offen sc1
    v_mfma_f32_16x16x32_bf16 a[84:87], a[240:243], v[24:27], a[84:87]
    v_mfma_f32_16x16x32_bf16 a[88:91], a[240:243], v[28:31], a[88:91]
    v_mfma_f32_16x16x32_bf16 a[92:95], a[240:243], v[32:35], a[92:95]
    v_mfma_f32_16x16x32_bf16 a[96:99], a[240:243], v[36:39], a[96:99]
    v_mfma_f32_16x16x32_bf16 a[100:103], a[244:247], v[20:23], a[100:103]
    v_mfma_f32_16x16x32_bf16 a[104:107], a[244:247], v[24:27], a[104:107]
    v_mfma_f32_16x16x32_bf16 a[108:111], a[244:247], v[28:31], a[108:111]
    buffer_load_dwordx4 v[112:115], v238, s[20:23], s47 offen offset:3072 sc1
    v_mfma_f32_16x16x32_bf16 a[112:115], a[244:247], v[32:35], a[112:115]
    v_mfma_f32_16x16x32_bf16 a[116:119], a[244:247], v[36:39], a[116:119]
    s_add_u32 s40, s48, 46080
    v_mfma_f32_16x16x32_bf16 a[120:123], a[248:251], v[20:23], a[120:123]
    buffer_store_dwordx4 v[172:175], v248, s[20:23], s40 offen sc1
    v_mfma_f32_16x16x32_bf16 a[124:127], a[248:251], v[24:27], a[124:127]
    v_mfma_f32_16x16x32_bf16 a[128:131], a[248:251], v[28:31], a[128:131]
    v_mfma_f32_16x16x32_bf16 a[132:135], a[248:251], v[32:35], a[132:135]
    v_mfma_f32_16x16x32_bf16 a[136:139], a[248:251], v[36:39], a[136:139]
    v_mfma_f32_16x16x32_bf16 a[140:143], a[252:255], v[20:23], a[140:143]
    v_mfma_f32_16x16x32_bf16 a[144:147], a[252:255], v[24:27], a[144:147]
    v_mfma_f32_16x16x32_bf16 a[148:151], a[252:255], v[28:31], a[148:151]
    buffer_load_dwordx4 v[116:119], v239, s[20:23], s47 offen offset:0 sc1
    v_mfma_f32_16x16x32_bf16 a[152:155], a[252:255], v[32:35], a[152:155]
    s_add_u32 s47, s61, 344064
    v_mfma_f32_16x16x32_bf16 a[156:159], a[252:255], v[36:39], a[156:159]
    s_waitcnt vmcnt(23)
    v_mfma_f32_16x16x32_bf16 a[0:3], a[160:163], v[40:43], a[0:3]
    buffer_load_dwordx4 v[120:123], v238, s[20:23], s47 offen offset:0 sc1
    v_mfma_f32_16x16x32_bf16 a[4:7], a[160:163], v[44:47], a[4:7]
    s_add_u32 s40, s48, 32768
    v_mfma_f32_16x16x32_bf16 a[8:11], a[160:163], v[48:51], a[8:11]
    buffer_store_dwordx4 v[176:179], v248, s[20:23], s40 offen sc1
    v_mfma_f32_16x16x32_bf16 a[12:15], a[160:163], v[52:55], a[12:15]
    v_mfma_f32_16x16x32_bf16 a[16:19], a[160:163], v[56:59], a[16:19]
    buffer_load_dwordx4 v[124:127], v238, s[20:23], s47 offen offset:1024 sc1
    v_mfma_f32_16x16x32_bf16 a[20:23], a[164:167], v[40:43], a[20:23]
    v_mfma_f32_16x16x32_bf16 a[24:27], a[164:167], v[44:47], a[24:27]
    v_mfma_f32_16x16x32_bf16 a[28:31], a[164:167], v[48:51], a[28:31]
    ds_read_b64_tr_b16 a[160:161], v224 offset:8192
    ds_read_b64_tr_b16 a[162:163], v224 offset:12288
    v_mfma_f32_16x16x32_bf16 a[32:35], a[164:167], v[52:55], a[32:35]
    v_mfma_f32_16x16x32_bf16 a[36:39], a[164:167], v[56:59], a[36:39]
    ds_read_b64_tr_b16 a[164:165], v225 offset:8192
    ds_read_b64_tr_b16 a[166:167], v225 offset:12288
    v_mfma_f32_16x16x32_bf16 a[40:43], a[168:171], v[40:43], a[40:43]
    v_mfma_f32_16x16x32_bf16 a[44:47], a[168:171], v[44:47], a[44:47]
    v_mfma_f32_16x16x32_bf16 a[48:51], a[168:171], v[48:51], a[48:51]
    v_mfma_f32_16x16x32_bf16 a[52:55], a[168:171], v[52:55], a[52:55]
    v_mfma_f32_16x16x32_bf16 a[56:59], a[168:171], v[56:59], a[56:59]
    ds_read_b64_tr_b16 a[168:169], v226 offset:8192
    ds_read_b64_tr_b16 a[170:171], v226 offset:12288
    s_add_u32 s40, s48, 47104
    v_mfma_f32_16x16x32_bf16 a[60:63], a[172:175], v[40:43], a[60:63]
    buffer_store_dwordx4 v[180:183], v248, s[20:23], s40 offen sc1
    v_mfma_f32_16x16x32_bf16 a[64:67], a[172:175], v[44:47], a[64:67]
    v_mfma_f32_16x16x32_bf16 a[68:71], a[172:175], v[48:51], a[68:71]
    buffer_load_dwordx4 v[128:131], v238, s[20:23], s47 offen offset:2048 sc1
    v_mfma_f32_16x16x32_bf16 a[72:75], a[172:175], v[52:55], a[72:75]
    v_mfma_f32_16x16x32_bf16 a[76:79], a[172:175], v[56:59], a[76:79]
    ds_read_b64_tr_b16 a[172:173], v227 offset:8192
    ds_read_b64_tr_b16 a[174:175], v227 offset:12288
    s_add_u32 s40, s48, 33792
    v_mfma_f32_16x16x32_bf16 a[80:83], a[176:179], v[40:43], a[80:83]
    buffer_store_dwordx4 v[184:187], v248, s[20:23], s40 offen sc1
    v_mfma_f32_16x16x32_bf16 a[84:87], a[176:179], v[44:47], a[84:87]
    v_mfma_f32_16x16x32_bf16 a[88:91], a[176:179], v[48:51], a[88:91]
    v_mfma_f32_16x16x32_bf16 a[92:95], a[176:179], v[52:55], a[92:95]
    v_mfma_f32_16x16x32_bf16 a[96:99], a[176:179], v[56:59], a[96:99]
    v_mfma_f32_16x16x32_bf16 a[100:103], a[180:183], v[40:43], a[100:103]
    ds_read_b64_tr_b16 a[176:177], v241 offset:8192
    ds_read_b64_tr_b16 a[178:179], v241 offset:12288
    v_mfma_f32_16x16x32_bf16 a[104:107], a[180:183], v[44:47], a[104:107]
    v_mfma_f32_16x16x32_bf16 a[108:111], a[180:183], v[48:51], a[108:111]
    buffer_load_dwordx4 v[132:135], v238, s[20:23], s47 offen offset:3072 sc1
Lpg14:
    s_cbranch_execz Lpg15
    v_mfma_f32_16x16x32_bf16 a[112:115], a[180:183], v[52:55], a[112:115]
    v_mfma_f32_16x16x32_bf16 a[116:119], a[180:183], v[56:59], a[116:119]
    ds_read_b64_tr_b16 a[180:181], v242 offset:8192
    ds_read_b64_tr_b16 a[182:183], v242 offset:12288
    v_mfma_f32_16x16x32_bf16 a[120:123], a[184:187], v[40:43], a[120:123]
    v_mfma_f32_16x16x32_bf16 a[124:127], a[184:187], v[44:47], a[124:127]
    v_mfma_f32_16x16x32_bf16 a[128:131], a[184:187], v[48:51], a[128:131]
    v_mfma_f32_16x16x32_bf16 a[132:135], a[184:187], v[52:55], a[132:135]
    buffer_load_dword v215, v217, s[20:23], 0 offen offset:1792 sc1
    v_mfma_f32_16x16x32_bf16 a[136:139], a[184:187], v[56:59], a[136:139]
    v_mfma_f32_16x16x32_bf16 a[140:143], a[188:191], v[40:43], a[140:143]
    ds_read_b64_tr_b16 a[184:185], v243 offset:8192
    ds_read_b64_tr_b16 a[186:187], v243 offset:12288
    v_mfma_f32_16x16x32_bf16 a[144:147], a[188:191], v[44:47], a[144:147]
    v_mfma_f32_16x16x32_bf16 a[148:151], a[188:191], v[48:51], a[148:151]
    buffer_load_dwordx4 v[136:139], v239, s[20:23], s47 offen offset:0 sc1
    v_mfma_f32_16x16x32_bf16 a[152:155], a[188:191], v[52:55], a[152:155]
    s_add_u32 s47, s61, 401408
    v_mfma_f32_16x16x32_bf16 a[156:159], a[188:191], v[56:59], a[156:159]
    ds_read_b64_tr_b16 a[188:189], v244 offset:8192
    ds_read_b64_tr_b16 a[190:191], v244 offset:12288
    s_waitcnt lgkmcnt(4)
    s_waitcnt vmcnt(27)
    v_mfma_f32_16x16x32_bf16 a[0:3], a[160:163], v[60:63], a[0:3]
    buffer_load_dwordx4 v[140:143], v238, s[20:23], s47 offen offset:0 sc1
    v_mfma_f32_16x16x32_bf16 a[4:7], a[160:163], v[64:67], a[4:7]
    s_add_u32 s40, s48, 48128
    v_mfma_f32_16x16x32_bf16 a[8:11], a[160:163], v[68:71], a[8:11]
    buffer_store_dwordx4 v[188:191], v248, s[20:23], s40 offen sc1
    v_mfma_f32_16x16x32_bf16 a[12:15], a[160:163], v[72:75], a[12:15]
    v_mfma_f32_16x16x32_bf16 a[16:19], a[160:163], v[76:79], a[16:19]
    buffer_load_dwordx4 v[144:147], v238, s[20:23], s47 offen offset:1024 sc1
    v_mfma_f32_16x16x32_bf16 a[20:23], a[164:167], v[60:63], a[20:23]
    v_mfma_f32_16x16x32_bf16 a[24:27], a[164:167], v[64:67], a[24:27]
    s_waitcnt vmcnt(62) lgkmcnt(0)
    s_barrier
    v_mfma_f32_16x16x32_bf16 a[28:31], a[164:167], v[68:71], a[28:31]
    ds_read_b64_tr_b16 a[160:161], v228 offset:16384
    ds_read_b64_tr_b16 a[162:163], v228 offset:20480
    v_mfma_f32_16x16x32_bf16 a[32:35], a[164:167], v[72:75], a[32:35]
    v_mfma_f32_16x16x32_bf16 a[36:39], a[164:167], v[76:79], a[36:39]
    ds_read_b64_tr_b16 a[164:165], v229 offset:16384
    ds_read_b64_tr_b16 a[166:167], v229 offset:20480
    v_mfma_f32_16x16x32_bf16 a[40:43], a[168:171], v[60:63], a[40:43]
    v_mfma_f32_16x16x32_bf16 a[44:47], a[168:171], v[64:67], a[44:47]
    v_mfma_f32_16x16x32_bf16 a[48:51], a[168:171], v[68:71], a[48:51]
    v_mfma_f32_16x16x32_bf16 a[52:55], a[168:171], v[72:75], a[52:55]
    v_mfma_f32_16x16x32_bf16 a[56:59], a[168:171], v[76:79], a[56:59]
    ds_read_b64_tr_b16 a[168:169], v230 offset:16384
    ds_read_b64_tr_b16 a[170:171], v230 offset:20480
    s_add_u32 s40, s48, 34816
    v_mfma_f32_16x16x32_bf16 a[60:63], a[172:175], v[60:63], a[60:63]
    buffer_store_dwordx4 v[192:195], v248, s[20:23], s40 offen sc1
    v_mfma_f32_16x16x32_bf16 a[64:67], a[172:175], v[64:67], a[64:67]
    v_mfma_f32_16x16x32_bf16 a[68:71], a[172:175], v[68:71], a[68:71]
    buffer_load_dwordx4 v[148:151], v238, s[20:23], s47 offen offset:2048 sc1
    v_mfma_f32_16x16x32_bf16 a[72:75], a[172:175], v[72:75], a[72:75]
    v_mfma_f32_16x16x32_bf16 a[76:79], a[172:175], v[76:79], a[76:79]
    ds_read_b64_tr_b16 a[172:173], v231 offset:16384
    ds_read_b64_tr_b16 a[174:175], v231 offset:20480
    s_add_u32 s40, s48, 49152
    v_mfma_f32_16x16x32_bf16 a[80:83], a[176:179], v[60:63], a[80:83]
    buffer_store_dwordx4 v[196:199], v248, s[20:23], s40 offen sc1
    v_mfma_f32_16x16x32_bf16 a[84:87], a[176:179], v[64:67], a[84:87]
    v_mfma_f32_16x16x32_bf16 a[88:91], a[176:179], v[68:71], a[88:91]
    v_mfma_f32_16x16x32_bf16 a[92:95], a[176:179], v[72:75], a[92:95]
    v_mfma_f32_16x16x32_bf16 a[96:99], a[176:179], v[76:79], a[96:99]
    v_mfma_f32_16x16x32_bf16 a[100:103], a[180:183], v[60:63], a[100:103]
    ds_read_b64_tr_b16 a[176:177], v232 offset:16384
    ds_read_b64_tr_b16 a[178:179], v232 offset:20480
    v_mfma_f32_16x16x32_bf16 a[104:107], a[180:183], v[64:67], a[104:107]
    v_mfma_f32_16x16x32_bf16 a[108:111], a[180:183], v[68:71], a[108:111]
    buffer_load_dwordx4 v[152:155], v238, s[20:23], s47 offen offset:3072 sc1
    v_mfma_f32_16x16x32_bf16 a[112:115], a[180:183], v[72:75], a[112:115]
    v_mfma_f32_16x16x32_bf16 a[116:119], a[180:183], v[76:79], a[116:119]
    ds_read_b64_tr_b16 a[180:181], v233 offset:16384
    ds_read_b64_tr_b16 a[182:183], v233 offset:20480
    v_mfma_f32_16x16x32_bf16 a[120:123], a[184:187], v[60:63], a[120:123]
    v_mfma_f32_16x16x32_bf16 a[124:127], a[184:187], v[64:67], a[124:127]
    v_mfma_f32_16x16x32_bf16 a[128:131], a[184:187], v[68:71], a[128:131]
    v_mfma_f32_16x16x32_bf16 a[132:135], a[184:187], v[72:75], a[132:135]
    v_mfma_f32_16x16x32_bf16 a[136:139], a[184:187], v[76:79], a[136:139]
    v_mfma_f32_16x16x32_bf16 a[140:143], a[188:191], v[60:63], a[140:143]
    ds_read_b64_tr_b16 a[184:185], v234 offset:16384
    ds_read_b64_tr_b16 a[186:187], v234 offset:20480
    v_mfma_f32_16x16x32_bf16 a[144:147], a[188:191], v[64:67], a[144:147]
    v_mfma_f32_16x16x32_bf16 a[148:151], a[188:191], v[68:71], a[148:151]
    buffer_load_dwordx4 v[156:159], v239, s[20:23], s47 offen offset:0 sc1
    v_mfma_f32_16x16x32_bf16 a[152:155], a[188:191], v[72:75], a[152:155]
    v_mfma_f32_16x16x32_bf16 a[156:159], a[188:191], v[76:79], a[156:159]
    ds_read_b64_tr_b16 a[188:189], v235 offset:16384
    ds_read_b64_tr_b16 a[190:191], v235 offset:20480
    s_waitcnt lgkmcnt(4)
    s_waitcnt vmcnt(26)
    v_mfma_f32_16x16x32_bf16 a[0:3], a[160:163], v[80:83], a[0:3]
    v_mfma_f32_16x16x32_bf16 a[4:7], a[160:163], v[84:87], a[4:7]
    v_mfma_f32_16x16x32_bf16 a[8:11], a[160:163], v[88:91], a[8:11]
    v_mfma_f32_16x16x32_bf16 a[12:15], a[160:163], v[92:95], a[12:15]
    v_mfma_f32_16x16x32_bf16 a[16:19], a[160:163], v[96:99], a[16:19]
    v_mfma_f32_16x16x32_bf16 a[20:23], a[164:167], v[80:83], a[20:23]
    v_mfma_f32_16x16x32_bf16 a[24:27], a[164:167], v[84:87], a[24:27]
    s_waitcnt lgkmcnt(0)
    v_mfma_f32_16x16x32_bf16 a[28:31], a[164:167], v[88:91], a[28:31]
    ds_read_b64_tr_b16 a[160:161], v224 offset:16384
    ds_read_b64_tr_b16 a[162:163], v224 offset:20480
    v_mfma_f32_16x16x32_bf16 a[32:35], a[164:167], v[92:95], a[32:35]
    v_mfma_f32_16x16x32_bf16 a[36:39], a[164:167], v[96:99], a[36:39]
    ds_read_b64_tr_b16 a[164:165], v225 offset:16384
    ds_read_b64_tr_b16 a[166:167], v225 offset:20480
    v_mfma_f32_16x16x32_bf16 a[40:43], a[168:171], v[80:83], a[40:43]
    v_mfma_f32_16x16x32_bf16 a[44:47], a[168:171], v[84:87], a[44:47]
    v_mfma_f32_16x16x32_bf16 a[48:51], a[168:171], v[88:91], a[48:51]
    v_mfma_f32_16x16x32_bf16 a[52:55], a[168:171], v[92:95], a[52:55]
    v_mfma_f32_16x16x32_bf16 a[56:59], a[168:171], v[96:99], a[56:59]
    ds_read_b64_tr_b16 a[168:169], v226 offset:16384
    ds_read_b64_tr_b16 a[170:171], v226 offset:20480
    v_mfma_f32_16x16x32_bf16 a[60:63], a[172:175], v[80:83], a[60:63]
    v_mfma_f32_16x16x32_bf16 a[64:67], a[172:175], v[84:87], a[64:67]
    v_mfma_f32_16x16x32_bf16 a[68:71], a[172:175], v[88:91], a[68:71]
    v_mfma_f32_16x16x32_bf16 a[72:75], a[172:175], v[92:95], a[72:75]
    v_mfma_f32_16x16x32_bf16 a[76:79], a[172:175], v[96:99], a[76:79]
    ds_read_b64_tr_b16 a[172:173], v227 offset:16384
    ds_read_b64_tr_b16 a[174:175], v227 offset:20480
    v_mfma_f32_16x16x32_bf16 a[80:83], a[176:179], v[80:83], a[80:83]
    v_mfma_f32_16x16x32_bf16 a[84:87], a[176:179], v[84:87], a[84:87]
    v_mfma_f32_16x16x32_bf16 a[88:91], a[176:179], v[88:91], a[88:91]
    v_mfma_f32_16x16x32_bf16 a[92:95], a[176:179], v[92:95], a[92:95]
    v_mfma_f32_16x16x32_bf16 a[96:99], a[176:179], v[96:99], a[96:99]
    v_mfma_f32_16x16x32_bf16 a[100:103], a[180:183], v[80:83], a[100:103]
    ds_read_b64_tr_b16 a[176:177], v241 offset:16384
    ds_read_b64_tr_b16 a[178:179], v241 offset:20480
    v_mfma_f32_16x16x32_bf16 a[104:107], a[180:183], v[84:87], a[104:107]
    v_mfma_f32_16x16x32_bf16 a[108:111], a[180:183], v[88:91], a[108:111]
    v_mfma_f32_16x16x32_bf16 a[112:115], a[180:183], v[92:95], a[112:115]
    v_mfma_f32_16x16x32_bf16 a[116:119], a[180:183], v[96:99], a[116:119]
    ds_read_b64_tr_b16 a[180:181], v242 offset:16384
    ds_read_b64_tr_b16 a[182:183], v242 offset:20480
    v_mfma_f32_16x16x32_bf16 a[120:123], a[184:187], v[80:83], a[120:123]
    v_mfma_f32_16x16x32_bf16 a[124:127], a[184:187], v[84:87], a[124:127]
    v_mfma_f32_16x16x32_bf16 a[128:131], a[184:187], v[88:91], a[128:131]
    v_mfma_f32_16x16x32_bf16 a[132:135], a[184:187], v[92:95], a[132:135]
    v_mfma_f32_16x16x32_bf16 a[136:139], a[184:187], v[96:99], a[136:139]
    v_mfma_f32_16x16x32_bf16 a[140:143], a[188:191], v[80:83], a[140:143]
    ds_read_b64_tr_b16 a[184:185], v243 offset:16384
    ds_read_b64_tr_b16 a[186:187], v243 offset:20480
    v_mfma_f32_16x16x32_bf16 a[144:147], a[188:191], v[84:87], a[144:147]
    v_mfma_f32_16x16x32_bf16 a[148:151], a[188:191], v[88:91], a[148:151]
    v_mfma_f32_16x16x32_bf16 a[152:155], a[188:191], v[92:95], a[152:155]
    s_add_u32 s47, s61, 14336
    v_mfma_f32_16x16x32_bf16 a[156:159], a[188:191], v[96:99], a[156:159]
    ds_read_b64_tr_b16 a[188:189], v244 offset:16384
    ds_read_b64_tr_b16 a[190:191], v244 offset:20480
    s_waitcnt lgkmcnt(4)
    s_waitcnt vmcnt(9)
    v_cmp_eq_u32 vcc, 1, v215
    s_cmp_eq_u32 vcc_lo, -1
    s_cbranch_scc0 Lspin1
Lback1:
    v_mfma_f32_16x16x32_bf16 a[0:3], a[160:163], v[100:103], a[0:3]
    buffer_load_dwordx4 v[160:163], v238, s[20:23], s47 offen offset:0 sc1
    v_mfma_f32_16x16x32_bf16 a[4:7], a[160:163], v[104:107], a[4:7]
    v_mfma_f32_16x16x32_bf16 a[8:11], a[160:163], v[108:111], a[8:11]
    buffer_load_dwordx4 v[164:167], v238, s[20:23], s47 offen offset:1024 sc1
    v_mfma_f32_16x16x32_bf16 a[12:15], a[160:163], v[112:115], a[12:15]
    s_add_u32 s41, s60, 860160
    v_mfma_f32_16x16x32_bf16 a[16:19], a[160:163], v[116:119], a[16:19]
    buffer_load_dwordx4 v[168:171], v238, s[20:23], s47 offen offset:2048 sc1
    v_mfma_f32_16x16x32_bf16 a[20:23], a[164:167], v[100:103], a[20:23]
    s_add_u32 m0, s35, 49152
    v_mfma_f32_16x16x32_bf16 a[24:27], a[164:167], v[104:107], a[24:27]
    s_waitcnt lgkmcnt(0)
    v_mfma_f32_16x16x32_bf16 a[28:31], a[164:167], v[108:111], a[28:31]
    ds_read_b64_tr_b16 a[160:161], v228 offset:24576
    ds_read_b64_tr_b16 a[162:163], v228 offset:28672
    v_mfma_f32_16x16x32_bf16 a[32:35], a[164:167], v[112:115], a[32:35]
    buffer_load_dwordx4 v208, s[24:27], s41 offen offset:0 lds
    v_mfma_f32_16x16x32_bf16 a[36:39], a[164:167], v[116:119], a[36:39]
    ds_read_b64_tr_b16 a[164:165], v229 offset:24576
    ds_read_b64_tr_b16 a[166:167], v229 offset:28672
    v_mfma_f32_16x16x32_bf16 a[40:43], a[168:171], v[100:103], a[40:43]
    buffer_load_dwordx4 v[172:175], v238, s[20:23], s47 offen offset:3072 sc1
    v_mfma_f32_16x16x32_bf16 a[44:47], a[168:171], v[104:107], a[44:47]
    v_mfma_f32_16x16x32_bf16 a[48:51], a[168:171], v[108:111], a[48:51]
    buffer_load_dwordx4 v209, s[24:27], s41 offen offset:1024 lds
    v_mfma_f32_16x16x32_bf16 a[52:55], a[168:171], v[112:115], a[52:55]
    v_mfma_f32_16x16x32_bf16 a[56:59], a[168:171], v[116:119], a[56:59]
    ds_read_b64_tr_b16 a[168:169], v230 offset:24576
    ds_read_b64_tr_b16 a[170:171], v230 offset:28672
    v_mfma_f32_16x16x32_bf16 a[60:63], a[172:175], v[100:103], a[60:63]
    buffer_load_dwordx4 v[176:179], v239, s[20:23], s47 offen offset:0 sc1
    v_mfma_f32_16x16x32_bf16 a[64:67], a[172:175], v[104:107], a[64:67]
    s_add_u32 s47, s61, 71680
    v_mfma_f32_16x16x32_bf16 a[68:71], a[172:175], v[108:111], a[68:71]
    buffer_load_dwordx4 v[0:3], v238, s[20:23], s47 offen offset:0 sc1
    v_mfma_f32_16x16x32_bf16 a[72:75], a[172:175], v[112:115], a[72:75]
    v_mfma_f32_16x16x32_bf16 a[76:79], a[172:175], v[116:119], a[76:79]
    ds_read_b64_tr_b16 a[172:173], v231 offset:24576
    ds_read_b64_tr_b16 a[174:175], v231 offset:28672
    v_mfma_f32_16x16x32_bf16 a[80:83], a[176:179], v[100:103], a[80:83]
    buffer_load_dwordx4 v[4:7], v238, s[20:23], s47 offen offset:1024 sc1
    v_mfma_f32_16x16x32_bf16 a[84:87], a[176:179], v[104:107], a[84:87]
    v_mfma_f32_16x16x32_bf16 a[88:91], a[176:179], v[108:111], a[88:91]
    buffer_load_dwordx4 v210, s[24:27], s41 offen offset:2048 lds
    v_mfma_f32_16x16x32_bf16 a[92:95], a[176:179], v[112:115], a[92:95]
    v_mfma_f32_16x16x32_bf16 a[96:99], a[176:179], v[116:119], a[96:99]
    v_mfma_f32_16x16x32_bf16 a[100:103], a[180:183], v[100:103], a[100:103]
    ds_read_b64_tr_b16 a[176:177], v232 offset:24576
    ds_read_b64_tr_b16 a[178:179], v232 offset:28672
    v_mfma_f32_16x16x32_bf16 a[104:107], a[180:183], v[104:107], a[104:107]
    v_mfma_f32_16x16x32_bf16 a[108:111], a[180:183], v[108:111], a[108:111]
    buffer_load_dwordx4 v[8:11], v238, s[20:23], s47 offen offset:2048 sc1
    v_mfma_f32_16x16x32_bf16 a[112:115], a[180:183], v[112:115], a[112:115]
    v_mfma_f32_16x16x32_bf16 a[116:119], a[180:183], v[116:119], a[116:119]
    ds_read_b64_tr_b16 a[180:181], v233 offset:24576
    ds_read_b64_tr_b16 a[182:183], v233 offset:28672
    v_mfma_f32_16x16x32_bf16 a[120:123], a[184:187], v[100:103], a[120:123]
    buffer_load_dwordx4 v[12:15], v238, s[20:23], s47 offen offset:3072 sc1
    v_mfma_f32_16x16x32_bf16 a[124:127], a[184:187], v[104:107], a[124:127]
    v_mfma_f32_16x16x32_bf16 a[128:131], a[184:187], v[108:111], a[128:131]
    buffer_load_dwordx4 v211, s[24:27], s41 offen offset:3072 lds
    v_mfma_f32_16x16x32_bf16 a[132:135], a[184:187], v[112:115], a[132:135]
    v_mfma_f32_16x16x32_bf16 a[136:139], a[184:187], v[116:119], a[136:139]
    v_mfma_f32_16x16x32_bf16 a[140:143], a[188:191], v[100:103], a[140:143]
    ds_read_b64_tr_b16 a[184:185], v234 offset:24576
    ds_read_b64_tr_b16 a[186:187], v234 offset:28672
    v_mfma_f32_16x16x32_bf16 a[144:147], a[188:191], v[104:107], a[144:147]
    v_mfma_f32_16x16x32_bf16 a[148:151], a[188:191], v[108:111], a[148:151]
    buffer_load_dwordx4 v[16:19], v239, s[20:23], s47 offen offset:0 sc1
    v_mfma_f32_16x16x32_bf16 a[152:155], a[188:191], v[112:115], a[152:155]
    s_add_u32 s47, s61, 129024
    v_mfma_f32_16x16x32_bf16 a[156:159], a[188:191], v[116:119], a[156:159]
    ds_read_b64_tr_b16 a[188:189], v235 offset:24576
    ds_read_b64_tr_b16 a[190:191], v235 offset:28672
    s_waitcnt lgkmcnt(4)
    s_waitcnt vmcnt(22)
    v_mfma_f32_16x16x32_bf16 a[0:3], a[160:163], v[120:123], a[0:3]
    buffer_load_dwordx4 v[20:23], v238, s[20:23], s47 offen offset:0 sc1
    v_mfma_f32_16x16x32_bf16 a[4:7], a[160:163], v[124:127], a[4:7]
    v_mfma_f32_16x16x32_bf16 a[8:11], a[160:163], v[128:131], a[8:11]
    v_mfma_f32_16x16x32_bf16 a[12:15], a[160:163], v[132:135], a[12:15]
    s_add_u32 s41, s60, 1024000
    v_mfma_f32_16x16x32_bf16 a[16:19], a[160:163], v[136:139], a[16:19]
    buffer_load_dwordx4 v[24:27], v238, s[20:23], s47 offen offset:1024 sc1
    v_mfma_f32_16x16x32_bf16 a[20:23], a[164:167], v[120:123], a[20:23]
    s_add_u32 m0, s35, 16384
    v_mfma_f32_16x16x32_bf16 a[24:27], a[164:167], v[124:127], a[24:27]
    s_waitcnt vmcnt(18) lgkmcnt(0)
    s_barrier
    v_mfma_f32_16x16x32_bf16 a[28:31], a[164:167], v[128:131], a[28:31]
    ds_read_b64_tr_b16 a[160:161], v224 offset:24576
    ds_read_b64_tr_b16 a[162:163], v224 offset:28672
    v_mfma_f32_16x16x32_bf16 a[32:35], a[164:167], v[132:135], a[32:35]
    buffer_load_dwordx4 v208, s[24:27], s41 offen offset:0 lds
    v_mfma_f32_16x16x32_bf16 a[36:39], a[164:167], v[136:139], a[36:39]
    ds_read_b64_tr_b16 a[164:165], v225 offset:24576
    ds_read_b64_tr_b16 a[166:167], v225 offset:28672
    v_mfma_f32_16x16x32_bf16 a[40:43], a[168:171], v[120:123], a[40:43]
    buffer_store_dword v218, v219, s[20:23], 0 offen offset:3584 sc1
    v_mfma_f32_16x16x32_bf16 a[44:47], a[168:171], v[124:127], a[44:47]
    v_mfma_f32_16x16x32_bf16 a[48:51], a[168:171], v[128:131], a[48:51]
    buffer_load_dwordx4 v209, s[24:27], s41 offen offset:1024 lds
    v_mfma_f32_16x16x32_bf16 a[52:55], a[168:171], v[132:135], a[52:55]
    v_mfma_f32_16x16x32_bf16 a[56:59], a[168:171], v[136:139], a[56:59]
    ds_read_b64_tr_b16 a[168:169], v226 offset:24576
    ds_read_b64_tr_b16 a[170:171], v226 offset:28672
    v_mfma_f32_16x16x32_bf16 a[60:63], a[172:175], v[120:123], a[60:63]
    v_mfma_f32_16x16x32_bf16 a[64:67], a[172:175], v[124:127], a[64:67]
    v_mfma_f32_16x16x32_bf16 a[68:71], a[172:175], v[128:131], a[68:71]
    buffer_load_dwordx4 v[28:31], v238, s[20:23], s47 offen offset:2048 sc1
    v_mfma_f32_16x16x32_bf16 a[72:75], a[172:175], v[132:135], a[72:75]
    v_mfma_f32_16x16x32_bf16 a[76:79], a[172:175], v[136:139], a[76:79]
    ds_read_b64_tr_b16 a[172:173], v227 offset:24576
    ds_read_b64_tr_b16 a[174:175], v227 offset:28672
    v_mfma_f32_16x16x32_bf16 a[80:83], a[176:179], v[120:123], a[80:83]
    v_mfma_f32_16x16x32_bf16 a[84:87], a[176:179], v[124:127], a[84:87]
    v_mfma_f32_16x16x32_bf16 a[88:91], a[176:179], v[128:131], a[88:91]
    buffer_load_dwordx4 v210, s[24:27], s41 offen offset:2048 lds
    v_mfma_f32_16x16x32_bf16 a[92:95], a[176:179], v[132:135], a[92:95]
    v_mfma_f32_16x16x32_bf16 a[96:99], a[176:179], v[136:139], a[96:99]
    v_mfma_f32_16x16x32_bf16 a[100:103], a[180:183], v[120:123], a[100:103]
    ds_read_b64_tr_b16 a[176:177], v241 offset:24576
    ds_read_b64_tr_b16 a[178:179], v241 offset:28672
    v_mfma_f32_16x16x32_bf16 a[104:107], a[180:183], v[124:127], a[104:107]
    v_mfma_f32_16x16x32_bf16 a[108:111], a[180:183], v[128:131], a[108:111]
    buffer_load_dwordx4 v[32:35], v238, s[20:23], s47 offen offset:3072 sc1
    v_mfma_f32_16x16x32_bf16 a[112:115], a[180:183], v[132:135], a[112:115]
    v_mfma_f32_16x16x32_bf16 a[116:119], a[180:183], v[136:139], a[116:119]
    ds_read_b64_tr_b16 a[180:181], v242 offset:24576
    ds_read_b64_tr_b16 a[182:183], v242 offset:28672
    v_mfma_f32_16x16x32_bf16 a[120:123], a[184:187], v[120:123], a[120:123]
    v_mfma_f32_16x16x32_bf16 a[124:127], a[184:187], v[124:127], a[124:127]
    v_mfma_f32_16x16x32_bf16 a[128:131], a[184:187], v[128:131], a[128:131]
    buffer_load_dwordx4 v211, s[24:27], s41 offen offset:3072 lds
    v_mfma_f32_16x16x32_bf16 a[132:135], a[184:187], v[132:135], a[132:135]
    v_mfma_f32_16x16x32_bf16 a[136:139], a[184:187], v[136:139], a[136:139]
    v_mfma_f32_16x16x32_bf16 a[140:143], a[188:191], v[120:123], a[140:143]
    ds_read_b64_tr_b16 a[184:185], v243 offset:24576
    ds_read_b64_tr_b16 a[186:187], v243 offset:28672
    v_mfma_f32_16x16x32_bf16 a[144:147], a[188:191], v[124:127], a[144:147]
    v_mfma_f32_16x16x32_bf16 a[148:151], a[188:191], v[128:131], a[148:151]
    buffer_load_dwordx4 v[36:39], v239, s[20:23], s47 offen offset:0 sc1
    v_mfma_f32_16x16x32_bf16 a[152:155], a[188:191], v[132:135], a[152:155]
    s_add_u32 s47, s61, 186368
    v_mfma_f32_16x16x32_bf16 a[156:159], a[188:191], v[136:139], a[156:159]
    ds_read_b64_tr_b16 a[188:189], v244 offset:24576
    ds_read_b64_tr_b16 a[190:191], v244 offset:28672
    s_waitcnt lgkmcnt(4)
    s_waitcnt vmcnt(24)
    v_mfma_f32_16x16x32_bf16 a[0:3], a[160:163], v[140:143], a[0:3]
    buffer_load_dwordx4 v[40:43], v238, s[20:23], s47 offen offset:0 sc1
    v_mfma_f32_16x16x32_bf16 a[4:7], a[160:163], v[144:147], a[4:7]
    v_mfma_f32_16x16x32_bf16 a[8:11], a[160:163], v[148:151], a[8:11]
    v_mfma_f32_16x16x32_bf16 a[12:15], a[160:163], v[152:155], a[12:15]
    s_add_u32 s41, s60, 1187840
    v_mfma_f32_16x16x32_bf16 a[16:19], a[160:163], v[156:159], a[16:19]
    buffer_load_dwordx4 v[44:47], v238, s[20:23], s47 offen offset:1024 sc1
    v_mfma_f32_16x16x32_bf16 a[20:23], a[164:167], v[140:143], a[20:23]
    s_add_u32 m0, s35, 57344
    v_mfma_f32_16x16x32_bf16 a[24:27], a[164:167], v[144:147], a[24:27]
    s_waitcnt lgkmcnt(0)
    v_mfma_f32_16x16x32_bf16 a[28:31], a[164:167], v[148:151], a[28:31]
    ds_read_b64_tr_b16 a[160:161], v228 offset:32768
    ds_read_b64_tr_b16 a[162:163], v228 offset:36864
    v_mfma_f32_16x16x32_bf16 a[32:35], a[164:167], v[152:155], a[32:35]
    buffer_load_dwordx4 v208, s[24:27], s41 offen offset:0 lds
    v_mfma_f32_16x16x32_bf16 a[36:39], a[164:167], v[156:159], a[36:39]
    ds_read_b64_tr_b16 a[164:165], v229 offset:32768
    ds_read_b64_tr_b16 a[166:167], v229 offset:36864
    v_mfma_f32_16x16x32_bf16 a[40:43], a[168:171], v[140:143], a[40:43]
    v_mfma_f32_16x16x32_bf16 a[44:47], a[168:171], v[144:147], a[44:47]
    v_mfma_f32_16x16x32_bf16 a[48:51], a[168:171], v[148:151], a[48:51]
    buffer_load_dwordx4 v209, s[24:27], s41 offen offset:1024 lds
    v_mfma_f32_16x16x32_bf16 a[52:55], a[168:171], v[152:155], a[52:55]
    v_mfma_f32_16x16x32_bf16 a[56:59], a[168:171], v[156:159], a[56:59]
    ds_read_b64_tr_b16 a[168:169], v230 offset:32768
    ds_read_b64_tr_b16 a[170:171], v230 offset:36864
    v_mfma_f32_16x16x32_bf16 a[60:63], a[172:175], v[140:143], a[60:63]
    v_mfma_f32_16x16x32_bf16 a[64:67], a[172:175], v[144:147], a[64:67]
    v_mfma_f32_16x16x32_bf16 a[68:71], a[172:175], v[148:151], a[68:71]
    buffer_load_dwordx4 v[48:51], v238, s[20:23], s47 offen offset:2048 sc1
    v_mfma_f32_16x16x32_bf16 a[72:75], a[172:175], v[152:155], a[72:75]
    v_mfma_f32_16x16x32_bf16 a[76:79], a[172:175], v[156:159], a[76:79]
    ds_read_b64_tr_b16 a[172:173], v231 offset:32768
    ds_read_b64_tr_b16 a[174:175], v231 offset:36864
    v_mfma_f32_16x16x32_bf16 a[80:83], a[176:179], v[140:143], a[80:83]
    v_mfma_f32_16x16x32_bf16 a[84:87], a[176:179], v[144:147], a[84:87]
    v_mfma_f32_16x16x32_bf16 a[88:91], a[176:179], v[148:151], a[88:91]
    buffer_load_dwordx4 v210, s[24:27], s41 offen offset:2048 lds
    v_mfma_f32_16x16x32_bf16 a[92:95], a[176:179], v[152:155], a[92:95]
    v_mfma_f32_16x16x32_bf16 a[96:99], a[176:179], v[156:159], a[96:99]
    v_mfma_f32_16x16x32_bf16 a[100:103], a[180:183], v[140:143], a[100:103]
    ds_read_b64_tr_b16 a[176:177], v232 offset:32768
    ds_read_b64_tr_b16 a[178:179], v232 offset:36864
    v_mfma_f32_16x16x32_bf16 a[104:107], a[180:183], v[144:147], a[104:107]
    v_mfma_f32_16x16x32_bf16 a[108:111], a[180:183], v[148:151], a[108:111]
    buffer_load_dwordx4 v[52:55], v238, s[20:23], s47 offen offset:3072 sc1
    v_mfma_f32_16x16x32_bf16 a[112:115], a[180:183], v[152:155], a[112:115]
    v_mfma_f32_16x16x32_bf16 a[116:119], a[180:183], v[156:159], a[116:119]
    ds_read_b64_tr_b16 a[180:181], v233 offset:32768
    ds_read_b64_tr_b16 a[182:183], v233 offset:36864
    v_mfma_f32_16x16x32_bf16 a[120:123], a[184:187], v[140:143], a[120:123]
    v_mfma_f32_16x16x32_bf16 a[124:127], a[184:187], v[144:147], a[124:127]
    v_mfma_f32_16x16x32_bf16 a[128:131], a[184:187], v[148:151], a[128:131]
    buffer_load_dwordx4 v211, s[24:27], s41 offen offset:3072 lds
    v_mfma_f32_16x16x32_bf16 a[132:135], a[184:187], v[152:155], a[132:135]
    v_mfma_f32_16x16x32_bf16 a[136:139], a[184:187], v[156:159], a[136:139]
    v_mfma_f32_16x16x32_bf16 a[140:143], a[188:191], v[140:143], a[140:143]
    ds_read_b64_tr_b16 a[184:185], v234 offset:32768
    ds_read_b64_tr_b16 a[186:187], v234 offset:36864
    v_mfma_f32_16x16x32_bf16 a[144:147], a[188:191], v[144:147], a[144:147]
    v_mfma_f32_16x16x32_bf16 a[148:151], a[188:191], v[148:151], a[148:151]
    buffer_load_dwordx4 v[56:59], v239, s[20:23], s47 offen offset:0 sc1
    v_mfma_f32_16x16x32_bf16 a[152:155], a[188:191], v[152:155], a[152:155]
    s_add_u32 s47, s61, 243712
    v_mfma_f32_16x16x32_bf16 a[156:159], a[188:191], v[156:159], a[156:159]
    ds_read_b64_tr_b16 a[188:189], v235 offset:32768
    ds_read_b64_tr_b16 a[190:191], v235 offset:36864
    s_waitcnt lgkmcnt(4)
    s_waitcnt vmcnt(26)
    v_mfma_f32_16x16x32_bf16 a[0:3], a[160:163], v[160:163], a[0:3]
    buffer_load_dwordx4 v[60:63], v238, s[20:23], s47 offen offset:0 sc1
    v_mfma_f32_16x16x32_bf16 a[4:7], a[160:163], v[164:167], a[4:7]
    v_mfma_f32_16x16x32_bf16 a[8:11], a[160:163], v[168:171], a[8:11]
    v_mfma_f32_16x16x32_bf16 a[12:15], a[160:163], v[172:175], a[12:15]
    s_add_u32 s41, s60, 81920
    v_mfma_f32_16x16x32_bf16 a[16:19], a[160:163], v[176:179], a[16:19]
    buffer_load_dwordx4 v[64:67], v238, s[20:23], s47 offen offset:1024 sc1
    v_mfma_f32_16x16x32_bf16 a[20:23], a[164:167], v[160:163], a[20:23]
    s_add_u32 m0, s35, 24576
    v_mfma_f32_16x16x32_bf16 a[24:27], a[164:167], v[164:167], a[24:27]
    s_waitcnt lgkmcnt(0)
    v_mfma_f32_16x16x32_bf16 a[28:31], a[164:167], v[168:171], a[28:31]
    ds_read_b64_tr_b16 a[160:161], v224 offset:32768
    ds_read_b64_tr_b16 a[162:163], v224 offset:36864
    v_mfma_f32_16x16x32_bf16 a[32:35], a[164:167], v[172:175], a[32:35]
    buffer_load_dwordx4 v208, s[24:27], s41 offen offset:0 lds
    v_mfma_f32_16x16x32_bf16 a[36:39], a[164:167], v[176:179], a[36:39]
    ds_read_b64_tr_b16 a[164:165], v225 offset:32768
    ds_read_b64_tr_b16 a[166:167], v225 offset:36864
    v_mfma_f32_16x16x32_bf16 a[40:43], a[168:171], v[160:163], a[40:43]
    v_mfma_f32_16x16x32_bf16 a[44:47], a[168:171], v[164:167], a[44:47]
    v_mfma_f32_16x16x32_bf16 a[48:51], a[168:171], v[168:171], a[48:51]
    buffer_load_dwordx4 v209, s[24:27], s41 offen offset:1024 lds
    v_mfma_f32_16x16x32_bf16 a[52:55], a[168:171], v[172:175], a[52:55]
    v_mfma_f32_16x16x32_bf16 a[56:59], a[168:171], v[176:179], a[56:59]
    ds_read_b64_tr_b16 a[168:169], v226 offset:32768
    ds_read_b64_tr_b16 a[170:171], v226 offset:36864
    v_mfma_f32_16x16x32_bf16 a[60:63], a[172:175], v[160:163], a[60:63]
    v_mfma_f32_16x16x32_bf16 a[64:67], a[172:175], v[164:167], a[64:67]
    v_mfma_f32_16x16x32_bf16 a[68:71], a[172:175], v[168:171], a[68:71]
    buffer_load_dwordx4 v[68:71], v238, s[20:23], s47 offen offset:2048 sc1
    v_mfma_f32_16x16x32_bf16 a[72:75], a[172:175], v[172:175], a[72:75]
    v_mfma_f32_16x16x32_bf16 a[76:79], a[172:175], v[176:179], a[76:79]
    ds_read_b64_tr_b16 a[172:173], v227 offset:32768
    ds_read_b64_tr_b16 a[174:175], v227 offset:36864
    v_mfma_f32_16x16x32_bf16 a[80:83], a[176:179], v[160:163], a[80:83]
    v_mfma_f32_16x16x32_bf16 a[84:87], a[176:179], v[164:167], a[84:87]
    v_mfma_f32_16x16x32_bf16 a[88:91], a[176:179], v[168:171], a[88:91]
    buffer_load_dwordx4 v210, s[24:27], s41 offen offset:2048 lds
    v_mfma_f32_16x16x32_bf16 a[92:95], a[176:179], v[172:175], a[92:95]
    v_mfma_f32_16x16x32_bf16 a[96:99], a[176:179], v[176:179], a[96:99]
    v_mfma_f32_16x16x32_bf16 a[100:103], a[180:183], v[160:163], a[100:103]
    ds_read_b64_tr_b16 a[176:177], v241 offset:32768
    ds_read_b64_tr_b16 a[178:179], v241 offset:36864
    v_mfma_f32_16x16x32_bf16 a[104:107], a[180:183], v[164:167], a[104:107]
    v_mfma_f32_16x16x32_bf16 a[108:111], a[180:183], v[168:171], a[108:111]
    buffer_load_dwordx4 v[72:75], v238, s[20:23], s47 offen offset:3072 sc1
    v_mfma_f32_16x16x32_bf16 a[112:115], a[180:183], v[172:175], a[112:115]
    v_mfma_f32_16x16x32_bf16 a[116:119], a[180:183], v[176:179], a[116:119]
    ds_read_b64_tr_b16 a[180:181], v242 offset:32768
    ds_read_b64_tr_b16 a[182:183], v242 offset:36864
    v_mfma_f32_16x16x32_bf16 a[120:123], a[184:187], v[160:163], a[120:123]
    v_mfma_f32_16x16x32_bf16 a[124:127], a[184:187], v[164:167], a[124:127]
    v_mfma_f32_16x16x32_bf16 a[128:131], a[184:187], v[168:171], a[128:131]
    buffer_load_dwordx4 v211, s[24:27], s41 offen offset:3072 lds
    v_mfma_f32_16x16x32_bf16 a[132:135], a[184:187], v[172:175], a[132:135]
    v_mfma_f32_16x16x32_bf16 a[136:139], a[184:187], v[176:179], a[136:139]
    v_mfma_f32_16x16x32_bf16 a[140:143], a[188:191], v[160:163], a[140:143]
    ds_read_b64_tr_b16 a[184:185], v243 offset:32768
    ds_read_b64_tr_b16 a[186:187], v243 offset:36864
    v_mfma_f32_16x16x32_bf16 a[144:147], a[188:191], v[164:167], a[144:147]
    v_mfma_f32_16x16x32_bf16 a[148:151], a[188:191], v[168:171], a[148:151]
    buffer_load_dwordx4 v[76:79], v239, s[20:23], s47 offen offset:0 sc1
    v_mfma_f32_16x16x32_bf16 a[152:155], a[188:191], v[172:175], a[152:155]
    s_add_u32 s47, s61, 301056
    v_mfma_f32_16x16x32_bf16 a[156:159], a[188:191], v[176:179], a[156:159]
    ds_read_b64_tr_b16 a[188:189], v244 offset:32768
    ds_read_b64_tr_b16 a[190:191], v244 offset:36864
    s_waitcnt lgkmcnt(4)
    s_waitcnt vmcnt(28)
    v_mfma_f32_16x16x32_bf16 a[0:3], a[160:163], v[0:3], a[0:3]
    buffer_load_dwordx4 v[80:83], v238, s[20:23], s47 offen offset:0 sc1
    v_mfma_f32_16x16x32_bf16 a[4:7], a[160:163], v[4:7], a[4:7]
    v_mfma_f32_16x16x32_bf16 a[8:11], a[160:163], v[8:11], a[8:11]
    v_mfma_f32_16x16x32_bf16 a[12:15], a[160:163], v[12:15], a[12:15]
    s_add_u32 s41, s60, 122880
    v_mfma_f32_16x16x32_bf16 a[16:19], a[160:163], v[16:19], a[16:19]
    buffer_load_dwordx4 v[84:87], v238, s[20:23], s47 offen offset:1024 sc1
    v_mfma_f32_16x16x32_bf16 a[20:23], a[164:167], v[0:3], a[20:23]
    s_add_u32 m0, s35, 65536
    v_mfma_f32_16x16x32_bf16 a[24:27], a[164:167], v[4:7], a[24:27]
    s_waitcnt vmcnt(63) lgkmcnt(0)
    s_barrier
    v_mfma_f32_16x16x32_bf16 a[28:31], a[164:167], v[8:11], a[28:31]
    ds_read_b64_tr_b16 a[160:161], v228 offset:0
    ds_read_b64_tr_b16 a[162:163], v228 offset:4096
    v_mfma_f32_16x16x32_bf16 a[32:35], a[164:167], v[12:15], a[32:35]
    buffer_load_dwordx4 v208, s[24:27], s41 offen offset:0 lds
    v_mfma_f32_16x16x32_bf16 a[36:39], a[164:167], v[16:19], a[36:39]
    ds_read_b64_tr_b16 a[164:165], v229 offset:0
    ds_read_b64_tr_b16 a[166:167], v229 offset:4096
    v_mfma_f32_16x16x32_bf16 a[40:43], a[168:171], v[0:3], a[40:43]
    v_mfma_f32_16x16x32_bf16 a[44:47], a[168:171], v[4:7], a[44:47]
    v_mfma_f32_16x16x32_bf16 a[48:51], a[168:171], v[8:11], a[48:51]
    buffer_load_dwordx4 v209, s[24:27], s41 offen offset:1024 lds
    v_mfma_f32_16x16x32_bf16 a[52:55], a[168:171], v[12:15], a[52:55]
    v_mfma_f32_16x16x32_bf16 a[56:59], a[168:171], v[16:19], a[56:59]
    ds_read_b64_tr_b16 a[168:169], v230 offset:0
    ds_read_b64_tr_b16 a[170:171], v230 offset:4096
    v_mfma_f32_16x16x32_bf16 a[60:63], a[172:175], v[0:3], a[60:63]
    v_mfma_f32_16x16x32_bf16 a[64:67], a[172:175], v[4:7], a[64:67]
    v_mfma_f32_16x16x32_bf16 a[68:71], a[172:175], v[8:11], a[68:71]
    buffer_load_dwordx4 v[88:91], v238, s[20:23], s47 offen offset:2048 sc1
    v_mfma_f32_16x16x32_bf16 a[72:75], a[172:175], v[12:15], a[72:75]
    v_mfma_f32_16x16x32_bf16 a[76:79], a[172:175], v[16:19], a[76:79]
    ds_read_b64_tr_b16 a[172:173], v231 offset:0
    ds_read_b64_tr_b16 a[174:175], v231 offset:4096
    v_mfma_f32_16x16x32_bf16 a[80:83], a[176:179], v[0:3], a[80:83]
    v_mfma_f32_16x16x32_bf16 a[84:87], a[176:179], v[4:7], a[84:87]
    v_mfma_f32_16x16x32_bf16 a[88:91], a[176:179], v[8:11], a[88:91]
    buffer_load_dwordx4 v210, s[24:27], s41 offen offset:2048 lds
    v_mfma_f32_16x16x32_bf16 a[92:95], a[176:179], v[12:15], a[92:95]
    v_mfma_f32_16x16x32_bf16 a[96:99], a[176:179], v[16:19], a[96:99]
    v_mfma_f32_16x16x32_bf16 a[100:103], a[180:183], v[0:3], a[100:103]
    ds_read_b64_tr_b16 a[176:177], v232 offset:0
    ds_read_b64_tr_b16 a[178:179], v232 offset:4096
    v_mfma_f32_16x16x32_bf16 a[104:107], a[180:183], v[4:7], a[104:107]
    v_mfma_f32_16x16x32_bf16 a[108:111], a[180:183], v[8:11], a[108:111]
    buffer_load_dwordx4 v[92:95], v238, s[20:23], s47 offen offset:3072 sc1
    v_mfma_f32_16x16x32_bf16 a[112:115], a[180:183], v[12:15], a[112:115]
    v_mfma_f32_16x16x32_bf16 a[116:119], a[180:183], v[16:19], a[116:119]
    ds_read_b64_tr_b16 a[180:181], v233 offset:0
    ds_read_b64_tr_b16 a[182:183], v233 offset:4096
    v_mfma_f32_16x16x32_bf16 a[120:123], a[184:187], v[0:3], a[120:123]
    v_mfma_f32_16x16x32_bf16 a[124:127], a[184:187], v[4:7], a[124:127]
    v_mfma_f32_16x16x32_bf16 a[128:131], a[184:187], v[8:11], a[128:131]
    buffer_load_dwordx4 v211, s[24:27], s41 offen offset:3072 lds
    v_mfma_f32_16x16x32_bf16 a[132:135], a[184:187], v[12:15], a[132:135]
    v_mfma_f32_16x16x32_bf16 a[136:139], a[184:187], v[16:19], a[136:139]
    v_mfma_f32_16x16x32_bf16 a[140:143], a[188:191], v[0:3], a[140:143]
    ds_read_b64_tr_b16 a[184:185], v234 offset:0
    ds_read_b64_tr_b16 a[186:187], v234 offset:4096
    v_mfma_f32_16x16x32_bf16 a[144:147], a[188:191], v[4:7], a[144:147]
    v_mfma_f32_16x16x32_bf16 a[148:151], a[188:191], v[8:11], a[148:151]
    buffer_load_dwordx4 v[96:99], v239, s[20:23], s47 offen offset:0 sc1
    v_mfma_f32_16x16x32_bf16 a[152:155], a[188:191], v[12:15], a[152:155]
    s_add_u32 s47, s61, 358400
    v_mfma_f32_16x16x32_bf16 a[156:159], a[188:191], v[16:19], a[156:159]
    ds_read_b64_tr_b16 a[188:189], v235 offset:0
    ds_read_b64_tr_b16 a[190:191], v235 offset:4096
    s_waitcnt lgkmcnt(4)
    s_waitcnt vmcnt(27)
    v_mfma_f32_16x16x32_bf16 a[0:3], a[160:163], v[20:23], a[0:3]
    buffer_load_dwordx4 v[100:103], v238, s[20:23], s47 offen offset:0 sc1
    v_mfma_f32_16x16x32_bf16 a[4:7], a[160:163], v[24:27], a[4:7]
    v_mfma_f32_16x16x32_bf16 a[8:11], a[160:163], v[28:31], a[8:11]
    v_mfma_f32_16x16x32_bf16 a[12:15], a[160:163], v[32:35], a[12:15]
Lpg15:
    s_cbranch_execz Ltch1
    s_add_u32 s41, s60, 245760
    v_mfma_f32_16x16x32_bf16 a[16:19], a[160:163], v[36:39], a[16:19]
    buffer_load_dwordx4 v[104:107], v238, s[20:23], s47 offen offset:1024 sc1
    v_mfma_f32_16x16x32_bf16 a[20:23], a[164:167], v[20:23], a[20:23]
    s_add_u32 m0, s35, 32768
    v_mfma_f32_16x16x32_bf16 a[24:27], a[164:167], v[24:27], a[24:27]
    s_waitcnt lgkmcnt(0)
    v_mfma_f32_16x16x32_bf16 a[28:31], a[164:167], v[28:31], a[28:31]
    ds_read_b64_tr_b16 a[160:161], v224 offset:0
    ds_read_b64_tr_b16 a[162:163], v224 offset:4096
    v_mfma_f32_16x16x32_bf16 a[32:35], a[164:167], v[32:35], a[32:35]
    buffer_load_dwordx4 v208, s[24:27], s41 offen offset:0 lds
    v_mfma_f32_16x16x32_bf16 a[36:39], a[164:167], v[36:39], a[36:39]
    ds_read_b64_tr_b16 a[164:165], v225 offset:0
    ds_read_b64_tr_b16 a[166:167], v225 offset:4096
    v_mfma_f32_16x16x32_bf16 a[40:43], a[168:171], v[20:23], a[40:43]
    v_mfma_f32_16x16x32_bf16 a[44:47], a[168:171], v[24:27], a[44:47]
    v_mfma_f32_16x16x32_bf16 a[48:51], a[168:171], v[28:31], a[48:51]
    buffer_load_dwordx4 v209, s[24:27], s41 offen offset:1024 lds
    v_mfma_f32_16x16x32_bf16 a[52:55], a[168:171], v[32:35], a[52:55]
    v_mfma_f32_16x16x32_bf16 a[56:59], a[168:171], v[36:39], a[56:59]
    ds_read_b64_tr_b16 a[168:169], v226 offset:0
    ds_read_b64_tr_b16 a[170:171], v226 offset:4096
    v_mfma_f32_16x16x32_bf16 a[60:63], a[172:175], v[20:23], a[60:63]
    v_mfma_f32_16x16x32_bf16 a[64:67], a[172:175], v[24:27], a[64:67]
    v_mfma_f32_16x16x32_bf16 a[68:71], a[172:175], v[28:31], a[68:71]
    buffer_load_dwordx4 v[108:111], v238, s[20:23], s47 offen offset:2048 sc1
    v_mfma_f32_16x16x32_bf16 a[72:75], a[172:175], v[32:35], a[72:75]
    v_mfma_f32_16x16x32_bf16 a[76:79], a[172:175], v[36:39], a[76:79]
    ds_read_b64_tr_b16 a[172:173], v227 offset:0
    ds_read_b64_tr_b16 a[174:175], v227 offset:4096
    v_mfma_f32_16x16x32_bf16 a[80:83], a[176:179], v[20:23], a[80:83]
    v_mfma_f32_16x16x32_bf16 a[84:87], a[176:179], v[24:27], a[84:87]
    v_mfma_f32_16x16x32_bf16 a[88:91], a[176:179], v[28:31], a[88:91]
    buffer_load_dwordx4 v210, s[24:27], s41 offen offset:2048 lds
    v_mfma_f32_16x16x32_bf16 a[92:95], a[176:179], v[32:35], a[92:95]
    v_mfma_f32_16x16x32_bf16 a[96:99], a[176:179], v[36:39], a[96:99]
    v_mfma_f32_16x16x32_bf16 a[100:103], a[180:183], v[20:23], a[100:103]
    ds_read_b64_tr_b16 a[176:177], v241 offset:0
    ds_read_b64_tr_b16 a[178:179], v241 offset:4096
    v_mfma_f32_16x16x32_bf16 a[104:107], a[180:183], v[24:27], a[104:107]
    v_mfma_f32_16x16x32_bf16 a[108:111], a[180:183], v[28:31], a[108:111]
    buffer_load_dwordx4 v[112:115], v238, s[20:23], s47 offen offset:3072 sc1
    v_mfma_f32_16x16x32_bf16 a[112:115], a[180:183], v[32:35], a[112:115]
    v_mfma_f32_16x16x32_bf16 a[116:119], a[180:183], v[36:39], a[116:119]
    ds_read_b64_tr_b16 a[180:181], v242 offset:0
    ds_read_b64_tr_b16 a[182:183], v242 offset:4096
    v_mfma_f32_16x16x32_bf16 a[120:123], a[184:187], v[20:23], a[120:123]
    v_mfma_f32_16x16x32_bf16 a[124:127], a[184:187], v[24:27], a[124:127]
    v_mfma_f32_16x16x32_bf16 a[128:131], a[184:187], v[28:31], a[128:131]
    buffer_load_dwordx4 v211, s[24:27], s41 offen offset:3072 lds
    v_mfma_f32_16x16x32_bf16 a[132:135], a[184:187], v[32:35], a[132:135]
    v_mfma_f32_16x16x32_bf16 a[136:139], a[184:187], v[36:39], a[136:139]
    v_mfma_f32_16x16x32_bf16 a[140:143], a[188:191], v[20:23], a[140:143]
    ds_read_b64_tr_b16 a[184:185], v243 offset:0
    ds_read_b64_tr_b16 a[186:187], v243 offset:4096
    v_mfma_f32_16x16x32_bf16 a[144:147], a[188:191], v[24:27], a[144:147]
    v_mfma_f32_16x16x32_bf16 a[148:151], a[188:191], v[28:31], a[148:151]
    buffer_load_dwordx4 v[116:119], v239, s[20:23], s47 offen offset:0 sc1
    v_mfma_f32_16x16x32_bf16 a[152:155], a[188:191], v[32:35], a[152:155]
    s_add_u32 s47, s61, 415744
    v_mfma_f32_16x16x32_bf16 a[156:159], a[188:191], v[36:39], a[156:159]
    ds_read_b64_tr_b16 a[188:189], v244 offset:0
    ds_read_b64_tr_b16 a[190:191], v244 offset:4096
    s_waitcnt lgkmcnt(4)
    s_waitcnt vmcnt(27)
    v_mfma_f32_16x16x32_bf16 a[0:3], a[160:163], v[40:43], a[0:3]
    buffer_load_dwordx4 v[120:123], v238, s[20:23], s47 offen offset:0 sc1
    v_mfma_f32_16x16x32_bf16 a[4:7], a[160:163], v[44:47], a[4:7]
    v_mfma_f32_16x16x32_bf16 a[8:11], a[160:163], v[48:51], a[8:11]
    v_mfma_f32_16x16x32_bf16 a[12:15], a[160:163], v[52:55], a[12:15]
    s_add_u32 s41, s60, 286720
    v_mfma_f32_16x16x32_bf16 a[16:19], a[160:163], v[56:59], a[16:19]
    buffer_load_dwordx4 v[124:127], v238, s[20:23], s47 offen offset:1024 sc1
    v_mfma_f32_16x16x32_bf16 a[20:23], a[164:167], v[40:43], a[20:23]
    s_add_u32 m0, s35, 73728
    v_mfma_f32_16x16x32_bf16 a[24:27], a[164:167], v[44:47], a[24:27]
    s_waitcnt lgkmcnt(0)
    v_mfma_f32_16x16x32_bf16 a[28:31], a[164:167], v[48:51], a[28:31]
    ds_read_b64_tr_b16 a[160:161], v228 offset:8192
    ds_read_b64_tr_b16 a[162:163], v228 offset:12288
    v_mfma_f32_16x16x32_bf16 a[32:35], a[164:167], v[52:55], a[32:35]
    buffer_load_dwordx4 v208, s[24:27], s41 offen offset:0 lds
    v_mfma_f32_16x16x32_bf16 a[36:39], a[164:167], v[56:59], a[36:39]
    ds_read_b64_tr_b16 a[164:165], v229 offset:8192
    ds_read_b64_tr_b16 a[166:167], v229 offset:12288
    v_mfma_f32_16x16x32_bf16 a[40:43], a[168:171], v[40:43], a[40:43]
    v_mfma_f32_16x16x32_bf16 a[44:47], a[168:171], v[44:47], a[44:47]
    v_mfma_f32_16x16x32_bf16 a[48:51], a[168:171], v[48:51], a[48:51]
    buffer_load_dwordx4 v209, s[24:27], s41 offen offset:1024 lds
    v_mfma_f32_16x16x32_bf16 a[52:55], a[168:171], v[52:55], a[52:55]
    v_mfma_f32_16x16x32_bf16 a[56:59], a[168:171], v[56:59], a[56:59]
    ds_read_b64_tr_b16 a[168:169], v230 offset:8192
    ds_read_b64_tr_b16 a[170:171], v230 offset:12288
    v_mfma_f32_16x16x32_bf16 a[60:63], a[172:175], v[40:43], a[60:63]
    v_mfma_f32_16x16x32_bf16 a[64:67], a[172:175], v[44:47], a[64:67]
    v_mfma_f32_16x16x32_bf16 a[68:71], a[172:175], v[48:51], a[68:71]
    buffer_load_dwordx4 v[128:131], v238, s[20:23], s47 offen offset:2048 sc1
    v_mfma_f32_16x16x32_bf16 a[72:75], a[172:175], v[52:55], a[72:75]
    v_mfma_f32_16x16x32_bf16 a[76:79], a[172:175], v[56:59], a[76:79]
    ds_read_b64_tr_b16 a[172:173], v231 offset:8192
    ds_read_b64_tr_b16 a[174:175], v231 offset:12288
    v_mfma_f32_16x16x32_bf16 a[80:83], a[176:179], v[40:43], a[80:83]
    v_mfma_f32_16x16x32_bf16 a[84:87], a[176:179], v[44:47], a[84:87]
    v_mfma_f32_16x16x32_bf16 a[88:91], a[176:179], v[48:51], a[88:91]
    buffer_load_dwordx4 v210, s[24:27], s41 offen offset:2048 lds
    v_mfma_f32_16x16x32_bf16 a[92:95], a[176:179], v[52:55], a[92:95]
    v_mfma_f32_16x16x32_bf16 a[96:99], a[176:179], v[56:59], a[96:99]
    v_mfma_f32_16x16x32_bf16 a[100:103], a[180:183], v[40:43], a[100:103]
    ds_read_b64_tr_b16 a[176:177], v232 offset:8192
    ds_read_b64_tr_b16 a[178:179], v232 offset:12288
    v_mfma_f32_16x16x32_bf16 a[104:107], a[180:183], v[44:47], a[104:107]
    v_mfma_f32_16x16x32_bf16 a[108:111], a[180:183], v[48:51], a[108:111]
    buffer_load_dwordx4 v[132:135], v238, s[20:23], s47 offen offset:3072 sc1
    v_mfma_f32_16x16x32_bf16 a[112:115], a[180:183], v[52:55], a[112:115]
    v_mfma_f32_16x16x32_bf16 a[116:119], a[180:183], v[56:59], a[116:119]
    ds_read_b64_tr_b16 a[180:181], v233 offset:8192
    ds_read_b64_tr_b16 a[182:183], v233 offset:12288
    v_mfma_f32_16x16x32_bf16 a[120:123], a[184:187], v[40:43], a[120:123]
    v_mfma_f32_16x16x32_bf16 a[124:127], a[184:187], v[44:47], a[124:127]
    v_mfma_f32_16x16x32_bf16 a[128:131], a[184:187], v[48:51], a[128:131]
    buffer_load_dwordx4 v211, s[24:27], s41 offen offset:3072 lds
    v_mfma_f32_16x16x32_bf16 a[132:135], a[184:187], v[52:55], a[132:135]
    buffer_load_dword v215, v217, s[20:23], 0 offen offset:3584 sc1
    v_mfma_f32_16x16x32_bf16 a[136:139], a[184:187], v[56:59], a[136:139]
    v_mfma_f32_16x16x32_bf16 a[140:143], a[188:191], v[40:43], a[140:143]
    ds_read_b64_tr_b16 a[184:185], v234 offset:8192
    ds_read_b64_tr_b16 a[186:187], v234 offset:12288
    v_mfma_f32_16x16x32_bf16 a[144:147], a[188:191], v[44:47], a[144:147]
    v_mfma_f32_16x16x32_bf16 a[148:151], a[188:191], v[48:51], a[148:151]
    buffer_load_dwordx4 v[136:139], v239, s[20:23], s47 offen offset:0 sc1
    v_mfma_f32_16x16x32_bf16 a[152:155], a[188:191], v[52:55], a[152:155]
    v_mfma_f32_16x16x32_bf16 a[156:159], a[188:191], v[56:59], a[156:159]
    ds_read_b64_tr_b16 a[188:189], v235 offset:8192
    ds_read_b64_tr_b16 a[190:191], v235 offset:12288
    s_waitcnt lgkmcnt(4)
    s_waitcnt vmcnt(28)
    v_mfma_f32_16x16x32_bf16 a[0:3], a[160:163], v[60:63], a[0:3]
    v_mfma_f32_16x16x32_bf16 a[4:7], a[160:163], v[64:67], a[4:7]
    v_mfma_f32_16x16x32_bf16 a[8:11], a[160:163], v[68:71], a[8:11]
    v_mfma_f32_16x16x32_bf16 a[12:15], a[160:163], v[72:75], a[12:15]
    s_add_u32 s41, s60, 409600
    v_mfma_f32_16x16x32_bf16 a[16:19], a[160:163], v[76:79], a[16:19]
    v_mfma_f32_16x16x32_bf16 a[20:23], a[164:167], v[60:63], a[20:23]
    s_add_u32 m0, s35, 0
    v_mfma_f32_16x16x32_bf16 a[24:27], a[164:167], v[64:67], a[24:27]
    s_waitcnt vmcnt(38) lgkmcnt(0)
    s_barrier
    v_mfma_f32_16x16x32_bf16 a[28:31], a[164:167], v[68:71], a[28:31]
    ds_read_b64_tr_b16 a[160:161], v224 offset:8192
    ds_read_b64_tr_b16 a[162:163], v224 offset:12288
    v_mfma_f32_16x16x32_bf16 a[32:35], a[164:167], v[72:75], a[32:35]
    buffer_load_dwordx4 v208, s[24:27], s41 offen offset:0 lds
    v_mfma_f32_16x16x32_bf16 a[36:39], a[164:167], v[76:79], a[36:39]
    ds_read_b64_tr_b16 a[164:165], v225 offset:8192
    ds_read_b64_tr_b16 a[166:167], v225 offset:12288
    v_mfma_f32_16x16x32_bf16 a[40:43], a[168:171], v[60:63], a[40:43]
    v_mfma_f32_16x16x32_bf16 a[44:47], a[168:171], v[64:67], a[44:47]
    v_mfma_f32_16x16x32_bf16 a[48:51], a[168:171], v[68:71], a[48:51]
    buffer_load_dwordx4 v209, s[24:27], s41 offen offset:1024 lds
    v_mfma_f32_16x16x32_bf16 a[52:55], a[168:171], v[72:75], a[52:55]
    v_mfma_f32_16x16x32_bf16 a[56:59], a[168:171], v[76:79], a[56:59]
    ds_read_b64_tr_b16 a[168:169], v226 offset:8192
    ds_read_b64_tr_b16 a[170:171], v226 offset:12288
    v_mfma_f32_16x16x32_bf16 a[60:63], a[172:175], v[60:63], a[60:63]
    v_mfma_f32_16x16x32_bf16 a[64:67], a[172:175], v[64:67], a[64:67]
    v_mfma_f32_16x16x32_bf16 a[68:71], a[172:175], v[68:71], a[68:71]
    v_mfma_f32_16x16x32_bf16 a[72:75], a[172:175], v[72:75], a[72:75]
    v_mfma_f32_16x16x32_bf16 a[76:79], a[172:175], v[76:79], a[76:79]
    ds_read_b64_tr_b16 a[172:173], v227 offset:8192
    ds_read_b64_tr_b16 a[174:175], v227 offset:12288
    v_mfma_f32_16x16x32_bf16 a[80:83], a[176:179], v[60:63], a[80:83]
    v_mfma_f32_16x16x32_bf16 a[84:87], a[176:179], v[64:67], a[84:87]
    v_mfma_f32_16x16x32_bf16 a[88:91], a[176:179], v[68:71], a[88:91]
    buffer_load_dwordx4 v210, s[24:27], s41 offen offset:2048 lds
    v_mfma_f32_16x16x32_bf16 a[92:95], a[176:179], v[72:75], a[92:95]
    v_mfma_f32_16x16x32_bf16 a[96:99], a[176:179], v[76:79], a[96:99]
    v_mfma_f32_16x16x32_bf16 a[100:103], a[180:183], v[60:63], a[100:103]
    ds_read_b64_tr_b16 a[176:177], v241 offset:8192
    ds_read_b64_tr_b16 a[178:179], v241 offset:12288
    v_mfma_f32_16x16x32_bf16 a[104:107], a[180:183], v[64:67], a[104:107]
    v_mfma_f32_16x16x32_bf16 a[108:111], a[180:183], v[68:71], a[108:111]
    v_mfma_f32_16x16x32_bf16 a[112:115], a[180:183], v[72:75], a[112:115]
    v_mfma_f32_16x16x32_bf16 a[116:119], a[180:183], v[76:79], a[116:119]
    ds_read_b64_tr_b16 a[180:181], v242 offset:8192
    ds_read_b64_tr_b16 a[182:183], v242 offset:12288
    v_mfma_f32_16x16x32_bf16 a[120:123], a[184:187], v[60:63], a[120:123]
    v_mfma_f32_16x16x32_bf16 a[124:127], a[184:187], v[64:67], a[124:127]
    v_mfma_f32_16x16x32_bf16 a[128:131], a[184:187], v[68:71], a[128:131]
    buffer_load_dwordx4 v211, s[24:27], s41 offen offset:3072 lds
    v_mfma_f32_16x16x32_bf16 a[132:135], a[184:187], v[72:75], a[132:135]
    v_mfma_f32_16x16x32_bf16 a[136:139], a[184:187], v[76:79], a[136:139]
    v_mfma_f32_16x16x32_bf16 a[140:143], a[188:191], v[60:63], a[140:143]
    ds_read_b64_tr_b16 a[184:185], v243 offset:8192
    ds_read_b64_tr_b16 a[186:187], v243 offset:12288
    v_mfma_f32_16x16x32_bf16 a[144:147], a[188:191], v[64:67], a[144:147]
    v_mfma_f32_16x16x32_bf16 a[148:151], a[188:191], v[68:71], a[148:151]
    v_mfma_f32_16x16x32_bf16 a[152:155], a[188:191], v[72:75], a[152:155]
    s_add_u32 s47, s61, 28672
    v_mfma_f32_16x16x32_bf16 a[156:159], a[188:191], v[76:79], a[156:159]
    ds_read_b64_tr_b16 a[188:189], v244 offset:8192
    ds_read_b64_tr_b16 a[190:191], v244 offset:12288
    s_waitcnt lgkmcnt(4)
    s_waitcnt vmcnt(5)
    v_cmp_eq_u32 vcc, 1, v215
    s_cmp_eq_u32 vcc_lo, -1
    s_cbranch_scc0 Lspin
Lback:
    v_mfma_f32_16x16x32_bf16 a[0:3], a[160:163], v[80:83], a[0:3]
    buffer_load_dwordx4 v[140:143], v238, s[20:23], s47 offen offset:0 sc1
    v_mfma_f32_16x16x32_bf16 a[4:7], a[160:163], v[84:87], a[4:7]
    v_mfma_f32_16x16x32_bf16 a[8:11], a[160:163], v[88:91], a[8:11]
    buffer_load_dwordx4 v[144:147], v238, s[20:23], s47 offen offset:1024 sc1
    v_mfma_f32_16x16x32_bf16 a[12:15], a[160:163], v[92:95], a[12:15]
    s_add_u32 s41, s60, 450560
    v_mfma_f32_16x16x32_bf16 a[16:19], a[160:163], v[96:99], a[16:19]
    buffer_load_dwordx4 v[148:151], v238, s[20:23], s47 offen offset:2048 sc1
    v_mfma_f32_16x16x32_bf16 a[20:23], a[164:167], v[80:83], a[20:23]
    s_add_u32 m0, s35, 40960
    v_mfma_f32_16x16x32_bf16 a[24:27], a[164:167], v[84:87], a[24:27]
    s_waitcnt lgkmcnt(0)
    v_mfma_f32_16x16x32_bf16 a[28:31], a[164:167], v[88:91], a[28:31]
    ds_read_b64_tr_b16 a[160:161], v228 offset:16384
    ds_read_b64_tr_b16 a[162:163], v228 offset:20480
    v_mfma_f32_16x16x32_bf16 a[32:35], a[164:167], v[92:95], a[32:35]
    buffer_load_dwordx4 v208, s[24:27], s41 offen offset:0 lds
    v_mfma_f32_16x16x32_bf16 a[36:39], a[164:167], v[96:99], a[36:39]
    ds_read_b64_tr_b16 a[164:165], v229 offset:16384
    ds_read_b64_tr_b16 a[166:167], v229 offset:20480
    v_mfma_f32_16x16x32_bf16 a[40:43], a[168:171], v[80:83], a[40:43]
    buffer_load_dwordx4 v[152:155], v238, s[20:23], s47 offen offset:3072 sc1
    v_mfma_f32_16x16x32_bf16 a[44:47], a[168:171], v[84:87], a[44:47]
    v_mfma_f32_16x16x32_bf16 a[48:51], a[168:171], v[88:91], a[48:51]
    buffer_load_dwordx4 v209, s[24:27], s41 offen offset:1024 lds
    v_mfma_f32_16x16x32_bf16 a[52:55], a[168:171], v[92:95], a[52:55]
    v_mfma_f32_16x16x32_bf16 a[56:59], a[168:171], v[96:99], a[56:59]
    ds_read_b64_tr_b16 a[168:169], v230 offset:16384
    ds_read_b64_tr_b16 a[170:171], v230 offset:20480
    v_mfma_f32_16x16x32_bf16 a[60:63], a[172:175], v[80:83], a[60:63]
    buffer_load_dwordx4 v[156:159], v239, s[20:23], s47 offen offset:0 sc1
    v_mfma_f32_16x16x32_bf16 a[64:67], a[172:175], v[84:87], a[64:67]
    s_add_u32 s47, s61, 43008
    v_mfma_f32_16x16x32_bf16 a[68:71], a[172:175], v[88:91], a[68:71]
    buffer_load_dwordx4 v[160:163], v238, s[20:23], s47 offen offset:0 sc1
    v_mfma_f32_16x16x32_bf16 a[72:75], a[172:175], v[92:95], a[72:75]
    v_mfma_f32_16x16x32_bf16 a[76:79], a[172:175], v[96:99], a[76:79]
    ds_read_b64_tr_b16 a[172:173], v231 offset:16384
    ds_read_b64_tr_b16 a[174:175], v231 offset:20480
    v_mfma_f32_16x16x32_bf16 a[80:83], a[176:179], v[80:83], a[80:83]
    buffer_load_dwordx4 v[164:167], v238, s[20:23], s47 offen offset:1024 sc1
    v_mfma_f32_16x16x32_bf16 a[84:87], a[176:179], v[84:87], a[84:87]
    v_mfma_f32_16x16x32_bf16 a[88:91], a[176:179], v[88:91], a[88:91]
    buffer_load_dwordx4 v210, s[24:27], s41 offen offset:2048 lds
    v_mfma_f32_16x16x32_bf16 a[92:95], a[176:179], v[92:95], a[92:95]
    v_mfma_f32_16x16x32_bf16 a[96:99], a[176:179], v[96:99], a[96:99]
    v_mfma_f32_16x16x32_bf16 a[100:103], a[180:183], v[80:83], a[100:103]
    ds_read_b64_tr_b16 a[176:177], v232 offset:16384
    ds_read_b64_tr_b16 a[178:179], v232 offset:20480
    v_mfma_f32_16x16x32_bf16 a[104:107], a[180:183], v[84:87], a[104:107]
    v_mfma_f32_16x16x32_bf16 a[108:111], a[180:183], v[88:91], a[108:111]
    buffer_load_dwordx4 v[168:171], v238, s[20:23], s47 offen offset:2048 sc1
    v_mfma_f32_16x16x32_bf16 a[112:115], a[180:183], v[92:95], a[112:115]
    v_mfma_f32_16x16x32_bf16 a[116:119], a[180:183], v[96:99], a[116:119]
    ds_read_b64_tr_b16 a[180:181], v233 offset:16384
    ds_read_b64_tr_b16 a[182:183], v233 offset:20480
    v_mfma_f32_16x16x32_bf16 a[120:123], a[184:187], v[80:83], a[120:123]
    buffer_load_dwordx4 v[172:175], v238, s[20:23], s47 offen offset:3072 sc1
    v_mfma_f32_16x16x32_bf16 a[124:127], a[184:187], v[84:87], a[124:127]
    v_mfma_f32_16x16x32_bf16 a[128:131], a[184:187], v[88:91], a[128:131]
    buffer_load_dwordx4 v211, s[24:27], s41 offen offset:3072 lds
    v_mfma_f32_16x16x32_bf16 a[132:135], a[184:187], v[92:95], a[132:135]
    v_mfma_f32_16x16x32_bf16 a[136:139], a[184:187], v[96:99], a[136:139]
    v_mfma_f32_16x16x32_bf16 a[140:143], a[188:191], v[80:83], a[140:143]
    ds_read_b64_tr_b16 a[184:185], v234 offset:16384
    ds_read_b64_tr_b16 a[186:187], v234 offset:20480
    v_mfma_f32_16x16x32_bf16 a[144:147], a[188:191], v[84:87], a[144:147]
    v_mfma_f32_16x16x32_bf16 a[148:151], a[188:191], v[88:91], a[148:151]
    buffer_load_dwordx4 v[176:179], v239, s[20:23], s47 offen offset:0 sc1
    v_mfma_f32_16x16x32_bf16 a[152:155], a[188:191], v[92:95], a[152:155]
    s_add_u32 s47, s61, 86016
    v_mfma_f32_16x16x32_bf16 a[156:159], a[188:191], v[96:99], a[156:159]
    ds_read_b64_tr_b16 a[188:189], v235 offset:16384
    ds_read_b64_tr_b16 a[190:191], v235 offset:20480
    s_waitcnt lgkmcnt(4)
    s_waitcnt vmcnt(28)
    v_mfma_f32_16x16x32_bf16 a[0:3], a[160:163], v[100:103], a[0:3]
    buffer_load_dwordx4 v[0:3], v238, s[20:23], s47 offen offset:0 sc1
    v_mfma_f32_16x16x32_bf16 a[4:7], a[160:163], v[104:107], a[4:7]
    v_mfma_f32_16x16x32_bf16 a[8:11], a[160:163], v[108:111], a[8:11]
    v_mfma_f32_16x16x32_bf16 a[12:15], a[160:163], v[112:115], a[12:15]
    s_add_u32 s41, s60, 573440
    v_mfma_f32_16x16x32_bf16 a[16:19], a[160:163], v[116:119], a[16:19]
    buffer_load_dwordx4 v[4:7], v238, s[20:23], s47 offen offset:1024 sc1
    v_mfma_f32_16x16x32_bf16 a[20:23], a[164:167], v[100:103], a[20:23]
    s_add_u32 m0, s35, 8192
    v_mfma_f32_16x16x32_bf16 a[24:27], a[164:167], v[104:107], a[24:27]
    s_waitcnt lgkmcnt(0)
    v_mfma_f32_16x16x32_bf16 a[28:31], a[164:167], v[108:111], a[28:31]
    ds_read_b64_tr_b16 a[160:161], v224 offset:16384
    ds_read_b64_tr_b16 a[162:163], v224 offset:20480
    v_mfma_f32_16x16x32_bf16 a[32:35], a[164:167], v[112:115], a[32:35]
    buffer_load_dwordx4 v208, s[24:27], s41 offen offset:0 lds
    v_mfma_f32_16x16x32_bf16 a[36:39], a[164:167], v[116:119], a[36:39]
    ds_read_b64_tr_b16 a[164:165], v225 offset:16384
    ds_read_b64_tr_b16 a[166:167], v225 offset:20480
    v_mfma_f32_16x16x32_bf16 a[40:43], a[168:171], v[100:103], a[40:43]
    v_mfma_f32_16x16x32_bf16 a[44:47], a[168:171], v[104:107], a[44:47]
    v_mfma_f32_16x16x32_bf16 a[48:51], a[168:171], v[108:111], a[48:51]
    buffer_load_dwordx4 v209, s[24:27], s41 offen offset:1024 lds
    v_mfma_f32_16x16x32_bf16 a[52:55], a[168:171], v[112:115], a[52:55]
    v_mfma_f32_16x16x32_bf16 a[56:59], a[168:171], v[116:119], a[56:59]
    ds_read_b64_tr_b16 a[168:169], v226 offset:16384
    ds_read_b64_tr_b16 a[170:171], v226 offset:20480
    v_mfma_f32_16x16x32_bf16 a[60:63], a[172:175], v[100:103], a[60:63]
    v_mfma_f32_16x16x32_bf16 a[64:67], a[172:175], v[104:107], a[64:67]
    v_mfma_f32_16x16x32_bf16 a[68:71], a[172:175], v[108:111], a[68:71]
    buffer_load_dwordx4 v[8:11], v238, s[20:23], s47 offen offset:2048 sc1
    v_mfma_f32_16x16x32_bf16 a[72:75], a[172:175], v[112:115], a[72:75]
    v_mfma_f32_16x16x32_bf16 a[76:79], a[172:175], v[116:119], a[76:79]
    ds_read_b64_tr_b16 a[172:173], v227 offset:16384
    ds_read_b64_tr_b16 a[174:175], v227 offset:20480
    v_mfma_f32_16x16x32_bf16 a[80:83], a[176:179], v[100:103], a[80:83]
    v_mfma_f32_16x16x32_bf16 a[84:87], a[176:179], v[104:107], a[84:87]
    v_mfma_f32_16x16x32_bf16 a[88:91], a[176:179], v[108:111], a[88:91]
    buffer_load_dwordx4 v210, s[24:27], s41 offen offset:2048 lds
    v_mfma_f32_16x16x32_bf16 a[92:95], a[176:179], v[112:115], a[92:95]
    v_mfma_f32_16x16x32_bf16 a[96:99], a[176:179], v[116:119], a[96:99]
    v_mfma_f32_16x16x32_bf16 a[100:103], a[180:183], v[100:103], a[100:103]
    ds_read_b64_tr_b16 a[176:177], v241 offset:16384
    ds_read_b64_tr_b16 a[178:179], v241 offset:20480
    v_mfma_f32_16x16x32_bf16 a[104:107], a[180:183], v[104:107], a[104:107]
    v_mfma_f32_16x16x32_bf16 a[108:111], a[180:183], v[108:111], a[108:111]
    buffer_load_dwordx4 v[12:15], v238, s[20:23], s47 offen offset:3072 sc1
    v_mfma_f32_16x16x32_bf16 a[112:115], a[180:183], v[112:115], a[112:115]
    v_mfma_f32_16x16x32_bf16 a[116:119], a[180:183], v[116:119], a[116:119]
    ds_read_b64_tr_b16 a[180:181], v242 offset:16384
    ds_read_b64_tr_b16 a[182:183], v242 offset:20480
    v_mfma_f32_16x16x32_bf16 a[120:123], a[184:187], v[100:103], a[120:123]
    v_mfma_f32_16x16x32_bf16 a[124:127], a[184:187], v[104:107], a[124:127]
    v_mfma_f32_16x16x32_bf16 a[128:131], a[184:187], v[108:111], a[128:131]
    buffer_load_dwordx4 v211, s[24:27], s41 offen offset:3072 lds
    v_mfma_f32_16x16x32_bf16 a[132:135], a[184:187], v[112:115], a[132:135]
    v_mfma_f32_16x16x32_bf16 a[136:139], a[184:187], v[116:119], a[136:139]
    v_mfma_f32_16x16x32_bf16 a[140:143], a[188:191], v[100:103], a[140:143]
    ds_read_b64_tr_b16 a[184:185], v243 offset:16384
    ds_read_b64_tr_b16 a[186:187], v243 offset:20480
    v_mfma_f32_16x16x32_bf16 a[144:147], a[188:191], v[104:107], a[144:147]
    v_mfma_f32_16x16x32_bf16 a[148:151], a[188:191], v[108:111], a[148:151]
    buffer_load_dwordx4 v[16:19], v239, s[20:23], s47 offen offset:0 sc1
    v_mfma_f32_16x16x32_bf16 a[152:155], a[188:191], v[112:115], a[152:155]
    s_add_u32 s47, s61, 100352
    v_mfma_f32_16x16x32_bf16 a[156:159], a[188:191], v[116:119], a[156:159]
    ds_read_b64_tr_b16 a[188:189], v244 offset:16384
    ds_read_b64_tr_b16 a[190:191], v244 offset:20480
    s_waitcnt lgkmcnt(4)
    s_waitcnt vmcnt(27)
    v_mfma_f32_16x16x32_bf16 a[0:3], a[160:163], v[120:123], a[0:3]
    buffer_load_dwordx4 v[20:23], v238, s[20:23], s47 offen offset:0 sc1
    v_mfma_f32_16x16x32_bf16 a[4:7], a[160:163], v[124:127], a[4:7]
    v_mfma_f32_16x16x32_bf16 a[8:11], a[160:163], v[128:131], a[8:11]
    v_mfma_f32_16x16x32_bf16 a[12:15], a[160:163], v[132:135], a[12:15]
    s_add_u32 s41, s60, 614400
    v_mfma_f32_16x16x32_bf16 a[16:19], a[160:163], v[136:139], a[16:19]
    buffer_load_dwordx4 v[24:27], v238, s[20:23], s47 offen offset:1024 sc1
    v_mfma_f32_16x16x32_bf16 a[20:23], a[164:167], v[120:123], a[20:23]
    s_add_u32 m0, s35, 49152
    v_mfma_f32_16x16x32_bf16 a[24:27], a[164:167], v[124:127], a[24:27]
    s_waitcnt vmcnt(40) lgkmcnt(0)
    s_barrier
    v_mfma_f32_16x16x32_bf16 a[28:31], a[164:167], v[128:131], a[28:31]
    ds_read_b64_tr_b16 a[160:161], v228 offset:24576
    ds_read_b64_tr_b16 a[162:163], v228 offset:28672
    v_mfma_f32_16x16x32_bf16 a[32:35], a[164:167], v[132:135], a[32:35]
    buffer_load_dwordx4 v208, s[24:27], s41 offen offset:0 lds
    v_mfma_f32_16x16x32_bf16 a[36:39], a[164:167], v[136:139], a[36:39]
    ds_read_b64_tr_b16 a[164:165], v229 offset:24576
    ds_read_b64_tr_b16 a[166:167], v229 offset:28672
    v_mfma_f32_16x16x32_bf16 a[40:43], a[168:171], v[120:123], a[40:43]
    v_mfma_f32_16x16x32_bf16 a[44:47], a[168:171], v[124:127], a[44:47]
    v_mfma_f32_16x16x32_bf16 a[48:51], a[168:171], v[128:131], a[48:51]
    buffer_load_dwordx4 v209, s[24:27], s41 offen offset:1024 lds
    v_mfma_f32_16x16x32_bf16 a[52:55], a[168:171], v[132:135], a[52:55]
    v_mfma_f32_16x16x32_bf16 a[56:59], a[168:171], v[136:139], a[56:59]
    ds_read_b64_tr_b16 a[168:169], v230 offset:24576
    ds_read_b64_tr_b16 a[170:171], v230 offset:28672
    v_mfma_f32_16x16x32_bf16 a[60:63], a[172:175], v[120:123], a[60:63]
    v_mfma_f32_16x16x32_bf16 a[64:67], a[172:175], v[124:127], a[64:67]
    v_mfma_f32_16x16x32_bf16 a[68:71], a[172:175], v[128:131], a[68:71]
    buffer_load_dwordx4 v[28:31], v238, s[20:23], s47 offen offset:2048 sc1
    v_mfma_f32_16x16x32_bf16 a[72:75], a[172:175], v[132:135], a[72:75]
    v_mfma_f32_16x16x32_bf16 a[76:79], a[172:175], v[136:139], a[76:79]
    ds_read_b64_tr_b16 a[172:173], v231 offset:24576
    ds_read_b64_tr_b16 a[174:175], v231 offset:28672
    v_mfma_f32_16x16x32_bf16 a[80:83], a[176:179], v[120:123], a[80:83]
    v_mfma_f32_16x16x32_bf16 a[84:87], a[176:179], v[124:127], a[84:87]
    v_mfma_f32_16x16x32_bf16 a[88:91], a[176:179], v[128:131], a[88:91]
    buffer_load_dwordx4 v210, s[24:27], s41 offen offset:2048 lds
    v_mfma_f32_16x16x32_bf16 a[92:95], a[176:179], v[132:135], a[92:95]
    v_mfma_f32_16x16x32_bf16 a[96:99], a[176:179], v[136:139], a[96:99]
    v_mfma_f32_16x16x32_bf16 a[100:103], a[180:183], v[120:123], a[100:103]
    ds_read_b64_tr_b16 a[176:177], v232 offset:24576
    ds_read_b64_tr_b16 a[178:179], v232 offset:28672
    v_mfma_f32_16x16x32_bf16 a[104:107], a[180:183], v[124:127], a[104:107]
    v_mfma_f32_16x16x32_bf16 a[108:111], a[180:183], v[128:131], a[108:111]
    buffer_load_dwordx4 v[32:35], v238, s[20:23], s47 offen offset:3072 sc1
    v_mfma_f32_16x16x32_bf16 a[112:115], a[180:183], v[132:135], a[112:115]
    v_mfma_f32_16x16x32_bf16 a[116:119], a[180:183], v[136:139], a[116:119]
    ds_read_b64_tr_b16 a[180:181], v233 offset:24576
    ds_read_b64_tr_b16 a[182:183], v233 offset:28672
    v_mfma_f32_16x16x32_bf16 a[120:123], a[184:187], v[120:123], a[120:123]
    v_mfma_f32_16x16x32_bf16 a[124:127], a[184:187], v[124:127], a[124:127]
    v_mfma_f32_16x16x32_bf16 a[128:131], a[184:187], v[128:131], a[128:131]
    buffer_load_dwordx4 v211, s[24:27], s41 offen offset:3072 lds
    v_mfma_f32_16x16x32_bf16 a[132:135], a[184:187], v[132:135], a[132:135]
    v_mfma_f32_16x16x32_bf16 a[136:139], a[184:187], v[136:139], a[136:139]
    v_mfma_f32_16x16x32_bf16 a[140:143], a[188:191], v[120:123], a[140:143]
    ds_read_b64_tr_b16 a[184:185], v234 offset:24576
    ds_read_b64_tr_b16 a[186:187], v234 offset:28672
    v_mfma_f32_16x16x32_bf16 a[144:147], a[188:191], v[124:127], a[144:147]
    v_mfma_f32_16x16x32_bf16 a[148:151], a[188:191], v[128:131], a[148:151]
    buffer_load_dwordx4 v[36:39], v239, s[20:23], s47 offen offset:0 sc1
    v_mfma_f32_16x16x32_bf16 a[152:155], a[188:191], v[132:135], a[152:155]
    s_add_u32 s47, s61, 143360
    v_mfma_f32_16x16x32_bf16 a[156:159], a[188:191], v[136:139], a[156:159]
    ds_read_b64_tr_b16 a[188:189], v235 offset:24576
    ds_read_b64_tr_b16 a[190:191], v235 offset:28672
    s_waitcnt lgkmcnt(4)
    s_waitcnt vmcnt(25)
    v_mfma_f32_16x16x32_bf16 a[0:3], a[160:163], v[140:143], a[0:3]
    buffer_load_dwordx4 v[40:43], v238, s[20:23], s47 offen offset:0 sc1
    v_mfma_f32_16x16x32_bf16 a[4:7], a[160:163], v[144:147], a[4:7]
    v_mfma_f32_16x16x32_bf16 a[8:11], a[160:163], v[148:151], a[8:11]
    v_mfma_f32_16x16x32_bf16 a[12:15], a[160:163], v[152:155], a[12:15]
    s_add_u32 s41, s60, 737280
    v_mfma_f32_16x16x32_bf16 a[16:19], a[160:163], v[156:159], a[16:19]
    buffer_load_dwordx4 v[44:47], v238, s[20:23], s47 offen offset:1024 sc1
    v_mfma_f32_16x16x32_bf16 a[20:23], a[164:167], v[140:143], a[20:23]
    s_add_u32 m0, s35, 16384
    v_mfma_f32_16x16x32_bf16 a[24:27], a[164:167], v[144:147], a[24:27]
    s_waitcnt lgkmcnt(0)
    v_mfma_f32_16x16x32_bf16 a[28:31], a[164:167], v[148:151], a[28:31]
    ds_read_b64_tr_b16 a[160:161], v224 offset:24576
    ds_read_b64_tr_b16 a[162:163], v224 offset:28672
    v_mfma_f32_16x16x32_bf16 a[32:35], a[164:167], v[152:155], a[32:35]
    buffer_load_dwordx4 v208, s[24:27], s41 offen offset:0 lds
    v_mfma_f32_16x16x32_bf16 a[36:39], a[164:167], v[156:159], a[36:39]
    ds_read_b64_tr_b16 a[164:165], v225 offset:24576
    ds_read_b64_tr_b16 a[166:167], v225 offset:28672
    v_mfma_f32_16x16x32_bf16 a[40:43], a[168:171], v[140:143], a[40:43]
    v_mfma_f32_16x16x32_bf16 a[44:47], a[168:171], v[144:147], a[44:47]
    v_mfma_f32_16x16x32_bf16 a[48:51], a[168:171], v[148:151], a[48:51]
    buffer_load_dwordx4 v209, s[24:27], s41 offen offset:1024 lds
    v_mfma_f32_16x16x32_bf16 a[52:55], a[168:171], v[152:155], a[52:55]
    v_mfma_f32_16x16x32_bf16 a[56:59], a[168:171], v[156:159], a[56:59]
    ds_read_b64_tr_b16 a[168:169], v226 offset:24576
    ds_read_b64_tr_b16 a[170:171], v226 offset:28672
    v_mfma_f32_16x16x32_bf16 a[60:63], a[172:175], v[140:143], a[60:63]
    v_mfma_f32_16x16x32_bf16 a[64:67], a[172:175], v[144:147], a[64:67]
    v_mfma_f32_16x16x32_bf16 a[68:71], a[172:175], v[148:151], a[68:71]
    buffer_load_dwordx4 v[48:51], v238, s[20:23], s47 offen offset:2048 sc1
    v_mfma_f32_16x16x32_bf16 a[72:75], a[172:175], v[152:155], a[72:75]
    v_mfma_f32_16x16x32_bf16 a[76:79], a[172:175], v[156:159], a[76:79]
    ds_read_b64_tr_b16 a[172:173], v227 offset:24576
    ds_read_b64_tr_b16 a[174:175], v227 offset:28672
    v_mfma_f32_16x16x32_bf16 a[80:83], a[176:179], v[140:143], a[80:83]
    v_mfma_f32_16x16x32_bf16 a[84:87], a[176:179], v[144:147], a[84:87]
    v_mfma_f32_16x16x32_bf16 a[88:91], a[176:179], v[148:151], a[88:91]
    buffer_load_dwordx4 v210, s[24:27], s41 offen offset:2048 lds
    v_mfma_f32_16x16x32_bf16 a[92:95], a[176:179], v[152:155], a[92:95]
    v_mfma_f32_16x16x32_bf16 a[96:99], a[176:179], v[156:159], a[96:99]
    v_mfma_f32_16x16x32_bf16 a[100:103], a[180:183], v[140:143], a[100:103]
    ds_read_b64_tr_b16 a[176:177], v241 offset:24576
    ds_read_b64_tr_b16 a[178:179], v241 offset:28672
    v_mfma_f32_16x16x32_bf16 a[104:107], a[180:183], v[144:147], a[104:107]
    v_mfma_f32_16x16x32_bf16 a[108:111], a[180:183], v[148:151], a[108:111]
    buffer_load_dwordx4 v[52:55], v238, s[20:23], s47 offen offset:3072 sc1
    v_mfma_f32_16x16x32_bf16 a[112:115], a[180:183], v[152:155], a[112:115]
    v_mfma_f32_16x16x32_bf16 a[116:119], a[180:183], v[156:159], a[116:119]
    ds_read_b64_tr_b16 a[180:181], v242 offset:24576
    ds_read_b64_tr_b16 a[182:183], v242 offset:28672
    v_mfma_f32_16x16x32_bf16 a[120:123], a[184:187], v[140:143], a[120:123]
    v_mfma_f32_16x16x32_bf16 a[124:127], a[184:187], v[144:147], a[124:127]
    v_mfma_f32_16x16x32_bf16 a[128:131], a[184:187], v[148:151], a[128:131]
    buffer_load_dwordx4 v211, s[24:27], s41 offen offset:3072 lds
    v_mfma_f32_16x16x32_bf16 a[132:135], a[184:187], v[152:155], a[132:135]
    v_mfma_f32_16x16x32_bf16 a[136:139], a[184:187], v[156:159], a[136:139]
    v_mfma_f32_16x16x32_bf16 a[140:143], a[188:191], v[140:143], a[140:143]
    ds_read_b64_tr_b16 a[184:185], v243 offset:24576
    ds_read_b64_tr_b16 a[186:187], v243 offset:28672
    v_mfma_f32_16x16x32_bf16 a[144:147], a[188:191], v[144:147], a[144:147]
    v_mfma_f32_16x16x32_bf16 a[148:151], a[188:191], v[148:151], a[148:151]
    buffer_load_dwordx4 v[56:59], v239, s[20:23], s47 offen offset:0 sc1
    v_mfma_f32_16x16x32_bf16 a[152:155], a[188:191], v[152:155], a[152:155]
    s_add_u32 s47, s61, 157696
    v_mfma_f32_16x16x32_bf16 a[156:159], a[188:191], v[156:159], a[156:159]
    ds_read_b64_tr_b16 a[188:189], v244 offset:24576
    ds_read_b64_tr_b16 a[190:191], v244 offset:28672
    s_waitcnt lgkmcnt(4)
    s_waitcnt vmcnt(27)
    v_mfma_f32_16x16x32_bf16 a[0:3], a[160:163], v[160:163], a[0:3]
    buffer_load_dwordx4 v[60:63], v238, s[20:23], s47 offen offset:0 sc1
    v_mfma_f32_16x16x32_bf16 a[4:7], a[160:163], v[164:167], a[4:7]
    v_mfma_f32_16x16x32_bf16 a[8:11], a[160:163], v[168:171], a[8:11]
    v_mfma_f32_16x16x32_bf16 a[12:15], a[160:163], v[172:175], a[12:15]
    s_add_u32 s41, s60, 778240
    v_mfma_f32_16x16x32_bf16 a[16:19], a[160:163], v[176:179], a[16:19]
    buffer_load_dwordx4 v[64:67], v238, s[20:23], s47 offen offset:1024 sc1
    v_mfma_f32_16x16x32_bf16 a[20:23], a[164:167], v[160:163], a[20:23]
    s_add_u32 m0, s35, 57344
    v_mfma_f32_16x16x32_bf16 a[24:27], a[164:167], v[164:167], a[24:27]
    s_waitcnt lgkmcnt(0)
    v_mfma_f32_16x16x32_bf16 a[28:31], a[164:167], v[168:171], a[28:31]
    ds_read_b64_tr_b16 a[160:161], v228 offset:32768
    ds_read_b64_tr_b16 a[162:163], v228 offset:36864
    v_mfma_f32_16x16x32_bf16 a[32:35], a[164:167], v[172:175], a[32:35]
    buffer_load_dwordx4 v208, s[24:27], s41 offen offset:0 lds
    v_mfma_f32_16x16x32_bf16 a[36:39], a[164:167], v[176:179], a[36:39]
    ds_read_b64_tr_b16 a[164:165], v229 offset:32768
    ds_read_b64_tr_b16 a[166:167], v229 offset:36864
    v_mfma_f32_16x16x32_bf16 a[40:43], a[168:171], v[160:163], a[40:43]
    v_mfma_f32_16x16x32_bf16 a[44:47], a[168:171], v[164:167], a[44:47]
    v_mfma_f32_16x16x32_bf16 a[48:51], a[168:171], v[168:171], a[48:51]
    buffer_load_dwordx4 v209, s[24:27], s41 offen offset:1024 lds
    v_mfma_f32_16x16x32_bf16 a[52:55], a[168:171], v[172:175], a[52:55]
    v_mfma_f32_16x16x32_bf16 a[56:59], a[168:171], v[176:179], a[56:59]
    ds_read_b64_tr_b16 a[168:169], v230 offset:32768
Lpg16:
    s_cbranch_execz Lpg17
    ds_read_b64_tr_b16 a[170:171], v230 offset:36864
    v_mfma_f32_16x16x32_bf16 a[60:63], a[172:175], v[160:163], a[60:63]
    v_mfma_f32_16x16x32_bf16 a[64:67], a[172:175], v[164:167], a[64:67]
    v_mfma_f32_16x16x32_bf16 a[68:71], a[172:175], v[168:171], a[68:71]
    buffer_load_dwordx4 v[68:71], v238, s[20:23], s47 offen offset:2048 sc1
    v_mfma_f32_16x16x32_bf16 a[72:75], a[172:175], v[172:175], a[72:75]
    v_mfma_f32_16x16x32_bf16 a[76:79], a[172:175], v[176:179], a[76:79]
    ds_read_b64_tr_b16 a[172:173], v231 offset:32768
    ds_read_b64_tr_b16 a[174:175], v231 offset:36864
    v_mfma_f32_16x16x32_bf16 a[80:83], a[176:179], v[160:163], a[80:83]
    v_mfma_f32_16x16x32_bf16 a[84:87], a[176:179], v[164:167], a[84:87]
    v_mfma_f32_16x16x32_bf16 a[88:91], a[176:179], v[168:171], a[88:91]
    buffer_load_dwordx4 v210, s[24:27], s41 offen offset:2048 lds
    v_mfma_f32_16x16x32_bf16 a[92:95], a[176:179], v[172:175], a[92:95]
    v_mfma_f32_16x16x32_bf16 a[96:99], a[176:179], v[176:179], a[96:99]
    v_mfma_f32_16x16x32_bf16 a[100:103], a[180:183], v[160:163], a[100:103]
    ds_read_b64_tr_b16 a[176:177], v232 offset:32768
    ds_read_b64_tr_b16 a[178:179], v232 offset:36864
    v_mfma_f32_16x16x32_bf16 a[104:107], a[180:183], v[164:167], a[104:107]
    v_mfma_f32_16x16x32_bf16 a[108:111], a[180:183], v[168:171], a[108:111]
    buffer_load_dwordx4 v[72:75], v238, s[20:23], s47 offen offset:3072 sc1
    v_mfma_f32_16x16x32_bf16 a[112:115], a[180:183], v[172:175], a[112:115]
    v_mfma_f32_16x16x32_bf16 a[116:119], a[180:183], v[176:179], a[116:119]
    ds_read_b64_tr_b16 a[180:181], v233 offset:32768
    ds_read_b64_tr_b16 a[182:183], v233 offset:36864
    v_mfma_f32_16x16x32_bf16 a[120:123], a[184:187], v[160:163], a[120:123]
    v_mfma_f32_16x16x32_bf16 a[124:127], a[184:187], v[164:167], a[124:127]
    v_mfma_f32_16x16x32_bf16 a[128:131], a[184:187], v[168:171], a[128:131]
    buffer_load_dwordx4 v211, s[24:27], s41 offen offset:3072 lds
    v_mfma_f32_16x16x32_bf16 a[132:135], a[184:187], v[172:175], a[132:135]
    v_mfma_f32_16x16x32_bf16 a[136:139], a[184:187], v[176:179], a[136:139]
    v_mfma_f32_16x16x32_bf16 a[140:143], a[188:191], v[160:163], a[140:143]
    ds_read_b64_tr_b16 a[184:185], v234 offset:32768
    ds_read_b64_tr_b16 a[186:187], v234 offset:36864
    v_mfma_f32_16x16x32_bf16 a[144:147], a[188:191], v[164:167], a[144:147]
    v_mfma_f32_16x16x32_bf16 a[148:151], a[188:191], v[168:171], a[148:151]
    buffer_load_dwordx4 v[76:79], v239, s[20:23], s47 offen offset:0 sc1
    v_mfma_f32_16x16x32_bf16 a[152:155], a[188:191], v[172:175], a[152:155]
    s_add_u32 s47, s61, 200704
    v_mfma_f32_16x16x32_bf16 a[156:159], a[188:191], v[176:179], a[156:159]
    ds_read_b64_tr_b16 a[188:189], v235 offset:32768
    ds_read_b64_tr_b16 a[190:191], v235 offset:36864
    s_waitcnt lgkmcnt(4)
    s_waitcnt vmcnt(27)
    v_mfma_f32_16x16x32_bf16 a[0:3], a[160:163], v[0:3], a[0:3]
    buffer_load_dwordx4 v[80:83], v238, s[20:23], s47 offen offset:0 sc1
    v_mfma_f32_16x16x32_bf16 a[4:7], a[160:163], v[4:7], a[4:7]
    v_mfma_f32_16x16x32_bf16 a[8:11], a[160:163], v[8:11], a[8:11]
    v_mfma_f32_16x16x32_bf16 a[12:15], a[160:163], v[12:15], a[12:15]
    s_add_u32 s41, s60, 901120
    v_mfma_f32_16x16x32_bf16 a[16:19], a[160:163], v[16:19], a[16:19]
    buffer_load_dwordx4 v[84:87], v238, s[20:23], s47 offen offset:1024 sc1
    v_mfma_f32_16x16x32_bf16 a[20:23], a[164:167], v[0:3], a[20:23]
    s_add_u32 m0, s35, 24576
    v_mfma_f32_16x16x32_bf16 a[24:27], a[164:167], v[4:7], a[24:27]
    s_waitcnt vmcnt(39) lgkmcnt(0)
    s_barrier
    v_mfma_f32_16x16x32_bf16 a[28:31], a[164:167], v[8:11], a[28:31]
    ds_read_b64_tr_b16 a[160:161], v224 offset:32768
    ds_read_b64_tr_b16 a[162:163], v224 offset:36864
    v_mfma_f32_16x16x32_bf16 a[32:35], a[164:167], v[12:15], a[32:35]
    buffer_load_dwordx4 v208, s[24:27], s41 offen offset:0 lds
    v_mfma_f32_16x16x32_bf16 a[36:39], a[164:167], v[16:19], a[36:39]
    ds_read_b64_tr_b16 a[164:165], v225 offset:32768
    ds_read_b64_tr_b16 a[166:167], v225 offset:36864
    v_mfma_f32_16x16x32_bf16 a[40:43], a[168:171], v[0:3], a[40:43]
    v_mfma_f32_16x16x32_bf16 a[44:47], a[168:171], v[4:7], a[44:47]
    v_mfma_f32_16x16x32_bf16 a[48:51], a[168:171], v[8:11], a[48:51]
    buffer_load_dwordx4 v209, s[24:27], s41 offen offset:1024 lds
    v_mfma_f32_16x16x32_bf16 a[52:55], a[168:171], v[12:15], a[52:55]
    v_mfma_f32_16x16x32_bf16 a[56:59], a[168:171], v[16:19], a[56:59]
    ds_read_b64_tr_b16 a[168:169], v226 offset:32768
    ds_read_b64_tr_b16 a[170:171], v226 offset:36864
    v_mfma_f32_16x16x32_bf16 a[60:63], a[172:175], v[0:3], a[60:63]
    v_mfma_f32_16x16x32_bf16 a[64:67], a[172:175], v[4:7], a[64:67]
    v_mfma_f32_16x16x32_bf16 a[68:71], a[172:175], v[8:11], a[68:71]
    buffer_load_dwordx4 v[88:91], v238, s[20:23], s47 offen offset:2048 sc1
    v_mfma_f32_16x16x32_bf16 a[72:75], a[172:175], v[12:15], a[72:75]
    v_mfma_f32_16x16x32_bf16 a[76:79], a[172:175], v[16:19], a[76:79]
    ds_read_b64_tr_b16 a[172:173], v227 offset:32768
    ds_read_b64_tr_b16 a[174:175], v227 offset:36864
    v_mfma_f32_16x16x32_bf16 a[80:83], a[176:179], v[0:3], a[80:83]
    v_mfma_f32_16x16x32_bf16 a[84:87], a[176:179], v[4:7], a[84:87]
    v_mfma_f32_16x16x32_bf16 a[88:91], a[176:179], v[8:11], a[88:91]
    buffer_load_dwordx4 v210, s[24:27], s41 offen offset:2048 lds
    v_mfma_f32_16x16x32_bf16 a[92:95], a[176:179], v[12:15], a[92:95]
    v_mfma_f32_16x16x32_bf16 a[96:99], a[176:179], v[16:19], a[96:99]
    v_mfma_f32_16x16x32_bf16 a[100:103], a[180:183], v[0:3], a[100:103]
    ds_read_b64_tr_b16 a[176:177], v241 offset:32768
    ds_read_b64_tr_b16 a[178:179], v241 offset:36864
    v_mfma_f32_16x16x32_bf16 a[104:107], a[180:183], v[4:7], a[104:107]
    v_mfma_f32_16x16x32_bf16 a[108:111], a[180:183], v[8:11], a[108:111]
    buffer_load_dwordx4 v[92:95], v238, s[20:23], s47 offen offset:3072 sc1
    v_mfma_f32_16x16x32_bf16 a[112:115], a[180:183], v[12:15], a[112:115]
    v_mfma_f32_16x16x32_bf16 a[116:119], a[180:183], v[16:19], a[116:119]
    ds_read_b64_tr_b16 a[180:181], v242 offset:32768
    ds_read_b64_tr_b16 a[182:183], v242 offset:36864
    v_mfma_f32_16x16x32_bf16 a[120:123], a[184:187], v[0:3], a[120:123]
    v_mfma_f32_16x16x32_bf16 a[124:127], a[184:187], v[4:7], a[124:127]
    v_mfma_f32_16x16x32_bf16 a[128:131], a[184:187], v[8:11], a[128:131]
    buffer_load_dwordx4 v211, s[24:27], s41 offen offset:3072 lds
    v_mfma_f32_16x16x32_bf16 a[132:135], a[184:187], v[12:15], a[132:135]
    v_mfma_f32_16x16x32_bf16 a[136:139], a[184:187], v[16:19], a[136:139]
    v_mfma_f32_16x16x32_bf16 a[140:143], a[188:191], v[0:3], a[140:143]
    ds_read_b64_tr_b16 a[184:185], v243 offset:32768
    ds_read_b64_tr_b16 a[186:187], v243 offset:36864
    v_mfma_f32_16x16x32_bf16 a[144:147], a[188:191], v[4:7], a[144:147]
    v_mfma_f32_16x16x32_bf16 a[148:151], a[188:191], v[8:11], a[148:151]
    buffer_load_dwordx4 v[96:99], v239, s[20:23], s47 offen offset:0 sc1
    v_mfma_f32_16x16x32_bf16 a[152:155], a[188:191], v[12:15], a[152:155]
    s_add_u32 s47, s61, 215040
    v_mfma_f32_16x16x32_bf16 a[156:159], a[188:191], v[16:19], a[156:159]
    ds_read_b64_tr_b16 a[188:189], v244 offset:32768
    ds_read_b64_tr_b16 a[190:191], v244 offset:36864
    s_waitcnt lgkmcnt(4)
    s_waitcnt vmcnt(27)
    v_mfma_f32_16x16x32_bf16 a[0:3], a[160:163], v[20:23], a[0:3]
    buffer_load_dwordx4 v[100:103], v238, s[20:23], s47 offen offset:0 sc1
    v_mfma_f32_16x16x32_bf16 a[4:7], a[160:163], v[24:27], a[4:7]
    v_mfma_f32_16x16x32_bf16 a[8:11], a[160:163], v[28:31], a[8:11]
    v_mfma_f32_16x16x32_bf16 a[12:15], a[160:163], v[32:35], a[12:15]
    s_add_u32 s41, s60, 942080
    v_mfma_f32_16x16x32_bf16 a[16:19], a[160:163], v[36:39], a[16:19]
    buffer_load_dwordx4 v[104:107], v238, s[20:23], s47 offen offset:1024 sc1
    v_mfma_f32_16x16x32_bf16 a[20:23], a[164:167], v[20:23], a[20:23]
    s_add_u32 m0, s35, 65536
    v_mfma_f32_16x16x32_bf16 a[24:27], a[164:167], v[24:27], a[24:27]
    s_waitcnt lgkmcnt(0)
    v_mfma_f32_16x16x32_bf16 a[28:31], a[164:167], v[28:31], a[28:31]
    ds_read_b64_tr_b16 a[160:161], v228 offset:0
    ds_read_b64_tr_b16 a[162:163], v228 offset:4096
    v_mfma_f32_16x16x32_bf16 a[32:35], a[164:167], v[32:35], a[32:35]
    buffer_load_dwordx4 v208, s[24:27], s41 offen offset:0 lds
    v_mfma_f32_16x16x32_bf16 a[36:39], a[164:167], v[36:39], a[36:39]
    ds_read_b64_tr_b16 a[164:165], v229 offset:0
    ds_read_b64_tr_b16 a[166:167], v229 offset:4096
    v_mfma_f32_16x16x32_bf16 a[40:43], a[168:171], v[20:23], a[40:43]
    v_mfma_f32_16x16x32_bf16 a[44:47], a[168:171], v[24:27], a[44:47]
    v_mfma_f32_16x16x32_bf16 a[48:51], a[168:171], v[28:31], a[48:51]
    buffer_load_dwordx4 v209, s[24:27], s41 offen offset:1024 lds
    v_mfma_f32_16x16x32_bf16 a[52:55], a[168:171], v[32:35], a[52:55]
    v_mfma_f32_16x16x32_bf16 a[56:59], a[168:171], v[36:39], a[56:59]
    ds_read_b64_tr_b16 a[168:169], v230 offset:0
    ds_read_b64_tr_b16 a[170:171], v230 offset:4096
    v_mfma_f32_16x16x32_bf16 a[60:63], a[172:175], v[20:23], a[60:63]
    v_mfma_f32_16x16x32_bf16 a[64:67], a[172:175], v[24:27], a[64:67]
    v_mfma_f32_16x16x32_bf16 a[68:71], a[172:175], v[28:31], a[68:71]
    buffer_load_dwordx4 v[108:111], v238, s[20:23], s47 offen offset:2048 sc1
    v_mfma_f32_16x16x32_bf16 a[72:75], a[172:175], v[32:35], a[72:75]
    v_mfma_f32_16x16x32_bf16 a[76:79], a[172:175], v[36:39], a[76:79]
    ds_read_b64_tr_b16 a[172:173], v231 offset:0
    ds_read_b64_tr_b16 a[174:175], v231 offset:4096
    v_mfma_f32_16x16x32_bf16 a[80:83], a[176:179], v[20:23], a[80:83]
    v_mfma_f32_16x16x32_bf16 a[84:87], a[176:179], v[24:27], a[84:87]
    v_mfma_f32_16x16x32_bf16 a[88:91], a[176:179], v[28:31], a[88:91]
    buffer_load_dwordx4 v210, s[24:27], s41 offen offset:2048 lds
    v_mfma_f32_16x16x32_bf16 a[92:95], a[176:179], v[32:35], a[92:95]
    v_mfma_f32_16x16x32_bf16 a[96:99], a[176:179], v[36:39], a[96:99]
    v_mfma_f32_16x16x32_bf16 a[100:103], a[180:183], v[20:23], a[100:103]
    ds_read_b64_tr_b16 a[176:177], v232 offset:0
    ds_read_b64_tr_b16 a[178:179], v232 offset:4096
    v_mfma_f32_16x16x32_bf16 a[104:107], a[180:183], v[24:27], a[104:107]
    v_mfma_f32_16x16x32_bf16 a[108:111], a[180:183], v[28:31], a[108:111]
    buffer_load_dwordx4 v[112:115], v238, s[20:23], s47 offen offset:3072 sc1
    v_mfma_f32_16x16x32_bf16 a[112:115], a[180:183], v[32:35], a[112:115]
    v_mfma_f32_16x16x32_bf16 a[116:119], a[180:183], v[36:39], a[116:119]
    ds_read_b64_tr_b16 a[180:181], v233 offset:0
    ds_read_b64_tr_b16 a[182:183], v233 offset:4096
    v_mfma_f32_16x16x32_bf16 a[120:123], a[184:187], v[20:23], a[120:123]
    v_mfma_f32_16x16x32_bf16 a[124:127], a[184:187], v[24:27], a[124:127]
    v_mfma_f32_16x16x32_bf16 a[128:131], a[184:187], v[28:31], a[128:131]
    buffer_load_dwordx4 v211, s[24:27], s41 offen offset:3072 lds
    v_mfma_f32_16x16x32_bf16 a[132:135], a[184:187], v[32:35], a[132:135]
    v_mfma_f32_16x16x32_bf16 a[136:139], a[184:187], v[36:39], a[136:139]
    v_mfma_f32_16x16x32_bf16 a[140:143], a[188:191], v[20:23], a[140:143]
    ds_read_b64_tr_b16 a[184:185], v234 offset:0
    ds_read_b64_tr_b16 a[186:187], v234 offset:4096
    v_mfma_f32_16x16x32_bf16 a[144:147], a[188:191], v[24:27], a[144:147]
    v_mfma_f32_16x16x32_bf16 a[148:151], a[188:191], v[28:31], a[148:151]
    buffer_load_dwordx4 v[116:119], v239, s[20:23], s47 offen offset:0 sc1
    v_mfma_f32_16x16x32_bf16 a[152:155], a[188:191], v[32:35], a[152:155]
    s_add_u32 s47, s61, 258048
    v_mfma_f32_16x16x32_bf16 a[156:159], a[188:191], v[36:39], a[156:159]
    ds_read_b64_tr_b16 a[188:189], v235 offset:0
    ds_read_b64_tr_b16 a[190:191], v235 offset:4096
    s_waitcnt lgkmcnt(4)
    s_waitcnt vmcnt(27)
    v_mfma_f32_16x16x32_bf16 a[0:3], a[160:163], v[40:43], a[0:3]
    buffer_load_dwordx4 v[120:123], v238, s[20:23], s47 offen offset:0 sc1
    v_mfma_f32_16x16x32_bf16 a[4:7], a[160:163], v[44:47], a[4:7]
    v_mfma_f32_16x16x32_bf16 a[8:11], a[160:163], v[48:51], a[8:11]
    v_mfma_f32_16x16x32_bf16 a[12:15], a[160:163], v[52:55], a[12:15]
    s_add_u32 s41, s60, 1064960
    v_mfma_f32_16x16x32_bf16 a[16:19], a[160:163], v[56:59], a[16:19]
    buffer_load_dwordx4 v[124:127], v238, s[20:23], s47 offen offset:1024 sc1
    v_mfma_f32_16x16x32_bf16 a[20:23], a[164:167], v[40:43], a[20:23]
    s_add_u32 m0, s35, 32768
    v_mfma_f32_16x16x32_bf16 a[24:27], a[164:167], v[44:47], a[24:27]
    s_waitcnt lgkmcnt(0)
    v_mfma_f32_16x16x32_bf16 a[28:31], a[164:167], v[48:51], a[28:31]
    ds_read_b64_tr_b16 a[160:161], v224 offset:0
    ds_read_b64_tr_b16 a[162:163], v224 offset:4096
    v_mfma_f32_16x16x32_bf16 a[32:35], a[164:167], v[52:55], a[32:35]
    buffer_load_dwordx4 v208, s[24:27], s41 offen offset:0 lds
    v_mfma_f32_16x16x32_bf16 a[36:39], a[164:167], v[56:59], a[36:39]
    ds_read_b64_tr_b16 a[164:165], v225 offset:0
    ds_read_b64_tr_b16 a[166:167], v225 offset:4096
    v_mfma_f32_16x16x32_bf16 a[40:43], a[168:171], v[40:43], a[40:43]
    v_mfma_f32_16x16x32_bf16 a[44:47], a[168:171], v[44:47], a[44:47]
    v_mfma_f32_16x16x32_bf16 a[48:51], a[168:171], v[48:51], a[48:51]
    buffer_load_dwordx4 v209, s[24:27], s41 offen offset:1024 lds
    v_mfma_f32_16x16x32_bf16 a[52:55], a[168:171], v[52:55], a[52:55]
    v_mfma_f32_16x16x32_bf16 a[56:59], a[168:171], v[56:59], a[56:59]
    ds_read_b64_tr_b16 a[168:169], v226 offset:0
    ds_read_b64_tr_b16 a[170:171], v226 offset:4096
    v_mfma_f32_16x16x32_bf16 a[60:63], a[172:175], v[40:43], a[60:63]
    v_mfma_f32_16x16x32_bf16 a[64:67], a[172:175], v[44:47], a[64:67]
    v_mfma_f32_16x16x32_bf16 a[68:71], a[172:175], v[48:51], a[68:71]
    buffer_load_dwordx4 v[128:131], v238, s[20:23], s47 offen offset:2048 sc1
    v_mfma_f32_16x16x32_bf16 a[72:75], a[172:175], v[52:55], a[72:75]
    v_mfma_f32_16x16x32_bf16 a[76:79], a[172:175], v[56:59], a[76:79]
    ds_read_b64_tr_b16 a[172:173], v227 offset:0
    ds_read_b64_tr_b16 a[174:175], v227 offset:4096
    v_mfma_f32_16x16x32_bf16 a[80:83], a[176:179], v[40:43], a[80:83]
    v_mfma_f32_16x16x32_bf16 a[84:87], a[176:179], v[44:47], a[84:87]
    v_mfma_f32_16x16x32_bf16 a[88:91], a[176:179], v[48:51], a[88:91]
    buffer_load_dwordx4 v210, s[24:27], s41 offen offset:2048 lds
    v_mfma_f32_16x16x32_bf16 a[92:95], a[176:179], v[52:55], a[92:95]
    v_mfma_f32_16x16x32_bf16 a[96:99], a[176:179], v[56:59], a[96:99]
    v_mfma_f32_16x16x32_bf16 a[100:103], a[180:183], v[40:43], a[100:103]
    ds_read_b64_tr_b16 a[176:177], v241 offset:0
    ds_read_b64_tr_b16 a[178:179], v241 offset:4096
    v_mfma_f32_16x16x32_bf16 a[104:107], a[180:183], v[44:47], a[104:107]
    v_mfma_f32_16x16x32_bf16 a[108:111], a[180:183], v[48:51], a[108:111]
    buffer_load_dwordx4 v[132:135], v238, s[20:23], s47 offen offset:3072 sc1
    v_mfma_f32_16x16x32_bf16 a[112:115], a[180:183], v[52:55], a[112:115]
    v_mfma_f32_16x16x32_bf16 a[116:119], a[180:183], v[56:59], a[116:119]
    ds_read_b64_tr_b16 a[180:181], v242 offset:0
    ds_read_b64_tr_b16 a[182:183], v242 offset:4096
    v_mfma_f32_16x16x32_bf16 a[120:123], a[184:187], v[40:43], a[120:123]
    v_mfma_f32_16x16x32_bf16 a[124:127], a[184:187], v[44:47], a[124:127]
    v_mfma_f32_16x16x32_bf16 a[128:131], a[184:187], v[48:51], a[128:131]
    buffer_load_dwordx4 v211, s[24:27], s41 offen offset:3072 lds
    v_mfma_f32_16x16x32_bf16 a[132:135], a[184:187], v[52:55], a[132:135]
    v_mfma_f32_16x16x32_bf16 a[136:139], a[184:187], v[56:59], a[136:139]
    v_mfma_f32_16x16x32_bf16 a[140:143], a[188:191], v[40:43], a[140:143]
    ds_read_b64_tr_b16 a[184:185], v243 offset:0
    ds_read_b64_tr_b16 a[186:187], v243 offset:4096
    v_mfma_f32_16x16x32_bf16 a[144:147], a[188:191], v[44:47], a[144:147]
    v_mfma_f32_16x16x32_bf16 a[148:151], a[188:191], v[48:51], a[148:151]
    buffer_load_dwordx4 v[136:139], v239, s[20:23], s47 offen offset:0 sc1
    v_mfma_f32_16x16x32_bf16 a[152:155], a[188:191], v[52:55], a[152:155]
    s_add_u32 s47, s61, 272384
    v_mfma_f32_16x16x32_bf16 a[156:159], a[188:191], v[56:59], a[156:159]
    ds_read_b64_tr_b16 a[188:189], v244 offset:0
    ds_read_b64_tr_b16 a[190:191], v244 offset:4096
    s_waitcnt lgkmcnt(4)
    s_waitcnt vmcnt(27)
    v_mfma_f32_16x16x32_bf16 a[0:3], a[160:163], v[60:63], a[0:3]
    buffer_load_dwordx4 v[140:143], v238, s[20:23], s47 offen offset:0 sc1
    v_mfma_f32_16x16x32_bf16 a[4:7], a[160:163], v[64:67], a[4:7]
    v_mfma_f32_16x16x32_bf16 a[8:11], a[160:163], v[68:71], a[8:11]
    v_mfma_f32_16x16x32_bf16 a[12:15], a[160:163], v[72:75], a[12:15]
    s_add_u32 s41, s60, 1105920
    v_mfma_f32_16x16x32_bf16 a[16:19], a[160:163], v[76:79], a[16:19]
    buffer_load_dwordx4 v[144:147], v238, s[20:23], s47 offen offset:1024 sc1
    v_mfma_f32_16x16x32_bf16 a[20:23], a[164:167], v[60:63], a[20:23]
    s_add_u32 m0, s35, 73728
    v_mfma_f32_16x16x32_bf16 a[24:27], a[164:167], v[64:67], a[24:27]
    s_waitcnt vmcnt(12) lgkmcnt(0)
    s_barrier
    v_mfma_f32_16x16x32_bf16 a[28:31], a[164:167], v[68:71], a[28:31]
    ds_read_b64_tr_b16 a[160:161], v228 offset:8192
    ds_read_b64_tr_b16 a[162:163], v228 offset:12288
    v_mfma_f32_16x16x32_bf16 a[32:35], a[164:167], v[72:75], a[32:35]
    buffer_load_dwordx4 v208, s[24:27], s41 offen offset:0 lds
    v_mfma_f32_16x16x32_bf16 a[36:39], a[164:167], v[76:79], a[36:39]
    ds_read_b64_tr_b16 a[164:165], v229 offset:8192
    ds_read_b64_tr_b16 a[166:167], v229 offset:12288
    v_mfma_f32_16x16x32_bf16 a[40:43], a[168:171], v[60:63], a[40:43]
    v_mfma_f32_16x16x32_bf16 a[44:47], a[168:171], v[64:67], a[44:47]
    v_mfma_f32_16x16x32_bf16 a[48:51], a[168:171], v[68:71], a[48:51]
    buffer_load_dwordx4 v209, s[24:27], s41 offen offset:1024 lds
    v_mfma_f32_16x16x32_bf16 a[52:55], a[168:171], v[72:75], a[52:55]
    v_mfma_f32_16x16x32_bf16 a[56:59], a[168:171], v[76:79], a[56:59]
    ds_read_b64_tr_b16 a[168:169], v230 offset:8192
    ds_read_b64_tr_b16 a[170:171], v230 offset:12288
    v_mfma_f32_16x16x32_bf16 a[60:63], a[172:175], v[60:63], a[60:63]
    v_mfma_f32_16x16x32_bf16 a[64:67], a[172:175], v[64:67], a[64:67]
    v_mfma_f32_16x16x32_bf16 a[68:71], a[172:175], v[68:71], a[68:71]
    buffer_load_dwordx4 v[148:151], v238, s[20:23], s47 offen offset:2048 sc1
    v_mfma_f32_16x16x32_bf16 a[72:75], a[172:175], v[72:75], a[72:75]
    v_mfma_f32_16x16x32_bf16 a[76:79], a[172:175], v[76:79], a[76:79]
    ds_read_b64_tr_b16 a[172:173], v231 offset:8192
    ds_read_b64_tr_b16 a[174:175], v231 offset:12288
    v_mfma_f32_16x16x32_bf16 a[80:83], a[176:179], v[60:63], a[80:83]
    v_mfma_f32_16x16x32_bf16 a[84:87], a[176:179], v[64:67], a[84:87]
    v_mfma_f32_16x16x32_bf16 a[88:91], a[176:179], v[68:71], a[88:91]
    buffer_load_dwordx4 v210, s[24:27], s41 offen offset:2048 lds
    v_mfma_f32_16x16x32_bf16 a[92:95], a[176:179], v[72:75], a[92:95]
    v_mfma_f32_16x16x32_bf16 a[96:99], a[176:179], v[76:79], a[96:99]
    v_mfma_f32_16x16x32_bf16 a[100:103], a[180:183], v[60:63], a[100:103]
    ds_read_b64_tr_b16 a[176:177], v232 offset:8192
    ds_read_b64_tr_b16 a[178:179], v232 offset:12288
    v_mfma_f32_16x16x32_bf16 a[104:107], a[180:183], v[64:67], a[104:107]
    v_mfma_f32_16x16x32_bf16 a[108:111], a[180:183], v[68:71], a[108:111]
    buffer_load_dwordx4 v[152:155], v238, s[20:23], s47 offen offset:3072 sc1
    v_mfma_f32_16x16x32_bf16 a[112:115], a[180:183], v[72:75], a[112:115]
    v_mfma_f32_16x16x32_bf16 a[116:119], a[180:183], v[76:79], a[116:119]
    ds_read_b64_tr_b16 a[180:181], v233 offset:8192
    ds_read_b64_tr_b16 a[182:183], v233 offset:12288
    v_mfma_f32_16x16x32_bf16 a[120:123], a[184:187], v[60:63], a[120:123]
    v_mfma_f32_16x16x32_bf16 a[124:127], a[184:187], v[64:67], a[124:127]
    v_mfma_f32_16x16x32_bf16 a[128:131], a[184:187], v[68:71], a[128:131]
    buffer_load_dwordx4 v211, s[24:27], s41 offen offset:3072 lds
    v_mfma_f32_16x16x32_bf16 a[132:135], a[184:187], v[72:75], a[132:135]
    v_mfma_f32_16x16x32_bf16 a[136:139], a[184:187], v[76:79], a[136:139]
    v_mfma_f32_16x16x32_bf16 a[140:143], a[188:191], v[60:63], a[140:143]
    ds_read_b64_tr_b16 a[184:185], v234 offset:8192
    ds_read_b64_tr_b16 a[186:187], v234 offset:12288
    v_mfma_f32_16x16x32_bf16 a[144:147], a[188:191], v[64:67], a[144:147]
    v_mfma_f32_16x16x32_bf16 a[148:151], a[188:191], v[68:71], a[148:151]
    buffer_load_dwordx4 v[156:159], v239, s[20:23], s47 offen offset:0 sc1
    v_mfma_f32_16x16x32_bf16 a[152:155], a[188:191], v[72:75], a[152:155]
    s_add_u32 s47, s61, 315392
    v_mfma_f32_16x16x32_bf16 a[156:159], a[188:191], v[76:79], a[156:159]
    ds_read_b64_tr_b16 a[188:189], v235 offset:8192
    ds_read_b64_tr_b16 a[190:191], v235 offset:12288
    s_waitcnt lgkmcnt(4)
    s_waitcnt vmcnt(27)
    v_mfma_f32_16x16x32_bf16 a[0:3], a[160:163], v[80:83], a[0:3]
    buffer_load_dwordx4 v[160:163], v238, s[20:23], s47 offen offset:0 sc1
    v_mfma_f32_16x16x32_bf16 a[4:7], a[160:163], v[84:87], a[4:7]
    v_mfma_f32_16x16x32_bf16 a[8:11], a[160:163], v[88:91], a[8:11]
    v_mfma_f32_16x16x32_bf16 a[12:15], a[160:163], v[92:95], a[12:15]
    s_add_u32 s41, s60, 1228800
    v_mfma_f32_16x16x32_bf16 a[16:19], a[160:163], v[96:99], a[16:19]
    buffer_load_dwordx4 v[164:167], v238, s[20:23], s47 offen offset:1024 sc1
    v_mfma_f32_16x16x32_bf16 a[20:23], a[164:167], v[80:83], a[20:23]
    s_add_u32 m0, s35, 0
    v_mfma_f32_16x16x32_bf16 a[24:27], a[164:167], v[84:87], a[24:27]
    s_waitcnt lgkmcnt(0)
    v_mfma_f32_16x16x32_bf16 a[28:31], a[164:167], v[88:91], a[28:31]
    ds_read_b64_tr_b16 a[160:161], v224 offset:8192
    ds_read_b64_tr_b16 a[162:163], v224 offset:12288
    v_mfma_f32_16x16x32_bf16 a[32:35], a[164:167], v[92:95], a[32:35]
    buffer_load_dwordx4 v208, s[24:27], s41 offen offset:0 lds
    v_mfma_f32_16x16x32_bf16 a[36:39], a[164:167], v[96:99], a[36:39]
    ds_read_b64_tr_b16 a[164:165], v225 offset:8192
    ds_read_b64_tr_b16 a[166:167], v225 offset:12288
    v_mfma_f32_16x16x32_bf16 a[40:43], a[168:171], v[80:83], a[40:43]
    v_mfma_f32_16x16x32_bf16 a[44:47], a[168:171], v[84:87], a[44:47]
    v_mfma_f32_16x16x32_bf16 a[48:51], a[168:171], v[88:91], a[48:51]
    buffer_load_dwordx4 v209, s[24:27], s41 offen offset:1024 lds
    v_mfma_f32_16x16x32_bf16 a[52:55], a[168:171], v[92:95], a[52:55]
    v_mfma_f32_16x16x32_bf16 a[56:59], a[168:171], v[96:99], a[56:59]
    ds_read_b64_tr_b16 a[168:169], v226 offset:8192
    ds_read_b64_tr_b16 a[170:171], v226 offset:12288
    v_mfma_f32_16x16x32_bf16 a[60:63], a[172:175], v[80:83], a[60:63]
    v_mfma_f32_16x16x32_bf16 a[64:67], a[172:175], v[84:87], a[64:67]
    v_mfma_f32_16x16x32_bf16 a[68:71], a[172:175], v[88:91], a[68:71]
    buffer_load_dwordx4 v[168:171], v238, s[20:23], s47 offen offset:2048 sc1
    v_mfma_f32_16x16x32_bf16 a[72:75], a[172:175], v[92:95], a[72:75]
    v_mfma_f32_16x16x32_bf16 a[76:79], a[172:175], v[96:99], a[76:79]
    ds_read_b64_tr_b16 a[172:173], v227 offset:8192
    ds_read_b64_tr_b16 a[174:175], v227 offset:12288
    v_mfma_f32_16x16x32_bf16 a[80:83], a[176:179], v[80:83], a[80:83]
    v_mfma_f32_16x16x32_bf16 a[84:87], a[176:179], v[84:87], a[84:87]
    v_mfma_f32_16x16x32_bf16 a[88:91], a[176:179], v[88:91], a[88:91]
    buffer_load_dwordx4 v210, s[24:27], s41 offen offset:2048 lds
    v_mfma_f32_16x16x32_bf16 a[92:95], a[176:179], v[92:95], a[92:95]
    v_mfma_f32_16x16x32_bf16 a[96:99], a[176:179], v[96:99], a[96:99]
    v_mfma_f32_16x16x32_bf16 a[100:103], a[180:183], v[80:83], a[100:103]
    ds_read_b64_tr_b16 a[176:177], v228 offset:16384
    ds_read_b64_tr_b16 a[178:179], v228 offset:20480
    v_mfma_f32_16x16x32_bf16 a[104:107], a[180:183], v[84:87], a[104:107]
    v_mfma_f32_16x16x32_bf16 a[108:111], a[180:183], v[88:91], a[108:111]
    buffer_load_dwordx4 v[172:175], v238, s[20:23], s47 offen offset:3072 sc1
    v_mfma_f32_16x16x32_bf16 a[112:115], a[180:183], v[92:95], a[112:115]
    v_mfma_f32_16x16x32_bf16 a[116:119], a[180:183], v[96:99], a[116:119]
    ds_read_b64_tr_b16 a[180:181], v229 offset:16384
    ds_read_b64_tr_b16 a[182:183], v229 offset:20480
    v_mfma_f32_16x16x32_bf16 a[120:123], a[184:187], v[80:83], a[120:123]
    v_mfma_f32_16x16x32_bf16 a[124:127], a[184:187], v[84:87], a[124:127]
    v_mfma_f32_16x16x32_bf16 a[128:131], a[184:187], v[88:91], a[128:131]
    buffer_load_dwordx4 v211, s[24:27], s41 offen offset:3072 lds
    v_mfma_f32_16x16x32_bf16 a[132:135], a[184:187], v[92:95], a[132:135]
    v_mfma_f32_16x16x32_bf16 a[136:139], a[184:187], v[96:99], a[136:139]
    v_mfma_f32_16x16x32_bf16 a[140:143], a[188:191], v[80:83], a[140:143]
    ds_read_b64_tr_b16 a[184:185], v230 offset:16384
    ds_read_b64_tr_b16 a[186:187], v230 offset:20480
    v_mfma_f32_16x16x32_bf16 a[144:147], a[188:191], v[84:87], a[144:147]
    v_mfma_f32_16x16x32_bf16 a[148:151], a[188:191], v[88:91], a[148:151]
    buffer_load_dwordx4 v[176:179], v239, s[20:23], s47 offen offset:0 sc1
    v_mfma_f32_16x16x32_bf16 a[152:155], a[188:191], v[92:95], a[152:155]
    s_add_u32 s47, s61, 329728
    v_mfma_f32_16x16x32_bf16 a[156:159], a[188:191], v[96:99], a[156:159]
    ds_read_b64_tr_b16 a[188:189], v231 offset:16384
    ds_read_b64_tr_b16 a[190:191], v231 offset:20480
    s_waitcnt lgkmcnt(4)
    s_waitcnt vmcnt(27)
    v_mfma_f32_16x16x32_bf16 a[0:3], a[160:163], v[100:103], a[0:3]
    buffer_load_dwordx4 v[0:3], v238, s[20:23], s47 offen offset:0 sc1
    s_add_u32 s41, s60, 1269760
    s_add_u32 m0, s35, 40960
    v_mfma_f32_16x16x32_bf16 a[4:7], a[160:163], v[104:107], a[4:7]
    v_mfma_f32_16x16x32_bf16 a[8:11], a[160:163], v[108:111], a[8:11]
    buffer_load_dwordx4 v208, s[24:27], s41 offen offset:0 lds
    v_mfma_f32_16x16x32_bf16 a[12:15], a[160:163], v[112:115], a[12:15]
    v_mfma_f32_16x16x32_bf16 a[16:19], a[160:163], v[116:119], a[16:19]
    buffer_load_dwordx4 v[4:7], v238, s[20:23], s47 offen offset:1024 sc1
    v_mfma_f32_16x16x32_bf16 a[20:23], a[164:167], v[100:103], a[20:23]
    v_mfma_f32_16x16x32_bf16 a[24:27], a[164:167], v[104:107], a[24:27]
    buffer_load_dwordx4 v209, s[24:27], s41 offen offset:1024 lds
    v_mfma_f32_16x16x32_bf16 a[28:31], a[164:167], v[108:111], a[28:31]
    v_mfma_f32_16x16x32_bf16 a[32:35], a[164:167], v[112:115], a[32:35]
    v_mfma_f32_16x16x32_bf16 a[36:39], a[164:167], v[116:119], a[36:39]
    buffer_load_dwordx4 v[8:11], v238, s[20:23], s47 offen offset:2048 sc1
    v_mfma_f32_16x16x32_bf16 a[40:43], a[168:171], v[100:103], a[40:43]
    ds_read_b64_tr_b16 a[192:193], v241 offset:8192
    ds_read_b64_tr_b16 a[194:195], v241 offset:12288
    v_mfma_f32_16x16x32_bf16 a[44:47], a[168:171], v[104:107], a[44:47]
    buffer_load_dwordx4 v210, s[24:27], s41 offen offset:2048 lds
    v_mfma_f32_16x16x32_bf16 a[48:51], a[168:171], v[108:111], a[48:51]
    ds_read_b64_tr_b16 a[196:197], v242 offset:8192
    ds_read_b64_tr_b16 a[198:199], v242 offset:12288
    v_mfma_f32_16x16x32_bf16 a[52:55], a[168:171], v[112:115], a[52:55]
    buffer_load_dwordx4 v[12:15], v238, s[20:23], s47 offen offset:3072 sc1
    v_mfma_f32_16x16x32_bf16 a[56:59], a[168:171], v[116:119], a[56:59]
    ds_read_b64_tr_b16 a[200:201], v243 offset:8192
    ds_read_b64_tr_b16 a[202:203], v243 offset:12288
    v_mfma_f32_16x16x32_bf16 a[60:63], a[172:175], v[100:103], a[60:63]
    buffer_load_dwordx4 v211, s[24:27], s41 offen offset:3072 lds
    v_mfma_f32_16x16x32_bf16 a[64:67], a[172:175], v[104:107], a[64:67]
    ds_read_b64_tr_b16 a[204:205], v244 offset:8192
    ds_read_b64_tr_b16 a[206:207], v244 offset:12288
    v_mfma_f32_16x16x32_bf16 a[68:71], a[172:175], v[108:111], a[68:71]
    buffer_load_dwordx4 v[16:19], v239, s[20:23], s47 offen offset:0 sc1
    v_mfma_f32_16x16x32_bf16 a[72:75], a[172:175], v[112:115], a[72:75]
    s_add_u32 s47, s61, 372736
    v_mfma_f32_16x16x32_bf16 a[76:79], a[172:175], v[116:119], a[76:79]
    s_waitcnt lgkmcnt(0)
    s_waitcnt vmcnt(27)
    v_mfma_f32_16x16x32_bf16 a[0:3], a[176:179], v[120:123], a[0:3]
    buffer_load_dwordx4 v[20:23], v238, s[20:23], s47 offen offset:0 sc1
    v_mfma_f32_16x16x32_bf16 a[4:7], a[176:179], v[124:127], a[4:7]
    ds_read_b64_tr_b16 a[160:161], v224 offset:16384
    ds_read_b64_tr_b16 a[162:163], v224 offset:20480
    v_mfma_f32_16x16x32_bf16 a[8:11], a[176:179], v[128:131], a[8:11]
    v_mfma_f32_16x16x32_bf16 a[12:15], a[176:179], v[132:135], a[12:15]
    ds_read_b64_tr_b16 a[164:165], v225 offset:16384
    ds_read_b64_tr_b16 a[166:167], v225 offset:20480
    v_mfma_f32_16x16x32_bf16 a[16:19], a[176:179], v[136:139], a[16:19]
    buffer_load_dwordx4 v[24:27], v238, s[20:23], s47 offen offset:1024 sc1
    v_mfma_f32_16x16x32_bf16 a[20:23], a[180:183], v[120:123], a[20:23]
    ds_read_b64_tr_b16 a[168:169], v226 offset:16384
    ds_read_b64_tr_b16 a[170:171], v226 offset:20480
    v_mfma_f32_16x16x32_bf16 a[24:27], a[180:183], v[124:127], a[24:27]
    v_mfma_f32_16x16x32_bf16 a[28:31], a[180:183], v[128:131], a[28:31]
    ds_read_b64_tr_b16 a[172:173], v227 offset:16384
    ds_read_b64_tr_b16 a[174:175], v227 offset:20480
    v_mfma_f32_16x16x32_bf16 a[32:35], a[180:183], v[132:135], a[32:35]
    v_mfma_f32_16x16x32_bf16 a[36:39], a[180:183], v[136:139], a[36:39]
    buffer_load_dwordx4 v[28:31], v238, s[20:23], s47 offen offset:2048 sc1
    v_mfma_f32_16x16x32_bf16 a[40:43], a[184:187], v[120:123], a[40:43]
    ds_read_b64_tr_b16 a[208:209], v232 offset:16384
    ds_read_b64_tr_b16 a[210:211], v232 offset:20480
    v_mfma_f32_16x16x32_bf16 a[44:47], a[184:187], v[124:127], a[44:47]
    v_mfma_f32_16x16x32_bf16 a[48:51], a[184:187], v[128:131], a[48:51]
    ds_read_b64_tr_b16 a[212:213], v233 offset:16384
    ds_read_b64_tr_b16 a[214:215], v233 offset:20480
    v_mfma_f32_16x16x32_bf16 a[52:55], a[184:187], v[132:135], a[52:55]
    buffer_load_dwordx4 v[32:35], v238, s[20:23], s47 offen offset:3072 sc1
    v_mfma_f32_16x16x32_bf16 a[56:59], a[184:187], v[136:139], a[56:59]
    ds_read_b64_tr_b16 a[216:217], v234 offset:16384
    ds_read_b64_tr_b16 a[218:219], v234 offset:20480
    v_mfma_f32_16x16x32_bf16 a[60:63], a[188:191], v[120:123], a[60:63]
    v_mfma_f32_16x16x32_bf16 a[64:67], a[188:191], v[124:127], a[64:67]
    ds_read_b64_tr_b16 a[220:221], v235 offset:16384
    ds_read_b64_tr_b16 a[222:223], v235 offset:20480
    v_mfma_f32_16x16x32_bf16 a[68:71], a[188:191], v[128:131], a[68:71]
    buffer_load_dwordx4 v[36:39], v239, s[20:23], s47 offen offset:0 sc1
    v_mfma_f32_16x16x32_bf16 a[72:75], a[188:191], v[132:135], a[72:75]
    s_add_u32 s47, s61, 387072
    v_mfma_f32_16x16x32_bf16 a[76:79], a[188:191], v[136:139], a[76:79]
    s_waitcnt lgkmcnt(0)
    s_waitcnt vmcnt(23)
    v_mfma_f32_16x16x32_bf16 a[0:3], a[160:163], v[140:143], a[0:3]
    buffer_load_dwordx4 v[40:43], v238, s[20:23], s47 offen offset:0 sc1
    v_mfma_f32_16x16x32_bf16 a[4:7], a[160:163], v[144:147], a[4:7]
    ds_read_b64_tr_b16 a[176:177], v228 offset:24576
    ds_read_b64_tr_b16 a[178:179], v228 offset:28672
    v_mfma_f32_16x16x32_bf16 a[8:11], a[160:163], v[148:151], a[8:11]
    v_mfma_f32_16x16x32_bf16 a[12:15], a[160:163], v[152:155], a[12:15]
    ds_read_b64_tr_b16 a[180:181], v229 offset:24576
    ds_read_b64_tr_b16 a[182:183], v229 offset:28672
    v_mfma_f32_16x16x32_bf16 a[16:19], a[160:163], v[156:159], a[16:19]
    buffer_load_dwordx4 v[44:47], v238, s[20:23], s47 offen offset:1024 sc1
    v_mfma_f32_16x16x32_bf16 a[20:23], a[164:167], v[140:143], a[20:23]
    ds_read_b64_tr_b16 a[184:185], v230 offset:24576
    ds_read_b64_tr_b16 a[186:187], v230 offset:28672
    v_mfma_f32_16x16x32_bf16 a[24:27], a[164:167], v[144:147], a[24:27]
    v_mfma_f32_16x16x32_bf16 a[28:31], a[164:167], v[148:151], a[28:31]
    ds_read_b64_tr_b16 a[188:189], v231 offset:24576
    ds_read_b64_tr_b16 a[190:191], v231 offset:28672
    v_mfma_f32_16x16x32_bf16 a[32:35], a[164:167], v[152:155], a[32:35]
    v_mfma_f32_16x16x32_bf16 a[36:39], a[164:167], v[156:159], a[36:39]
    buffer_load_dwordx4 v[48:51], v238, s[20:23], s47 offen offset:2048 sc1
    v_mfma_f32_16x16x32_bf16 a[40:43], a[168:171], v[140:143], a[40:43]
    ds_read_b64_tr_b16 a[224:225], v241 offset:16384
    ds_read_b64_tr_b16 a[226:227], v241 offset:20480
    v_mfma_f32_16x16x32_bf16 a[44:47], a[168:171], v[144:147], a[44:47]
    v_mfma_f32_16x16x32_bf16 a[48:51], a[168:171], v[148:151], a[48:51]
    ds_read_b64_tr_b16 a[228:229], v242 offset:16384
    ds_read_b64_tr_b16 a[230:231], v242 offset:20480
    v_mfma_f32_16x16x32_bf16 a[52:55], a[168:171], v[152:155], a[52:55]
    buffer_load_dwordx4 v[52:55], v238, s[20:23], s47 offen offset:3072 sc1
    v_mfma_f32_16x16x32_bf16 a[56:59], a[168:171], v[156:159], a[56:59]
    ds_read_b64_tr_b16 a[232:233], v243 offset:16384
    ds_read_b64_tr_b16 a[234:235], v243 offset:20480
    v_mfma_f32_16x16x32_bf16 a[60:63], a[172:175], v[140:143], a[60:63]
    v_mfma_f32_16x16x32_bf16 a[64:67], a[172:175], v[144:147], a[64:67]
    ds_read_b64_tr_b16 a[236:237], v244 offset:16384
    ds_read_b64_tr_b16 a[238:239], v244 offset:20480
Lpg17:
    s_cbranch_execz Ltch1
    v_mfma_f32_16x16x32_bf16 a[68:71], a[172:175], v[148:151], a[68:71]
    buffer_load_dwordx4 v[56:59], v239, s[20:23], s47 offen offset:0 sc1
    v_mfma_f32_16x16x32_bf16 a[72:75], a[172:175], v[152:155], a[72:75]
    s_add_u32 s47, s61, 430080
    v_mfma_f32_16x16x32_bf16 a[76:79], a[172:175], v[156:159], a[76:79]
    s_waitcnt lgkmcnt(0)
    s_waitcnt vmcnt(19)
    v_mfma_f32_16x16x32_bf16 a[0:3], a[176:179], v[160:163], a[0:3]
    buffer_load_dwordx4 v[60:63], v238, s[20:23], s47 offen offset:0 sc1
    v_mfma_f32_16x16x32_bf16 a[4:7], a[176:179], v[164:167], a[4:7]
    ds_read_b64_tr_b16 a[160:161], v224 offset:24576
    ds_read_b64_tr_b16 a[162:163], v224 offset:28672
    v_mfma_f32_16x16x32_bf16 a[8:11], a[176:179], v[168:171], a[8:11]
    v_mfma_f32_16x16x32_bf16 a[12:15], a[176:179], v[172:175], a[12:15]
    ds_read_b64_tr_b16 a[164:165], v225 offset:24576
    ds_read_b64_tr_b16 a[166:167], v225 offset:28672
    v_mfma_f32_16x16x32_bf16 a[16:19], a[176:179], v[176:179], a[16:19]
    buffer_load_dwordx4 v[64:67], v238, s[20:23], s47 offen offset:1024 sc1
    v_mfma_f32_16x16x32_bf16 a[20:23], a[180:183], v[160:163], a[20:23]
    ds_read_b64_tr_b16 a[168:169], v226 offset:24576
    ds_read_b64_tr_b16 a[170:171], v226 offset:28672
    v_mfma_f32_16x16x32_bf16 a[24:27], a[180:183], v[164:167], a[24:27]
    v_mfma_f32_16x16x32_bf16 a[28:31], a[180:183], v[168:171], a[28:31]
    ds_read_b64_tr_b16 a[172:173], v227 offset:24576
    ds_read_b64_tr_b16 a[174:175], v227 offset:28672
    v_mfma_f32_16x16x32_bf16 a[32:35], a[180:183], v[172:175], a[32:35]
    v_mfma_f32_16x16x32_bf16 a[36:39], a[180:183], v[176:179], a[36:39]
    buffer_load_dwordx4 v[68:71], v238, s[20:23], s47 offen offset:2048 sc1
    v_mfma_f32_16x16x32_bf16 a[40:43], a[184:187], v[160:163], a[40:43]
    ds_read_b64_tr_b16 a[240:241], v232 offset:24576
    ds_read_b64_tr_b16 a[242:243], v232 offset:28672
    v_mfma_f32_16x16x32_bf16 a[44:47], a[184:187], v[164:167], a[44:47]
    v_mfma_f32_16x16x32_bf16 a[48:51], a[184:187], v[168:171], a[48:51]
    ds_read_b64_tr_b16 a[244:245], v233 offset:24576
    ds_read_b64_tr_b16 a[246:247], v233 offset:28672
    v_mfma_f32_16x16x32_bf16 a[52:55], a[184:187], v[172:175], a[52:55]
    buffer_load_dwordx4 v[72:75], v238, s[20:23], s47 offen offset:3072 sc1
    v_mfma_f32_16x16x32_bf16 a[56:59], a[184:187], v[176:179], a[56:59]
    ds_read_b64_tr_b16 a[248:249], v234 offset:24576
    ds_read_b64_tr_b16 a[250:251], v234 offset:28672
    v_mfma_f32_16x16x32_bf16 a[60:63], a[188:191], v[160:163], a[60:63]
    v_mfma_f32_16x16x32_bf16 a[64:67], a[188:191], v[164:167], a[64:67]
    ds_read_b64_tr_b16 a[252:253], v235 offset:24576
    ds_read_b64_tr_b16 a[254:255], v235 offset:28672
    v_mfma_f32_16x16x32_bf16 a[68:71], a[188:191], v[168:171], a[68:71]
    buffer_load_dwordx4 v[76:79], v239, s[20:23], s47 offen offset:0 sc1
    v_mfma_f32_16x16x32_bf16 a[72:75], a[188:191], v[172:175], a[72:75]
    s_add_u32 s47, s61, 444416
    v_mfma_f32_16x16x32_bf16 a[76:79], a[188:191], v[176:179], a[76:79]
    s_waitcnt lgkmcnt(0)
    s_waitcnt vmcnt(16)
    s_barrier
    s_waitcnt vmcnt(15)
    v_mfma_f32_16x16x32_bf16 a[0:3], a[160:163], v[0:3], a[0:3]
    buffer_load_dwordx4 v[80:83], v238, s[20:23], s47 offen offset:0 sc1
    v_mfma_f32_16x16x32_bf16 a[4:7], a[160:163], v[4:7], a[4:7]
    ds_read_b64_tr_b16 a[176:177], v228 offset:32768
    ds_read_b64_tr_b16 a[178:179], v228 offset:36864
    v_mfma_f32_16x16x32_bf16 a[8:11], a[160:163], v[8:11], a[8:11]
    v_mfma_f32_16x16x32_bf16 a[12:15], a[160:163], v[12:15], a[12:15]
    ds_read_b64_tr_b16 a[180:181], v229 offset:32768
    ds_read_b64_tr_b16 a[182:183], v229 offset:36864
    v_mfma_f32_16x16x32_bf16 a[16:19], a[160:163], v[16:19], a[16:19]
    buffer_load_dwordx4 v[84:87], v238, s[20:23], s47 offen offset:1024 sc1
    v_mfma_f32_16x16x32_bf16 a[20:23], a[164:167], v[0:3], a[20:23]
    ds_read_b64_tr_b16 a[184:185], v230 offset:32768
    ds_read_b64_tr_b16 a[186:187], v230 offset:36864
    v_mfma_f32_16x16x32_bf16 a[24:27], a[164:167], v[4:7], a[24:27]
    v_mfma_f32_16x16x32_bf16 a[28:31], a[164:167], v[8:11], a[28:31]
    ds_read_b64_tr_b16 a[188:189], v231 offset:32768
    ds_read_b64_tr_b16 a[190:191], v231 offset:36864
    v_mfma_f32_16x16x32_bf16 a[32:35], a[164:167], v[12:15], a[32:35]
    v_mfma_f32_16x16x32_bf16 a[36:39], a[164:167], v[16:19], a[36:39]
    buffer_load_dwordx4 v[88:91], v238, s[20:23], s47 offen offset:2048 sc1
    v_mfma_f32_16x16x32_bf16 a[40:43], a[168:171], v[0:3], a[40:43]
    v_mfma_f32_16x16x32_bf16 a[44:47], a[168:171], v[4:7], a[44:47]
    v_mfma_f32_16x16x32_bf16 a[48:51], a[168:171], v[8:11], a[48:51]
    v_mfma_f32_16x16x32_bf16 a[52:55], a[168:171], v[12:15], a[52:55]
    buffer_load_dwordx4 v[92:95], v238, s[20:23], s47 offen offset:3072 sc1
    v_mfma_f32_16x16x32_bf16 a[56:59], a[168:171], v[16:19], a[56:59]
    v_mfma_f32_16x16x32_bf16 a[60:63], a[172:175], v[0:3], a[60:63]
    v_mfma_f32_16x16x32_bf16 a[64:67], a[172:175], v[4:7], a[64:67]
    v_mfma_f32_16x16x32_bf16 a[68:71], a[172:175], v[8:11], a[68:71]
    buffer_load_dwordx4 v[96:99], v239, s[20:23], s47 offen offset:0 sc1
    v_mfma_f32_16x16x32_bf16 a[72:75], a[172:175], v[12:15], a[72:75]
    v_mfma_f32_16x16x32_bf16 a[76:79], a[172:175], v[16:19], a[76:79]
    s_waitcnt lgkmcnt(0)
    s_waitcnt vmcnt(15)
    v_mfma_f32_16x16x32_bf16 a[0:3], a[176:179], v[20:23], a[0:3]
    v_mfma_f32_16x16x32_bf16 a[4:7], a[176:179], v[24:27], a[4:7]
    ds_read_b64_tr_b16 a[160:161], v224 offset:32768
    ds_read_b64_tr_b16 a[162:163], v224 offset:36864
    v_mfma_f32_16x16x32_bf16 a[8:11], a[176:179], v[28:31], a[8:11]
    v_mfma_f32_16x16x32_bf16 a[12:15], a[176:179], v[32:35], a[12:15]
    ds_read_b64_tr_b16 a[164:165], v225 offset:32768
    ds_read_b64_tr_b16 a[166:167], v225 offset:36864
    v_mfma_f32_16x16x32_bf16 a[16:19], a[176:179], v[36:39], a[16:19]
    v_mfma_f32_16x16x32_bf16 a[20:23], a[180:183], v[20:23], a[20:23]
    ds_read_b64_tr_b16 a[168:169], v226 offset:32768
    ds_read_b64_tr_b16 a[170:171], v226 offset:36864
    v_mfma_f32_16x16x32_bf16 a[24:27], a[180:183], v[24:27], a[24:27]
    v_mfma_f32_16x16x32_bf16 a[28:31], a[180:183], v[28:31], a[28:31]
    ds_read_b64_tr_b16 a[172:173], v227 offset:32768
    ds_read_b64_tr_b16 a[174:175], v227 offset:36864
    v_mfma_f32_16x16x32_bf16 a[32:35], a[180:183], v[32:35], a[32:35]
    v_mfma_f32_16x16x32_bf16 a[36:39], a[180:183], v[36:39], a[36:39]
    v_mfma_f32_16x16x32_bf16 a[40:43], a[184:187], v[20:23], a[40:43]
    v_mfma_f32_16x16x32_bf16 a[44:47], a[184:187], v[24:27], a[44:47]
    v_mfma_f32_16x16x32_bf16 a[48:51], a[184:187], v[28:31], a[48:51]
    v_mfma_f32_16x16x32_bf16 a[52:55], a[184:187], v[32:35], a[52:55]
    v_mfma_f32_16x16x32_bf16 a[56:59], a[184:187], v[36:39], a[56:59]
    v_mfma_f32_16x16x32_bf16 a[60:63], a[188:191], v[20:23], a[60:63]
    v_mfma_f32_16x16x32_bf16 a[64:67], a[188:191], v[24:27], a[64:67]
    v_mfma_f32_16x16x32_bf16 a[68:71], a[188:191], v[28:31], a[68:71]
    v_mfma_f32_16x16x32_bf16 a[72:75], a[188:191], v[32:35], a[72:75]
    v_mfma_f32_16x16x32_bf16 a[76:79], a[188:191], v[36:39], a[76:79]
    s_waitcnt lgkmcnt(0)
    s_waitcnt vmcnt(10)
    v_mfma_f32_16x16x32_bf16 a[0:3], a[160:163], v[40:43], a[0:3]
    v_mfma_f32_16x16x32_bf16 a[4:7], a[160:163], v[44:47], a[4:7]
    ds_read_b64_tr_b16 a[176:177], v228 offset:0
    ds_read_b64_tr_b16 a[178:179], v228 offset:4096
    v_mfma_f32_16x16x32_bf16 a[8:11], a[160:163], v[48:51], a[8:11]
    v_mfma_f32_16x16x32_bf16 a[12:15], a[160:163], v[52:55], a[12:15]
    ds_read_b64_tr_b16 a[180:181], v229 offset:0
    ds_read_b64_tr_b16 a[182:183], v229 offset:4096
    v_mfma_f32_16x16x32_bf16 a[16:19], a[160:163], v[56:59], a[16:19]
    v_mfma_f32_16x16x32_bf16 a[20:23], a[164:167], v[40:43], a[20:23]
    ds_read_b64_tr_b16 a[184:185], v230 offset:0
    ds_read_b64_tr_b16 a[186:187], v230 offset:4096
    v_mfma_f32_16x16x32_bf16 a[24:27], a[164:167], v[44:47], a[24:27]
    v_mfma_f32_16x16x32_bf16 a[28:31], a[164:167], v[48:51], a[28:31]
    ds_read_b64_tr_b16 a[188:189], v231 offset:0
    ds_read_b64_tr_b16 a[190:191], v231 offset:4096
    v_mfma_f32_16x16x32_bf16 a[32:35], a[164:167], v[52:55], a[32:35]
    v_mfma_f32_16x16x32_bf16 a[36:39], a[164:167], v[56:59], a[36:39]
    v_mfma_f32_16x16x32_bf16 a[40:43], a[168:171], v[40:43], a[40:43]
    v_mfma_f32_16x16x32_bf16 a[44:47], a[168:171], v[44:47], a[44:47]
    v_mfma_f32_16x16x32_bf16 a[48:51], a[168:171], v[48:51], a[48:51]
    v_mfma_f32_16x16x32_bf16 a[52:55], a[168:171], v[52:55], a[52:55]
    v_mfma_f32_16x16x32_bf16 a[56:59], a[168:171], v[56:59], a[56:59]
    v_mfma_f32_16x16x32_bf16 a[60:63], a[172:175], v[40:43], a[60:63]
    v_mfma_f32_16x16x32_bf16 a[64:67], a[172:175], v[44:47], a[64:67]
    v_mfma_f32_16x16x32_bf16 a[68:71], a[172:175], v[48:51], a[68:71]
    v_mfma_f32_16x16x32_bf16 a[72:75], a[172:175], v[52:55], a[72:75]
    v_mfma_f32_16x16x32_bf16 a[76:79], a[172:175], v[56:59], a[76:79]
    s_waitcnt lgkmcnt(0)
    s_waitcnt vmcnt(5)
    v_mfma_f32_16x16x32_bf16 a[0:3], a[176:179], v[60:63], a[0:3]
    v_mfma_f32_16x16x32_bf16 a[4:7], a[176:179], v[64:67], a[4:7]
    ds_read_b64_tr_b16 a[160:161], v224 offset:0
    ds_read_b64_tr_b16 a[162:163], v224 offset:4096
    v_mfma_f32_16x16x32_bf16 a[8:11], a[176:179], v[68:71], a[8:11]
    v_mfma_f32_16x16x32_bf16 a[12:15], a[176:179], v[72:75], a[12:15]
    ds_read_b64_tr_b16 a[164:165], v225 offset:0
    ds_read_b64_tr_b16 a[166:167], v225 offset:4096
    v_mfma_f32_16x16x32_bf16 a[16:19], a[176:179], v[76:79], a[16:19]
    v_mfma_f32_16x16x32_bf16 a[20:23], a[180:183], v[60:63], a[20:23]
    ds_read_b64_tr_b16 a[168:169], v226 offset:0
    ds_read_b64_tr_b16 a[170:171], v226 offset:4096
    v_mfma_f32_16x16x32_bf16 a[24:27], a[180:183], v[64:67], a[24:27]
    v_mfma_f32_16x16x32_bf16 a[28:31], a[180:183], v[68:71], a[28:31]
    ds_read_b64_tr_b16 a[172:173], v227 offset:0
    ds_read_b64_tr_b16 a[174:175], v227 offset:4096
    v_mfma_f32_16x16x32_bf16 a[32:35], a[180:183], v[72:75], a[32:35]
    v_mfma_f32_16x16x32_bf16 a[36:39], a[180:183], v[76:79], a[36:39]
    v_mfma_f32_16x16x32_bf16 a[40:43], a[184:187], v[60:63], a[40:43]
    v_mfma_f32_16x16x32_bf16 a[44:47], a[184:187], v[64:67], a[44:47]
    v_mfma_f32_16x16x32_bf16 a[48:51], a[184:187], v[68:71], a[48:51]
    v_mfma_f32_16x16x32_bf16 a[52:55], a[184:187], v[72:75], a[52:55]
    v_mfma_f32_16x16x32_bf16 a[56:59], a[184:187], v[76:79], a[56:59]
    v_mfma_f32_16x16x32_bf16 a[60:63], a[188:191], v[60:63], a[60:63]
    v_mfma_f32_16x16x32_bf16 a[64:67], a[188:191], v[64:67], a[64:67]
    v_mfma_f32_16x16x32_bf16 a[68:71], a[188:191], v[68:71], a[68:71]
    v_mfma_f32_16x16x32_bf16 a[72:75], a[188:191], v[72:75], a[72:75]
    v_mfma_f32_16x16x32_bf16 a[76:79], a[188:191], v[76:79], a[76:79]
    s_waitcnt lgkmcnt(0)
    s_waitcnt vmcnt(0)
    v_mfma_f32_16x16x32_bf16 a[0:3], a[160:163], v[80:83], a[0:3]
    v_mfma_f32_16x16x32_bf16 a[4:7], a[160:163], v[84:87], a[4:7]
    v_mfma_f32_16x16x32_bf16 a[8:11], a[160:163], v[88:91], a[8:11]
    v_mfma_f32_16x16x32_bf16 a[12:15], a[160:163], v[92:95], a[12:15]
    v_mfma_f32_16x16x32_bf16 a[16:19], a[160:163], v[96:99], a[16:19]
    v_mfma_f32_16x16x32_bf16 a[20:23], a[164:167], v[80:83], a[20:23]
    v_mfma_f32_16x16x32_bf16 a[24:27], a[164:167], v[84:87], a[24:27]
    v_mfma_f32_16x16x32_bf16 a[28:31], a[164:167], v[88:91], a[28:31]
    v_mfma_f32_16x16x32_bf16 a[32:35], a[164:167], v[92:95], a[32:35]
    v_mfma_f32_16x16x32_bf16 a[36:39], a[164:167], v[96:99], a[36:39]
    ds_write_b128 v220, a[0:3] offset:0
    v_mfma_f32_16x16x32_bf16 a[40:43], a[168:171], v[80:83], a[40:43]
    ds_write_b128 v220, a[4:7] offset:1024
    v_mfma_f32_16x16x32_bf16 a[44:47], a[168:171], v[84:87], a[44:47]
    ds_write_b128 v220, a[8:11] offset:2048
    v_mfma_f32_16x16x32_bf16 a[48:51], a[168:171], v[88:91], a[48:51]
    ds_write_b128 v220, a[12:15] offset:3072
    v_mfma_f32_16x16x32_bf16 a[52:55], a[168:171], v[92:95], a[52:55]
    ds_write_b128 v220, a[16:19] offset:4096
    v_mfma_f32_16x16x32_bf16 a[56:59], a[168:171], v[96:99], a[56:59]
    ds_write_b128 v220, a[20:23] offset:5120
    v_mfma_f32_16x16x32_bf16 a[60:63], a[172:175], v[80:83], a[60:63]
    ds_write_b128 v220, a[24:27] offset:6144
    v_mfma_f32_16x16x32_bf16 a[64:67], a[172:175], v[84:87], a[64:67]
    ds_write_b128 v220, a[28:31] offset:7168
    v_mfma_f32_16x16x32_bf16 a[68:71], a[172:175], v[88:91], a[68:71]
    ds_write_b128 v220, a[32:35] offset:8192
    v_mfma_f32_16x16x32_bf16 a[72:75], a[172:175], v[92:95], a[72:75]
    ds_write_b128 v220, a[36:39] offset:9216
    v_mfma_f32_16x16x32_bf16 a[76:79], a[172:175], v[96:99], a[76:79]
    s_waitcnt lgkmcnt(0)
    s_barrier
    v_mfma_f32_16x16x32_bf16 a[80:83], a[192:195], v[100:103], a[80:83]
    ds_read_b128 v[180:183], v221 offset:0
    v_mfma_f32_16x16x32_bf16 a[84:87], a[192:195], v[104:107], a[84:87]
    ds_read_b128 v[184:187], v221 offset:1024
    v_mfma_f32_16x16x32_bf16 a[88:91], a[192:195], v[108:111], a[88:91]
    ds_read_b128 v[188:191], v221 offset:2048
    v_mfma_f32_16x16x32_bf16 a[92:95], a[192:195], v[112:115], a[92:95]
    ds_read_b128 v[192:195], v221 offset:3072
    v_mfma_f32_16x16x32_bf16 a[96:99], a[192:195], v[116:119], a[96:99]
    ds_read_b128 v[196:199], v221 offset:4096
    v_mfma_f32_16x16x32_bf16 a[100:103], a[196:199], v[100:103], a[100:103]
    v_mfma_f32_16x16x32_bf16 a[104:107], a[196:199], v[104:107], a[104:107]
    v_mfma_f32_16x16x32_bf16 a[108:111], a[196:199], v[108:111], a[108:111]
    v_mfma_f32_16x16x32_bf16 a[112:115], a[196:199], v[112:115], a[112:115]
    v_mfma_f32_16x16x32_bf16 a[116:119], a[196:199], v[116:119], a[116:119]
    v_mfma_f32_16x16x32_bf16 a[120:123], a[200:203], v[100:103], a[120:123]
    v_mfma_f32_16x16x32_bf16 a[124:127], a[200:203], v[104:107], a[124:127]
    v_mfma_f32_16x16x32_bf16 a[128:131], a[200:203], v[108:111], a[128:131]
    v_mfma_f32_16x16x32_bf16 a[132:135], a[200:203], v[112:115], a[132:135]
    v_mfma_f32_16x16x32_bf16 a[136:139], a[200:203], v[116:119], a[136:139]
    v_mfma_f32_16x16x32_bf16 a[140:143], a[204:207], v[100:103], a[140:143]
    v_mfma_f32_16x16x32_bf16 a[144:147], a[204:207], v[104:107], a[144:147]
    v_mfma_f32_16x16x32_bf16 a[148:151], a[204:207], v[108:111], a[148:151]
    v_mfma_f32_16x16x32_bf16 a[152:155], a[204:207], v[112:115], a[152:155]
    v_mfma_f32_16x16x32_bf16 a[156:159], a[204:207], v[116:119], a[156:159]
    s_waitcnt lgkmcnt(0)
    v_mfma_f32_16x16x32_bf16 a[80:83], a[208:211], v[120:123], a[80:83]
    v_accvgpr_read_b32 v100, a40
    v_accvgpr_read_b32 v101, a41
    v_mfma_f32_16x16x32_bf16 a[84:87], a[208:211], v[124:127], a[84:87]
    v_accvgpr_read_b32 v102, a42
    v_accvgpr_read_b32 v103, a43
    v_mfma_f32_16x16x32_bf16 a[88:91], a[208:211], v[128:131], a[88:91]
    v_add_f32 v100, v100, v180
    v_add_f32 v101, v101, v181
    v_mfma_f32_16x16x32_bf16 a[92:95], a[208:211], v[132:135], a[92:95]
    v_add_f32 v102, v102, v182
    v_add_f32 v103, v103, v183
    s_add_u32 s40, s49, 0
    v_mfma_f32_16x16x32_bf16 a[96:99], a[208:211], v[136:139], a[96:99]
    buffer_store_dwordx4 v[100:103], v248, s[20:23], s40 offen offset:0 sc1
    v_mfma_f32_16x16x32_bf16 a[100:103], a[212:215], v[120:123], a[100:103]
    v_accvgpr_read_b32 v104, a44
    v_accvgpr_read_b32 v105, a45
    v_mfma_f32_16x16x32_bf16 a[104:107], a[212:215], v[124:127], a[104:107]
    v_accvgpr_read_b32 v106, a46
    v_accvgpr_read_b32 v107, a47
    v_mfma_f32_16x16x32_bf16 a[108:111], a[212:215], v[128:131], a[108:111]
    v_add_f32 v104, v104, v184
    v_add_f32 v105, v105, v185
    v_mfma_f32_16x16x32_bf16 a[112:115], a[212:215], v[132:135], a[112:115]
    v_add_f32 v106, v106, v186
    v_add_f32 v107, v107, v187
    v_mfma_f32_16x16x32_bf16 a[116:119], a[212:215], v[136:139], a[116:119]
    buffer_store_dwordx4 v[104:107], v248, s[20:23], s40 offen offset:1024 sc1
    v_mfma_f32_16x16x32_bf16 a[120:123], a[216:219], v[120:123], a[120:123]
    v_accvgpr_read_b32 v108, a48
    v_accvgpr_read_b32 v109, a49
    v_mfma_f32_16x16x32_bf16 a[124:127], a[216:219], v[124:127], a[124:127]
    v_accvgpr_read_b32 v110, a50
    v_accvgpr_read_b32 v111, a51
    v_mfma_f32_16x16x32_bf16 a[128:131], a[216:219], v[128:131], a[128:131]
    v_add_f32 v108, v108, v188
    v_add_f32 v109, v109, v189
    v_mfma_f32_16x16x32_bf16 a[132:135], a[216:219], v[132:135], a[132:135]
    v_add_f32 v110, v110, v190
    v_add_f32 v111, v111, v191
    v_mfma_f32_16x16x32_bf16 a[136:139], a[216:219], v[136:139], a[136:139]
    buffer_store_dwordx4 v[108:111], v248, s[20:23], s40 offen offset:2048 sc1
    v_mfma_f32_16x16x32_bf16 a[140:143], a[220:223], v[120:123], a[140:143]
    v_accvgpr_read_b32 v112, a52
    v_accvgpr_read_b32 v113, a53
    v_mfma_f32_16x16x32_bf16 a[144:147], a[220:223], v[124:127], a[144:147]
    v_accvgpr_read_b32 v114, a54
    v_accvgpr_read_b32 v115, a55
    v_mfma_f32_16x16x32_bf16 a[148:151], a[220:223], v[128:131], a[148:151]
    v_add_f32 v112, v112, v192
    v_add_f32 v113, v113, v193
    v_mfma_f32_16x16x32_bf16 a[152:155], a[220:223], v[132:135], a[152:155]
    v_add_f32 v114, v114, v194
    v_add_f32 v115, v115, v195
    v_mfma_f32_16x16x32_bf16 a[156:159], a[220:223], v[136:139], a[156:159]
    s_waitcnt lgkmcnt(0)
    buffer_store_dwordx4 v[112:115], v248, s[20:23], s40 offen offset:3072 sc1
    v_mfma_f32_16x16x32_bf16 a[80:83], a[224:227], v[140:143], a[80:83]
    ds_read_b128 v[120:123], v221 offset:5120
    v_accvgpr_read_b32 v116, a56
    v_mfma_f32_16x16x32_bf16 a[84:87], a[224:227], v[144:147], a[84:87]
    ds_read_b128 v[124:127], v221 offset:6144
    v_accvgpr_read_b32 v117, a57
    v_mfma_f32_16x16x32_bf16 a[88:91], a[224:227], v[148:151], a[88:91]
    ds_read_b128 v[128:131], v221 offset:7168
    v_accvgpr_read_b32 v118, a58
    v_mfma_f32_16x16x32_bf16 a[92:95], a[224:227], v[152:155], a[92:95]
    ds_read_b128 v[132:135], v221 offset:8192
    v_accvgpr_read_b32 v119, a59
    v_mfma_f32_16x16x32_bf16 a[96:99], a[224:227], v[156:159], a[96:99]
    ds_read_b128 v[136:139], v221 offset:9216
    v_add_f32 v116, v116, v196
    v_mfma_f32_16x16x32_bf16 a[100:103], a[228:231], v[140:143], a[100:103]
    v_add_f32 v117, v117, v197
    v_add_f32 v118, v118, v198
    v_mfma_f32_16x16x32_bf16 a[104:107], a[228:231], v[144:147], a[104:107]
    v_add_f32 v119, v119, v199
    s_add_u32 s40, s49, 4096
    v_mfma_f32_16x16x32_bf16 a[108:111], a[228:231], v[148:151], a[108:111]
    buffer_store_dwordx4 v[116:119], v248, s[20:23], s40 offen offset:0 sc1
    v_mfma_f32_16x16x32_bf16 a[112:115], a[228:231], v[152:155], a[112:115]
    v_mfma_f32_16x16x32_bf16 a[116:119], a[228:231], v[156:159], a[116:119]
    s_waitcnt lgkmcnt(0)
    v_accvgpr_read_b32 v100, a60
    v_accvgpr_read_b32 v101, a61
    v_mfma_f32_16x16x32_bf16 a[120:123], a[232:235], v[140:143], a[120:123]
    v_accvgpr_read_b32 v102, a62
    v_accvgpr_read_b32 v103, a63
    v_mfma_f32_16x16x32_bf16 a[124:127], a[232:235], v[144:147], a[124:127]
    v_add_f32 v100, v100, v120
    v_add_f32 v101, v101, v121
    v_mfma_f32_16x16x32_bf16 a[128:131], a[232:235], v[148:151], a[128:131]
    v_add_f32 v102, v102, v122
    v_add_f32 v103, v103, v123
    v_mfma_f32_16x16x32_bf16 a[132:135], a[232:235], v[152:155], a[132:135]
    buffer_store_dwordx4 v[100:103], v248, s[20:23], s40 offen offset:1024 sc1
    v_mfma_f32_16x16x32_bf16 a[136:139], a[232:235], v[156:159], a[136:139]
    v_accvgpr_read_b32 v104, a64
    v_accvgpr_read_b32 v105, a65
    v_mfma_f32_16x16x32_bf16 a[140:143], a[236:239], v[140:143], a[140:143]
    v_accvgpr_read_b32 v106, a66
    v_accvgpr_read_b32 v107, a67
    v_mfma_f32_16x16x32_bf16 a[144:147], a[236:239], v[144:147], a[144:147]
    v_add_f32 v104, v104, v124
    v_add_f32 v105, v105, v125
    v_mfma_f32_16x16x32_bf16 a[148:151], a[236:239], v[148:151], a[148:151]
    v_add_f32 v106, v106, v126
    v_add_f32 v107, v107, v127
    v_mfma_f32_16x16x32_bf16 a[152:155], a[236:239], v[152:155], a[152:155]
    buffer_store_dwordx4 v[104:107], v248, s[20:23], s40 offen offset:2048 sc1
    v_mfma_f32_16x16x32_bf16 a[156:159], a[236:239], v[156:159], a[156:159]
    s_waitcnt lgkmcnt(0)
    v_accvgpr_read_b32 v108, a68
    v_accvgpr_read_b32 v109, a69
    v_mfma_f32_16x16x32_bf16 a[80:83], a[240:243], v[160:163], a[80:83]
    v_accvgpr_read_b32 v110, a70
    v_accvgpr_read_b32 v111, a71
    v_mfma_f32_16x16x32_bf16 a[84:87], a[240:243], v[164:167], a[84:87]
    ds_read_b64_tr_b16 a[176:177], v241 offset:24576
    ds_read_b64_tr_b16 a[178:179], v241 offset:28672
    v_mfma_f32_16x16x32_bf16 a[88:91], a[240:243], v[168:171], a[88:91]
    v_add_f32 v108, v108, v128
    v_add_f32 v109, v109, v129
    v_mfma_f32_16x16x32_bf16 a[92:95], a[240:243], v[172:175], a[92:95]
    ds_read_b64_tr_b16 a[180:181], v242 offset:24576
    ds_read_b64_tr_b16 a[182:183], v242 offset:28672
    v_mfma_f32_16x16x32_bf16 a[96:99], a[240:243], v[176:179], a[96:99]
    v_add_f32 v110, v110, v130
    v_add_f32 v111, v111, v131
    v_mfma_f32_16x16x32_bf16 a[100:103], a[244:247], v[160:163], a[100:103]
    ds_read_b64_tr_b16 a[184:185], v243 offset:24576
    ds_read_b64_tr_b16 a[186:187], v243 offset:28672
    v_mfma_f32_16x16x32_bf16 a[104:107], a[244:247], v[164:167], a[104:107]
    buffer_store_dwordx4 v[108:111], v248, s[20:23], s40 offen offset:3072 sc1
    v_mfma_f32_16x16x32_bf16 a[108:111], a[244:247], v[168:171], a[108:111]
    ds_read_b64_tr_b16 a[188:189], v244 offset:24576
    ds_read_b64_tr_b16 a[190:191], v244 offset:28672
    v_mfma_f32_16x16x32_bf16 a[112:115], a[244:247], v[172:175], a[112:115]
    v_accvgpr_read_b32 v112, a72
    v_accvgpr_read_b32 v113, a73
    v_mfma_f32_16x16x32_bf16 a[116:119], a[244:247], v[176:179], a[116:119]
    v_accvgpr_read_b32 v114, a74
    v_accvgpr_read_b32 v115, a75
    v_mfma_f32_16x16x32_bf16 a[120:123], a[248:251], v[160:163], a[120:123]
    v_add_f32 v112, v112, v132
    v_add_f32 v113, v113, v133
    v_mfma_f32_16x16x32_bf16 a[124:127], a[248:251], v[164:167], a[124:127]
    v_add_f32 v114, v114, v134
    v_add_f32 v115, v115, v135
    s_add_u32 s40, s49, 8192
    v_mfma_f32_16x16x32_bf16 a[128:131], a[248:251], v[168:171], a[128:131]
    buffer_store_dwordx4 v[112:115], v248, s[20:23], s40 offen offset:0 sc1
    v_mfma_f32_16x16x32_bf16 a[132:135], a[248:251], v[172:175], a[132:135]
    v_accvgpr_read_b32 v116, a76
    v_accvgpr_read_b32 v117, a77
    v_mfma_f32_16x16x32_bf16 a[136:139], a[248:251], v[176:179], a[136:139]
    v_accvgpr_read_b32 v118, a78
    v_accvgpr_read_b32 v119, a79
    v_mfma_f32_16x16x32_bf16 a[140:143], a[252:255], v[160:163], a[140:143]
    v_add_f32 v116, v116, v136
    v_add_f32 v117, v117, v137
    v_mfma_f32_16x16x32_bf16 a[144:147], a[252:255], v[164:167], a[144:147]
    v_add_f32 v118, v118, v138
    v_add_f32 v119, v119, v139
    v_mfma_f32_16x16x32_bf16 a[148:151], a[252:255], v[168:171], a[148:151]
    buffer_store_dwordx4 v[116:119], v248, s[20:23], s40 offen offset:1024 sc1
    v_mfma_f32_16x16x32_bf16 a[152:155], a[252:255], v[172:175], a[152:155]
    v_mfma_f32_16x16x32_bf16 a[156:159], a[252:255], v[176:179], a[156:159]
    s_waitcnt lgkmcnt(0)
    v_mfma_f32_16x16x32_bf16 a[80:83], a[176:179], v[0:3], a[80:83]
    v_mfma_f32_16x16x32_bf16 a[84:87], a[176:179], v[4:7], a[84:87]
    ds_read_b64_tr_b16 a[160:161], v232 offset:32768
    ds_read_b64_tr_b16 a[162:163], v232 offset:36864
    v_mfma_f32_16x16x32_bf16 a[88:91], a[176:179], v[8:11], a[88:91]
    v_mfma_f32_16x16x32_bf16 a[92:95], a[176:179], v[12:15], a[92:95]
    ds_read_b64_tr_b16 a[164:165], v233 offset:32768
    ds_read_b64_tr_b16 a[166:167], v233 offset:36864
    v_mfma_f32_16x16x32_bf16 a[96:99], a[176:179], v[16:19], a[96:99]
    v_mfma_f32_16x16x32_bf16 a[100:103], a[180:183], v[0:3], a[100:103]
    ds_read_b64_tr_b16 a[168:169], v234 offset:32768
    ds_read_b64_tr_b16 a[170:171], v234 offset:36864
    v_mfma_f32_16x16x32_bf16 a[104:107], a[180:183], v[4:7], a[104:107]
    v_mfma_f32_16x16x32_bf16 a[108:111], a[180:183], v[8:11], a[108:111]
    ds_read_b64_tr_b16 a[172:173], v235 offset:32768
    ds_read_b64_tr_b16 a[174:175], v235 offset:36864
    v_mfma_f32_16x16x32_bf16 a[112:115], a[180:183], v[12:15], a[112:115]
    v_mfma_f32_16x16x32_bf16 a[116:119], a[180:183], v[16:19], a[116:119]
    v_mfma_f32_16x16x32_bf16 a[120:123], a[184:187], v[0:3], a[120:123]
    v_mfma_f32_16x16x32_bf16 a[124:127], a[184:187], v[4:7], a[124:127]
    v_mfma_f32_16x16x32_bf16 a[128:131], a[184:187], v[8:11], a[128:131]
    v_mfma_f32_16x16x32_bf16 a[132:135], a[184:187], v[12:15], a[132:135]
    v_mfma_f32_16x16x32_bf16 a[136:139], a[184:187], v[16:19], a[136:139]
    v_mfma_f32_16x16x32_bf16 a[140:143], a[188:191], v[0:3], a[140:143]
    v_mfma_f32_16x16x32_bf16 a[144:147], a[188:191], v[4:7], a[144:147]
    v_mfma_f32_16x16x32_bf16 a[148:151], a[188:191], v[8:11], a[148:151]
    v_mfma_f32_16x16x32_bf16 a[152:155], a[188:191], v[12:15], a[152:155]
    v_mfma_f32_16x16x32_bf16 a[156:159], a[188:191], v[16:19], a[156:159]
    s_waitcnt lgkmcnt(0)
    s_barrier
    v_mfma_f32_16x16x32_bf16 a[80:83], a[160:163], v[20:23], a[80:83]
    v_mfma_f32_16x16x32_bf16 a[84:87], a[160:163], v[24:27], a[84:87]
    ds_read_b64_tr_b16 a[176:177], v241 offset:32768
    ds_read_b64_tr_b16 a[178:179], v241 offset:36864
    v_mfma_f32_16x16x32_bf16 a[88:91], a[160:163], v[28:31], a[88:91]
    v_mfma_f32_16x16x32_bf16 a[92:95], a[160:163], v[32:35], a[92:95]
    ds_read_b64_tr_b16 a[180:181], v242 offset:32768
    ds_read_b64_tr_b16 a[182:183], v242 offset:36864
    v_mfma_f32_16x16x32_bf16 a[96:99], a[160:163], v[36:39], a[96:99]
    v_mfma_f32_16x16x32_bf16 a[100:103], a[164:167], v[20:23], a[100:103]
    ds_read_b64_tr_b16 a[184:185], v243 offset:32768
    ds_read_b64_tr_b16 a[186:187], v243 offset:36864
    v_mfma_f32_16x16x32_bf16 a[104:107], a[164:167], v[24:27], a[104:107]
    v_mfma_f32_16x16x32_bf16 a[108:111], a[164:167], v[28:31], a[108:111]
    ds_read_b64_tr_b16 a[188:189], v244 offset:32768
    ds_read_b64_tr_b16 a[190:191], v244 offset:36864
    v_mfma_f32_16x16x32_bf16 a[112:115], a[164:167], v[32:35], a[112:115]
    v_mfma_f32_16x16x32_bf16 a[116:119], a[164:167], v[36:39], a[116:119]
    v_mfma_f32_16x16x32_bf16 a[120:123], a[168:171], v[20:23], a[120:123]
    v_mfma_f32_16x16x32_bf16 a[124:127], a[168:171], v[24:27], a[124:127]
    v_mfma_f32_16x16x32_bf16 a[128:131], a[168:171], v[28:31], a[128:131]
    v_mfma_f32_16x16x32_bf16 a[132:135], a[168:171], v[32:35], a[132:135]
    v_mfma_f32_16x16x32_bf16 a[136:139], a[168:171], v[36:39], a[136:139]
    v_mfma_f32_16x16x32_bf16 a[140:143], a[172:175], v[20:23], a[140:143]
    v_mfma_f32_16x16x32_bf16 a[144:147], a[172:175], v[24:27], a[144:147]
    v_mfma_f32_16x16x32_bf16 a[148:151], a[172:175], v[28:31], a[148:151]
    v_mfma_f32_16x16x32_bf16 a[152:155], a[172:175], v[32:35], a[152:155]
    v_mfma_f32_16x16x32_bf16 a[156:159], a[172:175], v[36:39], a[156:159]
    s_waitcnt lgkmcnt(0)
    v_mfma_f32_16x16x32_bf16 a[80:83], a[176:179], v[40:43], a[80:83]
    s_waitcnt vmcnt(0)
    buffer_store_dword v218, v213, s[20:23], 0 offen sc1
    v_mfma_f32_16x16x32_bf16 a[84:87], a[176:179], v[44:47], a[84:87]
    ds_read_b64_tr_b16 a[160:161], v232 offset:0
    ds_read_b64_tr_b16 a[162:163], v232 offset:4096
    v_mfma_f32_16x16x32_bf16 a[88:91], a[176:179], v[48:51], a[88:91]
    v_mfma_f32_16x16x32_bf16 a[92:95], a[176:179], v[52:55], a[92:95]
    ds_read_b64_tr_b16 a[164:165], v233 offset:0
    ds_read_b64_tr_b16 a[166:167], v233 offset:4096
    v_mfma_f32_16x16x32_bf16 a[96:99], a[176:179], v[56:59], a[96:99]
    v_mfma_f32_16x16x32_bf16 a[100:103], a[180:183], v[40:43], a[100:103]
    ds_read_b64_tr_b16 a[168:169], v234 offset:0
    ds_read_b64_tr_b16 a[170:171], v234 offset:4096
    v_mfma_f32_16x16x32_bf16 a[104:107], a[180:183], v[44:47], a[104:107]
    v_mfma_f32_16x16x32_bf16 a[108:111], a[180:183], v[48:51], a[108:111]
    ds_read_b64_tr_b16 a[172:173], v235 offset:0
    ds_read_b64_tr_b16 a[174:175], v235 offset:4096
    v_mfma_f32_16x16x32_bf16 a[112:115], a[180:183], v[52:55], a[112:115]
    v_mfma_f32_16x16x32_bf16 a[116:119], a[180:183], v[56:59], a[116:119]
    v_mfma_f32_16x16x32_bf16 a[120:123], a[184:187], v[40:43], a[120:123]
    v_mfma_f32_16x16x32_bf16 a[124:127], a[184:187], v[44:47], a[124:127]
    v_mfma_f32_16x16x32_bf16 a[128:131], a[184:187], v[48:51], a[128:131]
    v_mfma_f32_16x16x32_bf16 a[132:135], a[184:187], v[52:55], a[132:135]
    v_mfma_f32_16x16x32_bf16 a[136:139], a[184:187], v[56:59], a[136:139]
    v_mfma_f32_16x16x32_bf16 a[140:143], a[188:191], v[40:43], a[140:143]
    v_mfma_f32_16x16x32_bf16 a[144:147], a[188:191], v[44:47], a[144:147]
    v_mfma_f32_16x16x32_bf16 a[148:151], a[188:191], v[48:51], a[148:151]
    v_mfma_f32_16x16x32_bf16 a[152:155], a[188:191], v[52:55], a[152:155]
    v_mfma_f32_16x16x32_bf16 a[156:159], a[188:191], v[56:59], a[156:159]
    s_waitcnt lgkmcnt(0)
    v_mfma_f32_16x16x32_bf16 a[80:83], a[160:163], v[60:63], a[80:83]
    v_mfma_f32_16x16x32_bf16 a[84:87], a[160:163], v[64:67], a[84:87]
    ds_read_b64_tr_b16 a[176:177], v241 offset:0
    ds_read_b64_tr_b16 a[178:179], v241 offset:4096
    v_mfma_f32_16x16x32_bf16 a[88:91], a[160:163], v[68:71], a[88:91]
    v_mfma_f32_16x16x32_bf16 a[92:95], a[160:163], v[72:75], a[92:95]
    ds_read_b64_tr_b16 a[180:181], v242 offset:0
    ds_read_b64_tr_b16 a[182:183], v242 offset:4096
    v_mfma_f32_16x16x32_bf16 a[96:99], a[160:163], v[76:79], a[96:99]
    v_mfma_f32_16x16x32_bf16 a[100:103], a[164:167], v[60:63], a[100:103]
    ds_read_b64_tr_b16 a[184:185], v243 offset:0
    ds_read_b64_tr_b16 a[186:187], v243 offset:4096
    v_mfma_f32_16x16x32_bf16 a[104:107], a[164:167], v[64:67], a[104:107]
    v_mfma_f32_16x16x32_bf16 a[108:111], a[164:167], v[68:71], a[108:111]
    ds_read_b64_tr_b16 a[188:189], v244 offset:0
    ds_read_b64_tr_b16 a[190:191], v244 offset:4096
    v_mfma_f32_16x16x32_bf16 a[112:115], a[164:167], v[72:75], a[112:115]
    v_mfma_f32_16x16x32_bf16 a[116:119], a[164:167], v[76:79], a[116:119]
    v_mfma_f32_16x16x32_bf16 a[120:123], a[168:171], v[60:63], a[120:123]
    s_load_dword s4, s[20:21], s93 glc
    v_mfma_f32_16x16x32_bf16 a[124:127], a[168:171], v[64:67], a[124:127]
    v_mfma_f32_16x16x32_bf16 a[128:131], a[168:171], v[68:71], a[128:131]
    v_mfma_f32_16x16x32_bf16 a[132:135], a[168:171], v[72:75], a[132:135]
    v_mfma_f32_16x16x32_bf16 a[136:139], a[168:171], v[76:79], a[136:139]
    v_mfma_f32_16x16x32_bf16 a[140:143], a[172:175], v[60:63], a[140:143]
    v_mfma_f32_16x16x32_bf16 a[144:147], a[172:175], v[64:67], a[144:147]
    v_mfma_f32_16x16x32_bf16 a[148:151], a[172:175], v[68:71], a[148:151]
    v_mfma_f32_16x16x32_bf16 a[152:155], a[172:175], v[72:75], a[152:155]
    v_mfma_f32_16x16x32_bf16 a[156:159], a[172:175], v[76:79], a[156:159]
    s_waitcnt lgkmcnt(0)
    s_cmp_eq_u32 s4, 1
    s_cbranch_scc0 Lxs
Lxs_ok:
    s_add_u32 s8, s50, 0
    s_add_u32 s9, s50, 4096
    s_add_u32 s10, s50, 8192
    v_mfma_f32_16x16x32_bf16 a[80:83], a[176:179], v[80:83], a[80:83]
    buffer_load_dwordx4 v[160:163], v248, s[20:23], s8 offen offset:0 sc1
    v_mfma_f32_16x16x32_bf16 a[84:87], a[176:179], v[84:87], a[84:87]
    v_mfma_f32_16x16x32_bf16 a[88:91], a[176:179], v[88:91], a[88:91]
    buffer_load_dwordx4 v[0:3], v248, s[20:23], s9 offen offset:1024 sc1
    v_mfma_f32_16x16x32_bf16 a[92:95], a[176:179], v[92:95], a[92:95]
    v_mfma_f32_16x16x32_bf16 a[96:99], a[176:179], v[96:99], a[96:99]
    buffer_load_dwordx4 v[164:167], v248, s[20:23], s8 offen offset:1024 sc1
    v_mfma_f32_16x16x32_bf16 a[100:103], a[180:183], v[80:83], a[100:103]
    v_mfma_f32_16x16x32_bf16 a[104:107], a[180:183], v[84:87], a[104:107]
    buffer_load_dwordx4 v[4:7], v248, s[20:23], s9 offen offset:2048 sc1
    v_mfma_f32_16x16x32_bf16 a[108:111], a[180:183], v[88:91], a[108:111]
    v_mfma_f32_16x16x32_bf16 a[112:115], a[180:183], v[92:95], a[112:115]
    buffer_load_dwordx4 v[168:171], v248, s[20:23], s8 offen offset:2048 sc1
    v_mfma_f32_16x16x32_bf16 a[116:119], a[180:183], v[96:99], a[116:119]
    ds_write_b128 v220, a[80:83] offset:0
Lpg18:
    s_cbranch_execz Lpg19
    v_mfma_f32_16x16x32_bf16 a[120:123], a[184:187], v[80:83], a[120:123]
    ds_write_b128 v220, a[84:87] offset:1024
    buffer_load_dwordx4 v[8:11], v248, s[20:23], s9 offen offset:3072 sc1
    v_mfma_f32_16x16x32_bf16 a[124:127], a[184:187], v[84:87], a[124:127]
    ds_write_b128 v220, a[88:91] offset:2048
    v_mfma_f32_16x16x32_bf16 a[128:131], a[184:187], v[88:91], a[128:131]
    ds_write_b128 v220, a[92:95] offset:3072
    buffer_load_dwordx4 v[172:175], v248, s[20:23], s8 offen offset:3072 sc1
    v_mfma_f32_16x16x32_bf16 a[132:135], a[184:187], v[92:95], a[132:135]
    ds_write_b128 v220, a[96:99] offset:4096
    v_mfma_f32_16x16x32_bf16 a[136:139], a[184:187], v[96:99], a[136:139]
    ds_write_b128 v220, a[100:103] offset:5120
    buffer_load_dwordx4 v[12:15], v248, s[20:23], s10 offen offset:0 sc1
    v_mfma_f32_16x16x32_bf16 a[140:143], a[188:191], v[80:83], a[140:143]
    ds_write_b128 v220, a[104:107] offset:6144
    v_mfma_f32_16x16x32_bf16 a[144:147], a[188:191], v[84:87], a[144:147]
    ds_write_b128 v220, a[108:111] offset:7168
    buffer_load_dwordx4 v[176:179], v248, s[20:23], s9 offen offset:0 sc1
    v_mfma_f32_16x16x32_bf16 a[148:151], a[188:191], v[88:91], a[148:151]
    ds_write_b128 v220, a[112:115] offset:8192
    v_mfma_f32_16x16x32_bf16 a[152:155], a[188:191], v[92:95], a[152:155]
    ds_write_b128 v220, a[116:119] offset:9216
    buffer_load_dwordx4 v[16:19], v248, s[20:23], s10 offen offset:1024 sc1
    v_mfma_f32_16x16x32_bf16 a[156:159], a[188:191], v[96:99], a[156:159]
    s_waitcnt lgkmcnt(0)
    s_barrier
    ds_read_b128 v[100:103], v221 offset:0
    ds_read_b128 v[104:107], v221 offset:1024
    ds_read_b128 v[108:111], v221 offset:2048
    ds_read_b128 v[112:115], v221 offset:3072
    ds_read_b128 v[116:119], v221 offset:4096
    ds_read_b128 v[120:123], v221 offset:5120
    ds_read_b128 v[124:127], v221 offset:6144
    ds_read_b128 v[128:131], v221 offset:7168
    ds_read_b128 v[132:135], v221 offset:8192
    ds_read_b128 v[136:139], v221 offset:9216
    v_accvgpr_read_b32 v20, a120
    v_accvgpr_read_b32 v21, a121
    v_accvgpr_read_b32 v22, a122
    v_accvgpr_read_b32 v23, a123
    v_accvgpr_read_b32 v24, a124
    v_accvgpr_read_b32 v25, a125
    v_accvgpr_read_b32 v26, a126
    v_accvgpr_read_b32 v27, a127
    v_accvgpr_read_b32 v28, a128
    v_accvgpr_read_b32 v29, a129
    v_accvgpr_read_b32 v30, a130
    v_accvgpr_read_b32 v31, a131
    v_accvgpr_read_b32 v32, a132
    v_accvgpr_read_b32 v33, a133
    v_accvgpr_read_b32 v34, a134
    v_accvgpr_read_b32 v35, a135
    v_accvgpr_read_b32 v36, a136
    v_accvgpr_read_b32 v37, a137
    v_accvgpr_read_b32 v38, a138
    v_accvgpr_read_b32 v39, a139
    v_accvgpr_read_b32 v40, a140
    v_accvgpr_read_b32 v41, a141
    v_accvgpr_read_b32 v42, a142
    v_accvgpr_read_b32 v43, a143
    v_accvgpr_read_b32 v44, a144
    v_accvgpr_read_b32 v45, a145
    v_accvgpr_read_b32 v46, a146
    v_accvgpr_read_b32 v47, a147
    v_accvgpr_read_b32 v48, a148
    v_accvgpr_read_b32 v49, a149
    v_accvgpr_read_b32 v50, a150
    v_accvgpr_read_b32 v51, a151
    v_accvgpr_read_b32 v52, a152
    v_accvgpr_read_b32 v53, a153
    v_accvgpr_read_b32 v54, a154
    v_accvgpr_read_b32 v55, a155
    v_accvgpr_read_b32 v56, a156
    v_accvgpr_read_b32 v57, a157
    v_accvgpr_read_b32 v58, a158
    v_accvgpr_read_b32 v59, a159
    s_waitcnt lgkmcnt(0)
    v_pk_add_f32 v[20:21], v[20:21], v[100:101]
    v_pk_add_f32 v[22:23], v[22:23], v[102:103]
    v_pk_add_f32 v[24:25], v[24:25], v[104:105]
    v_pk_add_f32 v[26:27], v[26:27], v[106:107]
    v_pk_add_f32 v[28:29], v[28:29], v[108:109]
    v_pk_add_f32 v[30:31], v[30:31], v[110:111]
    v_pk_add_f32 v[32:33], v[32:33], v[112:113]
    v_pk_add_f32 v[34:35], v[34:35], v[114:115]
    v_pk_add_f32 v[36:37], v[36:37], v[116:117]
    v_pk_add_f32 v[38:39], v[38:39], v[118:119]
    v_pk_add_f32 v[40:41], v[40:41], v[120:121]
    v_pk_add_f32 v[42:43], v[42:43], v[122:123]
    v_pk_add_f32 v[44:45], v[44:45], v[124:125]
    v_pk_add_f32 v[46:47], v[46:47], v[126:127]
    v_pk_add_f32 v[48:49], v[48:49], v[128:129]
    v_pk_add_f32 v[50:51], v[50:51], v[130:131]
    v_pk_add_f32 v[52:53], v[52:53], v[132:133]
    v_pk_add_f32 v[54:55], v[54:55], v[134:135]
    v_pk_add_f32 v[56:57], v[56:57], v[136:137]
    v_pk_add_f32 v[58:59], v[58:59], v[138:139]
    v_add_u32 v200, 0, v240
    v_add_u32 v201, 40960, v240
    v_add_u32 v202, 81920, v240
    v_add_u32 v203, 122880, v240
    v_add_u32 v204, 163840, v240
    s_waitcnt vmcnt(8)
    v_pk_add_f32 v[20:21], v[20:21], v[160:161]
    v_pk_add_f32 v[22:23], v[22:23], v[162:163]
    v_pk_add_f32 v[40:41], v[40:41], v[0:1]
    v_pk_add_f32 v[42:43], v[42:43], v[2:3]
    v_cvt_pk_bf16_f32 v100, v20, v21
    v_cvt_pk_bf16_f32 v101, v22, v23
    v_cvt_pk_bf16_f32 v102, v40, v41
    v_cvt_pk_bf16_f32 v103, v42, v43
    s_nop 0
    v_permlane16_swap_b32 v100, v102
    v_permlane16_swap_b32 v101, v103
    buffer_store_dwordx4 v[100:103], v200, s[52:55], 0 offen sc1
    s_waitcnt vmcnt(7)
    v_pk_add_f32 v[24:25], v[24:25], v[164:165]
    v_pk_add_f32 v[26:27], v[26:27], v[166:167]
    v_pk_add_f32 v[44:45], v[44:45], v[4:5]
    v_pk_add_f32 v[46:47], v[46:47], v[6:7]
    v_cvt_pk_bf16_f32 v104, v24, v25
    v_cvt_pk_bf16_f32 v105, v26, v27
    v_cvt_pk_bf16_f32 v106, v44, v45
    v_cvt_pk_bf16_f32 v107, v46, v47
    s_nop 0
    v_permlane16_swap_b32 v104, v106
    v_permlane16_swap_b32 v105, v107
    buffer_store_dwordx4 v[104:107], v201, s[52:55], 0 offen sc1
    s_waitcnt vmcnt(6)
    v_pk_add_f32 v[28:29], v[28:29], v[168:169]
    v_pk_add_f32 v[30:31], v[30:31], v[170:171]
    v_pk_add_f32 v[48:49], v[48:49], v[8:9]
    v_pk_add_f32 v[50:51], v[50:51], v[10:11]
    v_cvt_pk_bf16_f32 v108, v28, v29
    v_cvt_pk_bf16_f32 v109, v30, v31
    v_cvt_pk_bf16_f32 v110, v48, v49
    v_cvt_pk_bf16_f32 v111, v50, v51
    s_nop 0
    v_permlane16_swap_b32 v108, v110
    v_permlane16_swap_b32 v109, v111
    buffer_store_dwordx4 v[108:111], v202, s[52:55], 0 offen sc1
    s_waitcnt vmcnt(5)
    v_pk_add_f32 v[32:33], v[32:33], v[172:173]
    v_pk_add_f32 v[34:35], v[34:35], v[174:175]
    v_pk_add_f32 v[52:53], v[52:53], v[12:13]
    v_pk_add_f32 v[54:55], v[54:55], v[14:15]
    v_cvt_pk_bf16_f32 v112, v32, v33
    v_cvt_pk_bf16_f32 v113, v34, v35
    v_cvt_pk_bf16_f32 v114, v52, v53
    v_cvt_pk_bf16_f32 v115, v54, v55
    s_nop 0
    v_permlane16_swap_b32 v112, v114
    v_permlane16_swap_b32 v113, v115
    buffer_store_dwordx4 v[112:115], v203, s[52:55], 0 offen sc1
    s_waitcnt vmcnt(4)
    v_pk_add_f32 v[36:37], v[36:37], v[176:177]
    v_pk_add_f32 v[38:39], v[38:39], v[178:179]
    v_pk_add_f32 v[56:57], v[56:57], v[16:17]
    v_pk_add_f32 v[58:59], v[58:59], v[18:19]
    v_cvt_pk_bf16_f32 v116, v36, v37
    v_cvt_pk_bf16_f32 v117, v38, v39
    v_cvt_pk_bf16_f32 v118, v56, v57
    v_cvt_pk_bf16_f32 v119, v58, v59
    s_nop 0
    v_permlane16_swap_b32 v116, v118
    v_permlane16_swap_b32 v117, v119
    buffer_store_dwordx4 v[116:119], v204, s[52:55], 0 offen sc1
Lk1_end:
    s_endpgm
Lt15:
    s_cbranch_execz Ltch0
    s_add_u32 s40, s48, 28672
    buffer_store_dwordx4 v[144:147], v248, s[20:23], s40 offen sc1
    s_add_u32 s40, s48, 43008
    buffer_store_dwordx4 v[148:151], v248, s[20:23], s40 offen sc1
    s_add_u32 s40, s48, 29696
    buffer_store_dwordx4 v[152:155], v248, s[20:23], s40 offen sc1
    s_add_u32 s40, s48, 44032
    buffer_store_dwordx4 v[156:159], v248, s[20:23], s40 offen sc1
    s_add_u32 s40, s48, 30720
    buffer_store_dwordx4 v[160:163], v248, s[20:23], s40 offen sc1
    s_add_u32 s40, s48, 45056
    buffer_store_dwordx4 v[164:167], v248, s[20:23], s40 offen sc1
    s_add_u32 s40, s48, 31744
    buffer_store_dwordx4 v[168:171], v248, s[20:23], s40 offen sc1
    s_add_u32 s40, s48, 46080
    buffer_store_dwordx4 v[172:175], v248, s[20:23], s40 offen sc1
    s_add_u32 s40, s48, 32768
    buffer_store_dwordx4 v[176:179], v248, s[20:23], s40 offen sc1
    s_add_u32 s40, s48, 47104
    buffer_store_dwordx4 v[180:183], v248, s[20:23], s40 offen sc1
    s_add_u32 s40, s48, 33792
    buffer_store_dwordx4 v[184:187], v248, s[20:23], s40 offen sc1
    s_add_u32 s40, s48, 48128
    buffer_store_dwordx4 v[188:191], v248, s[20:23], s40 offen sc1
    s_add_u32 s40, s48, 34816
    buffer_store_dwordx4 v[192:195], v248, s[20:23], s40 offen sc1
    s_add_u32 s40, s48, 49152
    buffer_store_dwordx4 v[196:199], v248, s[20:23], s40 offen sc1
    s_waitcnt vmcnt(15)
    s_barrier
    buffer_store_dword v218, v219, s[20:23], 0 offen offset:1792 sc1
    s_waitcnt vmcnt(1)
    s_barrier
    buffer_store_dword v218, v219, s[20:23], 0 offen offset:3584 sc1
    s_and_b32 s45, s2, 3
    s_mul_i32 s45, s45, 1310720
    s_lshr_b32 s46, s2, 7
    s_lshl_b32 s46, s46, 2
    s_add_u32 s46, s46, s28
    s_mul_i32 s46, s46, 10240
    s_add_u32 s45, s45, s46
    s_add_u32 s46, s45, 81920
    buffer_load_dword v254, v245, s[88:91], s46 offen
    s_add_u32 s46, s45, 87040
    buffer_load_dword v254, v245, s[88:91], s46 offen
    s_add_u32 s46, s45, 245760
    buffer_load_dword v254, v245, s[88:91], s46 offen
    s_add_u32 s46, s45, 250880
    buffer_load_dword v254, v245, s[88:91], s46 offen
    s_add_u32 s46, s45, 409600
    buffer_load_dword v254, v245, s[88:91], s46 offen
    s_add_u32 s46, s45, 414720
    buffer_load_dword v254, v245, s[88:91], s46 offen
    s_add_u32 s46, s45, 573440
    buffer_load_dword v254, v245, s[88:91], s46 offen
    s_add_u32 s46, s45, 578560
    buffer_load_dword v254, v245, s[88:91], s46 offen
    s_add_u32 s46, s45, 737280
    buffer_load_dword v254, v245, s[88:91], s46 offen
    s_add_u32 s46, s45, 742400
    buffer_load_dword v254, v245, s[88:91], s46 offen
    s_add_u32 s46, s45, 901120
    buffer_load_dword v254, v245, s[88:91], s46 offen
    s_add_u32 s46, s45, 906240
    buffer_load_dword v254, v245, s[88:91], s46 offen
    s_add_u32 s46, s45, 1064960
    buffer_load_dword v254, v245, s[88:91], s46 offen
    s_add_u32 s46, s45, 1070080
    buffer_load_dword v254, v245, s[88:91], s46 offen
    s_add_u32 s46, s45, 1228800
    buffer_load_dword v254, v245, s[88:91], s46 offen
    s_add_u32 s46, s45, 1233920
    buffer_load_dword v254, v245, s[88:91], s46 offen
    s_waitcnt vmcnt(0)
    s_branch Lk1_end
Lspin:
    s_mov_b32 s45, 0x40000
Lpb:
    buffer_load_dword v215, v217, s[20:23], 0 offen offset:3584 sc1
    s_waitcnt vmcnt(0)
    v_cmp_eq_u32 vcc, 1, v215
    s_cmp_eq_u32 vcc_lo, -1
    s_cbranch_scc1 Lpbed
    s_sub_u32 s45, s45, 1
    s_cmp_lg_u32 s45, 0
    s_cbranch_scc1 Lpb
Lpbed:
    s_branch Lback
Lspin0:
    s_mov_b32 s45, 0x40000
Lpa:
    buffer_load_dword v215, v217, s[20:23], 0 offen offset:0 sc1
    s_waitcnt vmcnt(0)
    v_cmp_eq_u32 vcc, 1, v215
    s_cmp_eq_u32 vcc_lo, -1
    s_cbranch_scc1 Lpaed
    s_sub_u32 s45, s45, 1
    s_cmp_lg_u32 s45, 0
    s_cbranch_scc1 Lpa
Lpaed:
    s_branch Lback0
Lspin1:
    s_mov_b32 s45, 0x40000
Lpc:
    buffer_load_dword v215, v217, s[20:23], 0 offen offset:1792 sc1
    s_waitcnt vmcnt(0)
    v_cmp_eq_u32 vcc, 1, v215
    s_cmp_eq_u32 vcc_lo, -1
    s_cbranch_scc1 Lpced
    s_sub_u32 s45, s45, 1
    s_cmp_lg_u32 s45, 0
    s_cbranch_scc1 Lpc
Lpced:
    s_branch Lback1
Lxs:
    s_mov_b32 s45, 0x80000
Lpx:
    s_load_dword s4, s[20:21], s93 glc
    s_waitcnt lgkmcnt(0)
    s_cmp_eq_u32 s4, 1
    s_cbranch_scc1 Lxs_ok
    s_sub_u32 s45, s45, 1
    s_cmp_lg_u32 s45, 0
    s_cbranch_scc1 Lpx
    s_branch Lxs_ok
Lrst:
    s_mov_b32 s45, 0x40000
Lrs:
    buffer_load_dword v216, v214, s[56:59], 0 offen sc1
    s_waitcnt vmcnt(0)
    v_cmp_le_u32 vcc, 16, v216
    s_cmp_eq_u32 vcc_lo, -1
    s_cbranch_scc1 Lrsed
    s_sub_u32 s45, s45, 1
    s_cmp_lg_u32 s45, 0
    s_cbranch_scc1 Lrs
Lrsed:
    s_branch Lrst_ok
Lcode_end:
Lslow:
    s_waitcnt vmcnt(0)
    v_and_b32 v112, 15, v247
    v_lshrrev_b32 v113, 4, v247
    v_lshlrev_b32 v243, 8, v112
    v_lshl_add_u32 v243, v113, 4, v243
    v_lshlrev_b32 v244, 1, v112
    v_lshl_add_u32 v244, v113, 10, v244
    v_mov_b32 v236, 0xff800000
    v_mov_b32 v237, 0xff800000
    v_mov_b32 v238, 0xff800000
    v_mov_b32 v239, 0xff800000
    v_mov_b32 v240, 0xff800000
    v_mov_b32 v241, 0xff800000
    v_mov_b32 v242, 0xff800000
    s_and_b32 s45, s43, 0x20000
    s_mov_b32 s46, 0
Lslow1:
    s_add_u32 s41, s45, 4096
    buffer_load_dwordx4 a[224:227], v243, s[12:15], s45 offen offset:0
    buffer_load_dwordx4 a[228:231], v243, s[12:15], s45 offen offset:64
    buffer_load_dwordx4 a[232:235], v243, s[12:15], s45 offen offset:128
    buffer_load_dwordx4 a[236:239], v243, s[12:15], s45 offen offset:192
    buffer_load_dwordx4 a[240:243], v243, s[12:15], s41 offen offset:0
    buffer_load_dwordx4 a[244:247], v243, s[12:15], s41 offen offset:64
    buffer_load_dwordx4 a[248:251], v243, s[12:15], s41 offen offset:128
    buffer_load_dwordx4 a[252:255], v243, s[12:15], s41 offen offset:192
    s_waitcnt vmcnt(0)
    v_mfma_f32_16x16x32_bf16 v[112:115], a[224:227], v[0:3], 0
    v_mfma_f32_16x16x32_bf16 v[112:115], a[228:231], v[28:31], v[112:115]
    v_mfma_f32_16x16x32_bf16 v[112:115], a[232:235], v[56:59], v[112:115]
    v_mfma_f32_16x16x32_bf16 v[112:115], a[236:239], v[84:87], v[112:115]
    v_mfma_f32_16x16x32_bf16 v[116:119], a[240:243], v[0:3], 0
    v_mfma_f32_16x16x32_bf16 v[116:119], a[244:247], v[28:31], v[116:119]
    v_mfma_f32_16x16x32_bf16 v[116:119], a[248:251], v[56:59], v[116:119]
    v_mfma_f32_16x16x32_bf16 v[116:119], a[252:255], v[84:87], v[116:119]
    v_mfma_f32_16x16x32_bf16 v[120:123], a[224:227], v[4:7], 0
    v_mfma_f32_16x16x32_bf16 v[120:123], a[228:231], v[32:35], v[120:123]
    v_mfma_f32_16x16x32_bf16 v[120:123], a[232:235], v[60:63], v[120:123]
    v_mfma_f32_16x16x32_bf16 v[120:123], a[236:239], v[88:91], v[120:123]
    v_mfma_f32_16x16x32_bf16 v[124:127], a[240:243], v[4:7], 0
    v_mfma_f32_16x16x32_bf16 v[124:127], a[244:247], v[32:35], v[124:127]
    v_mfma_f32_16x16x32_bf16 v[124:127], a[248:251], v[60:63], v[124:127]
    v_mfma_f32_16x16x32_bf16 v[124:127], a[252:255], v[88:91], v[124:127]
    v_mfma_f32_16x16x32_bf16 v[128:131], a[224:227], v[8:11], 0
    v_mfma_f32_16x16x32_bf16 v[128:131], a[228:231], v[36:39], v[128:131]
    v_mfma_f32_16x16x32_bf16 v[128:131], a[232:235], v[64:67], v[128:131]
    v_mfma_f32_16x16x32_bf16 v[128:131], a[236:239], v[92:95], v[128:131]
    v_mfma_f32_16x16x32_bf16 v[132:135], a[240:243], v[8:11], 0
    v_mfma_f32_16x16x32_bf16 v[132:135], a[244:247], v[36:39], v[132:135]
    v_mfma_f32_16x16x32_bf16 v[132:135], a[248:251], v[64:67], v[132:135]
    v_mfma_f32_16x16x32_bf16 v[132:135], a[252:255], v[92:95], v[132:135]
    v_mfma_f32_16x16x32_bf16 v[136:139], a[224:227], v[12:15], 0
    v_mfma_f32_16x16x32_bf16 v[136:139], a[228:231], v[40:43], v[136:139]
    v_mfma_f32_16x16x32_bf16 v[136:139], a[232:235], v[68:71], v[136:139]
    v_mfma_f32_16x16x32_bf16 v[136:139], a[236:239], v[96:99], v[136:139]
    v_mfma_f32_16x16x32_bf16 v[140:143], a[240:243], v[12:15], 0
    v_mfma_f32_16x16x32_bf16 v[140:143], a[244:247], v[40:43], v[140:143]
    v_mfma_f32_16x16x32_bf16 v[140:143], a[248:251], v[68:71], v[140:143]
    v_mfma_f32_16x16x32_bf16 v[140:143], a[252:255], v[96:99], v[140:143]
    v_mfma_f32_16x16x32_bf16 v[144:147], a[224:227], v[16:19], 0
    v_mfma_f32_16x16x32_bf16 v[144:147], a[228:231], v[44:47], v[144:147]
    v_mfma_f32_16x16x32_bf16 v[144:147], a[232:235], v[72:75], v[144:147]
    v_mfma_f32_16x16x32_bf16 v[144:147], a[236:239], v[100:103], v[144:147]
    v_mfma_f32_16x16x32_bf16 v[148:151], a[240:243], v[16:19], 0
    v_mfma_f32_16x16x32_bf16 v[148:151], a[244:247], v[44:47], v[148:151]
    v_mfma_f32_16x16x32_bf16 v[148:151], a[248:251], v[72:75], v[148:151]
    v_mfma_f32_16x16x32_bf16 v[148:151], a[252:255], v[100:103], v[148:151]
    v_mfma_f32_16x16x32_bf16 v[152:155], a[224:227], v[20:23], 0
    v_mfma_f32_16x16x32_bf16 v[152:155], a[228:231], v[48:51], v[152:155]
    v_mfma_f32_16x16x32_bf16 v[152:155], a[232:235], v[76:79], v[152:155]
    v_mfma_f32_16x16x32_bf16 v[152:155], a[236:239], v[104:107], v[152:155]
    v_mfma_f32_16x16x32_bf16 v[156:159], a[240:243], v[20:23], 0
    v_mfma_f32_16x16x32_bf16 v[156:159], a[244:247], v[48:51], v[156:159]
    v_mfma_f32_16x16x32_bf16 v[156:159], a[248:251], v[76:79], v[156:159]
    v_mfma_f32_16x16x32_bf16 v[156:159], a[252:255], v[104:107], v[156:159]
    v_mfma_f32_16x16x32_bf16 v[160:163], a[224:227], v[24:27], 0
    v_mfma_f32_16x16x32_bf16 v[160:163], a[228:231], v[52:55], v[160:163]
    v_mfma_f32_16x16x32_bf16 v[160:163], a[232:235], v[80:83], v[160:163]
    v_mfma_f32_16x16x32_bf16 v[160:163], a[236:239], v[108:111], v[160:163]
    v_mfma_f32_16x16x32_bf16 v[164:167], a[240:243], v[24:27], 0
    v_mfma_f32_16x16x32_bf16 v[164:167], a[244:247], v[52:55], v[164:167]
    v_mfma_f32_16x16x32_bf16 v[164:167], a[248:251], v[80:83], v[164:167]
    v_mfma_f32_16x16x32_bf16 v[164:167], a[252:255], v[108:111], v[164:167]
    s_nop 7
    v_max3_f32 v236, v236, v112, v113
    v_max3_f32 v236, v236, v114, v115
    v_max3_f32 v236, v236, v116, v117
    v_max3_f32 v236, v236, v118, v119
    v_max3_f32 v237, v237, v120, v121
    v_max3_f32 v237, v237, v122, v123
    v_max3_f32 v237, v237, v124, v125
    v_max3_f32 v237, v237, v126, v127
    v_max3_f32 v238, v238, v128, v129
    v_max3_f32 v238, v238, v130, v131
    v_max3_f32 v238, v238, v132, v133
    v_max3_f32 v238, v238, v134, v135
    v_max3_f32 v239, v239, v136, v137
    v_max3_f32 v239, v239, v138, v139
    v_max3_f32 v239, v239, v140, v141
    v_max3_f32 v239, v239, v142, v143
    v_max3_f32 v240, v240, v144, v145
    v_max3_f32 v240, v240, v146, v147
    v_max3_f32 v240, v240, v148, v149
    v_max3_f32 v240, v240, v150, v151
    v_max3_f32 v241, v241, v152, v153
    v_max3_f32 v241, v241, v154, v155
    v_max3_f32 v241, v241, v156, v157
    v_max3_f32 v241, v241, v158, v159
    v_max3_f32 v242, v242, v160, v161
    v_max3_f32 v242, v242, v162, v163
    v_max3_f32 v242, v242, v164, v165
    v_max3_f32 v242, v242, v166, v167
    s_add_u32 s45, s45, 8192
    s_add_u32 s46, s46, 1
    s_cmp_lt_u32 s46, 16
    s_cbranch_scc1 Lslow1
    v_mov_b32 v112, v236
    v_mov_b32 v113, v237
    v_mov_b32 v114, v238
    v_mov_b32 v115, v239
    v_mov_b32 v116, v240
    v_mov_b32 v117, v241
    v_mov_b32 v118, v242
    v_permlane16_swap_b32 v236, v112
    v_permlane16_swap_b32 v237, v113
    v_permlane16_swap_b32 v238, v114
    v_permlane16_swap_b32 v239, v115
    v_permlane16_swap_b32 v240, v116
    v_permlane16_swap_b32 v241, v117
    v_permlane16_swap_b32 v242, v118
    v_max_f32 v236, v236, v112
    v_max_f32 v237, v237, v113
    v_max_f32 v238, v238, v114
    v_max_f32 v239, v239, v115
    v_max_f32 v240, v240, v116
    v_max_f32 v241, v241, v117
    v_max_f32 v242, v242, v118
    v_mov_b32 v112, v236
    v_mov_b32 v113, v237
    v_mov_b32 v114, v238
    v_mov_b32 v115, v239
    v_mov_b32 v116, v240
    v_mov_b32 v117, v241
    v_mov_b32 v118, v242
    v_permlane32_swap_b32 v236, v112
    v_permlane32_swap_b32 v237, v113
    v_permlane32_swap_b32 v238, v114
    v_permlane32_swap_b32 v239, v115
    v_permlane32_swap_b32 v240, v116
    v_permlane32_swap_b32 v241, v117
    v_permlane32_swap_b32 v242, v118
    v_max_f32 v236, v236, v112
    v_max_f32 v237, v237, v113
    v_max_f32 v238, v238, v114
    v_max_f32 v239, v239, v115
    v_max_f32 v240, v240, v116
    v_max_f32 v241, v241, v117
    v_max_f32 v242, v242, v118
    v_mov_b32 v200, 0
    v_mov_b32 v201, 0
    v_mov_b32 v202, 0
    v_mov_b32 v203, 0
    v_mov_b32 v204, 0
    v_mov_b32 v205, 0
    v_mov_b32 v206, 0
    v_accvgpr_write_b32 a0, 0
    v_accvgpr_write_b32 a1, 0
    v_accvgpr_write_b32 a2, 0
    v_accvgpr_write_b32 a3, 0
    v_accvgpr_write_b32 a4, 0
    v_accvgpr_write_b32 a5, 0
    v_accvgpr_write_b32 a6, 0
    v_accvgpr_write_b32 a7, 0
    v_accvgpr_write_b32 a8, 0
    v_accvgpr_write_b32 a9, 0
    v_accvgpr_write_b32 a10, 0
    v_accvgpr_write_b32 a11, 0
    v_accvgpr_write_b32 a12, 0
    v_accvgpr_write_b32 a13, 0
    v_accvgpr_write_b32 a14, 0
    v_accvgpr_write_b32 a15, 0
    v_accvgpr_write_b32 a16, 0
    v_accvgpr_write_b32 a17, 0
    v_accvgpr_write_b32 a18, 0
    v_accvgpr_write_b32 a19, 0
    v_accvgpr_write_b32 a20, 0
    v_accvgpr_write_b32 a21, 0
    v_accvgpr_write_b32 a22, 0
    v_accvgpr_write_b32 a23, 0
    v_accvgpr_write_b32 a24, 0
    v_accvgpr_write_b32 a25, 0
    v_accvgpr_write_b32 a26, 0
    v_accvgpr_write_b32 a27, 0
    v_accvgpr_write_b32 a28, 0
    v_accvgpr_write_b32 a29, 0
    v_accvgpr_write_b32 a30, 0
    v_accvgpr_write_b32 a31, 0
    v_accvgpr_write_b32 a32, 0
    v_accvgpr_write_b32 a33, 0
    v_accvgpr_write_b32 a34, 0
    v_accvgpr_write_b32 a35, 0
    v_accvgpr_write_b32 a36, 0
    v_accvgpr_write_b32 a37, 0
    v_accvgpr_write_b32 a38, 0
    v_accvgpr_write_b32 a39, 0
    v_accvgpr_write_b32 a40, 0
    v_accvgpr_write_b32 a41, 0
    v_accvgpr_write_b32 a42, 0
    v_accvgpr_write_b32 a43, 0
    v_accvgpr_write_b32 a44, 0
    v_accvgpr_write_b32 a45, 0
    v_accvgpr_write_b32 a46, 0
    v_accvgpr_write_b32 a47, 0
    v_accvgpr_write_b32 a48, 0
    v_accvgpr_write_b32 a49, 0
    v_accvgpr_write_b32 a50, 0
    v_accvgpr_write_b32 a51, 0
    v_accvgpr_write_b32 a52, 0
    v_accvgpr_write_b32 a53, 0
    v_accvgpr_write_b32 a54, 0
    v_accvgpr_write_b32 a55, 0
    v_accvgpr_write_b32 a56, 0
    v_accvgpr_write_b32 a57, 0
    v_accvgpr_write_b32 a58, 0
    v_accvgpr_write_b32 a59, 0
    v_accvgpr_write_b32 a60, 0
    v_accvgpr_write_b32 a61, 0
    v_accvgpr_write_b32 a62, 0
    v_accvgpr_write_b32 a63, 0
    v_accvgpr_write_b32 a64, 0
    v_accvgpr_write_b32 a65, 0
    v_accvgpr_write_b32 a66, 0
    v_accvgpr_write_b32 a67, 0
    v_accvgpr_write_b32 a68, 0
    v_accvgpr_write_b32 a69, 0
    v_accvgpr_write_b32 a70, 0
    v_accvgpr_write_b32 a71, 0
    v_accvgpr_write_b32 a72, 0
    v_accvgpr_write_b32 a73, 0
    v_accvgpr_write_b32 a74, 0
    v_accvgpr_write_b32 a75, 0
    v_accvgpr_write_b32 a76, 0
    v_accvgpr_write_b32 a77, 0
    v_accvgpr_write_b32 a78, 0
    v_accvgpr_write_b32 a79, 0
    v_accvgpr_write_b32 a80, 0
    v_accvgpr_write_b32 a81, 0
    v_accvgpr_write_b32 a82, 0
    v_accvgpr_write_b32 a83, 0
    v_accvgpr_write_b32 a84, 0
    v_accvgpr_write_b32 a85, 0
    v_accvgpr_write_b32 a86, 0
    v_accvgpr_write_b32 a87, 0
    v_accvgpr_write_b32 a88, 0
    v_accvgpr_write_b32 a89, 0
    v_accvgpr_write_b32 a90, 0
    v_accvgpr_write_b32 a91, 0
    v_accvgpr_write_b32 a92, 0
    v_accvgpr_write_b32 a93, 0
    v_accvgpr_write_b32 a94, 0
    v_accvgpr_write_b32 a95, 0
    v_accvgpr_write_b32 a96, 0
    v_accvgpr_write_b32 a97, 0
    v_accvgpr_write_b32 a98, 0
    v_accvgpr_write_b32 a99, 0
    v_accvgpr_write_b32 a100, 0
    v_accvgpr_write_b32 a101, 0
    v_accvgpr_write_b32 a102, 0
    v_accvgpr_write_b32 a103, 0
    v_accvgpr_write_b32 a104, 0
    v_accvgpr_write_b32 a105, 0
    v_accvgpr_write_b32 a106, 0
    v_accvgpr_write_b32 a107, 0
    v_accvgpr_write_b32 a108, 0
    v_accvgpr_write_b32 a109, 0
    v_accvgpr_write_b32 a110, 0
    v_accvgpr_write_b32 a111, 0
    v_accvgpr_write_b32 a112, 0
    v_accvgpr_write_b32 a113, 0
    v_accvgpr_write_b32 a114, 0
    v_accvgpr_write_b32 a115, 0
    v_accvgpr_write_b32 a116, 0
    v_accvgpr_write_b32 a117, 0
    v_accvgpr_write_b32 a118, 0
    v_accvgpr_write_b32 a119, 0
    v_accvgpr_write_b32 a120, 0
    v_accvgpr_write_b32 a121, 0
Lpg19:
    s_cbranch_execz Ltch1
    v_accvgpr_write_b32 a122, 0
    v_accvgpr_write_b32 a123, 0
    v_accvgpr_write_b32 a124, 0
    v_accvgpr_write_b32 a125, 0
    v_accvgpr_write_b32 a126, 0
    v_accvgpr_write_b32 a127, 0
    v_accvgpr_write_b32 a128, 0
    v_accvgpr_write_b32 a129, 0
    v_accvgpr_write_b32 a130, 0
    v_accvgpr_write_b32 a131, 0
    v_accvgpr_write_b32 a132, 0
    v_accvgpr_write_b32 a133, 0
    v_accvgpr_write_b32 a134, 0
    v_accvgpr_write_b32 a135, 0
    v_accvgpr_write_b32 a136, 0
    v_accvgpr_write_b32 a137, 0
    v_accvgpr_write_b32 a138, 0
    v_accvgpr_write_b32 a139, 0
    v_accvgpr_write_b32 a140, 0
    v_accvgpr_write_b32 a141, 0
    v_accvgpr_write_b32 a142, 0
    v_accvgpr_write_b32 a143, 0
    v_accvgpr_write_b32 a144, 0
    v_accvgpr_write_b32 a145, 0
    v_accvgpr_write_b32 a146, 0
    v_accvgpr_write_b32 a147, 0
    v_accvgpr_write_b32 a148, 0
    v_accvgpr_write_b32 a149, 0
    v_accvgpr_write_b32 a150, 0
    v_accvgpr_write_b32 a151, 0
    v_accvgpr_write_b32 a152, 0
    v_accvgpr_write_b32 a153, 0
    v_accvgpr_write_b32 a154, 0
    v_accvgpr_write_b32 a155, 0
    v_accvgpr_write_b32 a156, 0
    v_accvgpr_write_b32 a157, 0
    v_accvgpr_write_b32 a158, 0
    v_accvgpr_write_b32 a159, 0
    v_accvgpr_write_b32 a160, 0
    v_accvgpr_write_b32 a161, 0
    v_accvgpr_write_b32 a162, 0
    v_accvgpr_write_b32 a163, 0
    v_accvgpr_write_b32 a164, 0
    v_accvgpr_write_b32 a165, 0
    v_accvgpr_write_b32 a166, 0
    v_accvgpr_write_b32 a167, 0
    v_accvgpr_write_b32 a168, 0
    v_accvgpr_write_b32 a169, 0
    v_accvgpr_write_b32 a170, 0
    v_accvgpr_write_b32 a171, 0
    v_accvgpr_write_b32 a172, 0
    v_accvgpr_write_b32 a173, 0
    v_accvgpr_write_b32 a174, 0
    v_accvgpr_write_b32 a175, 0
    v_accvgpr_write_b32 a176, 0
    v_accvgpr_write_b32 a177, 0
    v_accvgpr_write_b32 a178, 0
    v_accvgpr_write_b32 a179, 0
    v_accvgpr_write_b32 a180, 0
    v_accvgpr_write_b32 a181, 0
    v_accvgpr_write_b32 a182, 0
    v_accvgpr_write_b32 a183, 0
    v_accvgpr_write_b32 a184, 0
    v_accvgpr_write_b32 a185, 0
    v_accvgpr_write_b32 a186, 0
    v_accvgpr_write_b32 a187, 0
    v_accvgpr_write_b32 a188, 0
    v_accvgpr_write_b32 a189, 0
    v_accvgpr_write_b32 a190, 0
    v_accvgpr_write_b32 a191, 0
    v_accvgpr_write_b32 a192, 0
    v_accvgpr_write_b32 a193, 0
    v_accvgpr_write_b32 a194, 0
    v_accvgpr_write_b32 a195, 0
    v_accvgpr_write_b32 a196, 0
    v_accvgpr_write_b32 a197, 0
    v_accvgpr_write_b32 a198, 0
    v_accvgpr_write_b32 a199, 0
    v_accvgpr_write_b32 a200, 0
    v_accvgpr_write_b32 a201, 0
    v_accvgpr_write_b32 a202, 0
    v_accvgpr_write_b32 a203, 0
    v_accvgpr_write_b32 a204, 0
    v_accvgpr_write_b32 a205, 0
    v_accvgpr_write_b32 a206, 0
    v_accvgpr_write_b32 a207, 0
    v_accvgpr_write_b32 a208, 0
    v_accvgpr_write_b32 a209, 0
    v_accvgpr_write_b32 a210, 0
    v_accvgpr_write_b32 a211, 0
    v_accvgpr_write_b32 a212, 0
    v_accvgpr_write_b32 a213, 0
    v_accvgpr_write_b32 a214, 0
    v_accvgpr_write_b32 a215, 0
    v_accvgpr_write_b32 a216, 0
    v_accvgpr_write_b32 a217, 0
    v_accvgpr_write_b32 a218, 0
    v_accvgpr_write_b32 a219, 0
    v_accvgpr_write_b32 a220, 0
    v_accvgpr_write_b32 a221, 0
    v_accvgpr_write_b32 a222, 0
    v_accvgpr_write_b32 a223, 0
    s_and_b32 s45, s43, 0x20000
    s_mov_b32 s46, 0
Lslow2:
    s_add_u32 s41, s45, 4096
    buffer_load_dwordx4 a[224:227], v243, s[12:15], s45 offen offset:0
    buffer_load_dwordx4 a[228:231], v243, s[12:15], s45 offen offset:64
    buffer_load_dwordx4 a[232:235], v243, s[12:15], s45 offen offset:128
    buffer_load_dwordx4 a[236:239], v243, s[12:15], s45 offen offset:192
    buffer_load_dwordx4 a[240:243], v243, s[12:15], s41 offen offset:0
    buffer_load_dwordx4 a[244:247], v243, s[12:15], s41 offen offset:64
    buffer_load_dwordx4 a[248:251], v243, s[12:15], s41 offen offset:128
    buffer_load_dwordx4 a[252:255], v243, s[12:15], s41 offen offset:192
    buffer_load_ushort v112, v244, s[16:19], s45 offen offset:0
    buffer_load_ushort v113, v244, s[16:19], s45 offen offset:256
    buffer_load_ushort v114, v244, s[16:19], s45 offen offset:512
    buffer_load_ushort v115, v244, s[16:19], s45 offen offset:768
    buffer_load_ushort v116, v244, s[16:19], s41 offen offset:0
    buffer_load_ushort v117, v244, s[16:19], s41 offen offset:256
    buffer_load_ushort v118, v244, s[16:19], s41 offen offset:512
    buffer_load_ushort v119, v244, s[16:19], s41 offen offset:768
    buffer_load_ushort v120, v244, s[16:19], s45 offen offset:32
    buffer_load_ushort v121, v244, s[16:19], s45 offen offset:288
    buffer_load_ushort v122, v244, s[16:19], s45 offen offset:544
    buffer_load_ushort v123, v244, s[16:19], s45 offen offset:800
    buffer_load_ushort v124, v244, s[16:19], s41 offen offset:32
    buffer_load_ushort v125, v244, s[16:19], s41 offen offset:288
    buffer_load_ushort v126, v244, s[16:19], s41 offen offset:544
    buffer_load_ushort v127, v244, s[16:19], s41 offen offset:800
    buffer_load_ushort v128, v244, s[16:19], s45 offen offset:64
    buffer_load_ushort v129, v244, s[16:19], s45 offen offset:320
    buffer_load_ushort v130, v244, s[16:19], s45 offen offset:576
    buffer_load_ushort v131, v244, s[16:19], s45 offen offset:832
    buffer_load_ushort v132, v244, s[16:19], s41 offen offset:64
    buffer_load_ushort v133, v244, s[16:19], s41 offen offset:320
    buffer_load_ushort v134, v244, s[16:19], s41 offen offset:576
    buffer_load_ushort v135, v244, s[16:19], s41 offen offset:832
    buffer_load_ushort v136, v244, s[16:19], s45 offen offset:96
    buffer_load_ushort v137, v244, s[16:19], s45 offen offset:352
    buffer_load_ushort v138, v244, s[16:19], s45 offen offset:608
    buffer_load_ushort v139, v244, s[16:19], s45 offen offset:864
    buffer_load_ushort v140, v244, s[16:19], s41 offen offset:96
    buffer_load_ushort v141, v244, s[16:19], s41 offen offset:352
    buffer_load_ushort v142, v244, s[16:19], s41 offen offset:608
    buffer_load_ushort v143, v244, s[16:19], s41 offen offset:864
    s_waitcnt vmcnt(0)
    v_lshl_or_b32 v168, v113, 16, v112
    v_lshl_or_b32 v169, v115, 16, v114
    v_lshl_or_b32 v170, v117, 16, v116
    v_lshl_or_b32 v171, v119, 16, v118
    v_lshl_or_b32 v172, v121, 16, v120
    v_lshl_or_b32 v173, v123, 16, v122
    v_lshl_or_b32 v174, v125, 16, v124
    v_lshl_or_b32 v175, v127, 16, v126
    v_lshl_or_b32 v176, v129, 16, v128
    v_lshl_or_b32 v177, v131, 16, v130
    v_lshl_or_b32 v178, v133, 16, v132
    v_lshl_or_b32 v179, v135, 16, v134
    v_lshl_or_b32 v180, v137, 16, v136
    v_lshl_or_b32 v181, v139, 16, v138
    v_lshl_or_b32 v182, v141, 16, v140
    v_lshl_or_b32 v183, v143, 16, v142
    s_nop 1
    buffer_load_ushort v112, v244, s[16:19], s45 offen offset:128
    buffer_load_ushort v113, v244, s[16:19], s45 offen offset:384
    buffer_load_ushort v114, v244, s[16:19], s45 offen offset:640
    buffer_load_ushort v115, v244, s[16:19], s45 offen offset:896
    buffer_load_ushort v116, v244, s[16:19], s41 offen offset:128
    buffer_load_ushort v117, v244, s[16:19], s41 offen offset:384
    buffer_load_ushort v118, v244, s[16:19], s41 offen offset:640
    buffer_load_ushort v119, v244, s[16:19], s41 offen offset:896
    buffer_load_ushort v120, v244, s[16:19], s45 offen offset:160
    buffer_load_ushort v121, v244, s[16:19], s45 offen offset:416
    buffer_load_ushort v122, v244, s[16:19], s45 offen offset:672
    buffer_load_ushort v123, v244, s[16:19], s45 offen offset:928
    buffer_load_ushort v124, v244, s[16:19], s41 offen offset:160
    buffer_load_ushort v125, v244, s[16:19], s41 offen offset:416
    buffer_load_ushort v126, v244, s[16:19], s41 offen offset:672
    buffer_load_ushort v127, v244, s[16:19], s41 offen offset:928
    buffer_load_ushort v128, v244, s[16:19], s45 offen offset:192
    buffer_load_ushort v129, v244, s[16:19], s45 offen offset:448
    buffer_load_ushort v130, v244, s[16:19], s45 offen offset:704
    buffer_load_ushort v131, v244, s[16:19], s45 offen offset:960
    buffer_load_ushort v132, v244, s[16:19], s41 offen offset:192
    buffer_load_ushort v133, v244, s[16:19], s41 offen offset:448
    buffer_load_ushort v134, v244, s[16:19], s41 offen offset:704
    buffer_load_ushort v135, v244, s[16:19], s41 offen offset:960
    buffer_load_ushort v136, v244, s[16:19], s45 offen offset:224
    buffer_load_ushort v137, v244, s[16:19], s45 offen offset:480
    buffer_load_ushort v138, v244, s[16:19], s45 offen offset:736
    buffer_load_ushort v139, v244, s[16:19], s45 offen offset:992
    buffer_load_ushort v140, v244, s[16:19], s41 offen offset:224
    buffer_load_ushort v141, v244, s[16:19], s41 offen offset:480
    buffer_load_ushort v142, v244, s[16:19], s41 offen offset:736
    buffer_load_ushort v143, v244, s[16:19], s41 offen offset:992
    s_waitcnt vmcnt(0)
    v_lshl_or_b32 v184, v113, 16, v112
    v_lshl_or_b32 v185, v115, 16, v114
    v_lshl_or_b32 v186, v117, 16, v116
    v_lshl_or_b32 v187, v119, 16, v118
    v_lshl_or_b32 v188, v121, 16, v120
    v_lshl_or_b32 v189, v123, 16, v122
    v_lshl_or_b32 v190, v125, 16, v124
    v_lshl_or_b32 v191, v127, 16, v126
    v_lshl_or_b32 v192, v129, 16, v128
    v_lshl_or_b32 v193, v131, 16, v130
    v_lshl_or_b32 v194, v133, 16, v132
    v_lshl_or_b32 v195, v135, 16, v134
    v_lshl_or_b32 v196, v137, 16, v136
    v_lshl_or_b32 v197, v139, 16, v138
    v_lshl_or_b32 v198, v141, 16, v140
    v_lshl_or_b32 v199, v143, 16, v142
    s_nop 1
    s_waitcnt vmcnt(0)
    v_mfma_f32_16x16x32_bf16 v[112:115], a[224:227], v[0:3], 0
    v_mfma_f32_16x16x32_bf16 v[112:115], a[228:231], v[28:31], v[112:115]
    v_mfma_f32_16x16x32_bf16 v[112:115], a[232:235], v[56:59], v[112:115]
    v_mfma_f32_16x16x32_bf16 v[112:115], a[236:239], v[84:87], v[112:115]
    v_mfma_f32_16x16x32_bf16 v[116:119], a[240:243], v[0:3], 0
    v_mfma_f32_16x16x32_bf16 v[116:119], a[244:247], v[28:31], v[116:119]
    v_mfma_f32_16x16x32_bf16 v[116:119], a[248:251], v[56:59], v[116:119]
    v_mfma_f32_16x16x32_bf16 v[116:119], a[252:255], v[84:87], v[116:119]
    v_mfma_f32_16x16x32_bf16 v[120:123], a[224:227], v[4:7], 0
    v_mfma_f32_16x16x32_bf16 v[120:123], a[228:231], v[32:35], v[120:123]
    v_mfma_f32_16x16x32_bf16 v[120:123], a[232:235], v[60:63], v[120:123]
    v_mfma_f32_16x16x32_bf16 v[120:123], a[236:239], v[88:91], v[120:123]
    v_mfma_f32_16x16x32_bf16 v[124:127], a[240:243], v[4:7], 0
    v_mfma_f32_16x16x32_bf16 v[124:127], a[244:247], v[32:35], v[124:127]
    v_mfma_f32_16x16x32_bf16 v[124:127], a[248:251], v[60:63], v[124:127]
    v_mfma_f32_16x16x32_bf16 v[124:127], a[252:255], v[88:91], v[124:127]
    v_mfma_f32_16x16x32_bf16 v[128:131], a[224:227], v[8:11], 0
    v_mfma_f32_16x16x32_bf16 v[128:131], a[228:231], v[36:39], v[128:131]
    v_mfma_f32_16x16x32_bf16 v[128:131], a[232:235], v[64:67], v[128:131]
    v_mfma_f32_16x16x32_bf16 v[128:131], a[236:239], v[92:95], v[128:131]
    v_mfma_f32_16x16x32_bf16 v[132:135], a[240:243], v[8:11], 0
    v_mfma_f32_16x16x32_bf16 v[132:135], a[244:247], v[36:39], v[132:135]
    v_mfma_f32_16x16x32_bf16 v[132:135], a[248:251], v[64:67], v[132:135]
    v_mfma_f32_16x16x32_bf16 v[132:135], a[252:255], v[92:95], v[132:135]
    v_mfma_f32_16x16x32_bf16 v[136:139], a[224:227], v[12:15], 0
    v_mfma_f32_16x16x32_bf16 v[136:139], a[228:231], v[40:43], v[136:139]
    v_mfma_f32_16x16x32_bf16 v[136:139], a[232:235], v[68:71], v[136:139]
    v_mfma_f32_16x16x32_bf16 v[136:139], a[236:239], v[96:99], v[136:139]
    v_mfma_f32_16x16x32_bf16 v[140:143], a[240:243], v[12:15], 0
    v_mfma_f32_16x16x32_bf16 v[140:143], a[244:247], v[40:43], v[140:143]
    v_mfma_f32_16x16x32_bf16 v[140:143], a[248:251], v[68:71], v[140:143]
    v_mfma_f32_16x16x32_bf16 v[140:143], a[252:255], v[96:99], v[140:143]
    v_mfma_f32_16x16x32_bf16 v[144:147], a[224:227], v[16:19], 0
    v_mfma_f32_16x16x32_bf16 v[144:147], a[228:231], v[44:47], v[144:147]
    v_mfma_f32_16x16x32_bf16 v[144:147], a[232:235], v[72:75], v[144:147]
    v_mfma_f32_16x16x32_bf16 v[144:147], a[236:239], v[100:103], v[144:147]
    v_mfma_f32_16x16x32_bf16 v[148:151], a[240:243], v[16:19], 0
    v_mfma_f32_16x16x32_bf16 v[148:151], a[244:247], v[44:47], v[148:151]
    v_mfma_f32_16x16x32_bf16 v[148:151], a[248:251], v[72:75], v[148:151]
    v_mfma_f32_16x16x32_bf16 v[148:151], a[252:255], v[100:103], v[148:151]
    v_mfma_f32_16x16x32_bf16 v[152:155], a[224:227], v[20:23], 0
    v_mfma_f32_16x16x32_bf16 v[152:155], a[228:231], v[48:51], v[152:155]
    v_mfma_f32_16x16x32_bf16 v[152:155], a[232:235], v[76:79], v[152:155]
    v_mfma_f32_16x16x32_bf16 v[152:155], a[236:239], v[104:107], v[152:155]
    v_mfma_f32_16x16x32_bf16 v[156:159], a[240:243], v[20:23], 0
    v_mfma_f32_16x16x32_bf16 v[156:159], a[244:247], v[48:51], v[156:159]
    v_mfma_f32_16x16x32_bf16 v[156:159], a[248:251], v[76:79], v[156:159]
    v_mfma_f32_16x16x32_bf16 v[156:159], a[252:255], v[104:107], v[156:159]
    v_mfma_f32_16x16x32_bf16 v[160:163], a[224:227], v[24:27], 0
    v_mfma_f32_16x16x32_bf16 v[160:163], a[228:231], v[52:55], v[160:163]
    v_mfma_f32_16x16x32_bf16 v[160:163], a[232:235], v[80:83], v[160:163]
    v_mfma_f32_16x16x32_bf16 v[160:163], a[236:239], v[108:111], v[160:163]
    v_mfma_f32_16x16x32_bf16 v[164:167], a[240:243], v[24:27], 0
    v_mfma_f32_16x16x32_bf16 v[164:167], a[244:247], v[52:55], v[164:167]
    v_mfma_f32_16x16x32_bf16 v[164:167], a[248:251], v[80:83], v[164:167]
    v_mfma_f32_16x16x32_bf16 v[164:167], a[252:255], v[108:111], v[164:167]
    s_nop 7
    v_sub_f32 v112, v112, v236
    v_sub_f32 v113, v113, v236
    v_sub_f32 v114, v114, v236
    v_sub_f32 v115, v115, v236
    v_sub_f32 v116, v116, v236
    v_sub_f32 v117, v117, v236
    v_sub_f32 v118, v118, v236
    v_sub_f32 v119, v119, v236
    v_exp_f32 v112, v112
    v_exp_f32 v113, v113
    v_exp_f32 v114, v114
    v_exp_f32 v115, v115
    v_exp_f32 v116, v116
    v_exp_f32 v117, v117
    v_exp_f32 v118, v118
    v_exp_f32 v119, v119
    v_add_f32 v200, v200, v112
    v_add_f32 v200, v200, v113
    v_add_f32 v200, v200, v114
    v_add_f32 v200, v200, v115
    v_add_f32 v200, v200, v116
    v_add_f32 v200, v200, v117
    v_add_f32 v200, v200, v118
    v_add_f32 v200, v200, v119
    v_cvt_pk_bf16_f32 v112, v112, v113
    v_cvt_pk_bf16_f32 v113, v114, v115
    v_cvt_pk_bf16_f32 v114, v116, v117
    v_cvt_pk_bf16_f32 v115, v118, v119
    v_sub_f32 v120, v120, v237
    v_sub_f32 v121, v121, v237
    v_sub_f32 v122, v122, v237
    v_sub_f32 v123, v123, v237
    v_sub_f32 v124, v124, v237
    v_sub_f32 v125, v125, v237
    v_sub_f32 v126, v126, v237
    v_sub_f32 v127, v127, v237
    v_exp_f32 v120, v120
    v_exp_f32 v121, v121
    v_exp_f32 v122, v122
    v_exp_f32 v123, v123
    v_exp_f32 v124, v124
    v_exp_f32 v125, v125
    v_exp_f32 v126, v126
    v_exp_f32 v127, v127
    v_add_f32 v201, v201, v120
    v_add_f32 v201, v201, v121
    v_add_f32 v201, v201, v122
    v_add_f32 v201, v201, v123
    v_add_f32 v201, v201, v124
    v_add_f32 v201, v201, v125
    v_add_f32 v201, v201, v126
    v_add_f32 v201, v201, v127
    v_cvt_pk_bf16_f32 v120, v120, v121
    v_cvt_pk_bf16_f32 v121, v122, v123
    v_cvt_pk_bf16_f32 v122, v124, v125
    v_cvt_pk_bf16_f32 v123, v126, v127
    v_sub_f32 v128, v128, v238
    v_sub_f32 v129, v129, v238
    v_sub_f32 v130, v130, v238
    v_sub_f32 v131, v131, v238
    v_sub_f32 v132, v132, v238
    v_sub_f32 v133, v133, v238
    v_sub_f32 v134, v134, v238
    v_sub_f32 v135, v135, v238
    v_exp_f32 v128, v128
    v_exp_f32 v129, v129
    v_exp_f32 v130, v130
    v_exp_f32 v131, v131
    v_exp_f32 v132, v132
    v_exp_f32 v133, v133
    v_exp_f32 v134, v134
    v_exp_f32 v135, v135
    v_add_f32 v202, v202, v128
    v_add_f32 v202, v202, v129
    v_add_f32 v202, v202, v130
    v_add_f32 v202, v202, v131
    v_add_f32 v202, v202, v132
    v_add_f32 v202, v202, v133
    v_add_f32 v202, v202, v134
    v_add_f32 v202, v202, v135
    v_cvt_pk_bf16_f32 v128, v128, v129
    v_cvt_pk_bf16_f32 v129, v130, v131
    v_cvt_pk_bf16_f32 v130, v132, v133
    v_cvt_pk_bf16_f32 v131, v134, v135
    v_sub_f32 v136, v136, v239
    v_sub_f32 v137, v137, v239
    v_sub_f32 v138, v138, v239
    v_sub_f32 v139, v139, v239
    v_sub_f32 v140, v140, v239
    v_sub_f32 v141, v141, v239
    v_sub_f32 v142, v142, v239
    v_sub_f32 v143, v143, v239
    v_exp_f32 v136, v136
    v_exp_f32 v137, v137
    v_exp_f32 v138, v138
    v_exp_f32 v139, v139
    v_exp_f32 v140, v140
    v_exp_f32 v141, v141
    v_exp_f32 v142, v142
    v_exp_f32 v143, v143
    v_add_f32 v203, v203, v136
    v_add_f32 v203, v203, v137
    v_add_f32 v203, v203, v138
    v_add_f32 v203, v203, v139
    v_add_f32 v203, v203, v140
    v_add_f32 v203, v203, v141
    v_add_f32 v203, v203, v142
    v_add_f32 v203, v203, v143
    v_cvt_pk_bf16_f32 v136, v136, v137
    v_cvt_pk_bf16_f32 v137, v138, v139
    v_cvt_pk_bf16_f32 v138, v140, v141
    v_cvt_pk_bf16_f32 v139, v142, v143
    v_sub_f32 v144, v144, v240
    v_sub_f32 v145, v145, v240
    v_sub_f32 v146, v146, v240
    v_sub_f32 v147, v147, v240
    v_sub_f32 v148, v148, v240
    v_sub_f32 v149, v149, v240
    v_sub_f32 v150, v150, v240
    v_sub_f32 v151, v151, v240
    v_exp_f32 v144, v144
    v_exp_f32 v145, v145
    v_exp_f32 v146, v146
    v_exp_f32 v147, v147
    v_exp_f32 v148, v148
    v_exp_f32 v149, v149
    v_exp_f32 v150, v150
    v_exp_f32 v151, v151
    v_add_f32 v204, v204, v144
    v_add_f32 v204, v204, v145
    v_add_f32 v204, v204, v146
    v_add_f32 v204, v204, v147
    v_add_f32 v204, v204, v148
    v_add_f32 v204, v204, v149
    v_add_f32 v204, v204, v150
    v_add_f32 v204, v204, v151
    v_cvt_pk_bf16_f32 v144, v144, v145
    v_cvt_pk_bf16_f32 v145, v146, v147
    v_cvt_pk_bf16_f32 v146, v148, v149
    v_cvt_pk_bf16_f32 v147, v150, v151
    v_sub_f32 v152, v152, v241
    v_sub_f32 v153, v153, v241
    v_sub_f32 v154, v154, v241
    v_sub_f32 v155, v155, v241
    v_sub_f32 v156, v156, v241
    v_sub_f32 v157, v157, v241
    v_sub_f32 v158, v158, v241
    v_sub_f32 v159, v159, v241
    v_exp_f32 v152, v152
    v_exp_f32 v153, v153
    v_exp_f32 v154, v154
    v_exp_f32 v155, v155
    v_exp_f32 v156, v156
    v_exp_f32 v157, v157
    v_exp_f32 v158, v158
    v_exp_f32 v159, v159
    v_add_f32 v205, v205, v152
    v_add_f32 v205, v205, v153
    v_add_f32 v205, v205, v154
    v_add_f32 v205, v205, v155
    v_add_f32 v205, v205, v156
    v_add_f32 v205, v205, v157
    v_add_f32 v205, v205, v158
    v_add_f32 v205, v205, v159
    v_cvt_pk_bf16_f32 v152, v152, v153
    v_cvt_pk_bf16_f32 v153, v154, v155
    v_cvt_pk_bf16_f32 v154, v156, v157
    v_cvt_pk_bf16_f32 v155, v158, v159
    v_sub_f32 v160, v160, v242
    v_sub_f32 v161, v161, v242
    v_sub_f32 v162, v162, v242
    v_sub_f32 v163, v163, v242
    v_sub_f32 v164, v164, v242
    v_sub_f32 v165, v165, v242
    v_sub_f32 v166, v166, v242
    v_sub_f32 v167, v167, v242
    v_exp_f32 v160, v160
    v_exp_f32 v161, v161
    v_exp_f32 v162, v162
    v_exp_f32 v163, v163
    v_exp_f32 v164, v164
    v_exp_f32 v165, v165
    v_exp_f32 v166, v166
    v_exp_f32 v167, v167
    v_add_f32 v206, v206, v160
    v_add_f32 v206, v206, v161
    v_add_f32 v206, v206, v162
    v_add_f32 v206, v206, v163
    v_add_f32 v206, v206, v164
    v_add_f32 v206, v206, v165
    v_add_f32 v206, v206, v166
    v_add_f32 v206, v206, v167
    v_cvt_pk_bf16_f32 v160, v160, v161
    v_cvt_pk_bf16_f32 v161, v162, v163
    v_cvt_pk_bf16_f32 v162, v164, v165
    v_cvt_pk_bf16_f32 v163, v166, v167
    v_mfma_f32_16x16x32_bf16 a[0:3], v[168:171], v[112:115], a[0:3]
    v_mfma_f32_16x16x32_bf16 a[4:7], v[172:175], v[112:115], a[4:7]
    v_mfma_f32_16x16x32_bf16 a[8:11], v[176:179], v[112:115], a[8:11]
    v_mfma_f32_16x16x32_bf16 a[12:15], v[180:183], v[112:115], a[12:15]
    v_mfma_f32_16x16x32_bf16 a[16:19], v[184:187], v[112:115], a[16:19]
    v_mfma_f32_16x16x32_bf16 a[20:23], v[188:191], v[112:115], a[20:23]
    v_mfma_f32_16x16x32_bf16 a[24:27], v[192:195], v[112:115], a[24:27]
    v_mfma_f32_16x16x32_bf16 a[28:31], v[196:199], v[112:115], a[28:31]
    v_mfma_f32_16x16x32_bf16 a[32:35], v[168:171], v[120:123], a[32:35]
    v_mfma_f32_16x16x32_bf16 a[36:39], v[172:175], v[120:123], a[36:39]
    v_mfma_f32_16x16x32_bf16 a[40:43], v[176:179], v[120:123], a[40:43]
    v_mfma_f32_16x16x32_bf16 a[44:47], v[180:183], v[120:123], a[44:47]
    v_mfma_f32_16x16x32_bf16 a[48:51], v[184:187], v[120:123], a[48:51]
    v_mfma_f32_16x16x32_bf16 a[52:55], v[188:191], v[120:123], a[52:55]
    v_mfma_f32_16x16x32_bf16 a[56:59], v[192:195], v[120:123], a[56:59]
    v_mfma_f32_16x16x32_bf16 a[60:63], v[196:199], v[120:123], a[60:63]
    v_mfma_f32_16x16x32_bf16 a[64:67], v[168:171], v[128:131], a[64:67]
    v_mfma_f32_16x16x32_bf16 a[68:71], v[172:175], v[128:131], a[68:71]
    v_mfma_f32_16x16x32_bf16 a[72:75], v[176:179], v[128:131], a[72:75]
    v_mfma_f32_16x16x32_bf16 a[76:79], v[180:183], v[128:131], a[76:79]
    v_mfma_f32_16x16x32_bf16 a[80:83], v[184:187], v[128:131], a[80:83]
    v_mfma_f32_16x16x32_bf16 a[84:87], v[188:191], v[128:131], a[84:87]
    v_mfma_f32_16x16x32_bf16 a[88:91], v[192:195], v[128:131], a[88:91]
    v_mfma_f32_16x16x32_bf16 a[92:95], v[196:199], v[128:131], a[92:95]
    v_mfma_f32_16x16x32_bf16 a[96:99], v[168:171], v[136:139], a[96:99]
    v_mfma_f32_16x16x32_bf16 a[100:103], v[172:175], v[136:139], a[100:103]
    v_mfma_f32_16x16x32_bf16 a[104:107], v[176:179], v[136:139], a[104:107]
    v_mfma_f32_16x16x32_bf16 a[108:111], v[180:183], v[136:139], a[108:111]
    v_mfma_f32_16x16x32_bf16 a[112:115], v[184:187], v[136:139], a[112:115]
    v_mfma_f32_16x16x32_bf16 a[116:119], v[188:191], v[136:139], a[116:119]
    v_mfma_f32_16x16x32_bf16 a[120:123], v[192:195], v[136:139], a[120:123]
    v_mfma_f32_16x16x32_bf16 a[124:127], v[196:199], v[136:139], a[124:127]
    v_mfma_f32_16x16x32_bf16 a[128:131], v[168:171], v[144:147], a[128:131]
    v_mfma_f32_16x16x32_bf16 a[132:135], v[172:175], v[144:147], a[132:135]
    v_mfma_f32_16x16x32_bf16 a[136:139], v[176:179], v[144:147], a[136:139]
    v_mfma_f32_16x16x32_bf16 a[140:143], v[180:183], v[144:147], a[140:143]
    v_mfma_f32_16x16x32_bf16 a[144:147], v[184:187], v[144:147], a[144:147]
    v_mfma_f32_16x16x32_bf16 a[148:151], v[188:191], v[144:147], a[148:151]
    v_mfma_f32_16x16x32_bf16 a[152:155], v[192:195], v[144:147], a[152:155]
    v_mfma_f32_16x16x32_bf16 a[156:159], v[196:199], v[144:147], a[156:159]
    v_mfma_f32_16x16x32_bf16 a[160:163], v[168:171], v[152:155], a[160:163]
    v_mfma_f32_16x16x32_bf16 a[164:167], v[172:175], v[152:155], a[164:167]
    v_mfma_f32_16x16x32_bf16 a[168:171], v[176:179], v[152:155], a[168:171]
    v_mfma_f32_16x16x32_bf16 a[172:175], v[180:183], v[152:155], a[172:175]
    v_mfma_f32_16x16x32_bf16 a[176:179], v[184:187], v[152:155], a[176:179]
    v_mfma_f32_16x16x32_bf16 a[180:183], v[188:191], v[152:155], a[180:183]
    v_mfma_f32_16x16x32_bf16 a[184:187], v[192:195], v[152:155], a[184:187]
    v_mfma_f32_16x16x32_bf16 a[188:191], v[196:199], v[152:155], a[188:191]
    v_mfma_f32_16x16x32_bf16 a[192:195], v[168:171], v[160:163], a[192:195]
    v_mfma_f32_16x16x32_bf16 a[196:199], v[172:175], v[160:163], a[196:199]
    v_mfma_f32_16x16x32_bf16 a[200:203], v[176:179], v[160:163], a[200:203]
    v_mfma_f32_16x16x32_bf16 a[204:207], v[180:183], v[160:163], a[204:207]
    v_mfma_f32_16x16x32_bf16 a[208:211], v[184:187], v[160:163], a[208:211]
    v_mfma_f32_16x16x32_bf16 a[212:215], v[188:191], v[160:163], a[212:215]
    v_mfma_f32_16x16x32_bf16 a[216:219], v[192:195], v[160:163], a[216:219]
    v_mfma_f32_16x16x32_bf16 a[220:223], v[196:199], v[160:163], a[220:223]
    s_nop 7
    s_add_u32 s45, s45, 8192
    s_add_u32 s46, s46, 1
    s_cmp_lt_u32 s46, 16
    s_cbranch_scc1 Lslow2
    v_mov_b32 v112, v200
    v_mov_b32 v113, v201
    v_mov_b32 v114, v202
    v_mov_b32 v115, v203
    v_mov_b32 v116, v204
    v_mov_b32 v117, v205
    v_mov_b32 v118, v206
    v_permlane16_swap_b32 v200, v112
    v_permlane16_swap_b32 v201, v113
    v_permlane16_swap_b32 v202, v114
    v_permlane16_swap_b32 v203, v115
    v_permlane16_swap_b32 v204, v116
    v_permlane16_swap_b32 v205, v117
    v_permlane16_swap_b32 v206, v118
    v_add_f32 v200, v200, v112
    v_add_f32 v201, v201, v113
    v_add_f32 v202, v202, v114
    v_add_f32 v203, v203, v115
    v_add_f32 v204, v204, v116
    v_add_f32 v205, v205, v117
    v_add_f32 v206, v206, v118
    v_mov_b32 v112, v200
    v_mov_b32 v113, v201
    v_mov_b32 v114, v202
    v_mov_b32 v115, v203
    v_mov_b32 v116, v204
    v_mov_b32 v117, v205
    v_mov_b32 v118, v206
    v_permlane32_swap_b32 v200, v112
    v_permlane32_swap_b32 v201, v113
    v_permlane32_swap_b32 v202, v114
    v_permlane32_swap_b32 v203, v115
    v_permlane32_swap_b32 v204, v116
    v_permlane32_swap_b32 v205, v117
    v_permlane32_swap_b32 v206, v118
    v_add_f32 v200, v200, v112
    v_add_f32 v201, v201, v113
    v_add_f32 v202, v202, v114
    v_add_f32 v203, v203, v115
    v_add_f32 v204, v204, v116
    v_add_f32 v205, v205, v117
    v_add_f32 v206, v206, v118
    s_nop 7
    s_branch Lsafe
Lpg20:
    s_branch Lpg21
Lpg21:
    s_branch Ltch1
.section .rodata,"a"
.p2align 6
.amdhsa_kernel concat_heads__mha_block_cached__gqa_block_cached__near_ridge_kernel
  .amdhsa_next_free_vgpr 512
  .amdhsa_next_free_sgpr 102
  .amdhsa_accum_offset 256
  .amdhsa_group_segment_fixed_size 0
  .amdhsa_kernarg_size 104
  .amdhsa_user_sgpr_count 2
  .amdhsa_user_sgpr_kernarg_segment_ptr 1
  .amdhsa_system_sgpr_workgroup_id_x 1
.end_amdhsa_kernel
```
